```python
import torch

def _softmax(x, axis=-1):
    return torch.softmax(x, dim=axis)

def _gelu(x):
    return torch.nn.functional.gelu(x, approximate='tanh')

def _silu(x):
    return torch.nn.functional.silu(x)

def _sigmoid(x):
    return torch.sigmoid(x)

def _layernorm(x, axis=-1, eps=1e-05):
    m = x.mean(dim=axis, keepdim=True)
    v = x.var(dim=axis, keepdim=True, unbiased=False)
    return (x - m) / torch.sqrt(v + eps)

def _scatter_add(tgt, idx, src, axis=0):
    return tgt.clone().index_add_(axis, idx, src)

def _segment_sum(src, seg, n):
    out = torch.zeros((n,) + src.shape[1:], dtype=src.dtype)
    return out.index_add_(0, seg, src)

def _pad(x, pw):
    flat = tuple((v for pair in reversed(pw) for v in pair))
    return torch.nn.functional.pad(x, flat)
kernel_name = 'sequential_preLN__memory_aug_recurrent_mem_tr__dense_activation_mish__prompt'

def setup_inputs():

    _w = lambda a: (lambda t: t.to(torch.bfloat16) if t.is_floating_point() else t)(torch.as_tensor(a))

    def _A_setup():
        B, S, Dm = (1, 2048, 640)
        H, Dh = (32, 192)
        M, seg = (8, 32)
        seg = min(seg, S)
        S = S // seg * seg
        return {'x': _w((lambda *s: torch.randn(*s, dtype=torch.bfloat16) * 0.05)(B, S, Dm)), 'mem0': _w((lambda *s: torch.randn(*s, dtype=torch.bfloat16) * 0.2)(B, M, Dm)), 'Wq': _w((lambda *s: torch.randn(*s, dtype=torch.bfloat16) * 1.6)(Dm, H, Dh) * Dm ** (-0.5)), 'Wk': _w((lambda *s: torch.randn(*s, dtype=torch.bfloat16) * 1.6)(Dm, H, Dh) * Dm ** (-0.5)), 'Wv': _w((lambda *s: torch.randn(*s, dtype=torch.bfloat16) * 0.2)(Dm, H, Dh) * Dm ** (-0.5)), 'Wo': _w((lambda *s: torch.randn(*s, dtype=torch.bfloat16) * 0.2)(H, Dh, Dm) * (H * Dh) ** (-0.5)), 'seg_len': seg}
    _A_in = _A_setup()

    def _B_setup():
        B, S, D, F = (1, 2048, 640, 1536)
        return {'x': _w((lambda *s: torch.randn(*s, dtype=torch.bfloat16) * 0.05)(B, S, D)), 'w1': _w((lambda *s: torch.randn(*s, dtype=torch.bfloat16) * 0.8)(D, F) * D ** (-0.5)), 'b1': _w((lambda *s: torch.randn(*s, dtype=torch.bfloat16) * 0.2)(F)), 'w2': _w((lambda *s: torch.randn(*s, dtype=torch.bfloat16) * 0.1)(F, D) * F ** (-0.5))}
    _B_in = _B_setup()
    return {'A_x': _A_in['x'], 'A_mem0': _A_in['mem0'], 'A_Wq': _A_in['Wq'], 'A_Wk': _A_in['Wk'], 'A_Wv': _A_in['Wv'], 'A_Wo': _A_in['Wo'], 'A_seg_len': _A_in['seg_len'], 'B_x': _B_in['x'], 'B_w1': _B_in['w1'], 'B_b1': _B_in['b1'], 'B_w2': _B_in['w2']}

def reference(A_x, A_mem0, A_Wq, A_Wk, A_Wv, A_Wo, A_seg_len, B_x, B_w1, B_b1, B_w2):

    def _A_ref(x, mem0, Wq, Wk, Wv, Wo, seg_len):
        B, S, Dm = x.shape
        H, Dh = (Wq.shape[1], Wq.shape[2])
        M = mem0.shape[1]
        scale = Dh ** (-0.5)
        n_seg = S // seg_len
        L = M + seg_len
        idx = torch.arange(L)
        mask = (idx[:, None] < M) | (idx[:, None] >= idx[None, :])
        mem = mem0
        outs = []
        for s in range(n_seg):
            xs = x[:, s * seg_len:(s + 1) * seg_len, :].clone()
            h = torch.concatenate([mem, xs], axis=1)
            q = torch.einsum('btd,dhe->bhte', h, Wq)
            k = torch.einsum('btd,dhe->bhte', h, Wk)
            v = torch.einsum('btd,dhe->bhte', h, Wv)
            scores = torch.einsum('bhqe,bhke->bhqk', q, k) * scale
            scores = torch.where(mask[None, None], scores, -1000000000.0)
            p = _softmax(scores, axis=-1)
            o = torch.einsum('bhqk,bhke->bhqe', p, v)
            o = torch.einsum('bhte,hed->btd', o, Wo)
            mem = o[:, :M, :].clone()
            outs.append(o[:, M:, :])
        return torch.concatenate(outs, axis=1)

    def _B_ref(x, w1, b1, w2):
        h = torch.einsum('bsd,df->bsf', x, w1) + b1
        sp = torch.log1p(torch.exp(-torch.abs(h))) + torch.where(h > 0, h, torch.zeros_like(h))
        act = h * torch.tanh(sp)
        return torch.einsum('bsf,fd->bsd', act, w2)
    x = A_x
    h = x + _A_ref(_layernorm(x, axis=-1), A_mem0, A_Wq, A_Wk, A_Wv, A_Wo, A_seg_len)
    h2 = h + _B_ref(_layernorm(h, axis=-1), B_w1, B_b1, B_w2)
    return h2
```

```asm
; @launch grid=(256,1,1) block=(256,1,1) lds=163840
.amdgcn_target "amdgcn-amd-amdhsa--gfx950"
.text
.globl sequential_preLN__memory_aug_recurrent_mem_tr__dense_activation_mish__prompt_kernel
.p2align 8
.type sequential_preLN__memory_aug_recurrent_mem_tr__dense_activation_mish__prompt_kernel,@function
sequential_preLN__memory_aug_recurrent_mem_tr__dense_activation_mish__prompt_kernel:
    s_cmp_ge_u32 s2, 256
    s_cbranch_scc1 L_exit0
    s_load_dwordx16 s[32:47], s[0:1], 0
    s_load_dwordx8 s[48:55], s[0:1], 64
    s_load_dwordx4 s[56:59], s[0:1], 96
    s_getpc_b64 s[60:61]
L_pc:
    s_lshr_b32 s62, s2, 3
    s_lshl_b32 s62, s62, 12
    v_lshl_add_u32 v4, v0, 4, s62
    v_min_u32 v4, L_end-L_pc-16, v4
    global_load_dwordx4 v[8:11], v4, s[60:61]
    v_and_b32 v1, 63, v0
    v_lshlrev_b32 v2, 4, v1
    v_lshrrev_b32 v3, 6, v0
    s_nop 0
    v_readfirstlane_b32 s3, v3
    s_waitcnt lgkmcnt(0)
    s_mov_b32 s4, s58
    s_and_b32 s5, s59, 0xffff
    s_mov_b32 s6, 0x10000000
    s_mov_b32 s7, 0x20000
    s_mov_b32 s12, s32
    s_and_b32 s13, s33, 0xffff
    s_mov_b32 s14, 0x280000
    s_mov_b32 s15, 0x20000
    s_mov_b32 s16, s56
    s_and_b32 s17, s57, 0xffff
    s_mov_b32 s18, 0x100
    s_mov_b32 s19, 0x20000
    s_waitcnt vmcnt(0)
    s_and_b32 s28, s2, 7
    s_lshr_b32 s29, s2, 3
    s_cmp_ge_u32 s28, 4
    s_cbranch_scc1 L_workers
    s_lshl_b32 s24, s28, 3
    s_and_b32 s30, s29, 7
    s_add_u32 s24, s24, s30
    s_cmp_lt_u32 s29, 8
    s_cbranch_scc1 L_role_QK
    s_cmp_lt_u32 s29, 16
    s_cbranch_scc1 L_role_VO
    s_lshl_b32 s70, s28, 4
    s_add_u32 s70, s70, s29
    s_sub_u32 s70, s70, 16
    s_mov_b32 s80, s28
    s_mov_b32 s81, s29
    v_mov_b32 v4, -1
    v_mov_b32 v12, 0
    v_mov_b32 v140, 0x3f803f80
    v_mov_b32 v5, -1
    v_mov_b32 v13, 0
    v_mov_b32 v141, 0x3f803f80
    v_mov_b32 v6, -1
    v_mov_b32 v14, 0
    v_mov_b32 v142, 0x3f803f80
    v_mov_b32 v7, -1
    v_mov_b32 v15, 0
    v_mov_b32 v143, 0x3f803f80
    v_lshlrev_b32 v8, 4, v0
    v_and_b32 v16, 15, v1
    v_mul_u32_u24 v146, 1280, v16
    v_lshrrev_b32 v17, 4, v1
    v_lshl_add_u32 v146, v17, 4, v146
    v_lshlrev_b32 v145, 3, v16
    s_lshl_b32 s28, s3, 8
    v_add_u32 v144, s28, v145
    s_mul_i32 s28, s70, 40960
    s_mul_i32 s29, s3, 320
    s_add_u32 s28, s28, s29
    s_add_u32 s29, s28, 20480
    buffer_load_dwordx4 v[64:67], v146, s[12:15], s28 offen offset:0
    buffer_load_dwordx4 v[68:71], v146, s[12:15], s28 offen offset:64
    buffer_load_dwordx4 v[72:75], v146, s[12:15], s28 offen offset:128
    buffer_load_dwordx4 v[76:79], v146, s[12:15], s28 offen offset:192
    buffer_load_dwordx4 v[80:83], v146, s[12:15], s28 offen offset:256
    buffer_load_dwordx4 v[84:87], v146, s[12:15], s29 offen offset:0
    buffer_load_dwordx4 v[88:91], v146, s[12:15], s29 offen offset:64
    buffer_load_dwordx4 v[92:95], v146, s[12:15], s29 offen offset:128
    buffer_load_dwordx4 v[96:99], v146, s[12:15], s29 offen offset:192
    buffer_load_dwordx4 v[100:103], v146, s[12:15], s29 offen offset:256
    v_bfe_u32 v16, v1, 2, 2
    v_lshrrev_b32 v17, 4, v1
    v_cmp_eq_u32 s[74:75], v16, v17
    v_and_b32 v16, 1, v1
    v_cmp_eq_u32 s[76:77], 1, v16
    v_and_b32 v16, 2, v1
    v_cmp_eq_u32 s[78:79], 2, v16
    s_waitcnt vmcnt(0)
    s_sub_u32 s29, s70, 1
    s_cmp_ge_u32 s29, 28
    s_nop 0
    s_cbranch_scc1 Li_1
    s_lshl_b32 s28, s29, 12
    s_cmp_lt_u32 s29, 8
    s_cselect_b32 s30, 0x600000, s30
    s_cselect_b32 s30, s30, 0x138000
    s_add_u32 s60, s28, s30
    buffer_store_dwordx4 v[12:15], v8, s[4:7], s60 offen sc1
Li_1:
    v_mfma_f32_16x16x32_bf16 v[104:107], v[140:143], v[64:67], 0
    v_mfma_f32_16x16x32_bf16 v[108:111], v[64:67], v[64:67], 0
    v_mfma_f32_16x16x32_bf16 v[112:115], v[140:143], v[84:87], 0
    v_mfma_f32_16x16x32_bf16 v[116:119], v[84:87], v[84:87], 0
    v_mfma_f32_16x16x32_bf16 v[104:107], v[140:143], v[68:71], v[104:107]
    v_mfma_f32_16x16x32_bf16 v[108:111], v[68:71], v[68:71], v[108:111]
    v_mfma_f32_16x16x32_bf16 v[112:115], v[140:143], v[88:91], v[112:115]
    v_mfma_f32_16x16x32_bf16 v[116:119], v[88:91], v[88:91], v[116:119]
    v_mfma_f32_16x16x32_bf16 v[104:107], v[140:143], v[72:75], v[104:107]
    v_mfma_f32_16x16x32_bf16 v[108:111], v[72:75], v[72:75], v[108:111]
    v_mfma_f32_16x16x32_bf16 v[112:115], v[140:143], v[92:95], v[112:115]
    v_mfma_f32_16x16x32_bf16 v[116:119], v[92:95], v[92:95], v[116:119]
    v_mfma_f32_16x16x32_bf16 v[104:107], v[140:143], v[76:79], v[104:107]
    v_mfma_f32_16x16x32_bf16 v[108:111], v[76:79], v[76:79], v[108:111]
    v_mfma_f32_16x16x32_bf16 v[112:115], v[140:143], v[96:99], v[112:115]
    v_mfma_f32_16x16x32_bf16 v[116:119], v[96:99], v[96:99], v[116:119]
    v_mfma_f32_16x16x32_bf16 v[104:107], v[140:143], v[80:83], v[104:107]
    v_mfma_f32_16x16x32_bf16 v[108:111], v[80:83], v[80:83], v[108:111]
    v_mfma_f32_16x16x32_bf16 v[112:115], v[140:143], v[100:103], v[112:115]
    v_mfma_f32_16x16x32_bf16 v[116:119], v[100:103], v[100:103], v[116:119]
    s_nop 5
    v_cndmask_b32 v108, v108, v109, s[76:77]
    v_cndmask_b32 v110, v110, v111, s[76:77]
    v_cndmask_b32 v108, v108, v110, s[78:79]
    v_cndmask_b32 v116, v116, v117, s[76:77]
    v_cndmask_b32 v118, v118, v119, s[76:77]
    v_cndmask_b32 v116, v116, v118, s[78:79]
    s_mov_b64 exec, s[74:75]
    ds_write2_b32 v144, v104, v108 offset0:0 offset1:1
    ds_write2_b32 v144, v112, v116 offset0:32 offset1:33
    s_mov_b64 exec, -1
    s_waitcnt lgkmcnt(0)
    s_barrier
    ds_read_b64 v[120:121], v145 offset:0
    ds_read_b64 v[122:123], v145 offset:256
    ds_read_b64 v[124:125], v145 offset:512
    ds_read_b64 v[126:127], v145 offset:768
    ds_read_b64 v[128:129], v145 offset:128
    ds_read_b64 v[130:131], v145 offset:384
    ds_read_b64 v[132:133], v145 offset:640
    ds_read_b64 v[134:135], v145 offset:896
    s_waitcnt lgkmcnt(0)
    v_add_f32 v120, v120, v122
    v_add_f32 v124, v124, v126
    v_add_f32 v120, v120, v124
    v_add_f32 v121, v121, v123
    v_add_f32 v125, v125, v127
    v_add_f32 v121, v121, v125
    v_mul_f32 v136, 0x3acccccd, v120
    v_mul_f32 v137, 0x3acccccd, v121
    v_fma_f32 v137, -v136, v136, v137
    v_max_f32 v137, 0, v137
    v_cvt_pk_bf16_f32 v136, v136, v136
    v_and_b32 v136, 0xffff0000, v136
    v_cvt_pk_bf16_f32 v137, v137, v137
    v_and_b32 v137, 0xffff0000, v137
    v_add_f32 v137, 0x3727c5ac, v137
    v_cvt_pk_bf16_f32 v137, v137, v137
    v_and_b32 v137, 0xffff0000, v137
    v_sqrt_f32 v137, v137
    s_nop 0
    v_cvt_pk_bf16_f32 v137, v137, v137
    v_and_b32 v137, 0xffff0000, v137
    v_rcp_f32 v137, v137
    v_add_f32 v128, v128, v130
    v_add_f32 v132, v132, v134
    v_add_f32 v128, v128, v132
    v_add_f32 v129, v129, v131
    v_add_f32 v133, v133, v135
    v_add_f32 v129, v129, v133
    v_mul_f32 v138, 0x3acccccd, v128
    v_mul_f32 v139, 0x3acccccd, v129
    v_fma_f32 v139, -v138, v138, v139
    v_max_f32 v139, 0, v139
    v_cvt_pk_bf16_f32 v138, v138, v138
    v_and_b32 v138, 0xffff0000, v138
    v_cvt_pk_bf16_f32 v139, v139, v139
    v_and_b32 v139, 0xffff0000, v139
    v_add_f32 v139, 0x3727c5ac, v139
    v_cvt_pk_bf16_f32 v139, v139, v139
    v_and_b32 v139, 0xffff0000, v139
    v_sqrt_f32 v139, v139
    s_nop 0
    v_cvt_pk_bf16_f32 v139, v139, v139
    v_and_b32 v139, 0xffff0000, v139
    v_rcp_f32 v139, v139
    s_mul_i32 s28, s70, 40960
    s_mul_i32 s29, s3, 5120
    s_add_u32 s28, s28, s29
    v_lshlrev_b32 v20, 16, v64
    v_and_b32 v21, 0xffff0000, v64
    v_lshlrev_b32 v22, 16, v65
    v_and_b32 v23, 0xffff0000, v65
    v_lshlrev_b32 v24, 16, v66
    v_and_b32 v25, 0xffff0000, v66
    v_lshlrev_b32 v26, 16, v67
    v_and_b32 v27, 0xffff0000, v67
    v_pk_add_f32 v[20:21], v[20:21], v[136:137] op_sel_hi:[1,0] neg_lo:[0,1] neg_hi:[0,1]
    v_pk_add_f32 v[22:23], v[22:23], v[136:137] op_sel_hi:[1,0] neg_lo:[0,1] neg_hi:[0,1]
    v_pk_add_f32 v[24:25], v[24:25], v[136:137] op_sel_hi:[1,0] neg_lo:[0,1] neg_hi:[0,1]
    v_pk_add_f32 v[26:27], v[26:27], v[136:137] op_sel_hi:[1,0] neg_lo:[0,1] neg_hi:[0,1]
    v_cvt_pk_bf16_f32 v64, v20, v21
    v_cvt_pk_bf16_f32 v65, v22, v23
    v_cvt_pk_bf16_f32 v66, v24, v25
    v_cvt_pk_bf16_f32 v67, v26, v27
    v_lshlrev_b32 v20, 16, v64
    v_and_b32 v21, 0xffff0000, v64
    v_lshlrev_b32 v22, 16, v65
    v_and_b32 v23, 0xffff0000, v65
    v_lshlrev_b32 v24, 16, v66
    v_and_b32 v25, 0xffff0000, v66
    v_lshlrev_b32 v26, 16, v67
    v_and_b32 v27, 0xffff0000, v67
    v_pk_mul_f32 v[20:21], v[20:21], v[136:137] op_sel:[0,1] op_sel_hi:[1,1]
    v_pk_mul_f32 v[22:23], v[22:23], v[136:137] op_sel:[0,1] op_sel_hi:[1,1]
    v_pk_mul_f32 v[24:25], v[24:25], v[136:137] op_sel:[0,1] op_sel_hi:[1,1]
    v_pk_mul_f32 v[26:27], v[26:27], v[136:137] op_sel:[0,1] op_sel_hi:[1,1]
    v_cvt_pk_bf16_f32 v64, v20, v21
    v_cvt_pk_bf16_f32 v65, v22, v23
    v_cvt_pk_bf16_f32 v66, v24, v25
    v_cvt_pk_bf16_f32 v67, v26, v27
    s_add_u32 s60, s28, 0x200000
    buffer_store_dwordx4 v[64:67], v2, s[4:7], s60 offen sc1
    v_lshlrev_b32 v20, 16, v68
    v_and_b32 v21, 0xffff0000, v68
    v_lshlrev_b32 v22, 16, v69
    v_and_b32 v23, 0xffff0000, v69
    v_lshlrev_b32 v24, 16, v70
    v_and_b32 v25, 0xffff0000, v70
    v_lshlrev_b32 v26, 16, v71
    v_and_b32 v27, 0xffff0000, v71
    v_pk_add_f32 v[20:21], v[20:21], v[136:137] op_sel_hi:[1,0] neg_lo:[0,1] neg_hi:[0,1]
    v_pk_add_f32 v[22:23], v[22:23], v[136:137] op_sel_hi:[1,0] neg_lo:[0,1] neg_hi:[0,1]
    v_pk_add_f32 v[24:25], v[24:25], v[136:137] op_sel_hi:[1,0] neg_lo:[0,1] neg_hi:[0,1]
    v_pk_add_f32 v[26:27], v[26:27], v[136:137] op_sel_hi:[1,0] neg_lo:[0,1] neg_hi:[0,1]
    v_cvt_pk_bf16_f32 v68, v20, v21
    v_cvt_pk_bf16_f32 v69, v22, v23
    v_cvt_pk_bf16_f32 v70, v24, v25
    v_cvt_pk_bf16_f32 v71, v26, v27
    v_lshlrev_b32 v20, 16, v68
    v_and_b32 v21, 0xffff0000, v68
    v_lshlrev_b32 v22, 16, v69
    v_and_b32 v23, 0xffff0000, v69
    v_lshlrev_b32 v24, 16, v70
    v_and_b32 v25, 0xffff0000, v70
    v_lshlrev_b32 v26, 16, v71
    v_and_b32 v27, 0xffff0000, v71
    v_pk_mul_f32 v[20:21], v[20:21], v[136:137] op_sel:[0,1] op_sel_hi:[1,1]
    v_pk_mul_f32 v[22:23], v[22:23], v[136:137] op_sel:[0,1] op_sel_hi:[1,1]
    v_pk_mul_f32 v[24:25], v[24:25], v[136:137] op_sel:[0,1] op_sel_hi:[1,1]
    v_pk_mul_f32 v[26:27], v[26:27], v[136:137] op_sel:[0,1] op_sel_hi:[1,1]
    v_cvt_pk_bf16_f32 v68, v20, v21
    v_cvt_pk_bf16_f32 v69, v22, v23
    v_cvt_pk_bf16_f32 v70, v24, v25
    v_cvt_pk_bf16_f32 v71, v26, v27
    s_add_u32 s60, s28, 0x200400
    buffer_store_dwordx4 v[68:71], v2, s[4:7], s60 offen sc1
    v_lshlrev_b32 v20, 16, v72
    v_and_b32 v21, 0xffff0000, v72
    v_lshlrev_b32 v22, 16, v73
    v_and_b32 v23, 0xffff0000, v73
    v_lshlrev_b32 v24, 16, v74
    v_and_b32 v25, 0xffff0000, v74
    v_lshlrev_b32 v26, 16, v75
    v_and_b32 v27, 0xffff0000, v75
    v_pk_add_f32 v[20:21], v[20:21], v[136:137] op_sel_hi:[1,0] neg_lo:[0,1] neg_hi:[0,1]
    v_pk_add_f32 v[22:23], v[22:23], v[136:137] op_sel_hi:[1,0] neg_lo:[0,1] neg_hi:[0,1]
    v_pk_add_f32 v[24:25], v[24:25], v[136:137] op_sel_hi:[1,0] neg_lo:[0,1] neg_hi:[0,1]
    v_pk_add_f32 v[26:27], v[26:27], v[136:137] op_sel_hi:[1,0] neg_lo:[0,1] neg_hi:[0,1]
    v_cvt_pk_bf16_f32 v72, v20, v21
    v_cvt_pk_bf16_f32 v73, v22, v23
    v_cvt_pk_bf16_f32 v74, v24, v25
    v_cvt_pk_bf16_f32 v75, v26, v27
    v_lshlrev_b32 v20, 16, v72
    v_and_b32 v21, 0xffff0000, v72
    v_lshlrev_b32 v22, 16, v73
    v_and_b32 v23, 0xffff0000, v73
    v_lshlrev_b32 v24, 16, v74
    v_and_b32 v25, 0xffff0000, v74
    v_lshlrev_b32 v26, 16, v75
    v_and_b32 v27, 0xffff0000, v75
    v_pk_mul_f32 v[20:21], v[20:21], v[136:137] op_sel:[0,1] op_sel_hi:[1,1]
    v_pk_mul_f32 v[22:23], v[22:23], v[136:137] op_sel:[0,1] op_sel_hi:[1,1]
    v_pk_mul_f32 v[24:25], v[24:25], v[136:137] op_sel:[0,1] op_sel_hi:[1,1]
    v_pk_mul_f32 v[26:27], v[26:27], v[136:137] op_sel:[0,1] op_sel_hi:[1,1]
    v_cvt_pk_bf16_f32 v72, v20, v21
    v_cvt_pk_bf16_f32 v73, v22, v23
    v_cvt_pk_bf16_f32 v74, v24, v25
    v_cvt_pk_bf16_f32 v75, v26, v27
    s_add_u32 s60, s28, 0x200800
    buffer_store_dwordx4 v[72:75], v2, s[4:7], s60 offen sc1
    v_lshlrev_b32 v20, 16, v76
    v_and_b32 v21, 0xffff0000, v76
    v_lshlrev_b32 v22, 16, v77
    v_and_b32 v23, 0xffff0000, v77
    v_lshlrev_b32 v24, 16, v78
    v_and_b32 v25, 0xffff0000, v78
    v_lshlrev_b32 v26, 16, v79
    v_and_b32 v27, 0xffff0000, v79
    v_pk_add_f32 v[20:21], v[20:21], v[136:137] op_sel_hi:[1,0] neg_lo:[0,1] neg_hi:[0,1]
    v_pk_add_f32 v[22:23], v[22:23], v[136:137] op_sel_hi:[1,0] neg_lo:[0,1] neg_hi:[0,1]
    v_pk_add_f32 v[24:25], v[24:25], v[136:137] op_sel_hi:[1,0] neg_lo:[0,1] neg_hi:[0,1]
    v_pk_add_f32 v[26:27], v[26:27], v[136:137] op_sel_hi:[1,0] neg_lo:[0,1] neg_hi:[0,1]
    v_cvt_pk_bf16_f32 v76, v20, v21
    v_cvt_pk_bf16_f32 v77, v22, v23
    v_cvt_pk_bf16_f32 v78, v24, v25
    v_cvt_pk_bf16_f32 v79, v26, v27
    v_lshlrev_b32 v20, 16, v76
    v_and_b32 v21, 0xffff0000, v76
    v_lshlrev_b32 v22, 16, v77
    v_and_b32 v23, 0xffff0000, v77
    v_lshlrev_b32 v24, 16, v78
    v_and_b32 v25, 0xffff0000, v78
    v_lshlrev_b32 v26, 16, v79
    v_and_b32 v27, 0xffff0000, v79
    v_pk_mul_f32 v[20:21], v[20:21], v[136:137] op_sel:[0,1] op_sel_hi:[1,1]
    v_pk_mul_f32 v[22:23], v[22:23], v[136:137] op_sel:[0,1] op_sel_hi:[1,1]
    v_pk_mul_f32 v[24:25], v[24:25], v[136:137] op_sel:[0,1] op_sel_hi:[1,1]
    v_pk_mul_f32 v[26:27], v[26:27], v[136:137] op_sel:[0,1] op_sel_hi:[1,1]
    v_cvt_pk_bf16_f32 v76, v20, v21
    v_cvt_pk_bf16_f32 v77, v22, v23
    v_cvt_pk_bf16_f32 v78, v24, v25
    v_cvt_pk_bf16_f32 v79, v26, v27
    s_add_u32 s60, s28, 0x200c00
    buffer_store_dwordx4 v[76:79], v2, s[4:7], s60 offen sc1
    v_lshlrev_b32 v20, 16, v80
    v_and_b32 v21, 0xffff0000, v80
    v_lshlrev_b32 v22, 16, v81
    v_and_b32 v23, 0xffff0000, v81
    v_lshlrev_b32 v24, 16, v82
    v_and_b32 v25, 0xffff0000, v82
    v_lshlrev_b32 v26, 16, v83
    v_and_b32 v27, 0xffff0000, v83
    v_pk_add_f32 v[20:21], v[20:21], v[136:137] op_sel_hi:[1,0] neg_lo:[0,1] neg_hi:[0,1]
    v_pk_add_f32 v[22:23], v[22:23], v[136:137] op_sel_hi:[1,0] neg_lo:[0,1] neg_hi:[0,1]
    v_pk_add_f32 v[24:25], v[24:25], v[136:137] op_sel_hi:[1,0] neg_lo:[0,1] neg_hi:[0,1]
    v_pk_add_f32 v[26:27], v[26:27], v[136:137] op_sel_hi:[1,0] neg_lo:[0,1] neg_hi:[0,1]
    v_cvt_pk_bf16_f32 v80, v20, v21
    v_cvt_pk_bf16_f32 v81, v22, v23
    v_cvt_pk_bf16_f32 v82, v24, v25
    v_cvt_pk_bf16_f32 v83, v26, v27
    v_lshlrev_b32 v20, 16, v80
    v_and_b32 v21, 0xffff0000, v80
    v_lshlrev_b32 v22, 16, v81
    v_and_b32 v23, 0xffff0000, v81
    v_lshlrev_b32 v24, 16, v82
    v_and_b32 v25, 0xffff0000, v82
    v_lshlrev_b32 v26, 16, v83
    v_and_b32 v27, 0xffff0000, v83
    v_pk_mul_f32 v[20:21], v[20:21], v[136:137] op_sel:[0,1] op_sel_hi:[1,1]
    v_pk_mul_f32 v[22:23], v[22:23], v[136:137] op_sel:[0,1] op_sel_hi:[1,1]
    v_pk_mul_f32 v[24:25], v[24:25], v[136:137] op_sel:[0,1] op_sel_hi:[1,1]
    v_pk_mul_f32 v[26:27], v[26:27], v[136:137] op_sel:[0,1] op_sel_hi:[1,1]
    v_cvt_pk_bf16_f32 v80, v20, v21
    v_cvt_pk_bf16_f32 v81, v22, v23
    v_cvt_pk_bf16_f32 v82, v24, v25
    v_cvt_pk_bf16_f32 v83, v26, v27
    s_add_u32 s60, s28, 0x201000
    buffer_store_dwordx4 v[80:83], v2, s[4:7], s60 offen sc1
    v_lshlrev_b32 v20, 16, v84
    v_and_b32 v21, 0xffff0000, v84
    v_lshlrev_b32 v22, 16, v85
    v_and_b32 v23, 0xffff0000, v85
    v_lshlrev_b32 v24, 16, v86
    v_and_b32 v25, 0xffff0000, v86
    v_lshlrev_b32 v26, 16, v87
    v_and_b32 v27, 0xffff0000, v87
    v_pk_add_f32 v[20:21], v[20:21], v[138:139] op_sel_hi:[1,0] neg_lo:[0,1] neg_hi:[0,1]
    v_pk_add_f32 v[22:23], v[22:23], v[138:139] op_sel_hi:[1,0] neg_lo:[0,1] neg_hi:[0,1]
    v_pk_add_f32 v[24:25], v[24:25], v[138:139] op_sel_hi:[1,0] neg_lo:[0,1] neg_hi:[0,1]
    v_pk_add_f32 v[26:27], v[26:27], v[138:139] op_sel_hi:[1,0] neg_lo:[0,1] neg_hi:[0,1]
    v_cvt_pk_bf16_f32 v84, v20, v21
    v_cvt_pk_bf16_f32 v85, v22, v23
    v_cvt_pk_bf16_f32 v86, v24, v25
    v_cvt_pk_bf16_f32 v87, v26, v27
    v_lshlrev_b32 v20, 16, v84
    v_and_b32 v21, 0xffff0000, v84
    v_lshlrev_b32 v22, 16, v85
    v_and_b32 v23, 0xffff0000, v85
    v_lshlrev_b32 v24, 16, v86
    v_and_b32 v25, 0xffff0000, v86
    v_lshlrev_b32 v26, 16, v87
    v_and_b32 v27, 0xffff0000, v87
    v_pk_mul_f32 v[20:21], v[20:21], v[138:139] op_sel:[0,1] op_sel_hi:[1,1]
    v_pk_mul_f32 v[22:23], v[22:23], v[138:139] op_sel:[0,1] op_sel_hi:[1,1]
    v_pk_mul_f32 v[24:25], v[24:25], v[138:139] op_sel:[0,1] op_sel_hi:[1,1]
    v_pk_mul_f32 v[26:27], v[26:27], v[138:139] op_sel:[0,1] op_sel_hi:[1,1]
    v_cvt_pk_bf16_f32 v84, v20, v21
    v_cvt_pk_bf16_f32 v85, v22, v23
    v_cvt_pk_bf16_f32 v86, v24, v25
    v_cvt_pk_bf16_f32 v87, v26, v27
    s_add_u32 s60, s28, 0x205000
    buffer_store_dwordx4 v[84:87], v2, s[4:7], s60 offen sc1
    v_lshlrev_b32 v20, 16, v88
    v_and_b32 v21, 0xffff0000, v88
    v_lshlrev_b32 v22, 16, v89
    v_and_b32 v23, 0xffff0000, v89
    v_lshlrev_b32 v24, 16, v90
    v_and_b32 v25, 0xffff0000, v90
    v_lshlrev_b32 v26, 16, v91
    v_and_b32 v27, 0xffff0000, v91
    v_pk_add_f32 v[20:21], v[20:21], v[138:139] op_sel_hi:[1,0] neg_lo:[0,1] neg_hi:[0,1]
    v_pk_add_f32 v[22:23], v[22:23], v[138:139] op_sel_hi:[1,0] neg_lo:[0,1] neg_hi:[0,1]
    v_pk_add_f32 v[24:25], v[24:25], v[138:139] op_sel_hi:[1,0] neg_lo:[0,1] neg_hi:[0,1]
    v_pk_add_f32 v[26:27], v[26:27], v[138:139] op_sel_hi:[1,0] neg_lo:[0,1] neg_hi:[0,1]
    v_cvt_pk_bf16_f32 v88, v20, v21
    v_cvt_pk_bf16_f32 v89, v22, v23
    v_cvt_pk_bf16_f32 v90, v24, v25
    v_cvt_pk_bf16_f32 v91, v26, v27
    v_lshlrev_b32 v20, 16, v88
    v_and_b32 v21, 0xffff0000, v88
    v_lshlrev_b32 v22, 16, v89
    v_and_b32 v23, 0xffff0000, v89
    v_lshlrev_b32 v24, 16, v90
    v_and_b32 v25, 0xffff0000, v90
    v_lshlrev_b32 v26, 16, v91
    v_and_b32 v27, 0xffff0000, v91
    v_pk_mul_f32 v[20:21], v[20:21], v[138:139] op_sel:[0,1] op_sel_hi:[1,1]
    v_pk_mul_f32 v[22:23], v[22:23], v[138:139] op_sel:[0,1] op_sel_hi:[1,1]
    v_pk_mul_f32 v[24:25], v[24:25], v[138:139] op_sel:[0,1] op_sel_hi:[1,1]
    v_pk_mul_f32 v[26:27], v[26:27], v[138:139] op_sel:[0,1] op_sel_hi:[1,1]
    v_cvt_pk_bf16_f32 v88, v20, v21
    v_cvt_pk_bf16_f32 v89, v22, v23
    v_cvt_pk_bf16_f32 v90, v24, v25
    v_cvt_pk_bf16_f32 v91, v26, v27
    s_add_u32 s60, s28, 0x205400
    buffer_store_dwordx4 v[88:91], v2, s[4:7], s60 offen sc1
    v_lshlrev_b32 v20, 16, v92
    v_and_b32 v21, 0xffff0000, v92
    v_lshlrev_b32 v22, 16, v93
    v_and_b32 v23, 0xffff0000, v93
    v_lshlrev_b32 v24, 16, v94
    v_and_b32 v25, 0xffff0000, v94
    v_lshlrev_b32 v26, 16, v95
    v_and_b32 v27, 0xffff0000, v95
    v_pk_add_f32 v[20:21], v[20:21], v[138:139] op_sel_hi:[1,0] neg_lo:[0,1] neg_hi:[0,1]
    v_pk_add_f32 v[22:23], v[22:23], v[138:139] op_sel_hi:[1,0] neg_lo:[0,1] neg_hi:[0,1]
    v_pk_add_f32 v[24:25], v[24:25], v[138:139] op_sel_hi:[1,0] neg_lo:[0,1] neg_hi:[0,1]
    v_pk_add_f32 v[26:27], v[26:27], v[138:139] op_sel_hi:[1,0] neg_lo:[0,1] neg_hi:[0,1]
    v_cvt_pk_bf16_f32 v92, v20, v21
    v_cvt_pk_bf16_f32 v93, v22, v23
    v_cvt_pk_bf16_f32 v94, v24, v25
    v_cvt_pk_bf16_f32 v95, v26, v27
    v_lshlrev_b32 v20, 16, v92
    v_and_b32 v21, 0xffff0000, v92
    v_lshlrev_b32 v22, 16, v93
    v_and_b32 v23, 0xffff0000, v93
    v_lshlrev_b32 v24, 16, v94
    v_and_b32 v25, 0xffff0000, v94
    v_lshlrev_b32 v26, 16, v95
    v_and_b32 v27, 0xffff0000, v95
    v_pk_mul_f32 v[20:21], v[20:21], v[138:139] op_sel:[0,1] op_sel_hi:[1,1]
    v_pk_mul_f32 v[22:23], v[22:23], v[138:139] op_sel:[0,1] op_sel_hi:[1,1]
    v_pk_mul_f32 v[24:25], v[24:25], v[138:139] op_sel:[0,1] op_sel_hi:[1,1]
    v_pk_mul_f32 v[26:27], v[26:27], v[138:139] op_sel:[0,1] op_sel_hi:[1,1]
    v_cvt_pk_bf16_f32 v92, v20, v21
    v_cvt_pk_bf16_f32 v93, v22, v23
    v_cvt_pk_bf16_f32 v94, v24, v25
    v_cvt_pk_bf16_f32 v95, v26, v27
    s_add_u32 s60, s28, 0x205800
    buffer_store_dwordx4 v[92:95], v2, s[4:7], s60 offen sc1
    v_lshlrev_b32 v20, 16, v96
    v_and_b32 v21, 0xffff0000, v96
    v_lshlrev_b32 v22, 16, v97
    v_and_b32 v23, 0xffff0000, v97
    v_lshlrev_b32 v24, 16, v98
    v_and_b32 v25, 0xffff0000, v98
    v_lshlrev_b32 v26, 16, v99
    v_and_b32 v27, 0xffff0000, v99
    v_pk_add_f32 v[20:21], v[20:21], v[138:139] op_sel_hi:[1,0] neg_lo:[0,1] neg_hi:[0,1]
    v_pk_add_f32 v[22:23], v[22:23], v[138:139] op_sel_hi:[1,0] neg_lo:[0,1] neg_hi:[0,1]
    v_pk_add_f32 v[24:25], v[24:25], v[138:139] op_sel_hi:[1,0] neg_lo:[0,1] neg_hi:[0,1]
    v_pk_add_f32 v[26:27], v[26:27], v[138:139] op_sel_hi:[1,0] neg_lo:[0,1] neg_hi:[0,1]
    v_cvt_pk_bf16_f32 v96, v20, v21
    v_cvt_pk_bf16_f32 v97, v22, v23
    v_cvt_pk_bf16_f32 v98, v24, v25
    v_cvt_pk_bf16_f32 v99, v26, v27
    v_lshlrev_b32 v20, 16, v96
    v_and_b32 v21, 0xffff0000, v96
    v_lshlrev_b32 v22, 16, v97
    v_and_b32 v23, 0xffff0000, v97
    v_lshlrev_b32 v24, 16, v98
    v_and_b32 v25, 0xffff0000, v98
    v_lshlrev_b32 v26, 16, v99
    v_and_b32 v27, 0xffff0000, v99
    v_pk_mul_f32 v[20:21], v[20:21], v[138:139] op_sel:[0,1] op_sel_hi:[1,1]
    v_pk_mul_f32 v[22:23], v[22:23], v[138:139] op_sel:[0,1] op_sel_hi:[1,1]
    v_pk_mul_f32 v[24:25], v[24:25], v[138:139] op_sel:[0,1] op_sel_hi:[1,1]
    v_pk_mul_f32 v[26:27], v[26:27], v[138:139] op_sel:[0,1] op_sel_hi:[1,1]
    v_cvt_pk_bf16_f32 v96, v20, v21
    v_cvt_pk_bf16_f32 v97, v22, v23
    v_cvt_pk_bf16_f32 v98, v24, v25
    v_cvt_pk_bf16_f32 v99, v26, v27
    s_add_u32 s60, s28, 0x205c00
    buffer_store_dwordx4 v[96:99], v2, s[4:7], s60 offen sc1
    v_lshlrev_b32 v20, 16, v100
    v_and_b32 v21, 0xffff0000, v100
    v_lshlrev_b32 v22, 16, v101
    v_and_b32 v23, 0xffff0000, v101
    v_lshlrev_b32 v24, 16, v102
    v_and_b32 v25, 0xffff0000, v102
    v_lshlrev_b32 v26, 16, v103
    v_and_b32 v27, 0xffff0000, v103
    v_pk_add_f32 v[20:21], v[20:21], v[138:139] op_sel_hi:[1,0] neg_lo:[0,1] neg_hi:[0,1]
    v_pk_add_f32 v[22:23], v[22:23], v[138:139] op_sel_hi:[1,0] neg_lo:[0,1] neg_hi:[0,1]
    v_pk_add_f32 v[24:25], v[24:25], v[138:139] op_sel_hi:[1,0] neg_lo:[0,1] neg_hi:[0,1]
    v_pk_add_f32 v[26:27], v[26:27], v[138:139] op_sel_hi:[1,0] neg_lo:[0,1] neg_hi:[0,1]
    v_cvt_pk_bf16_f32 v100, v20, v21
    v_cvt_pk_bf16_f32 v101, v22, v23
    v_cvt_pk_bf16_f32 v102, v24, v25
    v_cvt_pk_bf16_f32 v103, v26, v27
    v_lshlrev_b32 v20, 16, v100
    v_and_b32 v21, 0xffff0000, v100
    v_lshlrev_b32 v22, 16, v101
    v_and_b32 v23, 0xffff0000, v101
    v_lshlrev_b32 v24, 16, v102
    v_and_b32 v25, 0xffff0000, v102
    v_lshlrev_b32 v26, 16, v103
    v_and_b32 v27, 0xffff0000, v103
    v_pk_mul_f32 v[20:21], v[20:21], v[138:139] op_sel:[0,1] op_sel_hi:[1,1]
    v_pk_mul_f32 v[22:23], v[22:23], v[138:139] op_sel:[0,1] op_sel_hi:[1,1]
    v_pk_mul_f32 v[24:25], v[24:25], v[138:139] op_sel:[0,1] op_sel_hi:[1,1]
    v_pk_mul_f32 v[26:27], v[26:27], v[138:139] op_sel:[0,1] op_sel_hi:[1,1]
    v_cvt_pk_bf16_f32 v100, v20, v21
    v_cvt_pk_bf16_f32 v101, v22, v23
    v_cvt_pk_bf16_f32 v102, v24, v25
    v_cvt_pk_bf16_f32 v103, v26, v27
    s_add_u32 s60, s28, 0x206000
    buffer_store_dwordx4 v[100:103], v2, s[4:7], s60 offen sc1
    s_waitcnt vmcnt(0)
    s_barrier
    s_cmp_lg_u32 s3, 0
    s_cbranch_scc1 Li_2
    s_mov_b64 exec, 1
    v_mov_b32 v20, 0x10000
    buffer_atomic_add v20, v12, s[16:19], 0 offen offset:4 sc0 sc1
    s_waitcnt vmcnt(0)
    v_readfirstlane_b32 s72, v20
    s_nop 0
    s_lshr_b32 s73, s72, 16
    s_cmp_lg_u32 s73, 63
    s_nop 0
    s_cbranch_scc1 La_3
    v_mov_b32 v20, 1
    buffer_store_dword v20, v12, s[16:19], 0 offen offset:132 sc1
La_3:
    s_mov_b64 exec, -1
Li_2:
    s_mul_i32 s28, s70, 20480
    s_add_u32 s60, s28, 0x0
    buffer_store_dwordx4 v[4:7], v8, s[4:7], s60 offen sc1
    s_add_u32 s60, s28, 0x1000
    buffer_store_dwordx4 v[4:7], v8, s[4:7], s60 offen sc1
    s_add_u32 s60, s28, 0x2000
    buffer_store_dwordx4 v[4:7], v8, s[4:7], s60 offen sc1
    s_add_u32 s60, s28, 0x3000
    buffer_store_dwordx4 v[4:7], v8, s[4:7], s60 offen sc1
    s_add_u32 s60, s28, 0x4000
    buffer_store_dwordx4 v[4:7], v8, s[4:7], s60 offen sc1
    s_mul_i32 s28, s70, 4096
    s_add_u32 s60, s28, 0xbd8000
    buffer_store_dwordx4 v[4:7], v8, s[4:7], s60 offen sc1
    s_mul_i32 s28, s70, 4096
    s_add_u32 s60, s28, 0xf44000
    buffer_store_dwordx4 v[4:7], v8, s[4:7], s60 offen sc1
    s_mul_i32 s28, s70, 12288
    s_add_u32 s60, s28, 0x1570000
    buffer_store_dwordx4 v[4:7], v8, s[4:7], s60 offen sc1
    s_add_u32 s60, s28, 0x1571000
    buffer_store_dwordx4 v[4:7], v8, s[4:7], s60 offen sc1
    s_add_u32 s60, s28, 0x1572000
    buffer_store_dwordx4 v[4:7], v8, s[4:7], s60 offen sc1
    s_mov_b32 s72, 0xfa00
    s_mov_b32 s73, 0
    s_bitcmp1_b64 s[72:73], s70
    s_cbranch_scc1 Li_4
    s_lshr_b32 s28, s70, 2
    s_mul_i32 s28, s28, 16384
    s_and_b32 s29, s70, 3
    s_lshl_b32 s29, s29, 12
    s_add_u32 s28, s28, s29
    s_add_u32 s60, s28, 0x180000
    buffer_store_dwordx4 v[4:7], v8, s[4:7], s60 offen sc1
Li_4:
    s_add_u32 s28, s70, s3
    s_cmp_lg_u32 s28, 0
    s_cbranch_scc1 Li_5
    s_mov_b32 s20, s34
    s_and_b32 s21, s35, 0xffff
    s_mov_b32 s22, 0x2800
    s_mov_b32 s23, 0x20000
    v_bfe_u32 v16, v1, 2, 2
    v_and_b32 v17, 1, v1
    v_lshl_add_u32 v16, v16, 1, v17
    v_mul_u32_u24 v16, 1280, v16
    v_lshrrev_b32 v17, 4, v1
    v_lshl_add_u32 v16, v17, 5, v16
    v_and_b32 v17, 2, v1
    v_lshl_add_u32 v16, v17, 3, v16
    buffer_load_dwordx4 v[20:23], v16, s[20:23], 0 offen offset:0
    buffer_load_dwordx4 v[24:27], v16, s[20:23], 0 offen offset:128
    buffer_load_dwordx4 v[28:31], v16, s[20:23], 0 offen offset:256
    buffer_load_dwordx4 v[32:35], v16, s[20:23], 0 offen offset:384
    buffer_load_dwordx4 v[36:39], v16, s[20:23], 0 offen offset:512
    buffer_load_dwordx4 v[40:43], v16, s[20:23], 0 offen offset:640
    buffer_load_dwordx4 v[44:47], v16, s[20:23], 0 offen offset:768
    buffer_load_dwordx4 v[48:51], v16, s[20:23], 0 offen offset:896
    buffer_load_dwordx4 v[52:55], v16, s[20:23], 0 offen offset:1024
    buffer_load_dwordx4 v[56:59], v16, s[20:23], 0 offen offset:1152
    s_waitcnt vmcnt(0)
    v_min_u32 v20, 0xfffffffe, v20
    v_min_u32 v21, 0xfffffffe, v21
    v_min_u32 v22, 0xfffffffe, v22
    v_min_u32 v23, 0xfffffffe, v23
    v_min_u32 v24, 0xfffffffe, v24
    v_min_u32 v25, 0xfffffffe, v25
    v_min_u32 v26, 0xfffffffe, v26
    v_min_u32 v27, 0xfffffffe, v27
    v_min_u32 v28, 0xfffffffe, v28
    v_min_u32 v29, 0xfffffffe, v29
    v_min_u32 v30, 0xfffffffe, v30
    v_min_u32 v31, 0xfffffffe, v31
    v_min_u32 v32, 0xfffffffe, v32
    v_min_u32 v33, 0xfffffffe, v33
    v_min_u32 v34, 0xfffffffe, v34
    v_min_u32 v35, 0xfffffffe, v35
    v_min_u32 v36, 0xfffffffe, v36
    v_min_u32 v37, 0xfffffffe, v37
    v_min_u32 v38, 0xfffffffe, v38
    v_min_u32 v39, 0xfffffffe, v39
    v_min_u32 v40, 0xfffffffe, v40
    v_min_u32 v41, 0xfffffffe, v41
    v_min_u32 v42, 0xfffffffe, v42
    v_min_u32 v43, 0xfffffffe, v43
    v_min_u32 v44, 0xfffffffe, v44
    v_min_u32 v45, 0xfffffffe, v45
    v_min_u32 v46, 0xfffffffe, v46
    v_min_u32 v47, 0xfffffffe, v47
    v_min_u32 v48, 0xfffffffe, v48
    v_min_u32 v49, 0xfffffffe, v49
    v_min_u32 v50, 0xfffffffe, v50
    v_min_u32 v51, 0xfffffffe, v51
    v_min_u32 v52, 0xfffffffe, v52
    v_min_u32 v53, 0xfffffffe, v53
    v_min_u32 v54, 0xfffffffe, v54
    v_min_u32 v55, 0xfffffffe, v55
    v_min_u32 v56, 0xfffffffe, v56
    v_min_u32 v57, 0xfffffffe, v57
    v_min_u32 v58, 0xfffffffe, v58
    v_min_u32 v59, 0xfffffffe, v59
    s_mov_b32 s60, 0x189000
    buffer_store_dwordx4 v[20:23], v2, s[4:7], s60 offen sc1
    s_mov_b32 s60, 0x18b000
    buffer_store_dwordx4 v[20:23], v2, s[4:7], s60 offen sc1
    s_mov_b32 s60, 0x189400
    buffer_store_dwordx4 v[24:27], v2, s[4:7], s60 offen sc1
    s_mov_b32 s60, 0x18b400
    buffer_store_dwordx4 v[24:27], v2, s[4:7], s60 offen sc1
    s_mov_b32 s60, 0x189800
    buffer_store_dwordx4 v[28:31], v2, s[4:7], s60 offen sc1
    s_mov_b32 s60, 0x18b800
    buffer_store_dwordx4 v[28:31], v2, s[4:7], s60 offen sc1
    s_mov_b32 s60, 0x189c00
    buffer_store_dwordx4 v[32:35], v2, s[4:7], s60 offen sc1
    s_mov_b32 s60, 0x18bc00
    buffer_store_dwordx4 v[32:35], v2, s[4:7], s60 offen sc1
    s_mov_b32 s60, 0x18c000
    buffer_store_dwordx4 v[36:39], v2, s[4:7], s60 offen sc1
    s_mov_b32 s60, 0x18e000
    buffer_store_dwordx4 v[36:39], v2, s[4:7], s60 offen sc1
    s_mov_b32 s60, 0x18c400
    buffer_store_dwordx4 v[40:43], v2, s[4:7], s60 offen sc1
    s_mov_b32 s60, 0x18e400
    buffer_store_dwordx4 v[40:43], v2, s[4:7], s60 offen sc1
    s_mov_b32 s60, 0x18c800
    buffer_store_dwordx4 v[44:47], v2, s[4:7], s60 offen sc1
    s_mov_b32 s60, 0x18e800
    buffer_store_dwordx4 v[44:47], v2, s[4:7], s60 offen sc1
    s_mov_b32 s60, 0x18cc00
    buffer_store_dwordx4 v[48:51], v2, s[4:7], s60 offen sc1
    s_mov_b32 s60, 0x18ec00
    buffer_store_dwordx4 v[48:51], v2, s[4:7], s60 offen sc1
    s_mov_b32 s60, 0x18d000
    buffer_store_dwordx4 v[52:55], v2, s[4:7], s60 offen sc1
    s_mov_b32 s60, 0x18f000
    buffer_store_dwordx4 v[52:55], v2, s[4:7], s60 offen sc1
    s_mov_b32 s60, 0x18d400
    buffer_store_dwordx4 v[56:59], v2, s[4:7], s60 offen sc1
    s_mov_b32 s60, 0x18f400
    buffer_store_dwordx4 v[56:59], v2, s[4:7], s60 offen sc1
Li_5:
    s_mov_b64 exec, 1
    s_lshl_b32 s72, s3, 14
    s_lshl_b32 s73, s70, 7
    s_add_u32 s72, s72, s73
    s_add_u32 s72, s72, 0x170000
    s_and_b32 s73, s3, 1
    s_lshl_b32 s73, s73, 13
    s_add_u32 s72, s72, s73
    s_xor_b32 s73, s72, 8192
    s_mov_b32 s74, 0
    buffer_store_dword v4, v12, s[4:7], s72 offen sc1
    buffer_store_dword v4, v12, s[4:7], s73 offen sc1
    s_waitcnt vmcnt(0)
    s_memtime s[76:77]
    s_waitcnt lgkmcnt(0)
    buffer_load_dword v16, v12, s[4:7], s72 offen sc1
    s_waitcnt vmcnt(0)
    s_memtime s[78:79]
    s_waitcnt lgkmcnt(0)
    buffer_load_dword v16, v12, s[4:7], s73 offen sc1
    s_sub_u32 s75, s78, s76
    s_waitcnt vmcnt(0)
    s_memtime s[76:77]
    s_waitcnt lgkmcnt(0)
    s_sub_u32 s76, s76, s78
    s_cmp_lt_u32 s76, s75
    s_cselect_b32 s75, 1, 0
    s_and_b32 s76, s3, 1
    s_xor_b32 s75, s75, s76
    s_add_u32 s74, s74, s75
    buffer_store_dword v4, v12, s[4:7], s72 offen sc1
    buffer_store_dword v4, v12, s[4:7], s73 offen sc1
    s_waitcnt vmcnt(0)
    s_memtime s[76:77]
    s_waitcnt lgkmcnt(0)
    buffer_load_dword v16, v12, s[4:7], s72 offen sc1
    s_waitcnt vmcnt(0)
    s_memtime s[78:79]
    s_waitcnt lgkmcnt(0)
    buffer_load_dword v16, v12, s[4:7], s73 offen sc1
    s_sub_u32 s75, s78, s76
    s_waitcnt vmcnt(0)
    s_memtime s[76:77]
    s_waitcnt lgkmcnt(0)
    s_sub_u32 s76, s76, s78
    s_cmp_lt_u32 s76, s75
    s_cselect_b32 s75, 1, 0
    s_and_b32 s76, s3, 1
    s_xor_b32 s75, s75, s76
    s_add_u32 s74, s74, s75
    buffer_store_dword v4, v12, s[4:7], s72 offen sc1
    buffer_store_dword v4, v12, s[4:7], s73 offen sc1
    s_waitcnt vmcnt(0)
    s_memtime s[76:77]
    s_waitcnt lgkmcnt(0)
    buffer_load_dword v16, v12, s[4:7], s72 offen sc1
    s_waitcnt vmcnt(0)
    s_memtime s[78:79]
    s_waitcnt lgkmcnt(0)
    buffer_load_dword v16, v12, s[4:7], s73 offen sc1
    s_sub_u32 s75, s78, s76
    s_waitcnt vmcnt(0)
    s_memtime s[76:77]
    s_waitcnt lgkmcnt(0)
    s_sub_u32 s76, s76, s78
    s_cmp_lt_u32 s76, s75
    s_cselect_b32 s75, 1, 0
    s_and_b32 s76, s3, 1
    s_xor_b32 s75, s75, s76
    s_add_u32 s74, s74, s75
    buffer_store_dword v4, v12, s[4:7], s72 offen sc1
    buffer_store_dword v4, v12, s[4:7], s73 offen sc1
    s_waitcnt vmcnt(0)
    s_memtime s[76:77]
    s_waitcnt lgkmcnt(0)
    buffer_load_dword v16, v12, s[4:7], s72 offen sc1
    s_waitcnt vmcnt(0)
    s_memtime s[78:79]
    s_waitcnt lgkmcnt(0)
    buffer_load_dword v16, v12, s[4:7], s73 offen sc1
    s_sub_u32 s75, s78, s76
    s_waitcnt vmcnt(0)
    s_memtime s[76:77]
    s_waitcnt lgkmcnt(0)
    s_sub_u32 s76, s76, s78
    s_cmp_lt_u32 s76, s75
    s_cselect_b32 s75, 1, 0
    s_and_b32 s76, s3, 1
    s_xor_b32 s75, s75, s76
    s_add_u32 s74, s74, s75
    s_lshl_b32 s72, s3, 2
    v_mov_b32 v16, s72
    v_mov_b32 v17, s74
    ds_write_b32 v16, v17 offset:2048
    s_mov_b64 exec, -1
    s_waitcnt vmcnt(0) lgkmcnt(0)
    s_barrier
    s_cmp_lg_u32 s3, 0
    s_cbranch_scc1 Li_6
    s_mov_b64 exec, 1
    ds_read_b128 v[20:23], v12 offset:2048
    s_waitcnt lgkmcnt(0)
    v_add3_u32 v20, v20, v21, v22
    v_add_u32 v23, 0x10000, v23
    v_add_u32 v20, v20, v23
    s_nop 0
    v_readfirstlane_b32 s74, v20
    buffer_atomic_add v20, v12, s[16:19], 0 offen offset:0 sc0 sc1
    s_waitcnt vmcnt(0)
    v_readfirstlane_b32 s72, v20
    s_nop 0
    s_lshr_b32 s73, s72, 16
    s_cmp_lg_u32 s73, 63
    s_nop 0
    s_cbranch_scc1 La_7
    s_add_u32 s72, s72, s74
    v_mov_b32 v20, s72
    buffer_store_dword v20, v12, s[16:19], 0 offen offset:128 sc1
La_7:
    s_mov_b64 exec, -1
Li_6:
    s_mul_i32 s24, s80, 10
    s_add_u32 s24, s24, s81
    s_sub_u32 s24, s24, 16
    s_cmp_lt_u32 s81, 26
    s_cbranch_scc1 L_role_S2
    s_sub_u32 s24, s81, 26
    s_branch L_role_X2
L_exit:
L_exit0:
    s_endpgm
L_abort:
    s_mov_b64 exec, 1
    v_mov_b32 v3, 0
    v_mov_b32 v4, s2
    v_or_b32 v4, 0x10000, v4
    buffer_store_dword v4, v3, s[16:19], 0 offen offset:8 sc1
    s_endpgm
L_workers:
    s_sub_u32 s28, s28, 4
    s_lshl_b32 s24, s28, 3
    s_lshr_b32 s30, s29, 2
    s_add_u32 s24, s24, s30
    s_and_b32 s70, s29, 3
    s_cmp_eq_u32 s70, 3
    s_cbranch_scc1 L_role_O
    s_branch L_role_G
L_phase2:
    s_and_b32 s28, s2, 3
    s_lshl_b32 s28, s28, 3
    s_lshr_b32 s29, s2, 5
    s_add_u32 s28, s28, s29
    s_bfe_u32 s29, s2, 0x20003
    s_waitcnt vmcnt(0) lgkmcnt(0)
    s_barrier
    s_cmp_eq_u32 s29, 3
    s_cbranch_scc1 L_phase2o
    s_mov_b32 s81, s29
    s_mov_b32 s24, s28
    s_cmp_lt_u32 s24, 24
    s_cbranch_scc1 L_role_F1
    s_sub_u32 s24, s24, 24
    s_branch L_role_F2
L_phase2o:
    s_lshr_b32 s81, s28, 3
    s_and_b32 s24, s28, 7
    s_add_u32 s24, s24, 8
    s_cmp_lt_u32 s81, 3
    s_cbranch_scc1 L_role_F2
    s_branch L_exit
L_role_G:
    s_cmp_eq_u32 s70, 1
    s_cselect_b32 s28, s38, s36
    s_cselect_b32 s29, s39, s37
    s_cmp_eq_u32 s70, 2
    s_cselect_b32 s28, s40, s28
    s_cselect_b32 s29, s41, s29
    s_mov_b32 s8, s28
    s_and_b32 s9, s29, 0xffff
    s_mov_b32 s10, 0x780000
    s_mov_b32 s11, 0x20000
    s_mul_i32 s71, s24, 384
    s_mul_i32 s28, s3, 196608
    s_add_u32 s71, s71, s28
    v_lshrrev_b32 v12, 4, v1
    v_bfe_u32 v13, v1, 2, 2
    v_and_b32 v14, 3, v1
    v_add_u32 v4, 0, v1
    v_mul_u32_u24 v5, 2731, v4
    v_lshrrev_b32 v5, 16, v5
    v_mul_u32_u24 v20, 24, v5
    v_sub_u32 v4, v4, v20
    v_bfe_u32 v20, v5, 1, 1
    v_lshlrev_b32 v20, 1, v20
    v_xor_b32 v4, v4, v20
    v_lshlrev_b32 v4, 4, v4
    v_mul_u32_u24 v5, 12288, v5
    v_add_u32 v20, v4, v5
    v_add_u32 v4, 64, v1
    v_mul_u32_u24 v5, 2731, v4
    v_lshrrev_b32 v5, 16, v5
    v_mul_u32_u24 v21, 24, v5
    v_sub_u32 v4, v4, v21
    v_bfe_u32 v21, v5, 1, 1
    v_lshlrev_b32 v21, 1, v21
    v_xor_b32 v4, v4, v21
    v_lshlrev_b32 v4, 4, v4
    v_mul_u32_u24 v5, 12288, v5
    v_add_u32 v21, v4, v5
    v_add_u32 v4, 128, v1
    v_mul_u32_u24 v5, 2731, v4
    v_lshrrev_b32 v5, 16, v5
    v_mul_u32_u24 v22, 24, v5
    v_sub_u32 v4, v4, v22
    v_bfe_u32 v22, v5, 1, 1
    v_lshlrev_b32 v22, 1, v22
    v_xor_b32 v4, v4, v22
    v_lshlrev_b32 v4, 4, v4
    v_mul_u32_u24 v5, 12288, v5
    v_add_u32 v22, v4, v5
    v_add_u32 v4, 192, v1
    v_mul_u32_u24 v5, 2731, v4
    v_lshrrev_b32 v5, 16, v5
    v_mul_u32_u24 v23, 24, v5
    v_sub_u32 v4, v4, v23
    v_bfe_u32 v23, v5, 1, 1
    v_lshlrev_b32 v23, 1, v23
    v_or_b32 v23, 4, v23
    v_xor_b32 v4, v4, v23
    v_lshlrev_b32 v4, 4, v4
    v_mul_u32_u24 v5, 12288, v5
    v_add_u32 v23, v4, v5
    v_add_u32 v4, 256, v1
    v_mul_u32_u24 v5, 2731, v4
    v_lshrrev_b32 v5, 16, v5
    v_mul_u32_u24 v24, 24, v5
    v_sub_u32 v4, v4, v24
    v_bfe_u32 v24, v5, 1, 1
    v_lshlrev_b32 v24, 1, v24
    v_or_b32 v24, 4, v24
    v_xor_b32 v4, v4, v24
    v_lshlrev_b32 v4, 4, v4
    v_mul_u32_u24 v5, 12288, v5
    v_add_u32 v24, v4, v5
    v_add_u32 v4, 320, v1
    v_mul_u32_u24 v5, 2731, v4
    v_lshrrev_b32 v5, 16, v5
    v_mul_u32_u24 v25, 24, v5
    v_sub_u32 v4, v4, v25
    v_bfe_u32 v25, v5, 1, 1
    v_lshlrev_b32 v25, 1, v25
    v_or_b32 v25, 4, v25
    v_xor_b32 v4, v4, v25
    v_lshlrev_b32 v4, 4, v4
    v_mul_u32_u24 v5, 12288, v5
    v_add_u32 v25, v4, v5
    v_lshl_add_u32 v10, v12, 3, v13
    v_mul_u32_u24 v10, 384, v10
    v_lshl_add_u32 v10, v14, 3, v10
    v_lshrrev_b32 v6, 1, v13
    v_and_b32 v7, 1, v12
    v_lshl_add_u32 v6, v7, 1, v6
    v_lshlrev_b32 v6, 5, v6
    s_mul_i32 s68, s3, 96
    s_cmp_eq_u32 s70, 2
    s_cbranch_scc1 Lq_8
    s_cmp_eq_u32 s70, 1
    s_cbranch_scc1 Lq_9
    s_mov_b32 s20, s42
    s_and_b32 s21, s43, 0xffff
    s_mov_b32 s22, 0x780000
    s_mov_b32 s23, 0x20000
    s_mul_i32 s28, s24, 245760
    v_lshlrev_b32 v30, 6, v0
    s_add_u32 s60, s28, 98304
    buffer_load_dword v31, v30, s[20:23], s60 offen
    s_add_u32 s60, s28, 114688
    buffer_load_dword v31, v30, s[20:23], s60 offen
    s_add_u32 s60, s28, 131072
    buffer_load_dword v31, v30, s[20:23], s60 offen
    s_add_u32 s60, s28, 147456
    buffer_load_dword v31, v30, s[20:23], s60 offen
    s_add_u32 s60, s28, 163840
    buffer_load_dword v31, v30, s[20:23], s60 offen
    s_add_u32 s60, s28, 180224
    buffer_load_dword v31, v30, s[20:23], s60 offen
    s_add_u32 s60, s28, 196608
    buffer_load_dword v31, v30, s[20:23], s60 offen
    s_add_u32 s60, s28, 212992
    buffer_load_dword v31, v30, s[20:23], s60 offen
    s_add_u32 s60, s28, 229376
    buffer_load_dword v31, v30, s[20:23], s60 offen
    s_branch Lq_8
Lq_9:
    s_mov_b32 s20, s40
    s_and_b32 s21, s41, 0xffff
    s_mov_b32 s22, 0x780000
    s_mov_b32 s23, 0x20000
    v_min_u32 v30, 239, v0
    v_mul_u32_u24 v31, 10923, v30
    v_lshrrev_b32 v31, 16, v31
    v_mul_u32_u24 v29, 6, v31
    v_sub_u32 v30, v30, v29
    v_mul_u32_u24 v31, 12288, v31
    v_lshl_add_u32 v30, v30, 6, v31
    s_mul_i32 s28, s24, 384
    s_add_u32 s60, s28, 2949120
    buffer_load_dword v31, v30, s[20:23], s60 offen
    s_add_u32 s60, s28, 3440640
    buffer_load_dword v31, v30, s[20:23], s60 offen
    s_add_u32 s60, s28, 3932160
    buffer_load_dword v31, v30, s[20:23], s60 offen
    s_add_u32 s60, s28, 4423680
    buffer_load_dword v31, v30, s[20:23], s60 offen
    s_add_u32 s60, s28, 4915200
    buffer_load_dword v31, v30, s[20:23], s60 offen
    s_add_u32 s60, s28, 5406720
    buffer_load_dword v31, v30, s[20:23], s60 offen
    s_add_u32 s60, s28, 5898240
    buffer_load_dword v31, v30, s[20:23], s60 offen
    s_add_u32 s60, s28, 6389760
    buffer_load_dword v31, v30, s[20:23], s60 offen
    s_add_u32 s60, s28, 6881280
    buffer_load_dword v31, v30, s[20:23], s60 offen
    s_add_u32 s60, s28, 7372800
    buffer_load_dword v31, v30, s[20:23], s60 offen
Lq_8:
    s_mul_i32 s61, s3, 6144
    s_add_u32 m0, s61, 0
    s_add_u32 s60, s71, 0x0
    buffer_load_dwordx4 v20, s[8:11], s60 offen lds
    s_add_u32 m0, s61, 1024
    s_add_u32 s60, s71, 0x0
    buffer_load_dwordx4 v21, s[8:11], s60 offen lds
    s_add_u32 m0, s61, 2048
    s_add_u32 s60, s71, 0x0
    buffer_load_dwordx4 v22, s[8:11], s60 offen lds
    s_add_u32 m0, s61, 3072
    s_add_u32 s60, s71, 0x0
    buffer_load_dwordx4 v23, s[8:11], s60 offen lds
    s_add_u32 m0, s61, 4096
    s_add_u32 s60, s71, 0x0
    buffer_load_dwordx4 v24, s[8:11], s60 offen lds
    s_add_u32 m0, s61, 5120
    s_add_u32 s60, s71, 0x0
    buffer_load_dwordx4 v25, s[8:11], s60 offen lds
    s_add_u32 m0, s61, 24576
    s_add_u32 s60, s71, 0xc0000
    buffer_load_dwordx4 v20, s[8:11], s60 offen lds
    s_add_u32 m0, s61, 25600
    s_add_u32 s60, s71, 0xc0000
    buffer_load_dwordx4 v21, s[8:11], s60 offen lds
    s_add_u32 m0, s61, 26624
    s_add_u32 s60, s71, 0xc0000
    buffer_load_dwordx4 v22, s[8:11], s60 offen lds
    s_add_u32 m0, s61, 27648
    s_add_u32 s60, s71, 0xc0000
    buffer_load_dwordx4 v23, s[8:11], s60 offen lds
    s_add_u32 m0, s61, 28672
    s_add_u32 s60, s71, 0xc0000
    buffer_load_dwordx4 v24, s[8:11], s60 offen lds
    s_add_u32 m0, s61, 29696
    s_add_u32 s60, s71, 0xc0000
    buffer_load_dwordx4 v25, s[8:11], s60 offen lds
    s_add_u32 m0, s61, 49152
    s_add_u32 s60, s71, 0x180000
    buffer_load_dwordx4 v20, s[8:11], s60 offen lds
    s_add_u32 m0, s61, 50176
    s_add_u32 s60, s71, 0x180000
    buffer_load_dwordx4 v21, s[8:11], s60 offen lds
    s_add_u32 m0, s61, 51200
    s_add_u32 s60, s71, 0x180000
    buffer_load_dwordx4 v22, s[8:11], s60 offen lds
    s_add_u32 m0, s61, 52224
    s_add_u32 s60, s71, 0x180000
    buffer_load_dwordx4 v23, s[8:11], s60 offen lds
    s_add_u32 m0, s61, 53248
    s_add_u32 s60, s71, 0x180000
    buffer_load_dwordx4 v24, s[8:11], s60 offen lds
    s_add_u32 m0, s61, 54272
    s_add_u32 s60, s71, 0x180000
    buffer_load_dwordx4 v25, s[8:11], s60 offen lds
    s_add_u32 m0, s61, 73728
    s_add_u32 s60, s71, 0x240000
    buffer_load_dwordx4 v20, s[8:11], s60 offen lds
    s_add_u32 m0, s61, 74752
    s_add_u32 s60, s71, 0x240000
    buffer_load_dwordx4 v21, s[8:11], s60 offen lds
    s_add_u32 m0, s61, 75776
    s_add_u32 s60, s71, 0x240000
    buffer_load_dwordx4 v22, s[8:11], s60 offen lds
    s_add_u32 m0, s61, 76800
    s_add_u32 s60, s71, 0x240000
    buffer_load_dwordx4 v23, s[8:11], s60 offen lds
    s_add_u32 m0, s61, 77824
    s_add_u32 s60, s71, 0x240000
    buffer_load_dwordx4 v24, s[8:11], s60 offen lds
    s_add_u32 m0, s61, 78848
    s_add_u32 s60, s71, 0x240000
    buffer_load_dwordx4 v25, s[8:11], s60 offen lds
    s_add_u32 m0, s61, 98304
    s_add_u32 s60, s71, 0x300000
    buffer_load_dwordx4 v20, s[8:11], s60 offen lds
    s_add_u32 m0, s61, 99328
    s_add_u32 s60, s71, 0x300000
    buffer_load_dwordx4 v21, s[8:11], s60 offen lds
    s_add_u32 m0, s61, 100352
    s_add_u32 s60, s71, 0x300000
    buffer_load_dwordx4 v22, s[8:11], s60 offen lds
    s_add_u32 m0, s61, 101376
    s_add_u32 s60, s71, 0x300000
    buffer_load_dwordx4 v23, s[8:11], s60 offen lds
    s_add_u32 m0, s61, 102400
    s_add_u32 s60, s71, 0x300000
    buffer_load_dwordx4 v24, s[8:11], s60 offen lds
    s_add_u32 m0, s61, 103424
    s_add_u32 s60, s71, 0x300000
    buffer_load_dwordx4 v25, s[8:11], s60 offen lds
    s_waitcnt vmcnt(24)
    s_barrier
    s_add_u32 m0, s61, 122880
    s_add_u32 s60, s71, 0x3c0000
    buffer_load_dwordx4 v20, s[8:11], s60 offen lds
    s_add_u32 m0, s61, 123904
    s_add_u32 s60, s71, 0x3c0000
    buffer_load_dwordx4 v21, s[8:11], s60 offen lds
    s_add_u32 m0, s61, 124928
    s_add_u32 s60, s71, 0x3c0000
    buffer_load_dwordx4 v22, s[8:11], s60 offen lds
    s_add_u32 m0, s61, 125952
    s_add_u32 s60, s71, 0x3c0000
    buffer_load_dwordx4 v23, s[8:11], s60 offen lds
    s_add_u32 m0, s61, 126976
    s_add_u32 s60, s71, 0x3c0000
    buffer_load_dwordx4 v24, s[8:11], s60 offen lds
    s_add_u32 m0, s61, 128000
    s_add_u32 s60, s71, 0x3c0000
    buffer_load_dwordx4 v25, s[8:11], s60 offen lds
    v_add_u32 v11, 0x0, v10
    s_add_u32 s60, s68, 0
    v_xad_u32 v8, s60, v6, v11
    ds_read_b64_tr_b16 a[0:1], v8 offset:0
    ds_read_b64_tr_b16 a[2:3], v8 offset:1536
    ds_read_b64_tr_b16 a[12:13], v8 offset:12288
    ds_read_b64_tr_b16 a[14:15], v8 offset:13824
    s_add_u32 s60, s68, 32
    v_xad_u32 v9, s60, v6, v11
    ds_read_b64_tr_b16 a[4:5], v9 offset:0
    ds_read_b64_tr_b16 a[6:7], v9 offset:1536
    ds_read_b64_tr_b16 a[16:17], v9 offset:12288
    ds_read_b64_tr_b16 a[18:19], v9 offset:13824
    s_add_u32 s60, s68, 64
    v_xad_u32 v8, s60, v6, v11
    ds_read_b64_tr_b16 a[8:9], v8 offset:0
    ds_read_b64_tr_b16 a[10:11], v8 offset:1536
    ds_read_b64_tr_b16 a[20:21], v8 offset:12288
    ds_read_b64_tr_b16 a[22:23], v8 offset:13824
    s_waitcnt lgkmcnt(0)
    s_waitcnt vmcnt(24)
    s_barrier
    s_add_u32 m0, s61, 0
    s_add_u32 s60, s71, 0x480000
    buffer_load_dwordx4 v20, s[8:11], s60 offen lds
    s_add_u32 m0, s61, 1024
    s_add_u32 s60, s71, 0x480000
    buffer_load_dwordx4 v21, s[8:11], s60 offen lds
    s_add_u32 m0, s61, 2048
    s_add_u32 s60, s71, 0x480000
    buffer_load_dwordx4 v22, s[8:11], s60 offen lds
    s_add_u32 m0, s61, 3072
    s_add_u32 s60, s71, 0x480000
    buffer_load_dwordx4 v23, s[8:11], s60 offen lds
    s_add_u32 m0, s61, 4096
    s_add_u32 s60, s71, 0x480000
    buffer_load_dwordx4 v24, s[8:11], s60 offen lds
    s_add_u32 m0, s61, 5120
    s_add_u32 s60, s71, 0x480000
    buffer_load_dwordx4 v25, s[8:11], s60 offen lds
    v_add_u32 v11, 0x6000, v10
    s_add_u32 s60, s68, 0
    v_xad_u32 v8, s60, v6, v11
    ds_read_b64_tr_b16 a[24:25], v8 offset:0
    ds_read_b64_tr_b16 a[26:27], v8 offset:1536
    ds_read_b64_tr_b16 a[36:37], v8 offset:12288
    ds_read_b64_tr_b16 a[38:39], v8 offset:13824
    s_add_u32 s60, s68, 32
    v_xad_u32 v9, s60, v6, v11
    ds_read_b64_tr_b16 a[28:29], v9 offset:0
    ds_read_b64_tr_b16 a[30:31], v9 offset:1536
    ds_read_b64_tr_b16 a[40:41], v9 offset:12288
    ds_read_b64_tr_b16 a[42:43], v9 offset:13824
    s_add_u32 s60, s68, 64
    v_xad_u32 v8, s60, v6, v11
    ds_read_b64_tr_b16 a[32:33], v8 offset:0
    ds_read_b64_tr_b16 a[34:35], v8 offset:1536
    ds_read_b64_tr_b16 a[44:45], v8 offset:12288
    ds_read_b64_tr_b16 a[46:47], v8 offset:13824
    s_waitcnt lgkmcnt(0)
    s_waitcnt vmcnt(24)
    s_barrier
    s_add_u32 m0, s61, 24576
    s_add_u32 s60, s71, 0x540000
    buffer_load_dwordx4 v20, s[8:11], s60 offen lds
    s_add_u32 m0, s61, 25600
    s_add_u32 s60, s71, 0x540000
    buffer_load_dwordx4 v21, s[8:11], s60 offen lds
    s_add_u32 m0, s61, 26624
    s_add_u32 s60, s71, 0x540000
    buffer_load_dwordx4 v22, s[8:11], s60 offen lds
    s_add_u32 m0, s61, 27648
    s_add_u32 s60, s71, 0x540000
    buffer_load_dwordx4 v23, s[8:11], s60 offen lds
    s_add_u32 m0, s61, 28672
    s_add_u32 s60, s71, 0x540000
    buffer_load_dwordx4 v24, s[8:11], s60 offen lds
    s_add_u32 m0, s61, 29696
    s_add_u32 s60, s71, 0x540000
    buffer_load_dwordx4 v25, s[8:11], s60 offen lds
    v_add_u32 v11, 0xc000, v10
    s_add_u32 s60, s68, 0
    v_xad_u32 v8, s60, v6, v11
    ds_read_b64_tr_b16 a[48:49], v8 offset:0
    ds_read_b64_tr_b16 a[50:51], v8 offset:1536
    ds_read_b64_tr_b16 a[60:61], v8 offset:12288
    ds_read_b64_tr_b16 a[62:63], v8 offset:13824
    s_add_u32 s60, s68, 32
    v_xad_u32 v9, s60, v6, v11
    ds_read_b64_tr_b16 a[52:53], v9 offset:0
    ds_read_b64_tr_b16 a[54:55], v9 offset:1536
    ds_read_b64_tr_b16 a[64:65], v9 offset:12288
    ds_read_b64_tr_b16 a[66:67], v9 offset:13824
    s_add_u32 s60, s68, 64
    v_xad_u32 v8, s60, v6, v11
    ds_read_b64_tr_b16 a[56:57], v8 offset:0
    ds_read_b64_tr_b16 a[58:59], v8 offset:1536
    ds_read_b64_tr_b16 a[68:69], v8 offset:12288
    ds_read_b64_tr_b16 a[70:71], v8 offset:13824
    s_waitcnt lgkmcnt(0)
    s_waitcnt vmcnt(24)
    s_barrier
    s_add_u32 m0, s61, 49152
    s_add_u32 s60, s71, 0x600000
    buffer_load_dwordx4 v20, s[8:11], s60 offen lds
    s_add_u32 m0, s61, 50176
    s_add_u32 s60, s71, 0x600000
    buffer_load_dwordx4 v21, s[8:11], s60 offen lds
    s_add_u32 m0, s61, 51200
    s_add_u32 s60, s71, 0x600000
    buffer_load_dwordx4 v22, s[8:11], s60 offen lds
    s_add_u32 m0, s61, 52224
    s_add_u32 s60, s71, 0x600000
    buffer_load_dwordx4 v23, s[8:11], s60 offen lds
    s_add_u32 m0, s61, 53248
    s_add_u32 s60, s71, 0x600000
    buffer_load_dwordx4 v24, s[8:11], s60 offen lds
    s_add_u32 m0, s61, 54272
    s_add_u32 s60, s71, 0x600000
    buffer_load_dwordx4 v25, s[8:11], s60 offen lds
    v_add_u32 v11, 0x12000, v10
    s_add_u32 s60, s68, 0
    v_xad_u32 v8, s60, v6, v11
    ds_read_b64_tr_b16 a[72:73], v8 offset:0
    ds_read_b64_tr_b16 a[74:75], v8 offset:1536
    ds_read_b64_tr_b16 a[84:85], v8 offset:12288
    ds_read_b64_tr_b16 a[86:87], v8 offset:13824
    s_add_u32 s60, s68, 32
    v_xad_u32 v9, s60, v6, v11
    ds_read_b64_tr_b16 a[76:77], v9 offset:0
    ds_read_b64_tr_b16 a[78:79], v9 offset:1536
    ds_read_b64_tr_b16 a[88:89], v9 offset:12288
    ds_read_b64_tr_b16 a[90:91], v9 offset:13824
    s_add_u32 s60, s68, 64
    v_xad_u32 v8, s60, v6, v11
    ds_read_b64_tr_b16 a[80:81], v8 offset:0
    ds_read_b64_tr_b16 a[82:83], v8 offset:1536
    ds_read_b64_tr_b16 a[92:93], v8 offset:12288
    ds_read_b64_tr_b16 a[94:95], v8 offset:13824
    s_waitcnt lgkmcnt(0)
    s_waitcnt vmcnt(24)
    s_barrier
    s_add_u32 m0, s61, 73728
    s_add_u32 s60, s71, 0x6c0000
    buffer_load_dwordx4 v20, s[8:11], s60 offen lds
    s_add_u32 m0, s61, 74752
    s_add_u32 s60, s71, 0x6c0000
    buffer_load_dwordx4 v21, s[8:11], s60 offen lds
    s_add_u32 m0, s61, 75776
    s_add_u32 s60, s71, 0x6c0000
    buffer_load_dwordx4 v22, s[8:11], s60 offen lds
    s_add_u32 m0, s61, 76800
    s_add_u32 s60, s71, 0x6c0000
    buffer_load_dwordx4 v23, s[8:11], s60 offen lds
    s_add_u32 m0, s61, 77824
    s_add_u32 s60, s71, 0x6c0000
    buffer_load_dwordx4 v24, s[8:11], s60 offen lds
    s_add_u32 m0, s61, 78848
    s_add_u32 s60, s71, 0x6c0000
    buffer_load_dwordx4 v25, s[8:11], s60 offen lds
    v_add_u32 v11, 0x18000, v10
    s_add_u32 s60, s68, 0
    v_xad_u32 v8, s60, v6, v11
    ds_read_b64_tr_b16 a[96:97], v8 offset:0
    ds_read_b64_tr_b16 a[98:99], v8 offset:1536
    ds_read_b64_tr_b16 a[108:109], v8 offset:12288
    ds_read_b64_tr_b16 a[110:111], v8 offset:13824
    s_add_u32 s60, s68, 32
    v_xad_u32 v9, s60, v6, v11
    ds_read_b64_tr_b16 a[100:101], v9 offset:0
    ds_read_b64_tr_b16 a[102:103], v9 offset:1536
    ds_read_b64_tr_b16 a[112:113], v9 offset:12288
    ds_read_b64_tr_b16 a[114:115], v9 offset:13824
    s_add_u32 s60, s68, 64
    v_xad_u32 v8, s60, v6, v11
    ds_read_b64_tr_b16 a[104:105], v8 offset:0
    ds_read_b64_tr_b16 a[106:107], v8 offset:1536
    ds_read_b64_tr_b16 a[116:117], v8 offset:12288
    ds_read_b64_tr_b16 a[118:119], v8 offset:13824
    s_waitcnt lgkmcnt(0)
    s_waitcnt vmcnt(24)
    s_barrier
    v_add_u32 v11, 0x1e000, v10
    s_add_u32 s60, s68, 0
    v_xad_u32 v8, s60, v6, v11
    ds_read_b64_tr_b16 a[120:121], v8 offset:0
    ds_read_b64_tr_b16 a[122:123], v8 offset:1536
    ds_read_b64_tr_b16 a[132:133], v8 offset:12288
    ds_read_b64_tr_b16 a[134:135], v8 offset:13824
    s_add_u32 s60, s68, 32
    v_xad_u32 v9, s60, v6, v11
    ds_read_b64_tr_b16 a[124:125], v9 offset:0
    ds_read_b64_tr_b16 a[126:127], v9 offset:1536
    ds_read_b64_tr_b16 a[136:137], v9 offset:12288
    ds_read_b64_tr_b16 a[138:139], v9 offset:13824
    s_add_u32 s60, s68, 64
    v_xad_u32 v8, s60, v6, v11
    ds_read_b64_tr_b16 a[128:129], v8 offset:0
    ds_read_b64_tr_b16 a[130:131], v8 offset:1536
    ds_read_b64_tr_b16 a[140:141], v8 offset:12288
    ds_read_b64_tr_b16 a[142:143], v8 offset:13824
    s_waitcnt lgkmcnt(0)
    s_waitcnt vmcnt(18)
    s_barrier
    v_add_u32 v11, 0x0, v10
    s_add_u32 s60, s68, 0
    v_xad_u32 v8, s60, v6, v11
    ds_read_b64_tr_b16 a[144:145], v8 offset:0
    ds_read_b64_tr_b16 a[146:147], v8 offset:1536
    ds_read_b64_tr_b16 a[156:157], v8 offset:12288
    ds_read_b64_tr_b16 a[158:159], v8 offset:13824
    s_add_u32 s60, s68, 32
    v_xad_u32 v9, s60, v6, v11
    ds_read_b64_tr_b16 a[148:149], v9 offset:0
    ds_read_b64_tr_b16 a[150:151], v9 offset:1536
    ds_read_b64_tr_b16 a[160:161], v9 offset:12288
    ds_read_b64_tr_b16 a[162:163], v9 offset:13824
    s_add_u32 s60, s68, 64
    v_xad_u32 v8, s60, v6, v11
    ds_read_b64_tr_b16 a[152:153], v8 offset:0
    ds_read_b64_tr_b16 a[154:155], v8 offset:1536
    ds_read_b64_tr_b16 a[164:165], v8 offset:12288
    ds_read_b64_tr_b16 a[166:167], v8 offset:13824
    s_waitcnt lgkmcnt(0)
    s_waitcnt vmcnt(12)
    s_barrier
    v_add_u32 v11, 0x6000, v10
    s_add_u32 s60, s68, 0
    v_xad_u32 v8, s60, v6, v11
    ds_read_b64_tr_b16 a[168:169], v8 offset:0
    ds_read_b64_tr_b16 a[170:171], v8 offset:1536
    ds_read_b64_tr_b16 a[180:181], v8 offset:12288
    ds_read_b64_tr_b16 a[182:183], v8 offset:13824
    s_add_u32 s60, s68, 32
    v_xad_u32 v9, s60, v6, v11
    ds_read_b64_tr_b16 a[172:173], v9 offset:0
    ds_read_b64_tr_b16 a[174:175], v9 offset:1536
    ds_read_b64_tr_b16 a[184:185], v9 offset:12288
    ds_read_b64_tr_b16 a[186:187], v9 offset:13824
    s_add_u32 s60, s68, 64
    v_xad_u32 v8, s60, v6, v11
    ds_read_b64_tr_b16 a[176:177], v8 offset:0
    ds_read_b64_tr_b16 a[178:179], v8 offset:1536
    ds_read_b64_tr_b16 a[188:189], v8 offset:12288
    ds_read_b64_tr_b16 a[190:191], v8 offset:13824
    s_waitcnt lgkmcnt(0)
    s_waitcnt vmcnt(6)
    s_barrier
    v_add_u32 v11, 0xc000, v10
    s_add_u32 s60, s68, 0
    v_xad_u32 v8, s60, v6, v11
    ds_read_b64_tr_b16 a[192:193], v8 offset:0
    ds_read_b64_tr_b16 a[194:195], v8 offset:1536
    ds_read_b64_tr_b16 a[204:205], v8 offset:12288
    ds_read_b64_tr_b16 a[206:207], v8 offset:13824
    s_add_u32 s60, s68, 32
    v_xad_u32 v9, s60, v6, v11
    ds_read_b64_tr_b16 a[196:197], v9 offset:0
    ds_read_b64_tr_b16 a[198:199], v9 offset:1536
    ds_read_b64_tr_b16 a[208:209], v9 offset:12288
    ds_read_b64_tr_b16 a[210:211], v9 offset:13824
    s_add_u32 s60, s68, 64
    v_xad_u32 v8, s60, v6, v11
    ds_read_b64_tr_b16 a[200:201], v8 offset:0
    ds_read_b64_tr_b16 a[202:203], v8 offset:1536
    ds_read_b64_tr_b16 a[212:213], v8 offset:12288
    ds_read_b64_tr_b16 a[214:215], v8 offset:13824
    s_waitcnt lgkmcnt(0)
    s_waitcnt vmcnt(0)
    s_barrier
    v_add_u32 v11, 0x12000, v10
    s_add_u32 s60, s68, 0
    v_xad_u32 v8, s60, v6, v11
    ds_read_b64_tr_b16 a[216:217], v8 offset:0
    ds_read_b64_tr_b16 a[218:219], v8 offset:1536
    ds_read_b64_tr_b16 a[228:229], v8 offset:12288
    ds_read_b64_tr_b16 a[230:231], v8 offset:13824
    s_add_u32 s60, s68, 32
    v_xad_u32 v9, s60, v6, v11
    ds_read_b64_tr_b16 a[220:221], v9 offset:0
    ds_read_b64_tr_b16 a[222:223], v9 offset:1536
    ds_read_b64_tr_b16 a[232:233], v9 offset:12288
    ds_read_b64_tr_b16 a[234:235], v9 offset:13824
    s_add_u32 s60, s68, 64
    v_xad_u32 v8, s60, v6, v11
    ds_read_b64_tr_b16 a[224:225], v8 offset:0
    ds_read_b64_tr_b16 a[226:227], v8 offset:1536
    ds_read_b64_tr_b16 a[236:237], v8 offset:12288
    ds_read_b64_tr_b16 a[238:239], v8 offset:13824
    s_waitcnt lgkmcnt(0)
    s_barrier
    s_mul_i32 s64, s3, 10240
    s_add_u32 s72, s64, 0x200000
    v_mov_b32 v16, v2
    v_add_u32 v17, 40960, v2
    v_lshlrev_b32 v18, 3, v1
    s_cmp_eq_u32 s70, 2
    s_cselect_b32 s65, 23, 24
    s_mul_i32 s73, s70, 0x2000000
    s_mul_i32 s28, s24, 12288
    s_add_u32 s73, s73, s28
    s_mul_i32 s28, s3, 3072
    s_add_u32 s73, s73, s28
    s_add_u32 s73, s73, 0x2000000
    s_lshl_b32 s29, s70, 5
    s_add_u32 s29, s29, s24
    s_lshl_b32 s62, s29, 7
    s_lshl_b32 s28, s3, 2
    s_add_u32 s62, s62, s28
    s_add_u32 s62, s62, 0x600000
    v_mov_b32 v3, 0
    s_mov_b32 s29, 132
    s_mov_b32 s27, 0x100000
Lp_10:
    buffer_load_dword v4, v3, s[16:19], s29 offen sc1
    s_waitcnt vmcnt(0)
    v_cmp_gt_u32 vcc, 1, v4
    s_nop 0
    s_cbranch_vccz Ld_11
    s_sub_u32 s27, s27, 1
    s_cbranch_scc1 L_abort
    s_sleep 6
    s_branch Lp_10
Ld_11:
    s_add_u32 m0, s64, 0
    s_add_u32 s60, s72, 0
    buffer_load_dwordx4 v2, s[4:7], s60 offen offset:0 sc1 lds
    buffer_load_dwordx4 v2, s[4:7], s60 offen offset:1024 sc1 lds
    buffer_load_dwordx4 v2, s[4:7], s60 offen offset:2048 sc1 lds
    buffer_load_dwordx4 v2, s[4:7], s60 offen offset:3072 sc1 lds
    s_add_u32 m0, s64, 4096
    s_add_u32 s60, s72, 4096
    buffer_load_dwordx4 v2, s[4:7], s60 offen offset:0 sc1 lds
    buffer_load_dwordx4 v2, s[4:7], s60 offen offset:1024 sc1 lds
    buffer_load_dwordx4 v2, s[4:7], s60 offen offset:2048 sc1 lds
    buffer_load_dwordx4 v2, s[4:7], s60 offen offset:3072 sc1 lds
    s_add_u32 m0, s64, 8192
    s_add_u32 s60, s72, 8192
    buffer_load_dwordx4 v2, s[4:7], s60 offen offset:0 sc1 lds
    buffer_load_dwordx4 v2, s[4:7], s60 offen offset:1024 sc1 lds
    s_add_u32 s72, s72, 40960
    s_mov_b32 s25, 0
    v_mov_b32 v4, 0x40000000
    v_cmp_eq_u32 vcc, 0, v1
    s_nop 1
    v_cndmask_b32 v19, v4, v3, vcc
    s_cmp_eq_u32 s70, 2
    s_cselect_b32 s66, 16, 32
    s_cselect_b32 s67, 16, 33
    s_waitcnt vmcnt(0)
    s_barrier
    ds_read_b128 v[72:75], v16 offset:0
    ds_read_b128 v[76:79], v16 offset:20480
    ds_read_b128 v[80:83], v16 offset:1024
    ds_read_b128 v[84:87], v16 offset:21504
    ds_read_b128 v[88:91], v16 offset:2048
    ds_read_b128 v[92:95], v16 offset:22528
    s_waitcnt lgkmcnt(4)
    v_mfma_f32_16x16x32_bf16 v[24:27], a[0:3], v[72:75], 0
    v_mfma_f32_16x16x32_bf16 v[36:39], a[0:3], v[76:79], 0
    v_mfma_f32_16x16x32_bf16 v[28:31], a[4:7], v[72:75], 0
    v_mfma_f32_16x16x32_bf16 v[40:43], a[4:7], v[76:79], 0
    v_mfma_f32_16x16x32_bf16 v[32:35], a[8:11], v[72:75], 0
    v_mfma_f32_16x16x32_bf16 v[44:47], a[8:11], v[76:79], 0
    ds_read_b128 v[96:99], v16 offset:3072
    ds_read_b128 v[100:103], v16 offset:23552
    s_waitcnt lgkmcnt(4)
    v_mfma_f32_16x16x32_bf16 v[24:27], a[12:15], v[80:83], v[24:27]
    s_add_u32 m0, s64, 40960
    s_add_u32 s60, s72, 0
    buffer_load_dwordx4 v2, s[4:7], s60 offen offset:0 sc1 lds
    v_mfma_f32_16x16x32_bf16 v[36:39], a[12:15], v[84:87], v[36:39]
    v_mfma_f32_16x16x32_bf16 v[28:31], a[16:19], v[80:83], v[28:31]
    v_mfma_f32_16x16x32_bf16 v[40:43], a[16:19], v[84:87], v[40:43]
    v_mfma_f32_16x16x32_bf16 v[32:35], a[20:23], v[80:83], v[32:35]
    v_mfma_f32_16x16x32_bf16 v[44:47], a[20:23], v[84:87], v[44:47]
    ds_read_b128 v[72:75], v16 offset:4096
    ds_read_b128 v[76:79], v16 offset:24576
    s_waitcnt lgkmcnt(4)
    v_mfma_f32_16x16x32_bf16 v[24:27], a[24:27], v[88:91], v[24:27]
    buffer_load_dwordx4 v2, s[4:7], s60 offen offset:1024 sc1 lds
    v_mfma_f32_16x16x32_bf16 v[36:39], a[24:27], v[92:95], v[36:39]
    v_mfma_f32_16x16x32_bf16 v[28:31], a[28:31], v[88:91], v[28:31]
    v_mfma_f32_16x16x32_bf16 v[40:43], a[28:31], v[92:95], v[40:43]
    v_mfma_f32_16x16x32_bf16 v[32:35], a[32:35], v[88:91], v[32:35]
    v_mfma_f32_16x16x32_bf16 v[44:47], a[32:35], v[92:95], v[44:47]
    ds_read_b128 v[80:83], v16 offset:5120
    ds_read_b128 v[84:87], v16 offset:25600
    s_waitcnt lgkmcnt(4)
    v_mfma_f32_16x16x32_bf16 v[24:27], a[36:39], v[96:99], v[24:27]
    buffer_load_dwordx4 v2, s[4:7], s60 offen offset:2048 sc1 lds
    v_mfma_f32_16x16x32_bf16 v[36:39], a[36:39], v[100:103], v[36:39]
    v_mfma_f32_16x16x32_bf16 v[28:31], a[40:43], v[96:99], v[28:31]
    v_mfma_f32_16x16x32_bf16 v[40:43], a[40:43], v[100:103], v[40:43]
    v_mfma_f32_16x16x32_bf16 v[32:35], a[44:47], v[96:99], v[32:35]
    v_mfma_f32_16x16x32_bf16 v[44:47], a[44:47], v[100:103], v[44:47]
    ds_read_b128 v[88:91], v16 offset:6144
    ds_read_b128 v[92:95], v16 offset:26624
    s_waitcnt lgkmcnt(4)
    v_mfma_f32_16x16x32_bf16 v[24:27], a[48:51], v[72:75], v[24:27]
    buffer_load_dwordx4 v2, s[4:7], s60 offen offset:3072 sc1 lds
    v_mfma_f32_16x16x32_bf16 v[36:39], a[48:51], v[76:79], v[36:39]
    v_mfma_f32_16x16x32_bf16 v[28:31], a[52:55], v[72:75], v[28:31]
    v_mfma_f32_16x16x32_bf16 v[40:43], a[52:55], v[76:79], v[40:43]
    v_mfma_f32_16x16x32_bf16 v[32:35], a[56:59], v[72:75], v[32:35]
    v_mfma_f32_16x16x32_bf16 v[44:47], a[56:59], v[76:79], v[44:47]
    ds_read_b128 v[96:99], v16 offset:7168
    ds_read_b128 v[100:103], v16 offset:27648
    s_waitcnt lgkmcnt(4)
    v_mfma_f32_16x16x32_bf16 v[24:27], a[60:63], v[80:83], v[24:27]
    s_add_u32 m0, s64, 45056
    s_add_u32 s60, s72, 4096
    buffer_load_dwordx4 v2, s[4:7], s60 offen offset:0 sc1 lds
    v_mfma_f32_16x16x32_bf16 v[36:39], a[60:63], v[84:87], v[36:39]
    v_mfma_f32_16x16x32_bf16 v[28:31], a[64:67], v[80:83], v[28:31]
    v_mfma_f32_16x16x32_bf16 v[40:43], a[64:67], v[84:87], v[40:43]
    v_mfma_f32_16x16x32_bf16 v[32:35], a[68:71], v[80:83], v[32:35]
    v_mfma_f32_16x16x32_bf16 v[44:47], a[68:71], v[84:87], v[44:47]
    ds_read_b128 v[72:75], v16 offset:8192
    ds_read_b128 v[76:79], v16 offset:28672
    s_waitcnt lgkmcnt(4)
    v_mfma_f32_16x16x32_bf16 v[24:27], a[72:75], v[88:91], v[24:27]
    buffer_load_dwordx4 v2, s[4:7], s60 offen offset:1024 sc1 lds
    v_mfma_f32_16x16x32_bf16 v[36:39], a[72:75], v[92:95], v[36:39]
    v_mfma_f32_16x16x32_bf16 v[28:31], a[76:79], v[88:91], v[28:31]
    v_mfma_f32_16x16x32_bf16 v[40:43], a[76:79], v[92:95], v[40:43]
    v_mfma_f32_16x16x32_bf16 v[32:35], a[80:83], v[88:91], v[32:35]
    v_mfma_f32_16x16x32_bf16 v[44:47], a[80:83], v[92:95], v[44:47]
    ds_read_b128 v[80:83], v16 offset:9216
    ds_read_b128 v[84:87], v16 offset:29696
    s_waitcnt lgkmcnt(4)
    v_mfma_f32_16x16x32_bf16 v[24:27], a[84:87], v[96:99], v[24:27]
    buffer_load_dwordx4 v2, s[4:7], s60 offen offset:2048 sc1 lds
    v_mfma_f32_16x16x32_bf16 v[36:39], a[84:87], v[100:103], v[36:39]
    v_mfma_f32_16x16x32_bf16 v[28:31], a[88:91], v[96:99], v[28:31]
    v_mfma_f32_16x16x32_bf16 v[40:43], a[88:91], v[100:103], v[40:43]
    v_mfma_f32_16x16x32_bf16 v[32:35], a[92:95], v[96:99], v[32:35]
    v_mfma_f32_16x16x32_bf16 v[44:47], a[92:95], v[100:103], v[44:47]
    ds_read_b128 v[88:91], v16 offset:10240
    ds_read_b128 v[92:95], v16 offset:30720
    s_waitcnt lgkmcnt(4)
    v_mfma_f32_16x16x32_bf16 v[24:27], a[96:99], v[72:75], v[24:27]
    buffer_load_dwordx4 v2, s[4:7], s60 offen offset:3072 sc1 lds
    v_mfma_f32_16x16x32_bf16 v[36:39], a[96:99], v[76:79], v[36:39]
    v_mfma_f32_16x16x32_bf16 v[28:31], a[100:103], v[72:75], v[28:31]
    v_mfma_f32_16x16x32_bf16 v[40:43], a[100:103], v[76:79], v[40:43]
    v_mfma_f32_16x16x32_bf16 v[32:35], a[104:107], v[72:75], v[32:35]
    v_mfma_f32_16x16x32_bf16 v[44:47], a[104:107], v[76:79], v[44:47]
    ds_read_b128 v[96:99], v16 offset:11264
    ds_read_b128 v[100:103], v16 offset:31744
    s_waitcnt lgkmcnt(4)
    v_mfma_f32_16x16x32_bf16 v[24:27], a[108:111], v[80:83], v[24:27]
    s_add_u32 m0, s64, 49152
    s_add_u32 s60, s72, 8192
    buffer_load_dwordx4 v2, s[4:7], s60 offen offset:0 sc1 lds
    v_mfma_f32_16x16x32_bf16 v[36:39], a[108:111], v[84:87], v[36:39]
    v_mfma_f32_16x16x32_bf16 v[28:31], a[112:115], v[80:83], v[28:31]
    v_mfma_f32_16x16x32_bf16 v[40:43], a[112:115], v[84:87], v[40:43]
    v_mfma_f32_16x16x32_bf16 v[32:35], a[116:119], v[80:83], v[32:35]
    v_mfma_f32_16x16x32_bf16 v[44:47], a[116:119], v[84:87], v[44:47]
    ds_read_b128 v[72:75], v16 offset:12288
    ds_read_b128 v[76:79], v16 offset:32768
    s_waitcnt lgkmcnt(4)
    v_mfma_f32_16x16x32_bf16 v[24:27], a[120:123], v[88:91], v[24:27]
    buffer_load_dwordx4 v2, s[4:7], s60 offen offset:1024 sc1 lds
    s_add_u32 s72, s72, 40960
    v_mfma_f32_16x16x32_bf16 v[36:39], a[120:123], v[92:95], v[36:39]
    v_mfma_f32_16x16x32_bf16 v[28:31], a[124:127], v[88:91], v[28:31]
    v_mfma_f32_16x16x32_bf16 v[40:43], a[124:127], v[92:95], v[40:43]
    v_mfma_f32_16x16x32_bf16 v[32:35], a[128:131], v[88:91], v[32:35]
    v_mfma_f32_16x16x32_bf16 v[44:47], a[128:131], v[92:95], v[44:47]
    ds_read_b128 v[80:83], v16 offset:13312
    ds_read_b128 v[84:87], v16 offset:33792
    s_waitcnt lgkmcnt(4)
    v_mfma_f32_16x16x32_bf16 v[24:27], a[132:135], v[96:99], v[24:27]
    v_mfma_f32_16x16x32_bf16 v[36:39], a[132:135], v[100:103], v[36:39]
    v_mov_b32 v4, s25
    v_mfma_f32_16x16x32_bf16 v[28:31], a[136:139], v[96:99], v[28:31]
    v_mfma_f32_16x16x32_bf16 v[40:43], a[136:139], v[100:103], v[40:43]
    v_mfma_f32_16x16x32_bf16 v[32:35], a[140:143], v[96:99], v[32:35]
    v_mfma_f32_16x16x32_bf16 v[44:47], a[140:143], v[100:103], v[44:47]
    ds_read_b128 v[88:91], v16 offset:14336
    ds_read_b128 v[92:95], v16 offset:34816
    s_waitcnt lgkmcnt(4)
    v_mfma_f32_16x16x32_bf16 v[24:27], a[144:147], v[72:75], v[24:27]
    v_mfma_f32_16x16x32_bf16 v[36:39], a[144:147], v[76:79], v[36:39]
    v_mfma_f32_16x16x32_bf16 v[28:31], a[148:151], v[72:75], v[28:31]
    v_mfma_f32_16x16x32_bf16 v[40:43], a[148:151], v[76:79], v[40:43]
    v_mfma_f32_16x16x32_bf16 v[32:35], a[152:155], v[72:75], v[32:35]
    v_mfma_f32_16x16x32_bf16 v[44:47], a[152:155], v[76:79], v[44:47]
    ds_read_b128 v[96:99], v16 offset:15360
    ds_read_b128 v[100:103], v16 offset:35840
    s_waitcnt lgkmcnt(4)
    v_mfma_f32_16x16x32_bf16 v[24:27], a[156:159], v[80:83], v[24:27]
    v_mfma_f32_16x16x32_bf16 v[36:39], a[156:159], v[84:87], v[36:39]
    v_mfma_f32_16x16x32_bf16 v[28:31], a[160:163], v[80:83], v[28:31]
    v_mfma_f32_16x16x32_bf16 v[40:43], a[160:163], v[84:87], v[40:43]
    v_mfma_f32_16x16x32_bf16 v[32:35], a[164:167], v[80:83], v[32:35]
    v_mfma_f32_16x16x32_bf16 v[44:47], a[164:167], v[84:87], v[44:47]
    ds_read_b128 v[72:75], v16 offset:16384
    ds_read_b128 v[76:79], v16 offset:36864
    s_waitcnt lgkmcnt(4)
    v_mfma_f32_16x16x32_bf16 v[24:27], a[168:171], v[88:91], v[24:27]
    v_mfma_f32_16x16x32_bf16 v[36:39], a[168:171], v[92:95], v[36:39]
    v_mfma_f32_16x16x32_bf16 v[28:31], a[172:175], v[88:91], v[28:31]
    v_mfma_f32_16x16x32_bf16 v[40:43], a[172:175], v[92:95], v[40:43]
    v_mfma_f32_16x16x32_bf16 v[32:35], a[176:179], v[88:91], v[32:35]
    v_mfma_f32_16x16x32_bf16 v[44:47], a[176:179], v[92:95], v[44:47]
    ds_read_b128 v[80:83], v16 offset:17408
    ds_read_b128 v[84:87], v16 offset:37888
    s_waitcnt lgkmcnt(4)
    v_mfma_f32_16x16x32_bf16 v[24:27], a[180:183], v[96:99], v[24:27]
    v_mfma_f32_16x16x32_bf16 v[36:39], a[180:183], v[100:103], v[36:39]
    v_mfma_f32_16x16x32_bf16 v[28:31], a[184:187], v[96:99], v[28:31]
    v_mfma_f32_16x16x32_bf16 v[40:43], a[184:187], v[100:103], v[40:43]
    v_mfma_f32_16x16x32_bf16 v[32:35], a[188:191], v[96:99], v[32:35]
    v_mfma_f32_16x16x32_bf16 v[44:47], a[188:191], v[100:103], v[44:47]
    ds_read_b128 v[88:91], v16 offset:18432
    ds_read_b128 v[92:95], v16 offset:38912
    s_waitcnt lgkmcnt(4)
    v_mfma_f32_16x16x32_bf16 v[24:27], a[192:195], v[72:75], v[24:27]
    v_mfma_f32_16x16x32_bf16 v[36:39], a[192:195], v[76:79], v[36:39]
    v_mfma_f32_16x16x32_bf16 v[28:31], a[196:199], v[72:75], v[28:31]
    v_mfma_f32_16x16x32_bf16 v[40:43], a[196:199], v[76:79], v[40:43]
    v_mfma_f32_16x16x32_bf16 v[32:35], a[200:203], v[72:75], v[32:35]
    v_mfma_f32_16x16x32_bf16 v[44:47], a[200:203], v[76:79], v[44:47]
    ds_read_b128 v[96:99], v16 offset:19456
    ds_read_b128 v[100:103], v16 offset:39936
    s_waitcnt lgkmcnt(4)
    v_mfma_f32_16x16x32_bf16 v[24:27], a[204:207], v[80:83], v[24:27]
    v_mfma_f32_16x16x32_bf16 v[36:39], a[204:207], v[84:87], v[36:39]
    v_mfma_f32_16x16x32_bf16 v[28:31], a[208:211], v[80:83], v[28:31]
    v_mfma_f32_16x16x32_bf16 v[40:43], a[208:211], v[84:87], v[40:43]
    v_mfma_f32_16x16x32_bf16 v[32:35], a[212:215], v[80:83], v[32:35]
    s_waitcnt vmcnt(0) lgkmcnt(0)
    s_barrier
    buffer_store_dword v4, v19, s[4:7], s62 offen sc1
    s_cmp_lt_u32 s25, s66
    s_cbranch_scc0 Lr_12
Lr_12b:
    v_mfma_f32_16x16x32_bf16 v[44:47], a[212:215], v[84:87], v[44:47]
    ds_read_b128 v[72:75], v17 offset:0
    ds_read_b128 v[76:79], v17 offset:20480
    s_waitcnt lgkmcnt(4)
    v_mfma_f32_16x16x32_bf16 v[24:27], a[216:219], v[88:91], v[24:27]
    v_mfma_f32_16x16x32_bf16 v[36:39], a[216:219], v[92:95], v[36:39]
    v_mfma_f32_16x16x32_bf16 v[28:31], a[220:223], v[88:91], v[28:31]
    v_mfma_f32_16x16x32_bf16 v[40:43], a[220:223], v[92:95], v[40:43]
    v_mfma_f32_16x16x32_bf16 v[32:35], a[224:227], v[88:91], v[32:35]
    v_mfma_f32_16x16x32_bf16 v[44:47], a[224:227], v[92:95], v[44:47]
    ds_read_b128 v[80:83], v17 offset:1024
    ds_read_b128 v[84:87], v17 offset:21504
    s_waitcnt lgkmcnt(4)
    v_mfma_f32_16x16x32_bf16 v[24:27], a[228:231], v[96:99], v[24:27]
    v_mfma_f32_16x16x32_bf16 v[36:39], a[228:231], v[100:103], v[36:39]
    v_mfma_f32_16x16x32_bf16 v[28:31], a[232:235], v[96:99], v[28:31]
    v_mfma_f32_16x16x32_bf16 v[40:43], a[232:235], v[100:103], v[40:43]
    v_mfma_f32_16x16x32_bf16 v[32:35], a[236:239], v[96:99], v[32:35]
    v_mfma_f32_16x16x32_bf16 v[44:47], a[236:239], v[100:103], v[44:47]
    s_add_u32 s25, s25, 1
    s_nop 1
    v_cvt_pk_bf16_f32 v104, v24, v25
    v_cvt_pk_bf16_f32 v105, v26, v27
    v_cvt_pk_bf16_f32 v106, v28, v29
    v_cvt_pk_bf16_f32 v107, v30, v31
    v_cvt_pk_bf16_f32 v108, v32, v33
    v_cvt_pk_bf16_f32 v109, v34, v35
    v_cvt_pk_bf16_f32 v110, v36, v37
    v_cvt_pk_bf16_f32 v111, v38, v39
    v_cvt_pk_bf16_f32 v112, v40, v41
    v_cvt_pk_bf16_f32 v113, v42, v43
    v_cvt_pk_bf16_f32 v114, v44, v45
    v_cvt_pk_bf16_f32 v115, v46, v47
    buffer_store_dwordx4 v[104:107], v2, s[4:7], s73 offen offset:0 sc1
    buffer_store_dwordx2 v[108:109], v18, s[4:7], s73 offen offset:1024 sc1
    buffer_store_dwordx4 v[110:113], v2, s[4:7], s73 offen offset:1536 sc1
    buffer_store_dwordx2 v[114:115], v18, s[4:7], s73 offen offset:2560 sc1
    s_add_u32 s73, s73, 524288
    s_bitset0_b32 s73, s65
    ds_read_b128 v[88:91], v17 offset:2048
    ds_read_b128 v[92:95], v17 offset:22528
    s_waitcnt lgkmcnt(4)
    v_mfma_f32_16x16x32_bf16 v[48:51], a[0:3], v[72:75], 0
    v_mfma_f32_16x16x32_bf16 v[60:63], a[0:3], v[76:79], 0
    v_mov_b32 v4, s25
    v_mfma_f32_16x16x32_bf16 v[52:55], a[4:7], v[72:75], 0
    v_mfma_f32_16x16x32_bf16 v[64:67], a[4:7], v[76:79], 0
    s_waitcnt vmcnt(0)
    buffer_store_dword v4, v19, s[4:7], s62 offen sc1
    v_mfma_f32_16x16x32_bf16 v[56:59], a[8:11], v[72:75], 0
    v_mfma_f32_16x16x32_bf16 v[68:71], a[8:11], v[76:79], 0
    ds_read_b128 v[96:99], v17 offset:3072
    ds_read_b128 v[100:103], v17 offset:23552
    s_waitcnt lgkmcnt(4)
    v_mfma_f32_16x16x32_bf16 v[48:51], a[12:15], v[80:83], v[48:51]
    s_add_u32 m0, s64, 0
    s_add_u32 s60, s72, 0
    buffer_load_dwordx4 v2, s[4:7], s60 offen offset:0 sc1 lds
    v_mfma_f32_16x16x32_bf16 v[60:63], a[12:15], v[84:87], v[60:63]
    v_mfma_f32_16x16x32_bf16 v[52:55], a[16:19], v[80:83], v[52:55]
    v_mfma_f32_16x16x32_bf16 v[64:67], a[16:19], v[84:87], v[64:67]
    v_mfma_f32_16x16x32_bf16 v[56:59], a[20:23], v[80:83], v[56:59]
    v_mfma_f32_16x16x32_bf16 v[68:71], a[20:23], v[84:87], v[68:71]
    ds_read_b128 v[72:75], v17 offset:4096
    ds_read_b128 v[76:79], v17 offset:24576
    s_waitcnt lgkmcnt(4)
    v_mfma_f32_16x16x32_bf16 v[48:51], a[24:27], v[88:91], v[48:51]
    buffer_load_dwordx4 v2, s[4:7], s60 offen offset:1024 sc1 lds
    v_mfma_f32_16x16x32_bf16 v[60:63], a[24:27], v[92:95], v[60:63]
    v_mfma_f32_16x16x32_bf16 v[52:55], a[28:31], v[88:91], v[52:55]
    v_mfma_f32_16x16x32_bf16 v[64:67], a[28:31], v[92:95], v[64:67]
    v_mfma_f32_16x16x32_bf16 v[56:59], a[32:35], v[88:91], v[56:59]
    v_mfma_f32_16x16x32_bf16 v[68:71], a[32:35], v[92:95], v[68:71]
    ds_read_b128 v[80:83], v17 offset:5120
    ds_read_b128 v[84:87], v17 offset:25600
    s_waitcnt lgkmcnt(4)
    v_mfma_f32_16x16x32_bf16 v[48:51], a[36:39], v[96:99], v[48:51]
    buffer_load_dwordx4 v2, s[4:7], s60 offen offset:2048 sc1 lds
    v_mfma_f32_16x16x32_bf16 v[60:63], a[36:39], v[100:103], v[60:63]
    v_mfma_f32_16x16x32_bf16 v[52:55], a[40:43], v[96:99], v[52:55]
    v_mfma_f32_16x16x32_bf16 v[64:67], a[40:43], v[100:103], v[64:67]
    v_mfma_f32_16x16x32_bf16 v[56:59], a[44:47], v[96:99], v[56:59]
    v_mfma_f32_16x16x32_bf16 v[68:71], a[44:47], v[100:103], v[68:71]
    ds_read_b128 v[88:91], v17 offset:6144
    ds_read_b128 v[92:95], v17 offset:26624
    s_waitcnt lgkmcnt(4)
    v_mfma_f32_16x16x32_bf16 v[48:51], a[48:51], v[72:75], v[48:51]
    buffer_load_dwordx4 v2, s[4:7], s60 offen offset:3072 sc1 lds
    v_mfma_f32_16x16x32_bf16 v[60:63], a[48:51], v[76:79], v[60:63]
    v_mfma_f32_16x16x32_bf16 v[52:55], a[52:55], v[72:75], v[52:55]
    v_mfma_f32_16x16x32_bf16 v[64:67], a[52:55], v[76:79], v[64:67]
    v_mfma_f32_16x16x32_bf16 v[56:59], a[56:59], v[72:75], v[56:59]
    v_mfma_f32_16x16x32_bf16 v[68:71], a[56:59], v[76:79], v[68:71]
    ds_read_b128 v[96:99], v17 offset:7168
    ds_read_b128 v[100:103], v17 offset:27648
    s_waitcnt lgkmcnt(4)
    v_mfma_f32_16x16x32_bf16 v[48:51], a[60:63], v[80:83], v[48:51]
    s_add_u32 m0, s64, 4096
    s_add_u32 s60, s72, 4096
    buffer_load_dwordx4 v2, s[4:7], s60 offen offset:0 sc1 lds
    v_mfma_f32_16x16x32_bf16 v[60:63], a[60:63], v[84:87], v[60:63]
    v_mfma_f32_16x16x32_bf16 v[52:55], a[64:67], v[80:83], v[52:55]
    v_mfma_f32_16x16x32_bf16 v[64:67], a[64:67], v[84:87], v[64:67]
    v_mfma_f32_16x16x32_bf16 v[56:59], a[68:71], v[80:83], v[56:59]
    v_mfma_f32_16x16x32_bf16 v[68:71], a[68:71], v[84:87], v[68:71]
    ds_read_b128 v[72:75], v17 offset:8192
    ds_read_b128 v[76:79], v17 offset:28672
    s_waitcnt lgkmcnt(4)
    v_mfma_f32_16x16x32_bf16 v[48:51], a[72:75], v[88:91], v[48:51]
    buffer_load_dwordx4 v2, s[4:7], s60 offen offset:1024 sc1 lds
    v_mfma_f32_16x16x32_bf16 v[60:63], a[72:75], v[92:95], v[60:63]
    v_mfma_f32_16x16x32_bf16 v[52:55], a[76:79], v[88:91], v[52:55]
    v_mfma_f32_16x16x32_bf16 v[64:67], a[76:79], v[92:95], v[64:67]
    v_mfma_f32_16x16x32_bf16 v[56:59], a[80:83], v[88:91], v[56:59]
    v_mfma_f32_16x16x32_bf16 v[68:71], a[80:83], v[92:95], v[68:71]
    ds_read_b128 v[80:83], v17 offset:9216
    ds_read_b128 v[84:87], v17 offset:29696
    s_waitcnt lgkmcnt(4)
    v_mfma_f32_16x16x32_bf16 v[48:51], a[84:87], v[96:99], v[48:51]
    buffer_load_dwordx4 v2, s[4:7], s60 offen offset:2048 sc1 lds
    v_mfma_f32_16x16x32_bf16 v[60:63], a[84:87], v[100:103], v[60:63]
    v_mfma_f32_16x16x32_bf16 v[52:55], a[88:91], v[96:99], v[52:55]
    v_mfma_f32_16x16x32_bf16 v[64:67], a[88:91], v[100:103], v[64:67]
    v_mfma_f32_16x16x32_bf16 v[56:59], a[92:95], v[96:99], v[56:59]
    v_mfma_f32_16x16x32_bf16 v[68:71], a[92:95], v[100:103], v[68:71]
    ds_read_b128 v[88:91], v17 offset:10240
    ds_read_b128 v[92:95], v17 offset:30720
    s_waitcnt lgkmcnt(4)
    v_mfma_f32_16x16x32_bf16 v[48:51], a[96:99], v[72:75], v[48:51]
    buffer_load_dwordx4 v2, s[4:7], s60 offen offset:3072 sc1 lds
    v_mfma_f32_16x16x32_bf16 v[60:63], a[96:99], v[76:79], v[60:63]
    v_mfma_f32_16x16x32_bf16 v[52:55], a[100:103], v[72:75], v[52:55]
    v_mfma_f32_16x16x32_bf16 v[64:67], a[100:103], v[76:79], v[64:67]
    v_mfma_f32_16x16x32_bf16 v[56:59], a[104:107], v[72:75], v[56:59]
    v_mfma_f32_16x16x32_bf16 v[68:71], a[104:107], v[76:79], v[68:71]
    ds_read_b128 v[96:99], v17 offset:11264
    ds_read_b128 v[100:103], v17 offset:31744
    s_waitcnt lgkmcnt(4)
    v_mfma_f32_16x16x32_bf16 v[48:51], a[108:111], v[80:83], v[48:51]
    s_add_u32 m0, s64, 8192
    s_add_u32 s60, s72, 8192
    buffer_load_dwordx4 v2, s[4:7], s60 offen offset:0 sc1 lds
    v_mfma_f32_16x16x32_bf16 v[60:63], a[108:111], v[84:87], v[60:63]
    v_mfma_f32_16x16x32_bf16 v[52:55], a[112:115], v[80:83], v[52:55]
    v_mfma_f32_16x16x32_bf16 v[64:67], a[112:115], v[84:87], v[64:67]
    v_mfma_f32_16x16x32_bf16 v[56:59], a[116:119], v[80:83], v[56:59]
    v_mfma_f32_16x16x32_bf16 v[68:71], a[116:119], v[84:87], v[68:71]
    ds_read_b128 v[72:75], v17 offset:12288
    ds_read_b128 v[76:79], v17 offset:32768
    s_waitcnt lgkmcnt(4)
    v_mfma_f32_16x16x32_bf16 v[48:51], a[120:123], v[88:91], v[48:51]
    buffer_load_dwordx4 v2, s[4:7], s60 offen offset:1024 sc1 lds
    s_add_u32 s72, s72, 40960
    v_mfma_f32_16x16x32_bf16 v[60:63], a[120:123], v[92:95], v[60:63]
    v_mfma_f32_16x16x32_bf16 v[52:55], a[124:127], v[88:91], v[52:55]
    v_mfma_f32_16x16x32_bf16 v[64:67], a[124:127], v[92:95], v[64:67]
    v_mfma_f32_16x16x32_bf16 v[56:59], a[128:131], v[88:91], v[56:59]
    v_mfma_f32_16x16x32_bf16 v[68:71], a[128:131], v[92:95], v[68:71]
    ds_read_b128 v[80:83], v17 offset:13312
    ds_read_b128 v[84:87], v17 offset:33792
    s_waitcnt lgkmcnt(4)
    v_mfma_f32_16x16x32_bf16 v[48:51], a[132:135], v[96:99], v[48:51]
    v_mfma_f32_16x16x32_bf16 v[60:63], a[132:135], v[100:103], v[60:63]
    v_mfma_f32_16x16x32_bf16 v[52:55], a[136:139], v[96:99], v[52:55]
    v_mfma_f32_16x16x32_bf16 v[64:67], a[136:139], v[100:103], v[64:67]
    v_mfma_f32_16x16x32_bf16 v[56:59], a[140:143], v[96:99], v[56:59]
    v_mfma_f32_16x16x32_bf16 v[68:71], a[140:143], v[100:103], v[68:71]
    ds_read_b128 v[88:91], v17 offset:14336
    ds_read_b128 v[92:95], v17 offset:34816
    s_waitcnt lgkmcnt(4)
    v_mfma_f32_16x16x32_bf16 v[48:51], a[144:147], v[72:75], v[48:51]
    v_mfma_f32_16x16x32_bf16 v[60:63], a[144:147], v[76:79], v[60:63]
    v_mfma_f32_16x16x32_bf16 v[52:55], a[148:151], v[72:75], v[52:55]
    v_mfma_f32_16x16x32_bf16 v[64:67], a[148:151], v[76:79], v[64:67]
    v_mfma_f32_16x16x32_bf16 v[56:59], a[152:155], v[72:75], v[56:59]
    v_mfma_f32_16x16x32_bf16 v[68:71], a[152:155], v[76:79], v[68:71]
    ds_read_b128 v[96:99], v17 offset:15360
    ds_read_b128 v[100:103], v17 offset:35840
    s_waitcnt lgkmcnt(4)
    v_mfma_f32_16x16x32_bf16 v[48:51], a[156:159], v[80:83], v[48:51]
    v_mfma_f32_16x16x32_bf16 v[60:63], a[156:159], v[84:87], v[60:63]
    v_mfma_f32_16x16x32_bf16 v[52:55], a[160:163], v[80:83], v[52:55]
    v_mfma_f32_16x16x32_bf16 v[64:67], a[160:163], v[84:87], v[64:67]
    v_mfma_f32_16x16x32_bf16 v[56:59], a[164:167], v[80:83], v[56:59]
    v_mfma_f32_16x16x32_bf16 v[68:71], a[164:167], v[84:87], v[68:71]
    ds_read_b128 v[72:75], v17 offset:16384
    ds_read_b128 v[76:79], v17 offset:36864
    s_waitcnt lgkmcnt(4)
    v_mfma_f32_16x16x32_bf16 v[48:51], a[168:171], v[88:91], v[48:51]
    v_mfma_f32_16x16x32_bf16 v[60:63], a[168:171], v[92:95], v[60:63]
    v_mfma_f32_16x16x32_bf16 v[52:55], a[172:175], v[88:91], v[52:55]
    v_mfma_f32_16x16x32_bf16 v[64:67], a[172:175], v[92:95], v[64:67]
    v_mfma_f32_16x16x32_bf16 v[56:59], a[176:179], v[88:91], v[56:59]
    v_mfma_f32_16x16x32_bf16 v[68:71], a[176:179], v[92:95], v[68:71]
    ds_read_b128 v[80:83], v17 offset:17408
    ds_read_b128 v[84:87], v17 offset:37888
    s_waitcnt lgkmcnt(4)
    v_mfma_f32_16x16x32_bf16 v[48:51], a[180:183], v[96:99], v[48:51]
    v_mfma_f32_16x16x32_bf16 v[60:63], a[180:183], v[100:103], v[60:63]
    v_mfma_f32_16x16x32_bf16 v[52:55], a[184:187], v[96:99], v[52:55]
    v_mfma_f32_16x16x32_bf16 v[64:67], a[184:187], v[100:103], v[64:67]
    v_mfma_f32_16x16x32_bf16 v[56:59], a[188:191], v[96:99], v[56:59]
    v_mfma_f32_16x16x32_bf16 v[68:71], a[188:191], v[100:103], v[68:71]
    ds_read_b128 v[88:91], v17 offset:18432
    ds_read_b128 v[92:95], v17 offset:38912
    s_waitcnt lgkmcnt(4)
    v_mfma_f32_16x16x32_bf16 v[48:51], a[192:195], v[72:75], v[48:51]
    v_mfma_f32_16x16x32_bf16 v[60:63], a[192:195], v[76:79], v[60:63]
    v_mfma_f32_16x16x32_bf16 v[52:55], a[196:199], v[72:75], v[52:55]
    v_mfma_f32_16x16x32_bf16 v[64:67], a[196:199], v[76:79], v[64:67]
    v_mfma_f32_16x16x32_bf16 v[56:59], a[200:203], v[72:75], v[56:59]
    v_mfma_f32_16x16x32_bf16 v[68:71], a[200:203], v[76:79], v[68:71]
    ds_read_b128 v[96:99], v17 offset:19456
    ds_read_b128 v[100:103], v17 offset:39936
    s_waitcnt lgkmcnt(4)
    v_mfma_f32_16x16x32_bf16 v[48:51], a[204:207], v[80:83], v[48:51]
    v_mfma_f32_16x16x32_bf16 v[60:63], a[204:207], v[84:87], v[60:63]
    v_mfma_f32_16x16x32_bf16 v[52:55], a[208:211], v[80:83], v[52:55]
    v_mfma_f32_16x16x32_bf16 v[64:67], a[208:211], v[84:87], v[64:67]
    v_mfma_f32_16x16x32_bf16 v[56:59], a[212:215], v[80:83], v[56:59]
    s_waitcnt vmcnt(0) lgkmcnt(0)
    s_barrier
    buffer_store_dword v4, v19, s[4:7], s62 offen sc1
    s_cmp_lt_u32 s25, s66
    s_cbranch_scc0 Lr_13
Lr_13b:
    v_mfma_f32_16x16x32_bf16 v[68:71], a[212:215], v[84:87], v[68:71]
    ds_read_b128 v[72:75], v16 offset:0
    ds_read_b128 v[76:79], v16 offset:20480
    s_waitcnt lgkmcnt(4)
    v_mfma_f32_16x16x32_bf16 v[48:51], a[216:219], v[88:91], v[48:51]
    v_mfma_f32_16x16x32_bf16 v[60:63], a[216:219], v[92:95], v[60:63]
    v_mfma_f32_16x16x32_bf16 v[52:55], a[220:223], v[88:91], v[52:55]
    v_mfma_f32_16x16x32_bf16 v[64:67], a[220:223], v[92:95], v[64:67]
    v_mfma_f32_16x16x32_bf16 v[56:59], a[224:227], v[88:91], v[56:59]
    v_mfma_f32_16x16x32_bf16 v[68:71], a[224:227], v[92:95], v[68:71]
    ds_read_b128 v[80:83], v16 offset:1024
    ds_read_b128 v[84:87], v16 offset:21504
    s_waitcnt lgkmcnt(4)
    v_mfma_f32_16x16x32_bf16 v[48:51], a[228:231], v[96:99], v[48:51]
    v_mfma_f32_16x16x32_bf16 v[60:63], a[228:231], v[100:103], v[60:63]
    v_mfma_f32_16x16x32_bf16 v[52:55], a[232:235], v[96:99], v[52:55]
    v_mfma_f32_16x16x32_bf16 v[64:67], a[232:235], v[100:103], v[64:67]
    v_mfma_f32_16x16x32_bf16 v[56:59], a[236:239], v[96:99], v[56:59]
    v_mfma_f32_16x16x32_bf16 v[68:71], a[236:239], v[100:103], v[68:71]
    s_add_u32 s25, s25, 1
L_loop_G:
    ds_read_b128 v[88:91], v16 offset:2048
    ds_read_b128 v[92:95], v16 offset:22528
    s_waitcnt lgkmcnt(4)
    v_mfma_f32_16x16x32_bf16 v[24:27], a[0:3], v[72:75], 0
    v_mfma_f32_16x16x32_bf16 v[36:39], a[0:3], v[76:79], 0
    v_mfma_f32_16x16x32_bf16 v[28:31], a[4:7], v[72:75], 0
    v_mfma_f32_16x16x32_bf16 v[40:43], a[4:7], v[76:79], 0
    v_mfma_f32_16x16x32_bf16 v[32:35], a[8:11], v[72:75], 0
    v_mfma_f32_16x16x32_bf16 v[44:47], a[8:11], v[76:79], 0
    ds_read_b128 v[96:99], v16 offset:3072
    ds_read_b128 v[100:103], v16 offset:23552
    s_waitcnt lgkmcnt(4)
    v_mfma_f32_16x16x32_bf16 v[24:27], a[12:15], v[80:83], v[24:27]
    s_add_u32 m0, s64, 40960
    s_add_u32 s60, s72, 0
    buffer_load_dwordx4 v2, s[4:7], s60 offen offset:0 sc1 lds
    v_mfma_f32_16x16x32_bf16 v[36:39], a[12:15], v[84:87], v[36:39]
    v_cvt_pk_bf16_f32 v104, v48, v49
    v_mfma_f32_16x16x32_bf16 v[28:31], a[16:19], v[80:83], v[28:31]
    v_cvt_pk_bf16_f32 v105, v50, v51
    v_mfma_f32_16x16x32_bf16 v[40:43], a[16:19], v[84:87], v[40:43]
    v_cvt_pk_bf16_f32 v106, v52, v53
    v_mfma_f32_16x16x32_bf16 v[32:35], a[20:23], v[80:83], v[32:35]
    v_cvt_pk_bf16_f32 v107, v54, v55
    v_mfma_f32_16x16x32_bf16 v[44:47], a[20:23], v[84:87], v[44:47]
    ds_read_b128 v[72:75], v16 offset:4096
    ds_read_b128 v[76:79], v16 offset:24576
    s_waitcnt lgkmcnt(4)
    v_mfma_f32_16x16x32_bf16 v[24:27], a[24:27], v[88:91], v[24:27]
    buffer_load_dwordx4 v2, s[4:7], s60 offen offset:1024 sc1 lds
    v_mfma_f32_16x16x32_bf16 v[36:39], a[24:27], v[92:95], v[36:39]
    v_cvt_pk_bf16_f32 v108, v56, v57
    v_mfma_f32_16x16x32_bf16 v[28:31], a[28:31], v[88:91], v[28:31]
    v_cvt_pk_bf16_f32 v109, v58, v59
    v_mfma_f32_16x16x32_bf16 v[40:43], a[28:31], v[92:95], v[40:43]
    v_cvt_pk_bf16_f32 v110, v60, v61
    v_mfma_f32_16x16x32_bf16 v[32:35], a[32:35], v[88:91], v[32:35]
    v_cvt_pk_bf16_f32 v111, v62, v63
    v_mfma_f32_16x16x32_bf16 v[44:47], a[32:35], v[92:95], v[44:47]
    ds_read_b128 v[80:83], v16 offset:5120
    ds_read_b128 v[84:87], v16 offset:25600
    s_waitcnt lgkmcnt(4)
    v_mfma_f32_16x16x32_bf16 v[24:27], a[36:39], v[96:99], v[24:27]
    buffer_load_dwordx4 v2, s[4:7], s60 offen offset:2048 sc1 lds
    v_mfma_f32_16x16x32_bf16 v[36:39], a[36:39], v[100:103], v[36:39]
    v_cvt_pk_bf16_f32 v112, v64, v65
    v_mfma_f32_16x16x32_bf16 v[28:31], a[40:43], v[96:99], v[28:31]
    v_cvt_pk_bf16_f32 v113, v66, v67
    v_mfma_f32_16x16x32_bf16 v[40:43], a[40:43], v[100:103], v[40:43]
    v_cvt_pk_bf16_f32 v114, v68, v69
    v_mfma_f32_16x16x32_bf16 v[32:35], a[44:47], v[96:99], v[32:35]
    v_cvt_pk_bf16_f32 v115, v70, v71
    v_mfma_f32_16x16x32_bf16 v[44:47], a[44:47], v[100:103], v[44:47]
    ds_read_b128 v[88:91], v16 offset:6144
    ds_read_b128 v[92:95], v16 offset:26624
    s_waitcnt lgkmcnt(4)
    v_mfma_f32_16x16x32_bf16 v[24:27], a[48:51], v[72:75], v[24:27]
    buffer_load_dwordx4 v2, s[4:7], s60 offen offset:3072 sc1 lds
    v_mfma_f32_16x16x32_bf16 v[36:39], a[48:51], v[76:79], v[36:39]
    v_mfma_f32_16x16x32_bf16 v[28:31], a[52:55], v[72:75], v[28:31]
    buffer_store_dwordx4 v[104:107], v2, s[4:7], s73 offen offset:0 sc1
    v_mfma_f32_16x16x32_bf16 v[40:43], a[52:55], v[76:79], v[40:43]
    v_mfma_f32_16x16x32_bf16 v[32:35], a[56:59], v[72:75], v[32:35]
    buffer_store_dwordx2 v[108:109], v18, s[4:7], s73 offen offset:1024 sc1
    v_mfma_f32_16x16x32_bf16 v[44:47], a[56:59], v[76:79], v[44:47]
    ds_read_b128 v[96:99], v16 offset:7168
    ds_read_b128 v[100:103], v16 offset:27648
    s_waitcnt lgkmcnt(4)
    v_mfma_f32_16x16x32_bf16 v[24:27], a[60:63], v[80:83], v[24:27]
    s_add_u32 m0, s64, 45056
    s_add_u32 s60, s72, 4096
    buffer_load_dwordx4 v2, s[4:7], s60 offen offset:0 sc1 lds
    v_mfma_f32_16x16x32_bf16 v[36:39], a[60:63], v[84:87], v[36:39]
    v_mfma_f32_16x16x32_bf16 v[28:31], a[64:67], v[80:83], v[28:31]
    buffer_store_dwordx4 v[110:113], v2, s[4:7], s73 offen offset:1536 sc1
    v_mfma_f32_16x16x32_bf16 v[40:43], a[64:67], v[84:87], v[40:43]
    v_mfma_f32_16x16x32_bf16 v[32:35], a[68:71], v[80:83], v[32:35]
    buffer_store_dwordx2 v[114:115], v18, s[4:7], s73 offen offset:2560 sc1
    v_mfma_f32_16x16x32_bf16 v[44:47], a[68:71], v[84:87], v[44:47]
    ds_read_b128 v[72:75], v16 offset:8192
    ds_read_b128 v[76:79], v16 offset:28672
    s_waitcnt lgkmcnt(4)
    v_mfma_f32_16x16x32_bf16 v[24:27], a[72:75], v[88:91], v[24:27]
    buffer_load_dwordx4 v2, s[4:7], s60 offen offset:1024 sc1 lds
    v_mfma_f32_16x16x32_bf16 v[36:39], a[72:75], v[92:95], v[36:39]
    v_mfma_f32_16x16x32_bf16 v[28:31], a[76:79], v[88:91], v[28:31]
    s_add_u32 s73, s73, 524288
    s_bitset0_b32 s73, s65
    v_mfma_f32_16x16x32_bf16 v[40:43], a[76:79], v[92:95], v[40:43]
    v_mfma_f32_16x16x32_bf16 v[32:35], a[80:83], v[88:91], v[32:35]
    v_mfma_f32_16x16x32_bf16 v[44:47], a[80:83], v[92:95], v[44:47]
    ds_read_b128 v[80:83], v16 offset:9216
    ds_read_b128 v[84:87], v16 offset:29696
    s_waitcnt lgkmcnt(4)
    v_mfma_f32_16x16x32_bf16 v[24:27], a[84:87], v[96:99], v[24:27]
    buffer_load_dwordx4 v2, s[4:7], s60 offen offset:2048 sc1 lds
    v_mfma_f32_16x16x32_bf16 v[36:39], a[84:87], v[100:103], v[36:39]
    v_mfma_f32_16x16x32_bf16 v[28:31], a[88:91], v[96:99], v[28:31]
    v_mfma_f32_16x16x32_bf16 v[40:43], a[88:91], v[100:103], v[40:43]
    v_mfma_f32_16x16x32_bf16 v[32:35], a[92:95], v[96:99], v[32:35]
    v_mfma_f32_16x16x32_bf16 v[44:47], a[92:95], v[100:103], v[44:47]
    ds_read_b128 v[88:91], v16 offset:10240
    ds_read_b128 v[92:95], v16 offset:30720
    s_waitcnt lgkmcnt(4)
    v_mfma_f32_16x16x32_bf16 v[24:27], a[96:99], v[72:75], v[24:27]
    buffer_load_dwordx4 v2, s[4:7], s60 offen offset:3072 sc1 lds
    v_mfma_f32_16x16x32_bf16 v[36:39], a[96:99], v[76:79], v[36:39]
    v_mfma_f32_16x16x32_bf16 v[28:31], a[100:103], v[72:75], v[28:31]
    v_mfma_f32_16x16x32_bf16 v[40:43], a[100:103], v[76:79], v[40:43]
    v_mfma_f32_16x16x32_bf16 v[32:35], a[104:107], v[72:75], v[32:35]
    v_mfma_f32_16x16x32_bf16 v[44:47], a[104:107], v[76:79], v[44:47]
    ds_read_b128 v[96:99], v16 offset:11264
    ds_read_b128 v[100:103], v16 offset:31744
    s_waitcnt lgkmcnt(4)
    v_mfma_f32_16x16x32_bf16 v[24:27], a[108:111], v[80:83], v[24:27]
    s_add_u32 m0, s64, 49152
    s_add_u32 s60, s72, 8192
    buffer_load_dwordx4 v2, s[4:7], s60 offen offset:0 sc1 lds
    v_mfma_f32_16x16x32_bf16 v[36:39], a[108:111], v[84:87], v[36:39]
    v_mfma_f32_16x16x32_bf16 v[28:31], a[112:115], v[80:83], v[28:31]
    v_mfma_f32_16x16x32_bf16 v[40:43], a[112:115], v[84:87], v[40:43]
    v_mfma_f32_16x16x32_bf16 v[32:35], a[116:119], v[80:83], v[32:35]
    v_mfma_f32_16x16x32_bf16 v[44:47], a[116:119], v[84:87], v[44:47]
    ds_read_b128 v[72:75], v16 offset:12288
    ds_read_b128 v[76:79], v16 offset:32768
    s_waitcnt lgkmcnt(4)
    v_mfma_f32_16x16x32_bf16 v[24:27], a[120:123], v[88:91], v[24:27]
    buffer_load_dwordx4 v2, s[4:7], s60 offen offset:1024 sc1 lds
    s_add_u32 s72, s72, 40960
    v_mfma_f32_16x16x32_bf16 v[36:39], a[120:123], v[92:95], v[36:39]
    v_mfma_f32_16x16x32_bf16 v[28:31], a[124:127], v[88:91], v[28:31]
    v_mfma_f32_16x16x32_bf16 v[40:43], a[124:127], v[92:95], v[40:43]
    v_mfma_f32_16x16x32_bf16 v[32:35], a[128:131], v[88:91], v[32:35]
    v_mfma_f32_16x16x32_bf16 v[44:47], a[128:131], v[92:95], v[44:47]
    ds_read_b128 v[80:83], v16 offset:13312
    ds_read_b128 v[84:87], v16 offset:33792
    s_waitcnt lgkmcnt(4)
    v_mfma_f32_16x16x32_bf16 v[24:27], a[132:135], v[96:99], v[24:27]
    v_mfma_f32_16x16x32_bf16 v[36:39], a[132:135], v[100:103], v[36:39]
    v_mov_b32 v4, s25
    v_mfma_f32_16x16x32_bf16 v[28:31], a[136:139], v[96:99], v[28:31]
    v_mfma_f32_16x16x32_bf16 v[40:43], a[136:139], v[100:103], v[40:43]
    s_cmp_ge_u32 s25, 6
    s_cbranch_scc1 Le_14
    s_waitcnt vmcnt(5)
    buffer_store_dword v4, v19, s[4:7], s62 offen sc1
Le_14:
    v_mfma_f32_16x16x32_bf16 v[32:35], a[140:143], v[96:99], v[32:35]
    v_mfma_f32_16x16x32_bf16 v[44:47], a[140:143], v[100:103], v[44:47]
    ds_read_b128 v[88:91], v16 offset:14336
    ds_read_b128 v[92:95], v16 offset:34816
    s_waitcnt lgkmcnt(4)
    v_mfma_f32_16x16x32_bf16 v[24:27], a[144:147], v[72:75], v[24:27]
    v_mfma_f32_16x16x32_bf16 v[36:39], a[144:147], v[76:79], v[36:39]
    v_mfma_f32_16x16x32_bf16 v[28:31], a[148:151], v[72:75], v[28:31]
    v_mfma_f32_16x16x32_bf16 v[40:43], a[148:151], v[76:79], v[40:43]
    v_mfma_f32_16x16x32_bf16 v[32:35], a[152:155], v[72:75], v[32:35]
    v_mfma_f32_16x16x32_bf16 v[44:47], a[152:155], v[76:79], v[44:47]
    ds_read_b128 v[96:99], v16 offset:15360
    ds_read_b128 v[100:103], v16 offset:35840
    s_waitcnt lgkmcnt(4)
    v_mfma_f32_16x16x32_bf16 v[24:27], a[156:159], v[80:83], v[24:27]
    v_mfma_f32_16x16x32_bf16 v[36:39], a[156:159], v[84:87], v[36:39]
    v_mfma_f32_16x16x32_bf16 v[28:31], a[160:163], v[80:83], v[28:31]
    v_mfma_f32_16x16x32_bf16 v[40:43], a[160:163], v[84:87], v[40:43]
    v_mfma_f32_16x16x32_bf16 v[32:35], a[164:167], v[80:83], v[32:35]
    v_mfma_f32_16x16x32_bf16 v[44:47], a[164:167], v[84:87], v[44:47]
    ds_read_b128 v[72:75], v16 offset:16384
    ds_read_b128 v[76:79], v16 offset:36864
    s_waitcnt lgkmcnt(4)
    v_mfma_f32_16x16x32_bf16 v[24:27], a[168:171], v[88:91], v[24:27]
    v_mfma_f32_16x16x32_bf16 v[36:39], a[168:171], v[92:95], v[36:39]
    v_mfma_f32_16x16x32_bf16 v[28:31], a[172:175], v[88:91], v[28:31]
    v_mfma_f32_16x16x32_bf16 v[40:43], a[172:175], v[92:95], v[40:43]
    v_mfma_f32_16x16x32_bf16 v[32:35], a[176:179], v[88:91], v[32:35]
    v_mfma_f32_16x16x32_bf16 v[44:47], a[176:179], v[92:95], v[44:47]
    ds_read_b128 v[80:83], v16 offset:17408
    ds_read_b128 v[84:87], v16 offset:37888
    s_waitcnt lgkmcnt(4)
    v_mfma_f32_16x16x32_bf16 v[24:27], a[180:183], v[96:99], v[24:27]
    v_mfma_f32_16x16x32_bf16 v[36:39], a[180:183], v[100:103], v[36:39]
    v_mfma_f32_16x16x32_bf16 v[28:31], a[184:187], v[96:99], v[28:31]
    v_mfma_f32_16x16x32_bf16 v[40:43], a[184:187], v[100:103], v[40:43]
    v_mfma_f32_16x16x32_bf16 v[32:35], a[188:191], v[96:99], v[32:35]
    v_mfma_f32_16x16x32_bf16 v[44:47], a[188:191], v[100:103], v[44:47]
    ds_read_b128 v[88:91], v16 offset:18432
    ds_read_b128 v[92:95], v16 offset:38912
    s_waitcnt lgkmcnt(4)
    v_mfma_f32_16x16x32_bf16 v[24:27], a[192:195], v[72:75], v[24:27]
    v_mfma_f32_16x16x32_bf16 v[36:39], a[192:195], v[76:79], v[36:39]
    v_mfma_f32_16x16x32_bf16 v[28:31], a[196:199], v[72:75], v[28:31]
    v_mfma_f32_16x16x32_bf16 v[40:43], a[196:199], v[76:79], v[40:43]
    v_mfma_f32_16x16x32_bf16 v[32:35], a[200:203], v[72:75], v[32:35]
    v_mfma_f32_16x16x32_bf16 v[44:47], a[200:203], v[76:79], v[44:47]
    ds_read_b128 v[96:99], v16 offset:19456
    ds_read_b128 v[100:103], v16 offset:39936
    s_waitcnt lgkmcnt(4)
    v_mfma_f32_16x16x32_bf16 v[24:27], a[204:207], v[80:83], v[24:27]
    v_mfma_f32_16x16x32_bf16 v[36:39], a[204:207], v[84:87], v[36:39]
    v_mfma_f32_16x16x32_bf16 v[28:31], a[208:211], v[80:83], v[28:31]
    v_mfma_f32_16x16x32_bf16 v[40:43], a[208:211], v[84:87], v[40:43]
    v_mfma_f32_16x16x32_bf16 v[32:35], a[212:215], v[80:83], v[32:35]
    s_waitcnt vmcnt(0) lgkmcnt(0)
    s_barrier
    buffer_store_dword v4, v19, s[4:7], s62 offen sc1
    s_cmp_lt_u32 s25, s66
    s_cbranch_scc0 Lr_15
Lr_15b:
    v_mfma_f32_16x16x32_bf16 v[44:47], a[212:215], v[84:87], v[44:47]
    ds_read_b128 v[72:75], v17 offset:0
    ds_read_b128 v[76:79], v17 offset:20480
    s_waitcnt lgkmcnt(4)
    v_mfma_f32_16x16x32_bf16 v[24:27], a[216:219], v[88:91], v[24:27]
    v_mfma_f32_16x16x32_bf16 v[36:39], a[216:219], v[92:95], v[36:39]
    v_mfma_f32_16x16x32_bf16 v[28:31], a[220:223], v[88:91], v[28:31]
    v_mfma_f32_16x16x32_bf16 v[40:43], a[220:223], v[92:95], v[40:43]
    v_mfma_f32_16x16x32_bf16 v[32:35], a[224:227], v[88:91], v[32:35]
    v_mfma_f32_16x16x32_bf16 v[44:47], a[224:227], v[92:95], v[44:47]
    ds_read_b128 v[80:83], v17 offset:1024
    ds_read_b128 v[84:87], v17 offset:21504
    s_waitcnt lgkmcnt(4)
    v_mfma_f32_16x16x32_bf16 v[24:27], a[228:231], v[96:99], v[24:27]
    v_mfma_f32_16x16x32_bf16 v[36:39], a[228:231], v[100:103], v[36:39]
    v_mfma_f32_16x16x32_bf16 v[28:31], a[232:235], v[96:99], v[28:31]
    v_mfma_f32_16x16x32_bf16 v[40:43], a[232:235], v[100:103], v[40:43]
    v_mfma_f32_16x16x32_bf16 v[32:35], a[236:239], v[96:99], v[32:35]
    v_mfma_f32_16x16x32_bf16 v[44:47], a[236:239], v[100:103], v[44:47]
    s_add_u32 s25, s25, 1
L_G_in:
    ds_read_b128 v[88:91], v17 offset:2048
    ds_read_b128 v[92:95], v17 offset:22528
    s_waitcnt lgkmcnt(4)
    v_mfma_f32_16x16x32_bf16 v[48:51], a[0:3], v[72:75], 0
    v_mfma_f32_16x16x32_bf16 v[60:63], a[0:3], v[76:79], 0
    v_mfma_f32_16x16x32_bf16 v[52:55], a[4:7], v[72:75], 0
    v_mfma_f32_16x16x32_bf16 v[64:67], a[4:7], v[76:79], 0
    v_mfma_f32_16x16x32_bf16 v[56:59], a[8:11], v[72:75], 0
    v_mfma_f32_16x16x32_bf16 v[68:71], a[8:11], v[76:79], 0
    ds_read_b128 v[96:99], v17 offset:3072
    ds_read_b128 v[100:103], v17 offset:23552
    s_waitcnt lgkmcnt(4)
    v_mfma_f32_16x16x32_bf16 v[48:51], a[12:15], v[80:83], v[48:51]
    s_add_u32 m0, s64, 0
    s_add_u32 s60, s72, 0
    buffer_load_dwordx4 v2, s[4:7], s60 offen offset:0 sc1 lds
    v_mfma_f32_16x16x32_bf16 v[60:63], a[12:15], v[84:87], v[60:63]
    v_cvt_pk_bf16_f32 v104, v24, v25
    v_mfma_f32_16x16x32_bf16 v[52:55], a[16:19], v[80:83], v[52:55]
    v_cvt_pk_bf16_f32 v105, v26, v27
    v_mfma_f32_16x16x32_bf16 v[64:67], a[16:19], v[84:87], v[64:67]
    v_cvt_pk_bf16_f32 v106, v28, v29
    v_mfma_f32_16x16x32_bf16 v[56:59], a[20:23], v[80:83], v[56:59]
    v_cvt_pk_bf16_f32 v107, v30, v31
    v_mfma_f32_16x16x32_bf16 v[68:71], a[20:23], v[84:87], v[68:71]
    ds_read_b128 v[72:75], v17 offset:4096
    ds_read_b128 v[76:79], v17 offset:24576
    s_waitcnt lgkmcnt(4)
    v_mfma_f32_16x16x32_bf16 v[48:51], a[24:27], v[88:91], v[48:51]
    buffer_load_dwordx4 v2, s[4:7], s60 offen offset:1024 sc1 lds
    v_mfma_f32_16x16x32_bf16 v[60:63], a[24:27], v[92:95], v[60:63]
    v_cvt_pk_bf16_f32 v108, v32, v33
    v_mfma_f32_16x16x32_bf16 v[52:55], a[28:31], v[88:91], v[52:55]
    v_cvt_pk_bf16_f32 v109, v34, v35
    v_mfma_f32_16x16x32_bf16 v[64:67], a[28:31], v[92:95], v[64:67]
    v_cvt_pk_bf16_f32 v110, v36, v37
    v_mfma_f32_16x16x32_bf16 v[56:59], a[32:35], v[88:91], v[56:59]
    v_cvt_pk_bf16_f32 v111, v38, v39
    v_mfma_f32_16x16x32_bf16 v[68:71], a[32:35], v[92:95], v[68:71]
    ds_read_b128 v[80:83], v17 offset:5120
    ds_read_b128 v[84:87], v17 offset:25600
    s_waitcnt lgkmcnt(4)
    v_mfma_f32_16x16x32_bf16 v[48:51], a[36:39], v[96:99], v[48:51]
    buffer_load_dwordx4 v2, s[4:7], s60 offen offset:2048 sc1 lds
    v_mfma_f32_16x16x32_bf16 v[60:63], a[36:39], v[100:103], v[60:63]
    v_cvt_pk_bf16_f32 v112, v40, v41
    v_mfma_f32_16x16x32_bf16 v[52:55], a[40:43], v[96:99], v[52:55]
    v_cvt_pk_bf16_f32 v113, v42, v43
    v_mfma_f32_16x16x32_bf16 v[64:67], a[40:43], v[100:103], v[64:67]
    v_cvt_pk_bf16_f32 v114, v44, v45
    v_mfma_f32_16x16x32_bf16 v[56:59], a[44:47], v[96:99], v[56:59]
    v_cvt_pk_bf16_f32 v115, v46, v47
    v_mfma_f32_16x16x32_bf16 v[68:71], a[44:47], v[100:103], v[68:71]
    ds_read_b128 v[88:91], v17 offset:6144
    ds_read_b128 v[92:95], v17 offset:26624
    s_waitcnt lgkmcnt(4)
    v_mfma_f32_16x16x32_bf16 v[48:51], a[48:51], v[72:75], v[48:51]
    buffer_load_dwordx4 v2, s[4:7], s60 offen offset:3072 sc1 lds
    v_mfma_f32_16x16x32_bf16 v[60:63], a[48:51], v[76:79], v[60:63]
    v_mfma_f32_16x16x32_bf16 v[52:55], a[52:55], v[72:75], v[52:55]
    buffer_store_dwordx4 v[104:107], v2, s[4:7], s73 offen offset:0 sc1
    v_mfma_f32_16x16x32_bf16 v[64:67], a[52:55], v[76:79], v[64:67]
    v_mfma_f32_16x16x32_bf16 v[56:59], a[56:59], v[72:75], v[56:59]
    buffer_store_dwordx2 v[108:109], v18, s[4:7], s73 offen offset:1024 sc1
    v_mfma_f32_16x16x32_bf16 v[68:71], a[56:59], v[76:79], v[68:71]
    ds_read_b128 v[96:99], v17 offset:7168
    ds_read_b128 v[100:103], v17 offset:27648
    s_waitcnt lgkmcnt(4)
    v_mfma_f32_16x16x32_bf16 v[48:51], a[60:63], v[80:83], v[48:51]
    s_add_u32 m0, s64, 4096
    s_add_u32 s60, s72, 4096
    buffer_load_dwordx4 v2, s[4:7], s60 offen offset:0 sc1 lds
    v_mfma_f32_16x16x32_bf16 v[60:63], a[60:63], v[84:87], v[60:63]
    v_mfma_f32_16x16x32_bf16 v[52:55], a[64:67], v[80:83], v[52:55]
    buffer_store_dwordx4 v[110:113], v2, s[4:7], s73 offen offset:1536 sc1
    v_mfma_f32_16x16x32_bf16 v[64:67], a[64:67], v[84:87], v[64:67]
    v_mfma_f32_16x16x32_bf16 v[56:59], a[68:71], v[80:83], v[56:59]
    buffer_store_dwordx2 v[114:115], v18, s[4:7], s73 offen offset:2560 sc1
    v_mfma_f32_16x16x32_bf16 v[68:71], a[68:71], v[84:87], v[68:71]
    ds_read_b128 v[72:75], v17 offset:8192
    ds_read_b128 v[76:79], v17 offset:28672
    s_waitcnt lgkmcnt(4)
    v_mfma_f32_16x16x32_bf16 v[48:51], a[72:75], v[88:91], v[48:51]
    buffer_load_dwordx4 v2, s[4:7], s60 offen offset:1024 sc1 lds
    v_mfma_f32_16x16x32_bf16 v[60:63], a[72:75], v[92:95], v[60:63]
    v_mfma_f32_16x16x32_bf16 v[52:55], a[76:79], v[88:91], v[52:55]
    s_add_u32 s73, s73, 524288
    s_bitset0_b32 s73, s65
    v_mfma_f32_16x16x32_bf16 v[64:67], a[76:79], v[92:95], v[64:67]
    v_mfma_f32_16x16x32_bf16 v[56:59], a[80:83], v[88:91], v[56:59]
    v_mfma_f32_16x16x32_bf16 v[68:71], a[80:83], v[92:95], v[68:71]
    ds_read_b128 v[80:83], v17 offset:9216
    ds_read_b128 v[84:87], v17 offset:29696
    s_waitcnt lgkmcnt(4)
    v_mfma_f32_16x16x32_bf16 v[48:51], a[84:87], v[96:99], v[48:51]
    buffer_load_dwordx4 v2, s[4:7], s60 offen offset:2048 sc1 lds
    v_mfma_f32_16x16x32_bf16 v[60:63], a[84:87], v[100:103], v[60:63]
    v_mfma_f32_16x16x32_bf16 v[52:55], a[88:91], v[96:99], v[52:55]
    v_mfma_f32_16x16x32_bf16 v[64:67], a[88:91], v[100:103], v[64:67]
    v_mfma_f32_16x16x32_bf16 v[56:59], a[92:95], v[96:99], v[56:59]
    v_mfma_f32_16x16x32_bf16 v[68:71], a[92:95], v[100:103], v[68:71]
    ds_read_b128 v[88:91], v17 offset:10240
    ds_read_b128 v[92:95], v17 offset:30720
    s_waitcnt lgkmcnt(4)
    v_mfma_f32_16x16x32_bf16 v[48:51], a[96:99], v[72:75], v[48:51]
    buffer_load_dwordx4 v2, s[4:7], s60 offen offset:3072 sc1 lds
    v_mfma_f32_16x16x32_bf16 v[60:63], a[96:99], v[76:79], v[60:63]
    v_mfma_f32_16x16x32_bf16 v[52:55], a[100:103], v[72:75], v[52:55]
    v_mfma_f32_16x16x32_bf16 v[64:67], a[100:103], v[76:79], v[64:67]
    v_mfma_f32_16x16x32_bf16 v[56:59], a[104:107], v[72:75], v[56:59]
    v_mfma_f32_16x16x32_bf16 v[68:71], a[104:107], v[76:79], v[68:71]
    ds_read_b128 v[96:99], v17 offset:11264
    ds_read_b128 v[100:103], v17 offset:31744
    s_waitcnt lgkmcnt(4)
    v_mfma_f32_16x16x32_bf16 v[48:51], a[108:111], v[80:83], v[48:51]
    s_add_u32 m0, s64, 8192
    s_add_u32 s60, s72, 8192
    buffer_load_dwordx4 v2, s[4:7], s60 offen offset:0 sc1 lds
    v_mfma_f32_16x16x32_bf16 v[60:63], a[108:111], v[84:87], v[60:63]
    v_mfma_f32_16x16x32_bf16 v[52:55], a[112:115], v[80:83], v[52:55]
    v_mfma_f32_16x16x32_bf16 v[64:67], a[112:115], v[84:87], v[64:67]
    v_mfma_f32_16x16x32_bf16 v[56:59], a[116:119], v[80:83], v[56:59]
    v_mfma_f32_16x16x32_bf16 v[68:71], a[116:119], v[84:87], v[68:71]
    ds_read_b128 v[72:75], v17 offset:12288
    ds_read_b128 v[76:79], v17 offset:32768
    s_waitcnt lgkmcnt(4)
    v_mfma_f32_16x16x32_bf16 v[48:51], a[120:123], v[88:91], v[48:51]
    buffer_load_dwordx4 v2, s[4:7], s60 offen offset:1024 sc1 lds
    s_add_u32 s72, s72, 40960
    v_mfma_f32_16x16x32_bf16 v[60:63], a[120:123], v[92:95], v[60:63]
    v_mfma_f32_16x16x32_bf16 v[52:55], a[124:127], v[88:91], v[52:55]
    v_mfma_f32_16x16x32_bf16 v[64:67], a[124:127], v[92:95], v[64:67]
    v_mfma_f32_16x16x32_bf16 v[56:59], a[128:131], v[88:91], v[56:59]
    v_mfma_f32_16x16x32_bf16 v[68:71], a[128:131], v[92:95], v[68:71]
    ds_read_b128 v[80:83], v17 offset:13312
    ds_read_b128 v[84:87], v17 offset:33792
    s_waitcnt lgkmcnt(4)
    v_mfma_f32_16x16x32_bf16 v[48:51], a[132:135], v[96:99], v[48:51]
    v_mfma_f32_16x16x32_bf16 v[60:63], a[132:135], v[100:103], v[60:63]
    v_mov_b32 v4, s25
    v_mfma_f32_16x16x32_bf16 v[52:55], a[136:139], v[96:99], v[52:55]
    v_mfma_f32_16x16x32_bf16 v[64:67], a[136:139], v[100:103], v[64:67]
    s_cmp_ge_u32 s25, 6
    s_cbranch_scc1 Le_16
    s_waitcnt vmcnt(5)
    buffer_store_dword v4, v19, s[4:7], s62 offen sc1
Le_16:
    v_mfma_f32_16x16x32_bf16 v[56:59], a[140:143], v[96:99], v[56:59]
    v_mfma_f32_16x16x32_bf16 v[68:71], a[140:143], v[100:103], v[68:71]
    ds_read_b128 v[88:91], v17 offset:14336
    ds_read_b128 v[92:95], v17 offset:34816
    s_waitcnt lgkmcnt(4)
    v_mfma_f32_16x16x32_bf16 v[48:51], a[144:147], v[72:75], v[48:51]
    v_mfma_f32_16x16x32_bf16 v[60:63], a[144:147], v[76:79], v[60:63]
    v_mfma_f32_16x16x32_bf16 v[52:55], a[148:151], v[72:75], v[52:55]
    v_mfma_f32_16x16x32_bf16 v[64:67], a[148:151], v[76:79], v[64:67]
    v_mfma_f32_16x16x32_bf16 v[56:59], a[152:155], v[72:75], v[56:59]
    v_mfma_f32_16x16x32_bf16 v[68:71], a[152:155], v[76:79], v[68:71]
    ds_read_b128 v[96:99], v17 offset:15360
    ds_read_b128 v[100:103], v17 offset:35840
    s_waitcnt lgkmcnt(4)
    v_mfma_f32_16x16x32_bf16 v[48:51], a[156:159], v[80:83], v[48:51]
    v_mfma_f32_16x16x32_bf16 v[60:63], a[156:159], v[84:87], v[60:63]
    v_mfma_f32_16x16x32_bf16 v[52:55], a[160:163], v[80:83], v[52:55]
    v_mfma_f32_16x16x32_bf16 v[64:67], a[160:163], v[84:87], v[64:67]
    v_mfma_f32_16x16x32_bf16 v[56:59], a[164:167], v[80:83], v[56:59]
    v_mfma_f32_16x16x32_bf16 v[68:71], a[164:167], v[84:87], v[68:71]
    ds_read_b128 v[72:75], v17 offset:16384
    ds_read_b128 v[76:79], v17 offset:36864
    s_waitcnt lgkmcnt(4)
    v_mfma_f32_16x16x32_bf16 v[48:51], a[168:171], v[88:91], v[48:51]
    v_mfma_f32_16x16x32_bf16 v[60:63], a[168:171], v[92:95], v[60:63]
    v_mfma_f32_16x16x32_bf16 v[52:55], a[172:175], v[88:91], v[52:55]
    v_mfma_f32_16x16x32_bf16 v[64:67], a[172:175], v[92:95], v[64:67]
    v_mfma_f32_16x16x32_bf16 v[56:59], a[176:179], v[88:91], v[56:59]
    v_mfma_f32_16x16x32_bf16 v[68:71], a[176:179], v[92:95], v[68:71]
    ds_read_b128 v[80:83], v17 offset:17408
    ds_read_b128 v[84:87], v17 offset:37888
    s_waitcnt lgkmcnt(4)
    v_mfma_f32_16x16x32_bf16 v[48:51], a[180:183], v[96:99], v[48:51]
    v_mfma_f32_16x16x32_bf16 v[60:63], a[180:183], v[100:103], v[60:63]
    v_mfma_f32_16x16x32_bf16 v[52:55], a[184:187], v[96:99], v[52:55]
    v_mfma_f32_16x16x32_bf16 v[64:67], a[184:187], v[100:103], v[64:67]
    v_mfma_f32_16x16x32_bf16 v[56:59], a[188:191], v[96:99], v[56:59]
    v_mfma_f32_16x16x32_bf16 v[68:71], a[188:191], v[100:103], v[68:71]
    ds_read_b128 v[88:91], v17 offset:18432
    ds_read_b128 v[92:95], v17 offset:38912
    s_waitcnt lgkmcnt(4)
    v_mfma_f32_16x16x32_bf16 v[48:51], a[192:195], v[72:75], v[48:51]
    v_mfma_f32_16x16x32_bf16 v[60:63], a[192:195], v[76:79], v[60:63]
    v_mfma_f32_16x16x32_bf16 v[52:55], a[196:199], v[72:75], v[52:55]
    v_mfma_f32_16x16x32_bf16 v[64:67], a[196:199], v[76:79], v[64:67]
    v_mfma_f32_16x16x32_bf16 v[56:59], a[200:203], v[72:75], v[56:59]
    v_mfma_f32_16x16x32_bf16 v[68:71], a[200:203], v[76:79], v[68:71]
    ds_read_b128 v[96:99], v17 offset:19456
    ds_read_b128 v[100:103], v17 offset:39936
    s_waitcnt lgkmcnt(4)
    v_mfma_f32_16x16x32_bf16 v[48:51], a[204:207], v[80:83], v[48:51]
    v_mfma_f32_16x16x32_bf16 v[60:63], a[204:207], v[84:87], v[60:63]
    v_mfma_f32_16x16x32_bf16 v[52:55], a[208:211], v[80:83], v[52:55]
    v_mfma_f32_16x16x32_bf16 v[64:67], a[208:211], v[84:87], v[64:67]
    v_mfma_f32_16x16x32_bf16 v[56:59], a[212:215], v[80:83], v[56:59]
    s_waitcnt vmcnt(0) lgkmcnt(0)
    s_barrier
    buffer_store_dword v4, v19, s[4:7], s62 offen sc1
    s_cmp_lt_u32 s25, s66
    s_cbranch_scc0 Lr_17
Lr_17b:
    v_mfma_f32_16x16x32_bf16 v[68:71], a[212:215], v[84:87], v[68:71]
    ds_read_b128 v[72:75], v16 offset:0
    ds_read_b128 v[76:79], v16 offset:20480
    s_waitcnt lgkmcnt(4)
    v_mfma_f32_16x16x32_bf16 v[48:51], a[216:219], v[88:91], v[48:51]
    v_mfma_f32_16x16x32_bf16 v[60:63], a[216:219], v[92:95], v[60:63]
    v_mfma_f32_16x16x32_bf16 v[52:55], a[220:223], v[88:91], v[52:55]
    v_mfma_f32_16x16x32_bf16 v[64:67], a[220:223], v[92:95], v[64:67]
    v_mfma_f32_16x16x32_bf16 v[56:59], a[224:227], v[88:91], v[56:59]
    v_mfma_f32_16x16x32_bf16 v[68:71], a[224:227], v[92:95], v[68:71]
    ds_read_b128 v[80:83], v16 offset:1024
    ds_read_b128 v[84:87], v16 offset:21504
    s_waitcnt lgkmcnt(4)
    v_mfma_f32_16x16x32_bf16 v[48:51], a[228:231], v[96:99], v[48:51]
    v_mfma_f32_16x16x32_bf16 v[60:63], a[228:231], v[100:103], v[60:63]
    v_mfma_f32_16x16x32_bf16 v[52:55], a[232:235], v[96:99], v[52:55]
    v_mfma_f32_16x16x32_bf16 v[64:67], a[232:235], v[100:103], v[64:67]
    v_mfma_f32_16x16x32_bf16 v[56:59], a[236:239], v[96:99], v[56:59]
    v_mfma_f32_16x16x32_bf16 v[68:71], a[236:239], v[100:103], v[68:71]
    s_add_u32 s25, s25, 1
    s_cmp_lt_u32 s25, 64
    s_nop 4
    s_cbranch_scc1 L_loop_G
L_G_fin:
    v_cvt_pk_bf16_f32 v104, v48, v49
    v_cvt_pk_bf16_f32 v105, v50, v51
    v_cvt_pk_bf16_f32 v106, v52, v53
    v_cvt_pk_bf16_f32 v107, v54, v55
    v_cvt_pk_bf16_f32 v108, v56, v57
    v_cvt_pk_bf16_f32 v109, v58, v59
    v_cvt_pk_bf16_f32 v110, v60, v61
    v_cvt_pk_bf16_f32 v111, v62, v63
    v_cvt_pk_bf16_f32 v112, v64, v65
    v_cvt_pk_bf16_f32 v113, v66, v67
    v_cvt_pk_bf16_f32 v114, v68, v69
    v_cvt_pk_bf16_f32 v115, v70, v71
    buffer_store_dwordx4 v[104:107], v2, s[4:7], s73 offen offset:0 sc1
    buffer_store_dwordx2 v[108:109], v18, s[4:7], s73 offen offset:1024 sc1
    buffer_store_dwordx4 v[110:113], v2, s[4:7], s73 offen offset:1536 sc1
    buffer_store_dwordx2 v[114:115], v18, s[4:7], s73 offen offset:2560 sc1
    s_add_u32 s73, s73, 524288
    s_bitset0_b32 s73, s65
    s_waitcnt vmcnt(0)
    v_mov_b32 v4, s25
    s_mov_b64 exec, 1
    buffer_store_dword v4, v3, s[4:7], s62 offen sc1
    s_mov_b64 exec, -1
    s_branch L_phase2
Lr_12:
    v_mov_b32 v3, 0
    s_mov_b32 s29, 128
    s_mov_b32 s27, 0x100000
Lp_18:
    buffer_load_dword v120, v3, s[16:19], s29 offen sc1
    s_waitcnt vmcnt(0)
    v_cmp_gt_u32 vcc, 1, v120
    s_nop 0
    s_cbranch_vccz Ld_19
    s_sub_u32 s27, s27, 1
    s_cbranch_scc1 L_abort
    s_sleep 6
    s_branch Lp_18
Ld_19:
    v_readfirstlane_b32 s26, v120
    s_nop 0
    s_and_b32 s26, s26, 0xffff
    s_cmp_gt_u32 s26, 512
    s_cselect_b32 s26, 8192, 0
    s_lshl_b32 s30, s24, 7
    s_add_u32 s30, s30, s26
    s_add_u32 s30, s30, 0x148000
    s_lshl_b32 s31, s24, 7
    s_add_u32 s31, s31, 0x603000
    v_and_b32 v121, 3, v1
    v_lshlrev_b32 v121, 2, v121
    s_cmp_eq_u32 s70, 2
    s_cselect_b32 s30, s31, s30
    s_cselect_b32 s31, 12, 0
    v_and_b32 v121, s31, v121
    s_sub_u32 s29, s25, s67
    s_add_u32 s29, s29, 1
    s_max_u32 s29, s29, 1
    s_mov_b32 s27, 0x100000
Lp_20:
    buffer_load_dword v120, v121, s[4:7], s30 offen sc1
    s_waitcnt vmcnt(0)
    v_cmp_gt_u32 vcc, s29, v120
    s_nop 0
    s_cbranch_vccz Ld_21
    s_sub_u32 s27, s27, 1
    s_cbranch_scc1 L_abort
    s_sleep 8
    s_branch Lp_20
Ld_21:
    v_readlane_b32 s66, v120, 0
    v_readlane_b32 s29, v120, 1
    s_nop 0
    s_min_u32 s66, s66, s29
    v_readlane_b32 s29, v120, 2
    s_nop 0
    s_min_u32 s66, s66, s29
    v_readlane_b32 s29, v120, 3
    s_nop 0
    s_min_u32 s66, s66, s29
    s_add_u32 s66, s66, s67
    s_nop 0
    s_branch Lr_12b
Lr_13:
    v_mov_b32 v3, 0
    s_mov_b32 s29, 128
    s_mov_b32 s27, 0x100000
Lp_22:
    buffer_load_dword v120, v3, s[16:19], s29 offen sc1
    s_waitcnt vmcnt(0)
    v_cmp_gt_u32 vcc, 1, v120
    s_nop 0
    s_cbranch_vccz Ld_23
    s_sub_u32 s27, s27, 1
    s_cbranch_scc1 L_abort
    s_sleep 6
    s_branch Lp_22
Ld_23:
    v_readfirstlane_b32 s26, v120
    s_nop 0
    s_and_b32 s26, s26, 0xffff
    s_cmp_gt_u32 s26, 512
    s_cselect_b32 s26, 8192, 0
    s_lshl_b32 s30, s24, 7
    s_add_u32 s30, s30, s26
    s_add_u32 s30, s30, 0x148000
    s_lshl_b32 s31, s24, 7
    s_add_u32 s31, s31, 0x603000
    v_and_b32 v121, 3, v1
    v_lshlrev_b32 v121, 2, v121
    s_cmp_eq_u32 s70, 2
    s_cselect_b32 s30, s31, s30
    s_cselect_b32 s31, 12, 0
    v_and_b32 v121, s31, v121
    s_sub_u32 s29, s25, s67
    s_add_u32 s29, s29, 1
    s_max_u32 s29, s29, 1
    s_mov_b32 s27, 0x100000
Lp_24:
    buffer_load_dword v120, v121, s[4:7], s30 offen sc1
    s_waitcnt vmcnt(0)
    v_cmp_gt_u32 vcc, s29, v120
    s_nop 0
    s_cbranch_vccz Ld_25
    s_sub_u32 s27, s27, 1
    s_cbranch_scc1 L_abort
    s_sleep 8
    s_branch Lp_24
Ld_25:
    v_readlane_b32 s66, v120, 0
    v_readlane_b32 s29, v120, 1
    s_nop 0
    s_min_u32 s66, s66, s29
    v_readlane_b32 s29, v120, 2
    s_nop 0
    s_min_u32 s66, s66, s29
    v_readlane_b32 s29, v120, 3
    s_nop 0
    s_min_u32 s66, s66, s29
    s_add_u32 s66, s66, s67
    s_nop 0
    s_branch Lr_13b
Lr_15:
    v_mov_b32 v3, 0
    s_mov_b32 s29, 128
    s_mov_b32 s27, 0x100000
Lp_26:
    buffer_load_dword v120, v3, s[16:19], s29 offen sc1
    s_waitcnt vmcnt(0)
    v_cmp_gt_u32 vcc, 1, v120
    s_nop 0
    s_cbranch_vccz Ld_27
    s_sub_u32 s27, s27, 1
    s_cbranch_scc1 L_abort
    s_sleep 6
    s_branch Lp_26
Ld_27:
    v_readfirstlane_b32 s26, v120
    s_nop 0
    s_and_b32 s26, s26, 0xffff
    s_cmp_gt_u32 s26, 512
    s_cselect_b32 s26, 8192, 0
    s_lshl_b32 s30, s24, 7
    s_add_u32 s30, s30, s26
    s_add_u32 s30, s30, 0x148000
    s_lshl_b32 s31, s24, 7
    s_add_u32 s31, s31, 0x603000
    v_and_b32 v121, 3, v1
    v_lshlrev_b32 v121, 2, v121
    s_cmp_eq_u32 s70, 2
    s_cselect_b32 s30, s31, s30
    s_cselect_b32 s31, 12, 0
    v_and_b32 v121, s31, v121
    s_sub_u32 s29, s25, s67
    s_add_u32 s29, s29, 1
    s_max_u32 s29, s29, 1
    s_mov_b32 s27, 0x100000
Lp_28:
    buffer_load_dword v120, v121, s[4:7], s30 offen sc1
    s_waitcnt vmcnt(0)
    v_cmp_gt_u32 vcc, s29, v120
    s_nop 0
    s_cbranch_vccz Ld_29
    s_sub_u32 s27, s27, 1
    s_cbranch_scc1 L_abort
    s_sleep 8
    s_branch Lp_28
Ld_29:
    v_readlane_b32 s66, v120, 0
    v_readlane_b32 s29, v120, 1
    s_nop 0
    s_min_u32 s66, s66, s29
    v_readlane_b32 s29, v120, 2
    s_nop 0
    s_min_u32 s66, s66, s29
    v_readlane_b32 s29, v120, 3
    s_nop 0
    s_min_u32 s66, s66, s29
    s_add_u32 s66, s66, s67
    s_nop 0
    s_branch Lr_15b
Lr_17:
    v_mov_b32 v3, 0
    s_mov_b32 s29, 128
    s_mov_b32 s27, 0x100000
Lp_30:
    buffer_load_dword v120, v3, s[16:19], s29 offen sc1
    s_waitcnt vmcnt(0)
    v_cmp_gt_u32 vcc, 1, v120
    s_nop 0
    s_cbranch_vccz Ld_31
    s_sub_u32 s27, s27, 1
    s_cbranch_scc1 L_abort
    s_sleep 6
    s_branch Lp_30
Ld_31:
    v_readfirstlane_b32 s26, v120
    s_nop 0
    s_and_b32 s26, s26, 0xffff
    s_cmp_gt_u32 s26, 512
    s_cselect_b32 s26, 8192, 0
    s_lshl_b32 s30, s24, 7
    s_add_u32 s30, s30, s26
    s_add_u32 s30, s30, 0x148000
    s_lshl_b32 s31, s24, 7
    s_add_u32 s31, s31, 0x603000
    v_and_b32 v121, 3, v1
    v_lshlrev_b32 v121, 2, v121
    s_cmp_eq_u32 s70, 2
    s_cselect_b32 s30, s31, s30
    s_cselect_b32 s31, 12, 0
    v_and_b32 v121, s31, v121
    s_sub_u32 s29, s25, s67
    s_add_u32 s29, s29, 1
    s_max_u32 s29, s29, 1
    s_mov_b32 s27, 0x100000
Lp_32:
    buffer_load_dword v120, v121, s[4:7], s30 offen sc1
    s_waitcnt vmcnt(0)
    v_cmp_gt_u32 vcc, s29, v120
    s_nop 0
    s_cbranch_vccz Ld_33
    s_sub_u32 s27, s27, 1
    s_cbranch_scc1 L_abort
    s_sleep 8
    s_branch Lp_32
Ld_33:
    v_readlane_b32 s66, v120, 0
    v_readlane_b32 s29, v120, 1
    s_nop 0
    s_min_u32 s66, s66, s29
    v_readlane_b32 s29, v120, 2
    s_nop 0
    s_min_u32 s66, s66, s29
    v_readlane_b32 s29, v120, 3
    s_nop 0
    s_min_u32 s66, s66, s29
    s_add_u32 s66, s66, s67
    s_nop 0
    s_branch Lr_17b
L_role_O:
    s_mov_b32 s8, s42
    s_and_b32 s9, s43, 0xffff
    s_mov_b32 s10, 0x780000
    s_mov_b32 s11, 0x20000
    s_mul_i32 s71, s24, 245760
    s_mul_i32 s28, s3, 5120
    s_add_u32 s71, s71, s28
    v_lshrrev_b32 v12, 4, v1
    v_bfe_u32 v13, v1, 2, 2
    v_and_b32 v14, 3, v1
    v_lshl_add_u32 v10, v12, 2, v13
    v_and_b32 v6, 7, v10
    v_lshlrev_b32 v6, 5, v6
    v_mul_u32_u24 v10, 1280, v10
    v_lshl_add_u32 v10, v14, 3, v10
    s_mul_i32 s68, s3, 320
    s_lshl_b32 s28, s3, 2
    v_add_u32 v4, 0, v1
    v_mul_u32_u24 v5, 820, v4
    v_lshrrev_b32 v5, 16, v5
    v_mul_u32_u24 v20, 80, v5
    v_sub_u32 v4, v4, v20
    v_add_u32 v5, s28, v5
    v_and_b32 v5, 7, v5
    v_lshlrev_b32 v5, 1, v5
    v_xor_b32 v4, v4, v5
    v_add_lshl_u32 v20, v20, v4, 4
    v_add_u32 v4, 64, v1
    v_mul_u32_u24 v5, 820, v4
    v_lshrrev_b32 v5, 16, v5
    v_mul_u32_u24 v21, 80, v5
    v_sub_u32 v4, v4, v21
    v_add_u32 v5, s28, v5
    v_and_b32 v5, 7, v5
    v_lshlrev_b32 v5, 1, v5
    v_xor_b32 v4, v4, v5
    v_add_lshl_u32 v21, v21, v4, 4
    v_add_u32 v4, 128, v1
    v_mul_u32_u24 v5, 820, v4
    v_lshrrev_b32 v5, 16, v5
    v_mul_u32_u24 v22, 80, v5
    v_sub_u32 v4, v4, v22
    v_add_u32 v5, s28, v5
    v_and_b32 v5, 7, v5
    v_lshlrev_b32 v5, 1, v5
    v_xor_b32 v4, v4, v5
    v_add_lshl_u32 v22, v22, v4, 4
    v_add_u32 v4, 192, v1
    v_mul_u32_u24 v5, 820, v4
    v_lshrrev_b32 v5, 16, v5
    v_mul_u32_u24 v23, 80, v5
    v_sub_u32 v4, v4, v23
    v_add_u32 v5, s28, v5
    v_and_b32 v5, 7, v5
    v_lshlrev_b32 v5, 1, v5
    v_xor_b32 v4, v4, v5
    v_add_lshl_u32 v23, v23, v4, 4
    v_add_u32 v4, 256, v1
    v_mul_u32_u24 v5, 820, v4
    v_lshrrev_b32 v5, 16, v5
    v_mul_u32_u24 v24, 80, v5
    v_sub_u32 v4, v4, v24
    v_add_u32 v5, s28, v5
    v_and_b32 v5, 7, v5
    v_lshlrev_b32 v5, 1, v5
    v_xor_b32 v4, v4, v5
    v_add_lshl_u32 v24, v24, v4, 4
    s_mul_i32 s61, s3, 5120
    s_add_u32 m0, s61, 0
    s_add_u32 s60, s71, 0x0
    buffer_load_dwordx4 v20, s[8:11], s60 offen lds
    s_add_u32 m0, s61, 1024
    s_add_u32 s60, s71, 0x0
    buffer_load_dwordx4 v21, s[8:11], s60 offen lds
    s_add_u32 m0, s61, 2048
    s_add_u32 s60, s71, 0x0
    buffer_load_dwordx4 v22, s[8:11], s60 offen lds
    s_add_u32 m0, s61, 3072
    s_add_u32 s60, s71, 0x0
    buffer_load_dwordx4 v23, s[8:11], s60 offen lds
    s_add_u32 m0, s61, 4096
    s_add_u32 s60, s71, 0x0
    buffer_load_dwordx4 v24, s[8:11], s60 offen lds
    s_add_u32 m0, s61, 20480
    s_add_u32 s60, s71, 0x5000
    buffer_load_dwordx4 v20, s[8:11], s60 offen lds
    s_add_u32 m0, s61, 21504
    s_add_u32 s60, s71, 0x5000
    buffer_load_dwordx4 v21, s[8:11], s60 offen lds
    s_add_u32 m0, s61, 22528
    s_add_u32 s60, s71, 0x5000
    buffer_load_dwordx4 v22, s[8:11], s60 offen lds
    s_add_u32 m0, s61, 23552
    s_add_u32 s60, s71, 0x5000
    buffer_load_dwordx4 v23, s[8:11], s60 offen lds
    s_add_u32 m0, s61, 24576
    s_add_u32 s60, s71, 0x5000
    buffer_load_dwordx4 v24, s[8:11], s60 offen lds
    s_add_u32 m0, s61, 40960
    s_add_u32 s60, s71, 0xa000
    buffer_load_dwordx4 v20, s[8:11], s60 offen lds
    s_add_u32 m0, s61, 41984
    s_add_u32 s60, s71, 0xa000
    buffer_load_dwordx4 v21, s[8:11], s60 offen lds
    s_add_u32 m0, s61, 43008
    s_add_u32 s60, s71, 0xa000
    buffer_load_dwordx4 v22, s[8:11], s60 offen lds
    s_add_u32 m0, s61, 44032
    s_add_u32 s60, s71, 0xa000
    buffer_load_dwordx4 v23, s[8:11], s60 offen lds
    s_add_u32 m0, s61, 45056
    s_add_u32 s60, s71, 0xa000
    buffer_load_dwordx4 v24, s[8:11], s60 offen lds
    s_add_u32 m0, s61, 61440
    s_add_u32 s60, s71, 0xf000
    buffer_load_dwordx4 v20, s[8:11], s60 offen lds
    s_add_u32 m0, s61, 62464
    s_add_u32 s60, s71, 0xf000
    buffer_load_dwordx4 v21, s[8:11], s60 offen lds
    s_add_u32 m0, s61, 63488
    s_add_u32 s60, s71, 0xf000
    buffer_load_dwordx4 v22, s[8:11], s60 offen lds
    s_add_u32 m0, s61, 64512
    s_add_u32 s60, s71, 0xf000
    buffer_load_dwordx4 v23, s[8:11], s60 offen lds
    s_add_u32 m0, s61, 65536
    s_add_u32 s60, s71, 0xf000
    buffer_load_dwordx4 v24, s[8:11], s60 offen lds
    s_add_u32 m0, s61, 81920
    s_add_u32 s60, s71, 0x14000
    buffer_load_dwordx4 v20, s[8:11], s60 offen lds
    s_add_u32 m0, s61, 82944
    s_add_u32 s60, s71, 0x14000
    buffer_load_dwordx4 v21, s[8:11], s60 offen lds
    s_add_u32 m0, s61, 83968
    s_add_u32 s60, s71, 0x14000
    buffer_load_dwordx4 v22, s[8:11], s60 offen lds
    s_add_u32 m0, s61, 84992
    s_add_u32 s60, s71, 0x14000
    buffer_load_dwordx4 v23, s[8:11], s60 offen lds
    s_add_u32 m0, s61, 86016
    s_add_u32 s60, s71, 0x14000
    buffer_load_dwordx4 v24, s[8:11], s60 offen lds
    s_add_u32 m0, s61, 102400
    s_add_u32 s60, s71, 0x19000
    buffer_load_dwordx4 v20, s[8:11], s60 offen lds
    s_add_u32 m0, s61, 103424
    s_add_u32 s60, s71, 0x19000
    buffer_load_dwordx4 v21, s[8:11], s60 offen lds
    s_add_u32 m0, s61, 104448
    s_add_u32 s60, s71, 0x19000
    buffer_load_dwordx4 v22, s[8:11], s60 offen lds
    s_add_u32 m0, s61, 105472
    s_add_u32 s60, s71, 0x19000
    buffer_load_dwordx4 v23, s[8:11], s60 offen lds
    s_add_u32 m0, s61, 106496
    s_add_u32 s60, s71, 0x19000
    buffer_load_dwordx4 v24, s[8:11], s60 offen lds
    s_waitcnt vmcnt(25)
    s_barrier
    s_add_u32 m0, s61, 122880
    s_add_u32 s60, s71, 0x1e000
    buffer_load_dwordx4 v20, s[8:11], s60 offen lds
    s_add_u32 m0, s61, 123904
    s_add_u32 s60, s71, 0x1e000
    buffer_load_dwordx4 v21, s[8:11], s60 offen lds
    s_add_u32 m0, s61, 124928
    s_add_u32 s60, s71, 0x1e000
    buffer_load_dwordx4 v22, s[8:11], s60 offen lds
    s_add_u32 m0, s61, 125952
    s_add_u32 s60, s71, 0x1e000
    buffer_load_dwordx4 v23, s[8:11], s60 offen lds
    s_add_u32 m0, s61, 126976
    s_add_u32 s60, s71, 0x1e000
    buffer_load_dwordx4 v24, s[8:11], s60 offen lds
    v_add_u32 v11, 0x0, v10
    s_add_u32 s60, s68, 0
    v_xad_u32 v8, s60, v6, v11
    ds_read_b64_tr_b16 a[0:1], v8 offset:0
    s_add_u32 s60, s68, 32
    v_xad_u32 v9, s60, v6, v11
    ds_read_b64_tr_b16 a[24:25], v9 offset:0
    s_add_u32 s60, s68, 64
    v_xad_u32 v8, s60, v6, v11
    ds_read_b64_tr_b16 a[48:49], v8 offset:0
    s_add_u32 s60, s68, 96
    v_xad_u32 v9, s60, v6, v11
    ds_read_b64_tr_b16 a[72:73], v9 offset:0
    s_add_u32 s60, s68, 128
    v_xad_u32 v8, s60, v6, v11
    ds_read_b64_tr_b16 a[96:97], v8 offset:0
    s_add_u32 s60, s68, 160
    v_xad_u32 v9, s60, v6, v11
    ds_read_b64_tr_b16 a[120:121], v9 offset:0
    s_add_u32 s60, s68, 192
    v_xad_u32 v8, s60, v6, v11
    ds_read_b64_tr_b16 a[144:145], v8 offset:0
    s_add_u32 s60, s68, 224
    v_xad_u32 v9, s60, v6, v11
    ds_read_b64_tr_b16 a[168:169], v9 offset:0
    s_add_u32 s60, s68, 256
    v_xad_u32 v8, s60, v6, v11
    ds_read_b64_tr_b16 a[192:193], v8 offset:0
    s_add_u32 s60, s68, 288
    v_xad_u32 v9, s60, v6, v11
    ds_read_b64_tr_b16 a[216:217], v9 offset:0
    s_waitcnt lgkmcnt(0)
    s_waitcnt vmcnt(25)
    s_barrier
    s_add_u32 m0, s61, 0
    s_add_u32 s60, s71, 0x23000
    buffer_load_dwordx4 v20, s[8:11], s60 offen lds
    s_add_u32 m0, s61, 1024
    s_add_u32 s60, s71, 0x23000
    buffer_load_dwordx4 v21, s[8:11], s60 offen lds
    s_add_u32 m0, s61, 2048
    s_add_u32 s60, s71, 0x23000
    buffer_load_dwordx4 v22, s[8:11], s60 offen lds
    s_add_u32 m0, s61, 3072
    s_add_u32 s60, s71, 0x23000
    buffer_load_dwordx4 v23, s[8:11], s60 offen lds
    s_add_u32 m0, s61, 4096
    s_add_u32 s60, s71, 0x23000
    buffer_load_dwordx4 v24, s[8:11], s60 offen lds
    v_add_u32 v11, 0x5000, v10
    s_add_u32 s60, s68, 0
    v_xad_u32 v8, s60, v6, v11
    ds_read_b64_tr_b16 a[2:3], v8 offset:0
    s_add_u32 s60, s68, 32
    v_xad_u32 v9, s60, v6, v11
    ds_read_b64_tr_b16 a[26:27], v9 offset:0
    s_add_u32 s60, s68, 64
    v_xad_u32 v8, s60, v6, v11
    ds_read_b64_tr_b16 a[50:51], v8 offset:0
    s_add_u32 s60, s68, 96
    v_xad_u32 v9, s60, v6, v11
    ds_read_b64_tr_b16 a[74:75], v9 offset:0
    s_add_u32 s60, s68, 128
    v_xad_u32 v8, s60, v6, v11
    ds_read_b64_tr_b16 a[98:99], v8 offset:0
    s_add_u32 s60, s68, 160
    v_xad_u32 v9, s60, v6, v11
    ds_read_b64_tr_b16 a[122:123], v9 offset:0
    s_add_u32 s60, s68, 192
    v_xad_u32 v8, s60, v6, v11
    ds_read_b64_tr_b16 a[146:147], v8 offset:0
    s_add_u32 s60, s68, 224
    v_xad_u32 v9, s60, v6, v11
    ds_read_b64_tr_b16 a[170:171], v9 offset:0
    s_add_u32 s60, s68, 256
    v_xad_u32 v8, s60, v6, v11
    ds_read_b64_tr_b16 a[194:195], v8 offset:0
    s_add_u32 s60, s68, 288
    v_xad_u32 v9, s60, v6, v11
    ds_read_b64_tr_b16 a[218:219], v9 offset:0
    s_waitcnt lgkmcnt(0)
    s_waitcnt vmcnt(25)
    s_barrier
    s_add_u32 m0, s61, 20480
    s_add_u32 s60, s71, 0x28000
    buffer_load_dwordx4 v20, s[8:11], s60 offen lds
    s_add_u32 m0, s61, 21504
    s_add_u32 s60, s71, 0x28000
    buffer_load_dwordx4 v21, s[8:11], s60 offen lds
    s_add_u32 m0, s61, 22528
    s_add_u32 s60, s71, 0x28000
    buffer_load_dwordx4 v22, s[8:11], s60 offen lds
    s_add_u32 m0, s61, 23552
    s_add_u32 s60, s71, 0x28000
    buffer_load_dwordx4 v23, s[8:11], s60 offen lds
    s_add_u32 m0, s61, 24576
    s_add_u32 s60, s71, 0x28000
    buffer_load_dwordx4 v24, s[8:11], s60 offen lds
    v_add_u32 v11, 0xa000, v10
    s_add_u32 s60, s68, 0
    v_xad_u32 v8, s60, v6, v11
    ds_read_b64_tr_b16 a[16:17], v8 offset:0
    s_add_u32 s60, s68, 32
    v_xad_u32 v9, s60, v6, v11
    ds_read_b64_tr_b16 a[40:41], v9 offset:0
    s_add_u32 s60, s68, 64
    v_xad_u32 v8, s60, v6, v11
    ds_read_b64_tr_b16 a[64:65], v8 offset:0
    s_add_u32 s60, s68, 96
    v_xad_u32 v9, s60, v6, v11
    ds_read_b64_tr_b16 a[88:89], v9 offset:0
    s_add_u32 s60, s68, 128
    v_xad_u32 v8, s60, v6, v11
    ds_read_b64_tr_b16 a[112:113], v8 offset:0
    s_add_u32 s60, s68, 160
    v_xad_u32 v9, s60, v6, v11
    ds_read_b64_tr_b16 a[136:137], v9 offset:0
    s_add_u32 s60, s68, 192
    v_xad_u32 v8, s60, v6, v11
    ds_read_b64_tr_b16 a[160:161], v8 offset:0
    s_add_u32 s60, s68, 224
    v_xad_u32 v9, s60, v6, v11
    ds_read_b64_tr_b16 a[184:185], v9 offset:0
    s_add_u32 s60, s68, 256
    v_xad_u32 v8, s60, v6, v11
    ds_read_b64_tr_b16 a[208:209], v8 offset:0
    s_add_u32 s60, s68, 288
    v_xad_u32 v9, s60, v6, v11
    ds_read_b64_tr_b16 a[232:233], v9 offset:0
    s_waitcnt lgkmcnt(0)
    s_waitcnt vmcnt(25)
    s_barrier
    s_add_u32 m0, s61, 40960
    s_add_u32 s60, s71, 0x2d000
    buffer_load_dwordx4 v20, s[8:11], s60 offen lds
    s_add_u32 m0, s61, 41984
    s_add_u32 s60, s71, 0x2d000
    buffer_load_dwordx4 v21, s[8:11], s60 offen lds
    s_add_u32 m0, s61, 43008
    s_add_u32 s60, s71, 0x2d000
    buffer_load_dwordx4 v22, s[8:11], s60 offen lds
    s_add_u32 m0, s61, 44032
    s_add_u32 s60, s71, 0x2d000
    buffer_load_dwordx4 v23, s[8:11], s60 offen lds
    s_add_u32 m0, s61, 45056
    s_add_u32 s60, s71, 0x2d000
    buffer_load_dwordx4 v24, s[8:11], s60 offen lds
    v_add_u32 v11, 0xf000, v10
    s_add_u32 s60, s68, 0
    v_xad_u32 v8, s60, v6, v11
    ds_read_b64_tr_b16 a[4:5], v8 offset:0
    s_add_u32 s60, s68, 32
    v_xad_u32 v9, s60, v6, v11
    ds_read_b64_tr_b16 a[28:29], v9 offset:0
    s_add_u32 s60, s68, 64
    v_xad_u32 v8, s60, v6, v11
    ds_read_b64_tr_b16 a[52:53], v8 offset:0
    s_add_u32 s60, s68, 96
    v_xad_u32 v9, s60, v6, v11
    ds_read_b64_tr_b16 a[76:77], v9 offset:0
    s_add_u32 s60, s68, 128
    v_xad_u32 v8, s60, v6, v11
    ds_read_b64_tr_b16 a[100:101], v8 offset:0
    s_add_u32 s60, s68, 160
    v_xad_u32 v9, s60, v6, v11
    ds_read_b64_tr_b16 a[124:125], v9 offset:0
    s_add_u32 s60, s68, 192
    v_xad_u32 v8, s60, v6, v11
    ds_read_b64_tr_b16 a[148:149], v8 offset:0
    s_add_u32 s60, s68, 224
    v_xad_u32 v9, s60, v6, v11
    ds_read_b64_tr_b16 a[172:173], v9 offset:0
    s_add_u32 s60, s68, 256
    v_xad_u32 v8, s60, v6, v11
    ds_read_b64_tr_b16 a[196:197], v8 offset:0
    s_add_u32 s60, s68, 288
    v_xad_u32 v9, s60, v6, v11
    ds_read_b64_tr_b16 a[220:221], v9 offset:0
    s_waitcnt lgkmcnt(0)
    s_waitcnt vmcnt(25)
    s_barrier
    s_add_u32 m0, s61, 61440
    s_add_u32 s60, s71, 0x32000
    buffer_load_dwordx4 v20, s[8:11], s60 offen lds
    s_add_u32 m0, s61, 62464
    s_add_u32 s60, s71, 0x32000
    buffer_load_dwordx4 v21, s[8:11], s60 offen lds
    s_add_u32 m0, s61, 63488
    s_add_u32 s60, s71, 0x32000
    buffer_load_dwordx4 v22, s[8:11], s60 offen lds
    s_add_u32 m0, s61, 64512
    s_add_u32 s60, s71, 0x32000
    buffer_load_dwordx4 v23, s[8:11], s60 offen lds
    s_add_u32 m0, s61, 65536
    s_add_u32 s60, s71, 0x32000
    buffer_load_dwordx4 v24, s[8:11], s60 offen lds
    v_add_u32 v11, 0x14000, v10
    s_add_u32 s60, s68, 0
    v_xad_u32 v8, s60, v6, v11
    ds_read_b64_tr_b16 a[6:7], v8 offset:0
    s_add_u32 s60, s68, 32
    v_xad_u32 v9, s60, v6, v11
    ds_read_b64_tr_b16 a[30:31], v9 offset:0
    s_add_u32 s60, s68, 64
    v_xad_u32 v8, s60, v6, v11
    ds_read_b64_tr_b16 a[54:55], v8 offset:0
    s_add_u32 s60, s68, 96
    v_xad_u32 v9, s60, v6, v11
    ds_read_b64_tr_b16 a[78:79], v9 offset:0
    s_add_u32 s60, s68, 128
    v_xad_u32 v8, s60, v6, v11
    ds_read_b64_tr_b16 a[102:103], v8 offset:0
    s_add_u32 s60, s68, 160
    v_xad_u32 v9, s60, v6, v11
    ds_read_b64_tr_b16 a[126:127], v9 offset:0
    s_add_u32 s60, s68, 192
    v_xad_u32 v8, s60, v6, v11
    ds_read_b64_tr_b16 a[150:151], v8 offset:0
    s_add_u32 s60, s68, 224
    v_xad_u32 v9, s60, v6, v11
    ds_read_b64_tr_b16 a[174:175], v9 offset:0
    s_add_u32 s60, s68, 256
    v_xad_u32 v8, s60, v6, v11
    ds_read_b64_tr_b16 a[198:199], v8 offset:0
    s_add_u32 s60, s68, 288
    v_xad_u32 v9, s60, v6, v11
    ds_read_b64_tr_b16 a[222:223], v9 offset:0
    s_waitcnt lgkmcnt(0)
    s_waitcnt vmcnt(25)
    s_barrier
    s_add_u32 m0, s61, 81920
    s_add_u32 s60, s71, 0x37000
    buffer_load_dwordx4 v20, s[8:11], s60 offen lds
    s_add_u32 m0, s61, 82944
    s_add_u32 s60, s71, 0x37000
    buffer_load_dwordx4 v21, s[8:11], s60 offen lds
    s_add_u32 m0, s61, 83968
    s_add_u32 s60, s71, 0x37000
    buffer_load_dwordx4 v22, s[8:11], s60 offen lds
    s_add_u32 m0, s61, 84992
    s_add_u32 s60, s71, 0x37000
    buffer_load_dwordx4 v23, s[8:11], s60 offen lds
    s_add_u32 m0, s61, 86016
    s_add_u32 s60, s71, 0x37000
    buffer_load_dwordx4 v24, s[8:11], s60 offen lds
    v_add_u32 v11, 0x19000, v10
    s_add_u32 s60, s68, 0
    v_xad_u32 v8, s60, v6, v11
    ds_read_b64_tr_b16 a[18:19], v8 offset:0
    s_add_u32 s60, s68, 32
    v_xad_u32 v9, s60, v6, v11
    ds_read_b64_tr_b16 a[42:43], v9 offset:0
    s_add_u32 s60, s68, 64
    v_xad_u32 v8, s60, v6, v11
    ds_read_b64_tr_b16 a[66:67], v8 offset:0
    s_add_u32 s60, s68, 96
    v_xad_u32 v9, s60, v6, v11
    ds_read_b64_tr_b16 a[90:91], v9 offset:0
    s_add_u32 s60, s68, 128
    v_xad_u32 v8, s60, v6, v11
    ds_read_b64_tr_b16 a[114:115], v8 offset:0
    s_add_u32 s60, s68, 160
    v_xad_u32 v9, s60, v6, v11
    ds_read_b64_tr_b16 a[138:139], v9 offset:0
    s_add_u32 s60, s68, 192
    v_xad_u32 v8, s60, v6, v11
    ds_read_b64_tr_b16 a[162:163], v8 offset:0
    s_add_u32 s60, s68, 224
    v_xad_u32 v9, s60, v6, v11
    ds_read_b64_tr_b16 a[186:187], v9 offset:0
    s_add_u32 s60, s68, 256
    v_xad_u32 v8, s60, v6, v11
    ds_read_b64_tr_b16 a[210:211], v8 offset:0
    s_add_u32 s60, s68, 288
    v_xad_u32 v9, s60, v6, v11
    ds_read_b64_tr_b16 a[234:235], v9 offset:0
    s_waitcnt lgkmcnt(0)
    s_waitcnt vmcnt(25)
    s_barrier
    v_add_u32 v11, 0x1e000, v10
    s_add_u32 s60, s68, 0
    v_xad_u32 v8, s60, v6, v11
    ds_read_b64_tr_b16 a[8:9], v8 offset:0
    s_add_u32 s60, s68, 32
    v_xad_u32 v9, s60, v6, v11
    ds_read_b64_tr_b16 a[32:33], v9 offset:0
    s_add_u32 s60, s68, 64
    v_xad_u32 v8, s60, v6, v11
    ds_read_b64_tr_b16 a[56:57], v8 offset:0
    s_add_u32 s60, s68, 96
    v_xad_u32 v9, s60, v6, v11
    ds_read_b64_tr_b16 a[80:81], v9 offset:0
    s_add_u32 s60, s68, 128
    v_xad_u32 v8, s60, v6, v11
    ds_read_b64_tr_b16 a[104:105], v8 offset:0
    s_add_u32 s60, s68, 160
    v_xad_u32 v9, s60, v6, v11
    ds_read_b64_tr_b16 a[128:129], v9 offset:0
    s_add_u32 s60, s68, 192
    v_xad_u32 v8, s60, v6, v11
    ds_read_b64_tr_b16 a[152:153], v8 offset:0
    s_add_u32 s60, s68, 224
    v_xad_u32 v9, s60, v6, v11
    ds_read_b64_tr_b16 a[176:177], v9 offset:0
    s_add_u32 s60, s68, 256
    v_xad_u32 v8, s60, v6, v11
    ds_read_b64_tr_b16 a[200:201], v8 offset:0
    s_add_u32 s60, s68, 288
    v_xad_u32 v9, s60, v6, v11
    ds_read_b64_tr_b16 a[224:225], v9 offset:0
    s_waitcnt lgkmcnt(0)
    s_waitcnt vmcnt(20)
    s_barrier
    v_add_u32 v11, 0x0, v10
    s_add_u32 s60, s68, 0
    v_xad_u32 v8, s60, v6, v11
    ds_read_b64_tr_b16 a[10:11], v8 offset:0
    s_add_u32 s60, s68, 32
    v_xad_u32 v9, s60, v6, v11
    ds_read_b64_tr_b16 a[34:35], v9 offset:0
    s_add_u32 s60, s68, 64
    v_xad_u32 v8, s60, v6, v11
    ds_read_b64_tr_b16 a[58:59], v8 offset:0
    s_add_u32 s60, s68, 96
    v_xad_u32 v9, s60, v6, v11
    ds_read_b64_tr_b16 a[82:83], v9 offset:0
    s_add_u32 s60, s68, 128
    v_xad_u32 v8, s60, v6, v11
    ds_read_b64_tr_b16 a[106:107], v8 offset:0
    s_add_u32 s60, s68, 160
    v_xad_u32 v9, s60, v6, v11
    ds_read_b64_tr_b16 a[130:131], v9 offset:0
    s_add_u32 s60, s68, 192
    v_xad_u32 v8, s60, v6, v11
    ds_read_b64_tr_b16 a[154:155], v8 offset:0
    s_add_u32 s60, s68, 224
    v_xad_u32 v9, s60, v6, v11
    ds_read_b64_tr_b16 a[178:179], v9 offset:0
    s_add_u32 s60, s68, 256
    v_xad_u32 v8, s60, v6, v11
    ds_read_b64_tr_b16 a[202:203], v8 offset:0
    s_add_u32 s60, s68, 288
    v_xad_u32 v9, s60, v6, v11
    ds_read_b64_tr_b16 a[226:227], v9 offset:0
    s_waitcnt lgkmcnt(0)
    s_waitcnt vmcnt(15)
    s_barrier
    v_add_u32 v11, 0x5000, v10
    s_add_u32 s60, s68, 0
    v_xad_u32 v8, s60, v6, v11
    ds_read_b64_tr_b16 a[20:21], v8 offset:0
    s_add_u32 s60, s68, 32
    v_xad_u32 v9, s60, v6, v11
    ds_read_b64_tr_b16 a[44:45], v9 offset:0
    s_add_u32 s60, s68, 64
    v_xad_u32 v8, s60, v6, v11
    ds_read_b64_tr_b16 a[68:69], v8 offset:0
    s_add_u32 s60, s68, 96
    v_xad_u32 v9, s60, v6, v11
    ds_read_b64_tr_b16 a[92:93], v9 offset:0
    s_add_u32 s60, s68, 128
    v_xad_u32 v8, s60, v6, v11
    ds_read_b64_tr_b16 a[116:117], v8 offset:0
    s_add_u32 s60, s68, 160
    v_xad_u32 v9, s60, v6, v11
    ds_read_b64_tr_b16 a[140:141], v9 offset:0
    s_add_u32 s60, s68, 192
    v_xad_u32 v8, s60, v6, v11
    ds_read_b64_tr_b16 a[164:165], v8 offset:0
    s_add_u32 s60, s68, 224
    v_xad_u32 v9, s60, v6, v11
    ds_read_b64_tr_b16 a[188:189], v9 offset:0
    s_add_u32 s60, s68, 256
    v_xad_u32 v8, s60, v6, v11
    ds_read_b64_tr_b16 a[212:213], v8 offset:0
    s_add_u32 s60, s68, 288
    v_xad_u32 v9, s60, v6, v11
    ds_read_b64_tr_b16 a[236:237], v9 offset:0
    s_waitcnt lgkmcnt(0)
    s_waitcnt vmcnt(10)
    s_barrier
    v_add_u32 v11, 0xa000, v10
    s_add_u32 s60, s68, 0
    v_xad_u32 v8, s60, v6, v11
    ds_read_b64_tr_b16 a[12:13], v8 offset:0
    s_add_u32 s60, s68, 32
    v_xad_u32 v9, s60, v6, v11
    ds_read_b64_tr_b16 a[36:37], v9 offset:0
    s_add_u32 s60, s68, 64
    v_xad_u32 v8, s60, v6, v11
    ds_read_b64_tr_b16 a[60:61], v8 offset:0
    s_add_u32 s60, s68, 96
    v_xad_u32 v9, s60, v6, v11
    ds_read_b64_tr_b16 a[84:85], v9 offset:0
    s_add_u32 s60, s68, 128
    v_xad_u32 v8, s60, v6, v11
    ds_read_b64_tr_b16 a[108:109], v8 offset:0
    s_add_u32 s60, s68, 160
    v_xad_u32 v9, s60, v6, v11
    ds_read_b64_tr_b16 a[132:133], v9 offset:0
    s_add_u32 s60, s68, 192
    v_xad_u32 v8, s60, v6, v11
    ds_read_b64_tr_b16 a[156:157], v8 offset:0
    s_add_u32 s60, s68, 224
    v_xad_u32 v9, s60, v6, v11
    ds_read_b64_tr_b16 a[180:181], v9 offset:0
    s_add_u32 s60, s68, 256
    v_xad_u32 v8, s60, v6, v11
    ds_read_b64_tr_b16 a[204:205], v8 offset:0
    s_add_u32 s60, s68, 288
    v_xad_u32 v9, s60, v6, v11
    ds_read_b64_tr_b16 a[228:229], v9 offset:0
    s_waitcnt lgkmcnt(0)
    s_waitcnt vmcnt(5)
    s_barrier
    v_add_u32 v11, 0xf000, v10
    s_add_u32 s60, s68, 0
    v_xad_u32 v8, s60, v6, v11
    ds_read_b64_tr_b16 a[14:15], v8 offset:0
    s_add_u32 s60, s68, 32
    v_xad_u32 v9, s60, v6, v11
    ds_read_b64_tr_b16 a[38:39], v9 offset:0
    s_add_u32 s60, s68, 64
    v_xad_u32 v8, s60, v6, v11
    ds_read_b64_tr_b16 a[62:63], v8 offset:0
    s_add_u32 s60, s68, 96
    v_xad_u32 v9, s60, v6, v11
    ds_read_b64_tr_b16 a[86:87], v9 offset:0
    s_add_u32 s60, s68, 128
    v_xad_u32 v8, s60, v6, v11
    ds_read_b64_tr_b16 a[110:111], v8 offset:0
    s_add_u32 s60, s68, 160
    v_xad_u32 v9, s60, v6, v11
    ds_read_b64_tr_b16 a[134:135], v9 offset:0
    s_add_u32 s60, s68, 192
    v_xad_u32 v8, s60, v6, v11
    ds_read_b64_tr_b16 a[158:159], v8 offset:0
    s_add_u32 s60, s68, 224
    v_xad_u32 v9, s60, v6, v11
    ds_read_b64_tr_b16 a[182:183], v9 offset:0
    s_add_u32 s60, s68, 256
    v_xad_u32 v8, s60, v6, v11
    ds_read_b64_tr_b16 a[206:207], v8 offset:0
    s_add_u32 s60, s68, 288
    v_xad_u32 v9, s60, v6, v11
    ds_read_b64_tr_b16 a[230:231], v9 offset:0
    s_waitcnt lgkmcnt(0)
    s_waitcnt vmcnt(0)
    s_barrier
    v_add_u32 v11, 0x14000, v10
    s_add_u32 s60, s68, 0
    v_xad_u32 v8, s60, v6, v11
    ds_read_b64_tr_b16 a[22:23], v8 offset:0
    s_add_u32 s60, s68, 32
    v_xad_u32 v9, s60, v6, v11
    ds_read_b64_tr_b16 a[46:47], v9 offset:0
    s_add_u32 s60, s68, 64
    v_xad_u32 v8, s60, v6, v11
    ds_read_b64_tr_b16 a[70:71], v8 offset:0
    s_add_u32 s60, s68, 96
    v_xad_u32 v9, s60, v6, v11
    ds_read_b64_tr_b16 a[94:95], v9 offset:0
    s_add_u32 s60, s68, 128
    v_xad_u32 v8, s60, v6, v11
    ds_read_b64_tr_b16 a[118:119], v8 offset:0
    s_add_u32 s60, s68, 160
    v_xad_u32 v9, s60, v6, v11
    ds_read_b64_tr_b16 a[142:143], v9 offset:0
    s_add_u32 s60, s68, 192
    v_xad_u32 v8, s60, v6, v11
    ds_read_b64_tr_b16 a[166:167], v8 offset:0
    s_add_u32 s60, s68, 224
    v_xad_u32 v9, s60, v6, v11
    ds_read_b64_tr_b16 a[190:191], v9 offset:0
    s_add_u32 s60, s68, 256
    v_xad_u32 v8, s60, v6, v11
    ds_read_b64_tr_b16 a[214:215], v8 offset:0
    s_add_u32 s60, s68, 288
    v_xad_u32 v9, s60, v6, v11
    ds_read_b64_tr_b16 a[238:239], v9 offset:0
    s_waitcnt lgkmcnt(0)
    s_barrier
    v_lshlrev_b32 v15, 3, v1
    s_mul_i32 s72, s24, 12288
    s_add_u32 s72, s72, 0x6000000
    s_mul_i32 s73, s3, 409600
    s_lshl_b32 s28, s24, 10
    s_add_u32 s73, s73, s28
    s_add_u32 s73, s73, 0x8000000
    s_lshl_b32 s28, s24, 7
    s_add_u32 s75, s28, 0x602000
    s_lshl_b32 s74, s24, 7
    s_lshl_b32 s28, s3, 2
    s_add_u32 s74, s74, s28
    s_add_u32 s74, s74, 0x603000
    s_mul_i32 s76, s3, 3072
    s_add_u32 s72, s72, s76
    s_lshl_b32 s28, s3, 2
    s_add_u32 s75, s75, s28
    v_mov_b32 v3, 0
    s_mov_b32 s29, 132
    s_mov_b32 s27, 0x100000
Lp_34:
    buffer_load_dword v4, v3, s[16:19], s29 offen sc1
    s_waitcnt vmcnt(0)
    v_cmp_gt_u32 vcc, 1, v4
    s_nop 0
    s_cbranch_vccz Ld_35
    s_sub_u32 s27, s27, 1
    s_cbranch_scc1 L_abort
    s_sleep 6
    s_branch Lp_34
Ld_35:
    v_mov_b32 v4, 0x40000000
    v_cmp_eq_u32 vcc, 0, v1
    s_nop 1
    v_cndmask_b32 v9, v4, v3, vcc
    s_mov_b32 s25, 0
    s_mov_b32 s77, 0
    v_mov_b32 v140, 0
    s_mov_b32 s78, 32
L_loop_O:
    v_mov_b32 v4, s25
    s_add_u32 s29, s25, 1
    s_waitcnt vmcnt(9)
    s_cmp_eq_u32 s77, 1
    s_cbranch_scc1 Lq_36
    v_cmp_gt_u32 vcc, s29, v140
    s_nop 0
    s_cbranch_vccz Lq_37
    s_waitcnt vmcnt(0)
    buffer_store_dword v4, v9, s[4:7], s74 offen sc1
    s_mov_b32 s27, 0x100000
Lp_38:
    buffer_load_dword v140, v3, s[4:7], s75 offen sc1
    s_waitcnt vmcnt(0)
    v_cmp_gt_u32 vcc, s29, v140
    s_nop 0
    s_cbranch_vccz Ld_39
    s_sub_u32 s27, s27, 1
    s_cbranch_scc1 L_abort
    s_sleep 1
    s_branch Lp_38
Ld_39:
Lq_37:
    s_add_u32 m0, s76, 0
    s_nop 0
    buffer_load_dwordx4 v2, s[4:7], s72 offen offset:0 sc1 lds
    buffer_load_dwordx4 v2, s[4:7], s72 offen offset:1024 sc1 lds
    buffer_load_dwordx4 v2, s[4:7], s72 offen offset:2048 sc1 lds
    s_add_u32 s72, s72, 524288
    s_bitset0_b32 s72, 23
    buffer_load_dword v140, v3, s[4:7], s75 offen sc1
    s_waitcnt vmcnt(4)
    buffer_store_dword v4, v9, s[4:7], s74 offen sc1
    s_waitcnt vmcnt(1)
Lq_36:
    s_cmp_lt_u32 s25, s78
    s_cbranch_scc1 Lr_40
    v_mov_b32 v3, 0
    s_mov_b32 s29, 128
    s_mov_b32 s27, 0x100000
Lp_41:
    buffer_load_dword v144, v3, s[16:19], s29 offen sc1
    s_waitcnt vmcnt(0)
    v_cmp_gt_u32 vcc, 1, v144
    s_nop 0
    s_cbranch_vccz Ld_42
    s_sub_u32 s27, s27, 1
    s_cbranch_scc1 L_abort
    s_sleep 6
    s_branch Lp_41
Ld_42:
    v_readfirstlane_b32 s26, v144
    s_nop 0
    s_and_b32 s26, s26, 0xffff
    s_cmp_gt_u32 s26, 512
    s_cselect_b32 s26, 8192, 0
    v_cmp_gt_u32 vcc, 24, v1
    v_lshlrev_b32 v145, 7, v1
    s_nop 0
    v_cndmask_b32 v145, 0, v145, vcc
    s_add_u32 s30, s26, 0x149000
    s_sub_u32 s29, s25, 31
    s_mul_i32 s29, s29, 5
    s_mov_b32 s27, 0x100000
Lp_43:
    buffer_load_dword v144, v145, s[4:7], s30 offen sc1
    s_waitcnt vmcnt(0)
    v_cmp_gt_u32 vcc, s29, v144
    s_nop 0
    s_cbranch_vccz Ld_44
    s_sub_u32 s27, s27, 1
    s_cbranch_scc1 L_abort
    s_sleep 8
    s_branch Lp_43
Ld_44:
    s_add_u32 s78, s25, 1
    s_add_u32 s30, s29, 10
    v_cmp_gt_u32 vcc, s30, v144
    s_add_u32 s31, s25, 3
    s_cmp_eq_u64 vcc, 0
    s_cselect_b32 s78, s31, s78
    s_add_u32 s30, s29, 30
    v_cmp_gt_u32 vcc, s30, v144
    s_add_u32 s31, s25, 7
    s_cmp_eq_u64 vcc, 0
    s_cselect_b32 s78, s31, s78
    s_add_u32 s30, s29, 60
    v_cmp_gt_u32 vcc, s30, v144
    s_add_u32 s31, s25, 13
    s_cmp_eq_u64 vcc, 0
    s_cselect_b32 s78, s31, s78
Lr_40:
    s_barrier
    ds_read_b128 v[16:19], v2 offset:0
    ds_read_b128 v[40:43], v2 offset:1536
    ds_read_b128 v[20:23], v2 offset:3072
    ds_read_b128 v[44:47], v2 offset:4608
    ds_read_b128 v[24:27], v2 offset:6144
    ds_read_b128 v[48:51], v2 offset:7680
    ds_read_b128 v[28:31], v2 offset:9216
    ds_read_b128 v[52:55], v2 offset:10752
    ds_read_b64 v[32:33], v15 offset:1024
    ds_read_b64 v[34:35], v15 offset:4096
    ds_read_b64 v[56:57], v15 offset:2560
    ds_read_b64 v[58:59], v15 offset:5632
    ds_read_b64 v[36:37], v15 offset:7168
    ds_read_b64 v[38:39], v15 offset:10240
    ds_read_b64 v[60:61], v15 offset:8704
    ds_read_b64 v[62:63], v15 offset:11776
    s_add_u32 s29, s25, 2
    v_cmp_gt_u32 vcc, s29, v140
    s_nop 0
    s_cmp_eq_u64 vcc, 0
    s_cselect_b32 s77, 1, 0
    s_waitcnt lgkmcnt(15)
    v_mfma_f32_16x16x32_bf16 v[112:115], v[16:19], a[0:3], 0
    s_waitcnt lgkmcnt(14)
    v_mfma_f32_16x16x32_bf16 v[116:119], v[40:43], a[0:3], 0
    s_waitcnt lgkmcnt(13)
    v_mfma_f32_16x16x32_bf16 v[112:115], v[20:23], a[4:7], v[112:115]
    s_waitcnt lgkmcnt(12)
    v_mfma_f32_16x16x32_bf16 v[116:119], v[44:47], a[4:7], v[116:119]
    s_waitcnt lgkmcnt(11)
    v_mfma_f32_16x16x32_bf16 v[112:115], v[24:27], a[8:11], v[112:115]
    s_waitcnt lgkmcnt(10)
    v_mfma_f32_16x16x32_bf16 v[116:119], v[48:51], a[8:11], v[116:119]
    s_waitcnt lgkmcnt(9)
    v_mfma_f32_16x16x32_bf16 v[112:115], v[28:31], a[12:15], v[112:115]
    s_waitcnt lgkmcnt(8)
    v_mfma_f32_16x16x32_bf16 v[116:119], v[52:55], a[12:15], v[116:119]
    s_waitcnt lgkmcnt(6)
    v_mfma_f32_16x16x32_bf16 v[112:115], v[32:35], a[16:19], v[112:115]
    s_waitcnt lgkmcnt(4)
    v_mfma_f32_16x16x32_bf16 v[116:119], v[56:59], a[16:19], v[116:119]
    s_waitcnt lgkmcnt(2)
    v_mfma_f32_16x16x32_bf16 v[112:115], v[36:39], a[20:23], v[112:115]
    s_waitcnt lgkmcnt(0)
    v_mfma_f32_16x16x32_bf16 v[116:119], v[60:63], a[20:23], v[116:119]
    v_mfma_f32_16x16x32_bf16 v[120:123], v[16:19], a[24:27], 0
    v_mfma_f32_16x16x32_bf16 v[124:127], v[40:43], a[24:27], 0
    v_mfma_f32_16x16x32_bf16 v[120:123], v[20:23], a[28:31], v[120:123]
    v_cvt_pk_bf16_f32 v128, v112, v113
    v_mfma_f32_16x16x32_bf16 v[124:127], v[44:47], a[28:31], v[124:127]
    v_cvt_pk_bf16_f32 v129, v116, v117
    v_mfma_f32_16x16x32_bf16 v[120:123], v[24:27], a[32:35], v[120:123]
    v_cvt_pk_bf16_f32 v130, v114, v115
    v_mfma_f32_16x16x32_bf16 v[124:127], v[48:51], a[32:35], v[124:127]
    v_cvt_pk_bf16_f32 v131, v118, v119
    v_mfma_f32_16x16x32_bf16 v[120:123], v[28:31], a[36:39], v[120:123]
    s_add_u32 s60, s73, 0
    buffer_store_dwordx4 v[128:131], v2, s[4:7], s60 offen sc1
    v_mfma_f32_16x16x32_bf16 v[124:127], v[52:55], a[36:39], v[124:127]
    v_mfma_f32_16x16x32_bf16 v[120:123], v[32:35], a[40:43], v[120:123]
    v_mfma_f32_16x16x32_bf16 v[124:127], v[56:59], a[40:43], v[124:127]
    s_cmp_eq_u32 s77, 0
    s_cbranch_scc1 Ls_45
    s_add_u32 m0, s76, 12288
    s_nop 0
    buffer_load_dwordx4 v2, s[4:7], s72 offen offset:0 sc1 lds
    buffer_load_dwordx4 v2, s[4:7], s72 offen offset:1024 sc1 lds
    buffer_load_dwordx4 v2, s[4:7], s72 offen offset:2048 sc1 lds
    s_add_u32 s72, s72, 524288
    s_bitset0_b32 s72, 23
Ls_45:
    v_mfma_f32_16x16x32_bf16 v[120:123], v[36:39], a[44:47], v[120:123]
    v_mfma_f32_16x16x32_bf16 v[124:127], v[60:63], a[44:47], v[124:127]
    v_mfma_f32_16x16x32_bf16 v[112:115], v[16:19], a[48:51], 0
    v_mfma_f32_16x16x32_bf16 v[116:119], v[40:43], a[48:51], 0
    v_mfma_f32_16x16x32_bf16 v[112:115], v[20:23], a[52:55], v[112:115]
    v_cvt_pk_bf16_f32 v132, v120, v121
    v_mfma_f32_16x16x32_bf16 v[116:119], v[44:47], a[52:55], v[116:119]
    v_cvt_pk_bf16_f32 v133, v124, v125
    v_mfma_f32_16x16x32_bf16 v[112:115], v[24:27], a[56:59], v[112:115]
    v_cvt_pk_bf16_f32 v134, v122, v123
    v_mfma_f32_16x16x32_bf16 v[116:119], v[48:51], a[56:59], v[116:119]
    v_cvt_pk_bf16_f32 v135, v126, v127
    v_mfma_f32_16x16x32_bf16 v[112:115], v[28:31], a[60:63], v[112:115]
    s_add_u32 s60, s73, 40960
    buffer_store_dwordx4 v[132:135], v2, s[4:7], s60 offen sc1
    v_mfma_f32_16x16x32_bf16 v[116:119], v[52:55], a[60:63], v[116:119]
    v_mfma_f32_16x16x32_bf16 v[112:115], v[32:35], a[64:67], v[112:115]
    v_mfma_f32_16x16x32_bf16 v[116:119], v[56:59], a[64:67], v[116:119]
    v_mfma_f32_16x16x32_bf16 v[112:115], v[36:39], a[68:71], v[112:115]
    buffer_load_dword v140, v3, s[4:7], s75 offen sc1
    v_mfma_f32_16x16x32_bf16 v[116:119], v[60:63], a[68:71], v[116:119]
    v_mfma_f32_16x16x32_bf16 v[120:123], v[16:19], a[72:75], 0
    v_mfma_f32_16x16x32_bf16 v[124:127], v[40:43], a[72:75], 0
    v_mfma_f32_16x16x32_bf16 v[120:123], v[20:23], a[76:79], v[120:123]
    v_cvt_pk_bf16_f32 v128, v112, v113
    v_mfma_f32_16x16x32_bf16 v[124:127], v[44:47], a[76:79], v[124:127]
    v_cvt_pk_bf16_f32 v129, v116, v117
    v_mfma_f32_16x16x32_bf16 v[120:123], v[24:27], a[80:83], v[120:123]
    v_cvt_pk_bf16_f32 v130, v114, v115
    v_mfma_f32_16x16x32_bf16 v[124:127], v[48:51], a[80:83], v[124:127]
    v_cvt_pk_bf16_f32 v131, v118, v119
    v_mfma_f32_16x16x32_bf16 v[120:123], v[28:31], a[84:87], v[120:123]
    s_add_u32 s60, s73, 81920
    buffer_store_dwordx4 v[128:131], v2, s[4:7], s60 offen sc1
    v_mfma_f32_16x16x32_bf16 v[124:127], v[52:55], a[84:87], v[124:127]
    v_mfma_f32_16x16x32_bf16 v[120:123], v[32:35], a[88:91], v[120:123]
    v_mfma_f32_16x16x32_bf16 v[124:127], v[56:59], a[88:91], v[124:127]
    v_mfma_f32_16x16x32_bf16 v[120:123], v[36:39], a[92:95], v[120:123]
    v_mfma_f32_16x16x32_bf16 v[124:127], v[60:63], a[92:95], v[124:127]
    v_mfma_f32_16x16x32_bf16 v[112:115], v[16:19], a[96:99], 0
    v_mfma_f32_16x16x32_bf16 v[116:119], v[40:43], a[96:99], 0
    v_mfma_f32_16x16x32_bf16 v[112:115], v[20:23], a[100:103], v[112:115]
    v_cvt_pk_bf16_f32 v132, v120, v121
    v_mfma_f32_16x16x32_bf16 v[116:119], v[44:47], a[100:103], v[116:119]
    v_cvt_pk_bf16_f32 v133, v124, v125
    v_mfma_f32_16x16x32_bf16 v[112:115], v[24:27], a[104:107], v[112:115]
    v_cvt_pk_bf16_f32 v134, v122, v123
    v_mfma_f32_16x16x32_bf16 v[116:119], v[48:51], a[104:107], v[116:119]
    v_cvt_pk_bf16_f32 v135, v126, v127
    v_mfma_f32_16x16x32_bf16 v[112:115], v[28:31], a[108:111], v[112:115]
    s_add_u32 s60, s73, 122880
    buffer_store_dwordx4 v[132:135], v2, s[4:7], s60 offen sc1
    v_mfma_f32_16x16x32_bf16 v[116:119], v[52:55], a[108:111], v[116:119]
    v_mfma_f32_16x16x32_bf16 v[112:115], v[32:35], a[112:115], v[112:115]
    v_mfma_f32_16x16x32_bf16 v[116:119], v[56:59], a[112:115], v[116:119]
    v_mfma_f32_16x16x32_bf16 v[112:115], v[36:39], a[116:119], v[112:115]
    v_mfma_f32_16x16x32_bf16 v[116:119], v[60:63], a[116:119], v[116:119]
    v_mfma_f32_16x16x32_bf16 v[120:123], v[16:19], a[120:123], 0
    v_mfma_f32_16x16x32_bf16 v[124:127], v[40:43], a[120:123], 0
    v_mfma_f32_16x16x32_bf16 v[120:123], v[20:23], a[124:127], v[120:123]
    v_cvt_pk_bf16_f32 v128, v112, v113
    v_mfma_f32_16x16x32_bf16 v[124:127], v[44:47], a[124:127], v[124:127]
    v_cvt_pk_bf16_f32 v129, v116, v117
    v_mfma_f32_16x16x32_bf16 v[120:123], v[24:27], a[128:131], v[120:123]
    v_cvt_pk_bf16_f32 v130, v114, v115
    v_mfma_f32_16x16x32_bf16 v[124:127], v[48:51], a[128:131], v[124:127]
    v_cvt_pk_bf16_f32 v131, v118, v119
    v_mfma_f32_16x16x32_bf16 v[120:123], v[28:31], a[132:135], v[120:123]
    s_add_u32 s60, s73, 163840
    buffer_store_dwordx4 v[128:131], v2, s[4:7], s60 offen sc1
    v_mfma_f32_16x16x32_bf16 v[124:127], v[52:55], a[132:135], v[124:127]
    v_mfma_f32_16x16x32_bf16 v[120:123], v[32:35], a[136:139], v[120:123]
    v_mfma_f32_16x16x32_bf16 v[124:127], v[56:59], a[136:139], v[124:127]
    v_mfma_f32_16x16x32_bf16 v[120:123], v[36:39], a[140:143], v[120:123]
    v_mfma_f32_16x16x32_bf16 v[124:127], v[60:63], a[140:143], v[124:127]
    v_mfma_f32_16x16x32_bf16 v[112:115], v[16:19], a[144:147], 0
    v_mfma_f32_16x16x32_bf16 v[116:119], v[40:43], a[144:147], 0
    v_mfma_f32_16x16x32_bf16 v[112:115], v[20:23], a[148:151], v[112:115]
    v_cvt_pk_bf16_f32 v132, v120, v121
    v_mfma_f32_16x16x32_bf16 v[116:119], v[44:47], a[148:151], v[116:119]
    v_cvt_pk_bf16_f32 v133, v124, v125
    v_mfma_f32_16x16x32_bf16 v[112:115], v[24:27], a[152:155], v[112:115]
    v_cvt_pk_bf16_f32 v134, v122, v123
    v_mfma_f32_16x16x32_bf16 v[116:119], v[48:51], a[152:155], v[116:119]
    v_cvt_pk_bf16_f32 v135, v126, v127
    v_mfma_f32_16x16x32_bf16 v[112:115], v[28:31], a[156:159], v[112:115]
    s_add_u32 s60, s73, 204800
    buffer_store_dwordx4 v[132:135], v2, s[4:7], s60 offen sc1
    v_mfma_f32_16x16x32_bf16 v[116:119], v[52:55], a[156:159], v[116:119]
    v_mfma_f32_16x16x32_bf16 v[112:115], v[32:35], a[160:163], v[112:115]
    v_mfma_f32_16x16x32_bf16 v[116:119], v[56:59], a[160:163], v[116:119]
    s_waitcnt vmcnt(10)
    s_cmp_eq_u32 s77, 1
    s_cbranch_scc1 Ls_46
    s_waitcnt vmcnt(7)
Ls_46:
    buffer_store_dword v4, v9, s[4:7], s74 offen sc1
    v_mfma_f32_16x16x32_bf16 v[112:115], v[36:39], a[164:167], v[112:115]
    v_mfma_f32_16x16x32_bf16 v[116:119], v[60:63], a[164:167], v[116:119]
    v_mfma_f32_16x16x32_bf16 v[120:123], v[16:19], a[168:171], 0
    v_mfma_f32_16x16x32_bf16 v[124:127], v[40:43], a[168:171], 0
    v_mfma_f32_16x16x32_bf16 v[120:123], v[20:23], a[172:175], v[120:123]
    v_cvt_pk_bf16_f32 v128, v112, v113
    v_mfma_f32_16x16x32_bf16 v[124:127], v[44:47], a[172:175], v[124:127]
    v_cvt_pk_bf16_f32 v129, v116, v117
    v_mfma_f32_16x16x32_bf16 v[120:123], v[24:27], a[176:179], v[120:123]
    v_cvt_pk_bf16_f32 v130, v114, v115
    v_mfma_f32_16x16x32_bf16 v[124:127], v[48:51], a[176:179], v[124:127]
    v_cvt_pk_bf16_f32 v131, v118, v119
    v_mfma_f32_16x16x32_bf16 v[120:123], v[28:31], a[180:183], v[120:123]
    s_add_u32 s60, s73, 245760
    buffer_store_dwordx4 v[128:131], v2, s[4:7], s60 offen sc1
    v_mfma_f32_16x16x32_bf16 v[124:127], v[52:55], a[180:183], v[124:127]
    v_mfma_f32_16x16x32_bf16 v[120:123], v[32:35], a[184:187], v[120:123]
    v_mfma_f32_16x16x32_bf16 v[124:127], v[56:59], a[184:187], v[124:127]
    v_mfma_f32_16x16x32_bf16 v[120:123], v[36:39], a[188:191], v[120:123]
    v_mfma_f32_16x16x32_bf16 v[124:127], v[60:63], a[188:191], v[124:127]
    v_mfma_f32_16x16x32_bf16 v[112:115], v[16:19], a[192:195], 0
    v_mfma_f32_16x16x32_bf16 v[116:119], v[40:43], a[192:195], 0
    v_mfma_f32_16x16x32_bf16 v[112:115], v[20:23], a[196:199], v[112:115]
    v_cvt_pk_bf16_f32 v132, v120, v121
    v_mfma_f32_16x16x32_bf16 v[116:119], v[44:47], a[196:199], v[116:119]
    v_cvt_pk_bf16_f32 v133, v124, v125
    v_mfma_f32_16x16x32_bf16 v[112:115], v[24:27], a[200:203], v[112:115]
    v_cvt_pk_bf16_f32 v134, v122, v123
    v_mfma_f32_16x16x32_bf16 v[116:119], v[48:51], a[200:203], v[116:119]
    v_cvt_pk_bf16_f32 v135, v126, v127
    v_mfma_f32_16x16x32_bf16 v[112:115], v[28:31], a[204:207], v[112:115]
    s_add_u32 s60, s73, 286720
    buffer_store_dwordx4 v[132:135], v2, s[4:7], s60 offen sc1
    v_mfma_f32_16x16x32_bf16 v[116:119], v[52:55], a[204:207], v[116:119]
    v_mfma_f32_16x16x32_bf16 v[112:115], v[32:35], a[208:211], v[112:115]
    v_mfma_f32_16x16x32_bf16 v[116:119], v[56:59], a[208:211], v[116:119]
    v_mfma_f32_16x16x32_bf16 v[112:115], v[36:39], a[212:215], v[112:115]
    v_mfma_f32_16x16x32_bf16 v[116:119], v[60:63], a[212:215], v[116:119]
    v_mfma_f32_16x16x32_bf16 v[120:123], v[16:19], a[216:219], 0
    v_mfma_f32_16x16x32_bf16 v[124:127], v[40:43], a[216:219], 0
    v_mfma_f32_16x16x32_bf16 v[120:123], v[20:23], a[220:223], v[120:123]
    v_cvt_pk_bf16_f32 v128, v112, v113
    v_mfma_f32_16x16x32_bf16 v[124:127], v[44:47], a[220:223], v[124:127]
    v_cvt_pk_bf16_f32 v129, v116, v117
    v_mfma_f32_16x16x32_bf16 v[120:123], v[24:27], a[224:227], v[120:123]
    v_cvt_pk_bf16_f32 v130, v114, v115
    v_mfma_f32_16x16x32_bf16 v[124:127], v[48:51], a[224:227], v[124:127]
    v_cvt_pk_bf16_f32 v131, v118, v119
    v_mfma_f32_16x16x32_bf16 v[120:123], v[28:31], a[228:231], v[120:123]
    s_add_u32 s60, s73, 327680
    buffer_store_dwordx4 v[128:131], v2, s[4:7], s60 offen sc1
    v_mfma_f32_16x16x32_bf16 v[124:127], v[52:55], a[228:231], v[124:127]
    v_mfma_f32_16x16x32_bf16 v[120:123], v[32:35], a[232:235], v[120:123]
    v_mfma_f32_16x16x32_bf16 v[124:127], v[56:59], a[232:235], v[124:127]
    v_mfma_f32_16x16x32_bf16 v[120:123], v[36:39], a[236:239], v[120:123]
    v_mfma_f32_16x16x32_bf16 v[124:127], v[60:63], a[236:239], v[124:127]
    s_nop 3
    v_cvt_pk_bf16_f32 v132, v120, v121
    s_nop 2
    v_cvt_pk_bf16_f32 v133, v124, v125
    v_cvt_pk_bf16_f32 v134, v122, v123
    v_cvt_pk_bf16_f32 v135, v126, v127
    s_add_u32 s60, s73, 368640
    buffer_store_dwordx4 v[132:135], v2, s[4:7], s60 offen sc1
    s_add_u32 s73, s73, 2097152
    s_bitset0_b32 s73, 26
    s_add_u32 s25, s25, 1
    v_mov_b32 v4, s25
    s_add_u32 s29, s25, 1
    s_waitcnt vmcnt(9)
    s_cmp_eq_u32 s77, 1
    s_cbranch_scc1 Lq_47
    v_cmp_gt_u32 vcc, s29, v140
    s_nop 0
    s_cbranch_vccz Lq_48
    s_waitcnt vmcnt(0)
    buffer_store_dword v4, v9, s[4:7], s74 offen sc1
    s_mov_b32 s27, 0x100000
Lp_49:
    buffer_load_dword v140, v3, s[4:7], s75 offen sc1
    s_waitcnt vmcnt(0)
    v_cmp_gt_u32 vcc, s29, v140
    s_nop 0
    s_cbranch_vccz Ld_50
    s_sub_u32 s27, s27, 1
    s_cbranch_scc1 L_abort
    s_sleep 1
    s_branch Lp_49
Ld_50:
Lq_48:
    s_add_u32 m0, s76, 12288
    s_nop 0
    buffer_load_dwordx4 v2, s[4:7], s72 offen offset:0 sc1 lds
    buffer_load_dwordx4 v2, s[4:7], s72 offen offset:1024 sc1 lds
    buffer_load_dwordx4 v2, s[4:7], s72 offen offset:2048 sc1 lds
    s_add_u32 s72, s72, 524288
    s_bitset0_b32 s72, 23
    buffer_load_dword v140, v3, s[4:7], s75 offen sc1
    s_waitcnt vmcnt(4)
    buffer_store_dword v4, v9, s[4:7], s74 offen sc1
    s_waitcnt vmcnt(1)
Lq_47:
    s_cmp_lt_u32 s25, s78
    s_cbranch_scc1 Lr_51
    v_mov_b32 v3, 0
    s_mov_b32 s29, 128
    s_mov_b32 s27, 0x100000
Lp_52:
    buffer_load_dword v144, v3, s[16:19], s29 offen sc1
    s_waitcnt vmcnt(0)
    v_cmp_gt_u32 vcc, 1, v144
    s_nop 0
    s_cbranch_vccz Ld_53
    s_sub_u32 s27, s27, 1
    s_cbranch_scc1 L_abort
    s_sleep 6
    s_branch Lp_52
Ld_53:
    v_readfirstlane_b32 s26, v144
    s_nop 0
    s_and_b32 s26, s26, 0xffff
    s_cmp_gt_u32 s26, 512
    s_cselect_b32 s26, 8192, 0
    v_cmp_gt_u32 vcc, 24, v1
    v_lshlrev_b32 v145, 7, v1
    s_nop 0
    v_cndmask_b32 v145, 0, v145, vcc
    s_add_u32 s30, s26, 0x149000
    s_sub_u32 s29, s25, 31
    s_mul_i32 s29, s29, 5
    s_mov_b32 s27, 0x100000
Lp_54:
    buffer_load_dword v144, v145, s[4:7], s30 offen sc1
    s_waitcnt vmcnt(0)
    v_cmp_gt_u32 vcc, s29, v144
    s_nop 0
    s_cbranch_vccz Ld_55
    s_sub_u32 s27, s27, 1
    s_cbranch_scc1 L_abort
    s_sleep 8
    s_branch Lp_54
Ld_55:
    s_add_u32 s78, s25, 1
    s_add_u32 s30, s29, 10
    v_cmp_gt_u32 vcc, s30, v144
    s_add_u32 s31, s25, 3
    s_cmp_eq_u64 vcc, 0
    s_cselect_b32 s78, s31, s78
    s_add_u32 s30, s29, 30
    v_cmp_gt_u32 vcc, s30, v144
    s_add_u32 s31, s25, 7
    s_cmp_eq_u64 vcc, 0
    s_cselect_b32 s78, s31, s78
    s_add_u32 s30, s29, 60
    v_cmp_gt_u32 vcc, s30, v144
    s_add_u32 s31, s25, 13
    s_cmp_eq_u64 vcc, 0
    s_cselect_b32 s78, s31, s78
Lr_51:
    s_barrier
    ds_read_b128 v[16:19], v2 offset:12288
    ds_read_b128 v[40:43], v2 offset:13824
    ds_read_b128 v[20:23], v2 offset:15360
    ds_read_b128 v[44:47], v2 offset:16896
    ds_read_b128 v[24:27], v2 offset:18432
    ds_read_b128 v[48:51], v2 offset:19968
    ds_read_b128 v[28:31], v2 offset:21504
    ds_read_b128 v[52:55], v2 offset:23040
    ds_read_b64 v[32:33], v15 offset:13312
    ds_read_b64 v[34:35], v15 offset:16384
    ds_read_b64 v[56:57], v15 offset:14848
    ds_read_b64 v[58:59], v15 offset:17920
    ds_read_b64 v[36:37], v15 offset:19456
    ds_read_b64 v[38:39], v15 offset:22528
    ds_read_b64 v[60:61], v15 offset:20992
    ds_read_b64 v[62:63], v15 offset:24064
    s_add_u32 s29, s25, 2
    v_cmp_gt_u32 vcc, s29, v140
    s_nop 0
    s_cmp_eq_u64 vcc, 0
    s_cselect_b32 s77, 1, 0
    s_waitcnt lgkmcnt(15)
    v_mfma_f32_16x16x32_bf16 v[112:115], v[16:19], a[0:3], 0
    s_waitcnt lgkmcnt(14)
    v_mfma_f32_16x16x32_bf16 v[116:119], v[40:43], a[0:3], 0
    s_waitcnt lgkmcnt(13)
    v_mfma_f32_16x16x32_bf16 v[112:115], v[20:23], a[4:7], v[112:115]
    s_waitcnt lgkmcnt(12)
    v_mfma_f32_16x16x32_bf16 v[116:119], v[44:47], a[4:7], v[116:119]
    s_waitcnt lgkmcnt(11)
    v_mfma_f32_16x16x32_bf16 v[112:115], v[24:27], a[8:11], v[112:115]
    s_waitcnt lgkmcnt(10)
    v_mfma_f32_16x16x32_bf16 v[116:119], v[48:51], a[8:11], v[116:119]
    s_waitcnt lgkmcnt(9)
    v_mfma_f32_16x16x32_bf16 v[112:115], v[28:31], a[12:15], v[112:115]
    s_waitcnt lgkmcnt(8)
    v_mfma_f32_16x16x32_bf16 v[116:119], v[52:55], a[12:15], v[116:119]
    s_waitcnt lgkmcnt(6)
    v_mfma_f32_16x16x32_bf16 v[112:115], v[32:35], a[16:19], v[112:115]
    s_waitcnt lgkmcnt(4)
    v_mfma_f32_16x16x32_bf16 v[116:119], v[56:59], a[16:19], v[116:119]
    s_waitcnt lgkmcnt(2)
    v_mfma_f32_16x16x32_bf16 v[112:115], v[36:39], a[20:23], v[112:115]
    s_waitcnt lgkmcnt(0)
    v_mfma_f32_16x16x32_bf16 v[116:119], v[60:63], a[20:23], v[116:119]
    v_mfma_f32_16x16x32_bf16 v[120:123], v[16:19], a[24:27], 0
    v_mfma_f32_16x16x32_bf16 v[124:127], v[40:43], a[24:27], 0
    v_mfma_f32_16x16x32_bf16 v[120:123], v[20:23], a[28:31], v[120:123]
    v_cvt_pk_bf16_f32 v128, v112, v113
    v_mfma_f32_16x16x32_bf16 v[124:127], v[44:47], a[28:31], v[124:127]
    v_cvt_pk_bf16_f32 v129, v116, v117
    v_mfma_f32_16x16x32_bf16 v[120:123], v[24:27], a[32:35], v[120:123]
    v_cvt_pk_bf16_f32 v130, v114, v115
    v_mfma_f32_16x16x32_bf16 v[124:127], v[48:51], a[32:35], v[124:127]
    v_cvt_pk_bf16_f32 v131, v118, v119
    v_mfma_f32_16x16x32_bf16 v[120:123], v[28:31], a[36:39], v[120:123]
    s_add_u32 s60, s73, 0
    buffer_store_dwordx4 v[128:131], v2, s[4:7], s60 offen sc1
    v_mfma_f32_16x16x32_bf16 v[124:127], v[52:55], a[36:39], v[124:127]
    v_mfma_f32_16x16x32_bf16 v[120:123], v[32:35], a[40:43], v[120:123]
    v_mfma_f32_16x16x32_bf16 v[124:127], v[56:59], a[40:43], v[124:127]
    s_cmp_eq_u32 s77, 0
    s_cbranch_scc1 Ls_56
    s_add_u32 m0, s76, 0
    s_nop 0
    buffer_load_dwordx4 v2, s[4:7], s72 offen offset:0 sc1 lds
    buffer_load_dwordx4 v2, s[4:7], s72 offen offset:1024 sc1 lds
    buffer_load_dwordx4 v2, s[4:7], s72 offen offset:2048 sc1 lds
    s_add_u32 s72, s72, 524288
    s_bitset0_b32 s72, 23
Ls_56:
    v_mfma_f32_16x16x32_bf16 v[120:123], v[36:39], a[44:47], v[120:123]
    v_mfma_f32_16x16x32_bf16 v[124:127], v[60:63], a[44:47], v[124:127]
    v_mfma_f32_16x16x32_bf16 v[112:115], v[16:19], a[48:51], 0
    v_mfma_f32_16x16x32_bf16 v[116:119], v[40:43], a[48:51], 0
    v_mfma_f32_16x16x32_bf16 v[112:115], v[20:23], a[52:55], v[112:115]
    v_cvt_pk_bf16_f32 v132, v120, v121
    v_mfma_f32_16x16x32_bf16 v[116:119], v[44:47], a[52:55], v[116:119]
    v_cvt_pk_bf16_f32 v133, v124, v125
    v_mfma_f32_16x16x32_bf16 v[112:115], v[24:27], a[56:59], v[112:115]
    v_cvt_pk_bf16_f32 v134, v122, v123
    v_mfma_f32_16x16x32_bf16 v[116:119], v[48:51], a[56:59], v[116:119]
    v_cvt_pk_bf16_f32 v135, v126, v127
    v_mfma_f32_16x16x32_bf16 v[112:115], v[28:31], a[60:63], v[112:115]
    s_add_u32 s60, s73, 40960
    buffer_store_dwordx4 v[132:135], v2, s[4:7], s60 offen sc1
    v_mfma_f32_16x16x32_bf16 v[116:119], v[52:55], a[60:63], v[116:119]
    v_mfma_f32_16x16x32_bf16 v[112:115], v[32:35], a[64:67], v[112:115]
    v_mfma_f32_16x16x32_bf16 v[116:119], v[56:59], a[64:67], v[116:119]
    v_mfma_f32_16x16x32_bf16 v[112:115], v[36:39], a[68:71], v[112:115]
    buffer_load_dword v140, v3, s[4:7], s75 offen sc1
    v_mfma_f32_16x16x32_bf16 v[116:119], v[60:63], a[68:71], v[116:119]
    v_mfma_f32_16x16x32_bf16 v[120:123], v[16:19], a[72:75], 0
    v_mfma_f32_16x16x32_bf16 v[124:127], v[40:43], a[72:75], 0
    v_mfma_f32_16x16x32_bf16 v[120:123], v[20:23], a[76:79], v[120:123]
    v_cvt_pk_bf16_f32 v128, v112, v113
    v_mfma_f32_16x16x32_bf16 v[124:127], v[44:47], a[76:79], v[124:127]
    v_cvt_pk_bf16_f32 v129, v116, v117
    v_mfma_f32_16x16x32_bf16 v[120:123], v[24:27], a[80:83], v[120:123]
    v_cvt_pk_bf16_f32 v130, v114, v115
    v_mfma_f32_16x16x32_bf16 v[124:127], v[48:51], a[80:83], v[124:127]
    v_cvt_pk_bf16_f32 v131, v118, v119
    v_mfma_f32_16x16x32_bf16 v[120:123], v[28:31], a[84:87], v[120:123]
    s_add_u32 s60, s73, 81920
    buffer_store_dwordx4 v[128:131], v2, s[4:7], s60 offen sc1
    v_mfma_f32_16x16x32_bf16 v[124:127], v[52:55], a[84:87], v[124:127]
    v_mfma_f32_16x16x32_bf16 v[120:123], v[32:35], a[88:91], v[120:123]
    v_mfma_f32_16x16x32_bf16 v[124:127], v[56:59], a[88:91], v[124:127]
    v_mfma_f32_16x16x32_bf16 v[120:123], v[36:39], a[92:95], v[120:123]
    v_mfma_f32_16x16x32_bf16 v[124:127], v[60:63], a[92:95], v[124:127]
    v_mfma_f32_16x16x32_bf16 v[112:115], v[16:19], a[96:99], 0
    v_mfma_f32_16x16x32_bf16 v[116:119], v[40:43], a[96:99], 0
    v_mfma_f32_16x16x32_bf16 v[112:115], v[20:23], a[100:103], v[112:115]
    v_cvt_pk_bf16_f32 v132, v120, v121
    v_mfma_f32_16x16x32_bf16 v[116:119], v[44:47], a[100:103], v[116:119]
    v_cvt_pk_bf16_f32 v133, v124, v125
    v_mfma_f32_16x16x32_bf16 v[112:115], v[24:27], a[104:107], v[112:115]
    v_cvt_pk_bf16_f32 v134, v122, v123
    v_mfma_f32_16x16x32_bf16 v[116:119], v[48:51], a[104:107], v[116:119]
    v_cvt_pk_bf16_f32 v135, v126, v127
    v_mfma_f32_16x16x32_bf16 v[112:115], v[28:31], a[108:111], v[112:115]
    s_add_u32 s60, s73, 122880
    buffer_store_dwordx4 v[132:135], v2, s[4:7], s60 offen sc1
    v_mfma_f32_16x16x32_bf16 v[116:119], v[52:55], a[108:111], v[116:119]
    v_mfma_f32_16x16x32_bf16 v[112:115], v[32:35], a[112:115], v[112:115]
    v_mfma_f32_16x16x32_bf16 v[116:119], v[56:59], a[112:115], v[116:119]
    v_mfma_f32_16x16x32_bf16 v[112:115], v[36:39], a[116:119], v[112:115]
    v_mfma_f32_16x16x32_bf16 v[116:119], v[60:63], a[116:119], v[116:119]
    v_mfma_f32_16x16x32_bf16 v[120:123], v[16:19], a[120:123], 0
    v_mfma_f32_16x16x32_bf16 v[124:127], v[40:43], a[120:123], 0
    v_mfma_f32_16x16x32_bf16 v[120:123], v[20:23], a[124:127], v[120:123]
    v_cvt_pk_bf16_f32 v128, v112, v113
    v_mfma_f32_16x16x32_bf16 v[124:127], v[44:47], a[124:127], v[124:127]
    v_cvt_pk_bf16_f32 v129, v116, v117
    v_mfma_f32_16x16x32_bf16 v[120:123], v[24:27], a[128:131], v[120:123]
    v_cvt_pk_bf16_f32 v130, v114, v115
    v_mfma_f32_16x16x32_bf16 v[124:127], v[48:51], a[128:131], v[124:127]
    v_cvt_pk_bf16_f32 v131, v118, v119
    v_mfma_f32_16x16x32_bf16 v[120:123], v[28:31], a[132:135], v[120:123]
    s_add_u32 s60, s73, 163840
    buffer_store_dwordx4 v[128:131], v2, s[4:7], s60 offen sc1
    v_mfma_f32_16x16x32_bf16 v[124:127], v[52:55], a[132:135], v[124:127]
    v_mfma_f32_16x16x32_bf16 v[120:123], v[32:35], a[136:139], v[120:123]
    v_mfma_f32_16x16x32_bf16 v[124:127], v[56:59], a[136:139], v[124:127]
    v_mfma_f32_16x16x32_bf16 v[120:123], v[36:39], a[140:143], v[120:123]
    v_mfma_f32_16x16x32_bf16 v[124:127], v[60:63], a[140:143], v[124:127]
    v_mfma_f32_16x16x32_bf16 v[112:115], v[16:19], a[144:147], 0
    v_mfma_f32_16x16x32_bf16 v[116:119], v[40:43], a[144:147], 0
    v_mfma_f32_16x16x32_bf16 v[112:115], v[20:23], a[148:151], v[112:115]
    v_cvt_pk_bf16_f32 v132, v120, v121
    v_mfma_f32_16x16x32_bf16 v[116:119], v[44:47], a[148:151], v[116:119]
    v_cvt_pk_bf16_f32 v133, v124, v125
    v_mfma_f32_16x16x32_bf16 v[112:115], v[24:27], a[152:155], v[112:115]
    v_cvt_pk_bf16_f32 v134, v122, v123
    v_mfma_f32_16x16x32_bf16 v[116:119], v[48:51], a[152:155], v[116:119]
    v_cvt_pk_bf16_f32 v135, v126, v127
    v_mfma_f32_16x16x32_bf16 v[112:115], v[28:31], a[156:159], v[112:115]
    s_add_u32 s60, s73, 204800
    buffer_store_dwordx4 v[132:135], v2, s[4:7], s60 offen sc1
    v_mfma_f32_16x16x32_bf16 v[116:119], v[52:55], a[156:159], v[116:119]
    v_mfma_f32_16x16x32_bf16 v[112:115], v[32:35], a[160:163], v[112:115]
    v_mfma_f32_16x16x32_bf16 v[116:119], v[56:59], a[160:163], v[116:119]
    s_waitcnt vmcnt(10)
    s_cmp_eq_u32 s77, 1
    s_cbranch_scc1 Ls_57
    s_waitcnt vmcnt(7)
Ls_57:
    buffer_store_dword v4, v9, s[4:7], s74 offen sc1
    v_mfma_f32_16x16x32_bf16 v[112:115], v[36:39], a[164:167], v[112:115]
    v_mfma_f32_16x16x32_bf16 v[116:119], v[60:63], a[164:167], v[116:119]
    v_mfma_f32_16x16x32_bf16 v[120:123], v[16:19], a[168:171], 0
    v_mfma_f32_16x16x32_bf16 v[124:127], v[40:43], a[168:171], 0
    v_mfma_f32_16x16x32_bf16 v[120:123], v[20:23], a[172:175], v[120:123]
    v_cvt_pk_bf16_f32 v128, v112, v113
    v_mfma_f32_16x16x32_bf16 v[124:127], v[44:47], a[172:175], v[124:127]
    v_cvt_pk_bf16_f32 v129, v116, v117
    v_mfma_f32_16x16x32_bf16 v[120:123], v[24:27], a[176:179], v[120:123]
    v_cvt_pk_bf16_f32 v130, v114, v115
    v_mfma_f32_16x16x32_bf16 v[124:127], v[48:51], a[176:179], v[124:127]
    v_cvt_pk_bf16_f32 v131, v118, v119
    v_mfma_f32_16x16x32_bf16 v[120:123], v[28:31], a[180:183], v[120:123]
    s_add_u32 s60, s73, 245760
    buffer_store_dwordx4 v[128:131], v2, s[4:7], s60 offen sc1
    v_mfma_f32_16x16x32_bf16 v[124:127], v[52:55], a[180:183], v[124:127]
    v_mfma_f32_16x16x32_bf16 v[120:123], v[32:35], a[184:187], v[120:123]
    v_mfma_f32_16x16x32_bf16 v[124:127], v[56:59], a[184:187], v[124:127]
    v_mfma_f32_16x16x32_bf16 v[120:123], v[36:39], a[188:191], v[120:123]
    v_mfma_f32_16x16x32_bf16 v[124:127], v[60:63], a[188:191], v[124:127]
    v_mfma_f32_16x16x32_bf16 v[112:115], v[16:19], a[192:195], 0
    v_mfma_f32_16x16x32_bf16 v[116:119], v[40:43], a[192:195], 0
    v_mfma_f32_16x16x32_bf16 v[112:115], v[20:23], a[196:199], v[112:115]
    v_cvt_pk_bf16_f32 v132, v120, v121
    v_mfma_f32_16x16x32_bf16 v[116:119], v[44:47], a[196:199], v[116:119]
    v_cvt_pk_bf16_f32 v133, v124, v125
    v_mfma_f32_16x16x32_bf16 v[112:115], v[24:27], a[200:203], v[112:115]
    v_cvt_pk_bf16_f32 v134, v122, v123
    v_mfma_f32_16x16x32_bf16 v[116:119], v[48:51], a[200:203], v[116:119]
    v_cvt_pk_bf16_f32 v135, v126, v127
    v_mfma_f32_16x16x32_bf16 v[112:115], v[28:31], a[204:207], v[112:115]
    s_add_u32 s60, s73, 286720
    buffer_store_dwordx4 v[132:135], v2, s[4:7], s60 offen sc1
    v_mfma_f32_16x16x32_bf16 v[116:119], v[52:55], a[204:207], v[116:119]
    v_mfma_f32_16x16x32_bf16 v[112:115], v[32:35], a[208:211], v[112:115]
    v_mfma_f32_16x16x32_bf16 v[116:119], v[56:59], a[208:211], v[116:119]
    v_mfma_f32_16x16x32_bf16 v[112:115], v[36:39], a[212:215], v[112:115]
    v_mfma_f32_16x16x32_bf16 v[116:119], v[60:63], a[212:215], v[116:119]
    v_mfma_f32_16x16x32_bf16 v[120:123], v[16:19], a[216:219], 0
    v_mfma_f32_16x16x32_bf16 v[124:127], v[40:43], a[216:219], 0
    v_mfma_f32_16x16x32_bf16 v[120:123], v[20:23], a[220:223], v[120:123]
    v_cvt_pk_bf16_f32 v128, v112, v113
    v_mfma_f32_16x16x32_bf16 v[124:127], v[44:47], a[220:223], v[124:127]
    v_cvt_pk_bf16_f32 v129, v116, v117
    v_mfma_f32_16x16x32_bf16 v[120:123], v[24:27], a[224:227], v[120:123]
    v_cvt_pk_bf16_f32 v130, v114, v115
    v_mfma_f32_16x16x32_bf16 v[124:127], v[48:51], a[224:227], v[124:127]
    v_cvt_pk_bf16_f32 v131, v118, v119
    v_mfma_f32_16x16x32_bf16 v[120:123], v[28:31], a[228:231], v[120:123]
    s_add_u32 s60, s73, 327680
    buffer_store_dwordx4 v[128:131], v2, s[4:7], s60 offen sc1
    v_mfma_f32_16x16x32_bf16 v[124:127], v[52:55], a[228:231], v[124:127]
    v_mfma_f32_16x16x32_bf16 v[120:123], v[32:35], a[232:235], v[120:123]
    v_mfma_f32_16x16x32_bf16 v[124:127], v[56:59], a[232:235], v[124:127]
    v_mfma_f32_16x16x32_bf16 v[120:123], v[36:39], a[236:239], v[120:123]
    v_mfma_f32_16x16x32_bf16 v[124:127], v[60:63], a[236:239], v[124:127]
    s_nop 3
    v_cvt_pk_bf16_f32 v132, v120, v121
    s_nop 2
    v_cvt_pk_bf16_f32 v133, v124, v125
    v_cvt_pk_bf16_f32 v134, v122, v123
    v_cvt_pk_bf16_f32 v135, v126, v127
    s_add_u32 s60, s73, 368640
    buffer_store_dwordx4 v[132:135], v2, s[4:7], s60 offen sc1
    s_add_u32 s73, s73, 2097152
    s_bitset0_b32 s73, 26
    s_add_u32 s25, s25, 1
    s_cmp_lt_u32 s25, 64
    s_cbranch_scc1 L_loop_O
    s_waitcnt vmcnt(0)
    v_mov_b32 v4, s25
    s_mov_b64 exec, 1
    buffer_store_dword v4, v3, s[4:7], s74 offen sc1
    s_mov_b64 exec, -1
    s_branch L_phase2
L_role_F1:
    s_mov_b32 s8, s48
    s_and_b32 s9, s49, 0xffff
    s_mov_b32 s10, 0x1e0000
    s_mov_b32 s11, 0x20000
    s_lshr_b32 s68, s3, 1
    s_lshl_b32 s71, s24, 7
    s_mul_i32 s28, s3, 98304
    s_add_u32 s71, s71, s28
    v_lshrrev_b32 v9, 4, v1
    v_bfe_u32 v10, v1, 2, 2
    v_and_b32 v11, 3, v1
    v_lshrrev_b32 v6, 3, v1
    v_mul_u32_u24 v6, 3072, v6
    v_and_b32 v4, 7, v1
    v_lshl_add_u32 v6, v4, 4, v6
    v_lshl_add_u32 v7, v9, 3, v10
    v_lshlrev_b32 v7, 7, v7
    v_lshl_add_u32 v7, v11, 3, v7
    s_lshl_b32 s28, s68, 6
    v_add_u32 v7, s28, v7
    s_mul_i32 s61, s3, 4096
    s_add_u32 m0, s61, 0
    s_add_u32 s60, s71, 0x0
    buffer_load_dwordx4 v6, s[8:11], s60 offen nt lds
    s_add_u32 m0, s61, 1024
    s_add_u32 s60, s71, 0x6000
    buffer_load_dwordx4 v6, s[8:11], s60 offen nt lds
    s_add_u32 m0, s61, 2048
    s_add_u32 s60, s71, 0xc000
    buffer_load_dwordx4 v6, s[8:11], s60 offen nt lds
    s_add_u32 m0, s61, 3072
    s_add_u32 s60, s71, 0x12000
    buffer_load_dwordx4 v6, s[8:11], s60 offen nt lds
    s_add_u32 m0, s61, 16384
    s_add_u32 s60, s71, 0x60000
    buffer_load_dwordx4 v6, s[8:11], s60 offen nt lds
    s_add_u32 m0, s61, 17408
    s_add_u32 s60, s71, 0x66000
    buffer_load_dwordx4 v6, s[8:11], s60 offen nt lds
    s_add_u32 m0, s61, 18432
    s_add_u32 s60, s71, 0x6c000
    buffer_load_dwordx4 v6, s[8:11], s60 offen nt lds
    s_add_u32 m0, s61, 19456
    s_add_u32 s60, s71, 0x72000
    buffer_load_dwordx4 v6, s[8:11], s60 offen nt lds
    s_waitcnt vmcnt(4)
    s_barrier
    s_add_u32 m0, s61, 32768
    s_add_u32 s60, s71, 0xc0000
    buffer_load_dwordx4 v6, s[8:11], s60 offen nt lds
    s_add_u32 m0, s61, 33792
    s_add_u32 s60, s71, 0xc6000
    buffer_load_dwordx4 v6, s[8:11], s60 offen nt lds
    s_add_u32 m0, s61, 34816
    s_add_u32 s60, s71, 0xcc000
    buffer_load_dwordx4 v6, s[8:11], s60 offen nt lds
    s_add_u32 m0, s61, 35840
    s_add_u32 s60, s71, 0xd2000
    buffer_load_dwordx4 v6, s[8:11], s60 offen nt lds
    v_add_u32 v8, 0x0, v7
    ds_read_b64_tr_b16 a[0:1], v8 offset:0
    ds_read_b64_tr_b16 a[2:3], v8 offset:512
    ds_read_b64_tr_b16 a[4:5], v8 offset:32
    ds_read_b64_tr_b16 a[6:7], v8 offset:544
    ds_read_b64_tr_b16 a[8:9], v8 offset:4096
    ds_read_b64_tr_b16 a[10:11], v8 offset:4608
    ds_read_b64_tr_b16 a[12:13], v8 offset:4128
    ds_read_b64_tr_b16 a[14:15], v8 offset:4640
    ds_read_b64_tr_b16 a[16:17], v8 offset:8192
    ds_read_b64_tr_b16 a[18:19], v8 offset:8704
    ds_read_b64_tr_b16 a[20:21], v8 offset:8224
    ds_read_b64_tr_b16 a[22:23], v8 offset:8736
    ds_read_b64_tr_b16 a[24:25], v8 offset:12288
    ds_read_b64_tr_b16 a[26:27], v8 offset:12800
    ds_read_b64_tr_b16 a[28:29], v8 offset:12320
    ds_read_b64_tr_b16 a[30:31], v8 offset:12832
    s_waitcnt lgkmcnt(0)
    s_waitcnt vmcnt(4)
    s_barrier
    s_add_u32 m0, s61, 0
    s_add_u32 s60, s71, 0x120000
    buffer_load_dwordx4 v6, s[8:11], s60 offen nt lds
    s_add_u32 m0, s61, 1024
    s_add_u32 s60, s71, 0x126000
    buffer_load_dwordx4 v6, s[8:11], s60 offen nt lds
    s_add_u32 m0, s61, 2048
    s_add_u32 s60, s71, 0x12c000
    buffer_load_dwordx4 v6, s[8:11], s60 offen nt lds
    s_add_u32 m0, s61, 3072
    s_add_u32 s60, s71, 0x132000
    buffer_load_dwordx4 v6, s[8:11], s60 offen nt lds
    v_add_u32 v8, 0x4000, v7
    ds_read_b64_tr_b16 a[32:33], v8 offset:0
    ds_read_b64_tr_b16 a[34:35], v8 offset:512
    ds_read_b64_tr_b16 a[36:37], v8 offset:32
    ds_read_b64_tr_b16 a[38:39], v8 offset:544
    ds_read_b64_tr_b16 a[40:41], v8 offset:4096
    ds_read_b64_tr_b16 a[42:43], v8 offset:4608
    ds_read_b64_tr_b16 a[44:45], v8 offset:4128
    ds_read_b64_tr_b16 a[46:47], v8 offset:4640
    ds_read_b64_tr_b16 a[48:49], v8 offset:8192
    ds_read_b64_tr_b16 a[50:51], v8 offset:8704
    ds_read_b64_tr_b16 a[52:53], v8 offset:8224
    ds_read_b64_tr_b16 a[54:55], v8 offset:8736
    ds_read_b64_tr_b16 a[56:57], v8 offset:12288
    ds_read_b64_tr_b16 a[58:59], v8 offset:12800
    ds_read_b64_tr_b16 a[60:61], v8 offset:12320
    ds_read_b64_tr_b16 a[62:63], v8 offset:12832
    s_waitcnt lgkmcnt(0)
    s_waitcnt vmcnt(4)
    s_barrier
    s_add_u32 m0, s61, 16384
    s_add_u32 s60, s71, 0x180000
    buffer_load_dwordx4 v6, s[8:11], s60 offen nt lds
    s_add_u32 m0, s61, 17408
    s_add_u32 s60, s71, 0x186000
    buffer_load_dwordx4 v6, s[8:11], s60 offen nt lds
    s_add_u32 m0, s61, 18432
    s_add_u32 s60, s71, 0x18c000
    buffer_load_dwordx4 v6, s[8:11], s60 offen nt lds
    s_add_u32 m0, s61, 19456
    s_add_u32 s60, s71, 0x192000
    buffer_load_dwordx4 v6, s[8:11], s60 offen nt lds
    v_add_u32 v8, 0x8000, v7
    ds_read_b64_tr_b16 a[64:65], v8 offset:0
    ds_read_b64_tr_b16 a[66:67], v8 offset:512
    ds_read_b64_tr_b16 a[68:69], v8 offset:32
    ds_read_b64_tr_b16 a[70:71], v8 offset:544
    ds_read_b64_tr_b16 a[72:73], v8 offset:4096
    ds_read_b64_tr_b16 a[74:75], v8 offset:4608
    ds_read_b64_tr_b16 a[76:77], v8 offset:4128
    ds_read_b64_tr_b16 a[78:79], v8 offset:4640
    ds_read_b64_tr_b16 a[80:81], v8 offset:8192
    ds_read_b64_tr_b16 a[82:83], v8 offset:8704
    ds_read_b64_tr_b16 a[84:85], v8 offset:8224
    ds_read_b64_tr_b16 a[86:87], v8 offset:8736
    ds_read_b64_tr_b16 a[88:89], v8 offset:12288
    ds_read_b64_tr_b16 a[90:91], v8 offset:12800
    ds_read_b64_tr_b16 a[92:93], v8 offset:12320
    ds_read_b64_tr_b16 a[94:95], v8 offset:12832
    s_waitcnt lgkmcnt(0)
    s_waitcnt vmcnt(4)
    s_barrier
    v_add_u32 v8, 0x0, v7
    ds_read_b64_tr_b16 a[96:97], v8 offset:0
    ds_read_b64_tr_b16 a[98:99], v8 offset:512
    ds_read_b64_tr_b16 a[100:101], v8 offset:32
    ds_read_b64_tr_b16 a[102:103], v8 offset:544
    ds_read_b64_tr_b16 a[104:105], v8 offset:4096
    ds_read_b64_tr_b16 a[106:107], v8 offset:4608
    ds_read_b64_tr_b16 a[108:109], v8 offset:4128
    ds_read_b64_tr_b16 a[110:111], v8 offset:4640
    ds_read_b64_tr_b16 a[112:113], v8 offset:8192
    ds_read_b64_tr_b16 a[114:115], v8 offset:8704
    ds_read_b64_tr_b16 a[116:117], v8 offset:8224
    ds_read_b64_tr_b16 a[118:119], v8 offset:8736
    ds_read_b64_tr_b16 a[120:121], v8 offset:12288
    ds_read_b64_tr_b16 a[122:123], v8 offset:12800
    ds_read_b64_tr_b16 a[124:125], v8 offset:12320
    ds_read_b64_tr_b16 a[126:127], v8 offset:12832
    s_waitcnt lgkmcnt(0)
    s_waitcnt vmcnt(0)
    s_barrier
    v_add_u32 v8, 0x4000, v7
    ds_read_b64_tr_b16 a[128:129], v8 offset:0
    ds_read_b64_tr_b16 a[130:131], v8 offset:512
    ds_read_b64_tr_b16 a[132:133], v8 offset:32
    ds_read_b64_tr_b16 a[134:135], v8 offset:544
    ds_read_b64_tr_b16 a[136:137], v8 offset:4096
    ds_read_b64_tr_b16 a[138:139], v8 offset:4608
    ds_read_b64_tr_b16 a[140:141], v8 offset:4128
    ds_read_b64_tr_b16 a[142:143], v8 offset:4640
    ds_read_b64_tr_b16 a[144:145], v8 offset:8192
    ds_read_b64_tr_b16 a[146:147], v8 offset:8704
    ds_read_b64_tr_b16 a[148:149], v8 offset:8224
    ds_read_b64_tr_b16 a[150:151], v8 offset:8736
    ds_read_b64_tr_b16 a[152:153], v8 offset:12288
    ds_read_b64_tr_b16 a[154:155], v8 offset:12800
    ds_read_b64_tr_b16 a[156:157], v8 offset:12320
    ds_read_b64_tr_b16 a[158:159], v8 offset:12832
    s_waitcnt lgkmcnt(0)
    s_barrier
    v_mov_b32 v20, 0x3f803f80
    v_mov_b32 v21, 0x3f803f80
    v_mov_b32 v22, 0x3f803f80
    v_mov_b32 v23, 0x3f803f80
    s_nop 1
    v_mfma_f32_16x16x32_bf16 v[24:27], a[0:3], v[20:23], 0
    v_mfma_f32_16x16x32_bf16 v[28:31], a[4:7], v[20:23], 0
    v_mfma_f32_16x16x32_bf16 v[24:27], a[8:11], v[20:23], v[24:27]
    v_mfma_f32_16x16x32_bf16 v[28:31], a[12:15], v[20:23], v[28:31]
    v_mfma_f32_16x16x32_bf16 v[24:27], a[16:19], v[20:23], v[24:27]
    v_mfma_f32_16x16x32_bf16 v[28:31], a[20:23], v[20:23], v[28:31]
    v_mfma_f32_16x16x32_bf16 v[24:27], a[24:27], v[20:23], v[24:27]
    v_mfma_f32_16x16x32_bf16 v[28:31], a[28:31], v[20:23], v[28:31]
    v_mfma_f32_16x16x32_bf16 v[24:27], a[32:35], v[20:23], v[24:27]
    v_mfma_f32_16x16x32_bf16 v[28:31], a[36:39], v[20:23], v[28:31]
    v_mfma_f32_16x16x32_bf16 v[24:27], a[40:43], v[20:23], v[24:27]
    v_mfma_f32_16x16x32_bf16 v[28:31], a[44:47], v[20:23], v[28:31]
    v_mfma_f32_16x16x32_bf16 v[24:27], a[48:51], v[20:23], v[24:27]
    v_mfma_f32_16x16x32_bf16 v[28:31], a[52:55], v[20:23], v[28:31]
    v_mfma_f32_16x16x32_bf16 v[24:27], a[56:59], v[20:23], v[24:27]
    v_mfma_f32_16x16x32_bf16 v[28:31], a[60:63], v[20:23], v[28:31]
    v_mfma_f32_16x16x32_bf16 v[24:27], a[64:67], v[20:23], v[24:27]
    v_mfma_f32_16x16x32_bf16 v[28:31], a[68:71], v[20:23], v[28:31]
    v_mfma_f32_16x16x32_bf16 v[24:27], a[72:75], v[20:23], v[24:27]
    v_mfma_f32_16x16x32_bf16 v[28:31], a[76:79], v[20:23], v[28:31]
    v_mfma_f32_16x16x32_bf16 v[24:27], a[80:83], v[20:23], v[24:27]
    v_mfma_f32_16x16x32_bf16 v[28:31], a[84:87], v[20:23], v[28:31]
    v_mfma_f32_16x16x32_bf16 v[24:27], a[88:91], v[20:23], v[24:27]
    v_mfma_f32_16x16x32_bf16 v[28:31], a[92:95], v[20:23], v[28:31]
    v_mfma_f32_16x16x32_bf16 v[24:27], a[96:99], v[20:23], v[24:27]
    v_mfma_f32_16x16x32_bf16 v[28:31], a[100:103], v[20:23], v[28:31]
    v_mfma_f32_16x16x32_bf16 v[24:27], a[104:107], v[20:23], v[24:27]
    v_mfma_f32_16x16x32_bf16 v[28:31], a[108:111], v[20:23], v[28:31]
    v_mfma_f32_16x16x32_bf16 v[24:27], a[112:115], v[20:23], v[24:27]
    v_mfma_f32_16x16x32_bf16 v[28:31], a[116:119], v[20:23], v[28:31]
    v_mfma_f32_16x16x32_bf16 v[24:27], a[120:123], v[20:23], v[24:27]
    v_mfma_f32_16x16x32_bf16 v[28:31], a[124:127], v[20:23], v[28:31]
    v_mfma_f32_16x16x32_bf16 v[24:27], a[128:131], v[20:23], v[24:27]
    v_mfma_f32_16x16x32_bf16 v[28:31], a[132:135], v[20:23], v[28:31]
    v_mfma_f32_16x16x32_bf16 v[24:27], a[136:139], v[20:23], v[24:27]
    v_mfma_f32_16x16x32_bf16 v[28:31], a[140:143], v[20:23], v[28:31]
    v_mfma_f32_16x16x32_bf16 v[24:27], a[144:147], v[20:23], v[24:27]
    v_mfma_f32_16x16x32_bf16 v[28:31], a[148:151], v[20:23], v[28:31]
    v_mfma_f32_16x16x32_bf16 v[24:27], a[152:155], v[20:23], v[24:27]
    v_mfma_f32_16x16x32_bf16 v[28:31], a[156:159], v[20:23], v[28:31]
    s_mov_b32 s20, s50
    s_and_b32 s21, s51, 0xffff
    s_mov_b32 s22, 0xc00
    s_mov_b32 s23, 0x20000
    s_lshl_b32 s28, s24, 7
    s_lshl_b32 s29, s68, 6
    s_add_u32 s28, s28, s29
    v_lshlrev_b32 v4, 3, v9
    buffer_load_dwordx2 v[84:85], v4, s[20:23], s28 offen offset:0
    buffer_load_dwordx2 v[86:87], v4, s[20:23], s28 offen offset:32
    s_waitcnt vmcnt(0)
    v_lshlrev_b32 v32, 16, v84
    v_and_b32 v33, 0xffff0000, v84
    v_lshlrev_b32 v34, 16, v85
    v_and_b32 v35, 0xffff0000, v85
    v_lshlrev_b32 v36, 16, v86
    v_and_b32 v37, 0xffff0000, v86
    v_lshlrev_b32 v38, 16, v87
    v_and_b32 v39, 0xffff0000, v87
    v_bfe_u32 v4, v1, 2, 2
    v_lshrrev_b32 v5, 4, v1
    v_cmp_eq_u32 s[74:75], v4, v5
    v_and_b32 v4, 1, v1
    v_cmp_eq_u32 s[76:77], 1, v4
    v_and_b32 v4, 2, v1
    v_cmp_eq_u32 s[78:79], 2, v4
    s_and_b32 s30, s3, 1
    s_mul_i32 s28, s30, 20480
    v_add_u32 v12, s28, v2
    v_add_u32 v13, 40960, v12
    v_and_b32 v4, 15, v1
    v_lshlrev_b32 v4, 3, v4
    s_lshl_b32 s28, s30, 7
    s_add_u32 s28, s28, 81920
    v_add_u32 v16, s28, v4
    s_lshl_b32 s28, s68, 8
    v_add_u32 v15, s28, v16
    s_mul_i32 s64, s3, 10240
    s_mul_i32 s72, s81, 40960
    s_add_u32 s72, s72, s64
    s_add_u32 s72, s72, 0xd00000
    s_lshl_b32 s73, s24, 1
    s_add_u32 s73, s73, s68
    s_lshl_b32 s73, s73, 10
    s_mul_i32 s28, s30, 49152
    s_add_u32 s73, s73, s28
    s_mul_i32 s28, s81, 98304
    s_add_u32 s73, s73, s28
    s_add_u32 s73, s73, 0x1000000
    s_mul_i32 s29, s81, 24
    s_add_u32 s29, s29, s24
    s_lshl_b32 s62, s29, 7
    s_add_u32 s62, s62, 0x604000
    v_mov_b32 v3, 0
    s_mov_b32 s29, 128
    s_mov_b32 s27, 0x100000
Lp_58:
    buffer_load_dword v4, v3, s[16:19], s29 offen sc1
    s_waitcnt vmcnt(0)
    v_cmp_gt_u32 vcc, 1, v4
    s_nop 0
    s_cbranch_vccz Ld_59
    s_sub_u32 s27, s27, 1
    s_cbranch_scc1 L_abort
    s_sleep 6
    s_branch Lp_58
Ld_59:
    v_readfirstlane_b32 s26, v4
    s_nop 0
    s_and_b32 s26, s26, 0xffff
    s_cmp_gt_u32 s26, 512
    s_cselect_b32 s26, 8192, 0
    s_add_u32 s63, s26, 0x149000
    v_cmp_gt_u32 vcc, 24, v1
    v_lshlrev_b32 v14, 7, v1
    s_nop 0
    v_cndmask_b32 v14, 0, v14, vcc
    v_lshlrev_b32 v17, 2, v0
    v_add_u32 v17, 82944, v17
    v_lshlrev_b32 v18, 2, v1
    v_add_u32 v18, 82944, v18
    s_mov_b32 s25, s81
    v_mov_b32 v3, 0
    s_mov_b32 s67, 0
    s_mov_b32 s69, 0
L_loop_F1:
    s_cmp_eq_u32 s67, 1
    s_cbranch_scc1 Lq_60
    s_mul_i32 s29, s25, 5
    s_add_u32 s29, s29, 5
    s_cmp_lt_u32 s25, 58
    s_cbranch_scc1 Lt_61
    s_cmp_lg_u32 s3, 0
    s_cbranch_scc1 Lw_63
    s_add_u32 s30, s26, 0x151400
    s_cmp_lt_u32 s25, 62
    s_cbranch_scc1 Lw_64
    v_cmp_gt_u32 vcc, 40, v1
    v_lshlrev_b32 v14, 7, v1
    s_nop 0
    v_cndmask_b32 v14, 0, v14, vcc
    s_add_u32 s30, s26, 0x150000
    s_sub_u32 s29, s25, 61
Lw_64:
    s_mov_b32 s27, 0x100000
Lp_65:
    buffer_load_dword v100, v14, s[4:7], s30 offen sc1
    s_waitcnt vmcnt(0)
    v_cmp_gt_u32 vcc, s29, v100
    s_nop 0
    s_cbranch_vccz Ld_66
    s_sub_u32 s27, s27, 1
    s_cbranch_scc1 L_abort
    s_sleep 2
    s_branch Lp_65
Ld_66:
Lw_63:
    s_mov_b32 s27, 0x100000
    s_barrier
    s_add_u32 s28, s64, 0
    v_add_u32 v5, s28, v2
Ld_67:
    s_add_u32 s60, s72, 0
    buffer_load_dwordx4 v[104:107], v2, s[4:7], s60 offen offset:0 sc1
    buffer_load_dwordx4 v[108:111], v2, s[4:7], s60 offen offset:1024 sc1
    buffer_load_dwordx4 v[112:115], v2, s[4:7], s60 offen offset:2048 sc1
    buffer_load_dwordx4 v[116:119], v2, s[4:7], s60 offen offset:3072 sc1
    s_add_u32 s60, s72, 4096
    buffer_load_dwordx4 v[120:123], v2, s[4:7], s60 offen offset:0 sc1
    buffer_load_dwordx4 v[124:127], v2, s[4:7], s60 offen offset:1024 sc1
    buffer_load_dwordx4 v[128:131], v2, s[4:7], s60 offen offset:2048 sc1
    buffer_load_dwordx4 v[132:135], v2, s[4:7], s60 offen offset:3072 sc1
    s_add_u32 s60, s72, 8192
    buffer_load_dwordx4 v[136:139], v2, s[4:7], s60 offen offset:0 sc1
    buffer_load_dwordx4 v[140:143], v2, s[4:7], s60 offen offset:1024 sc1
    s_sub_u32 s27, s27, 1
    s_cbranch_scc1 L_abort
    v_mov_b32 v4, 0
    s_waitcnt vmcnt(9)
    ds_write_b128 v5, v[104:107] offset:0
    v_max3_u32 v4, v4, v104, v105
    v_max3_u32 v4, v4, v106, v107
    s_waitcnt vmcnt(8)
    ds_write_b128 v5, v[108:111] offset:1024
    v_max3_u32 v4, v4, v108, v109
    v_max3_u32 v4, v4, v110, v111
    s_waitcnt vmcnt(7)
    ds_write_b128 v5, v[112:115] offset:2048
    v_max3_u32 v4, v4, v112, v113
    v_max3_u32 v4, v4, v114, v115
    s_waitcnt vmcnt(6)
    ds_write_b128 v5, v[116:119] offset:3072
    v_max3_u32 v4, v4, v116, v117
    v_max3_u32 v4, v4, v118, v119
    s_waitcnt vmcnt(5)
    ds_write_b128 v5, v[120:123] offset:4096
    v_max3_u32 v4, v4, v120, v121
    v_max3_u32 v4, v4, v122, v123
    s_waitcnt vmcnt(4)
    ds_write_b128 v5, v[124:127] offset:5120
    v_max3_u32 v4, v4, v124, v125
    v_max3_u32 v4, v4, v126, v127
    s_waitcnt vmcnt(3)
    ds_write_b128 v5, v[128:131] offset:6144
    v_max3_u32 v4, v4, v128, v129
    v_max3_u32 v4, v4, v130, v131
    s_waitcnt vmcnt(2)
    ds_write_b128 v5, v[132:135] offset:7168
    v_max3_u32 v4, v4, v132, v133
    v_max3_u32 v4, v4, v134, v135
    s_waitcnt vmcnt(1)
    ds_write_b128 v5, v[136:139] offset:8192
    v_max3_u32 v4, v4, v136, v137
    v_max3_u32 v4, v4, v138, v139
    s_waitcnt vmcnt(0)
    ds_write_b128 v5, v[140:143] offset:9216
    v_max3_u32 v4, v4, v140, v141
    v_max3_u32 v4, v4, v142, v143
    v_cmp_eq_u32 vcc, -1, v4
    s_waitcnt lgkmcnt(0)
    s_cbranch_vccnz Ld_67
    v_mov_b32 v100, 0
    s_add_u32 s72, s72, 122880
    s_branch Lq_60x
Lt_61:
    s_cmp_lg_u32 s3, 0
    s_cbranch_scc1 Lw_68
    s_mov_b32 s27, 0x100000
Lp_69:
    buffer_load_dword v100, v14, s[4:7], s63 offen sc1
    s_waitcnt vmcnt(0)
    v_cmp_gt_u32 vcc, s29, v100
    s_nop 0
    s_cbranch_vccz Ld_70
    s_sub_u32 s27, s27, 1
    s_cbranch_scc1 L_abort
    s_sleep 3
    s_branch Lp_69
Ld_70:
Lw_68:
    s_barrier
    s_add_u32 m0, s64, 0
    s_add_u32 s60, s72, 0
    buffer_load_dwordx4 v2, s[4:7], s60 offen offset:0 sc1 lds
    buffer_load_dwordx4 v2, s[4:7], s60 offen offset:1024 sc1 lds
    buffer_load_dwordx4 v2, s[4:7], s60 offen offset:2048 sc1 lds
    buffer_load_dwordx4 v2, s[4:7], s60 offen offset:3072 sc1 lds
    s_add_u32 m0, s64, 4096
    s_add_u32 s60, s72, 4096
    buffer_load_dwordx4 v2, s[4:7], s60 offen offset:0 sc1 lds
    buffer_load_dwordx4 v2, s[4:7], s60 offen offset:1024 sc1 lds
    buffer_load_dwordx4 v2, s[4:7], s60 offen offset:2048 sc1 lds
    buffer_load_dwordx4 v2, s[4:7], s60 offen offset:3072 sc1 lds
    s_add_u32 m0, s64, 8192
    s_add_u32 s60, s72, 8192
    buffer_load_dwordx4 v2, s[4:7], s60 offen offset:0 sc1 lds
    buffer_load_dwordx4 v2, s[4:7], s60 offen offset:1024 sc1 lds
    s_add_u32 s72, s72, 122880
    buffer_load_dword v100, v14, s[4:7], s63 offen sc1
Lq_60x:
    s_waitcnt vmcnt(0)
Lq_60:
    v_pk_mov_b32 v[48:49], 0, 0
    v_pk_mov_b32 v[50:51], 0, 0
    v_pk_mov_b32 v[52:53], 0, 0
    v_pk_mov_b32 v[54:55], 0, 0
    s_mul_i32 s29, s25, 5
    s_add_u32 s29, s29, 20
    s_waitcnt vmcnt(1)
    ds_write_b32 v17, v100
    s_waitcnt lgkmcnt(0)
    s_barrier
    ds_read_b32 v100, v18
    s_waitcnt lgkmcnt(0)
    v_cmp_gt_u32 vcc, s29, v100
    ds_read_b128 v[56:59], v12 offset:0
    ds_read_b128 v[60:63], v12 offset:1024
    ds_read_b128 v[64:67], v12 offset:2048
    s_mov_b32 s67, 0
    s_cbranch_vccnz Ln_62
    s_add_u32 m0, s64, 40960
    s_add_u32 s60, s72, 0
    buffer_load_dwordx4 v2, s[4:7], s60 offen offset:0 sc1 lds
    buffer_load_dwordx4 v2, s[4:7], s60 offen offset:1024 sc1 lds
    buffer_load_dwordx4 v2, s[4:7], s60 offen offset:2048 sc1 lds
    buffer_load_dwordx4 v2, s[4:7], s60 offen offset:3072 sc1 lds
    s_add_u32 m0, s64, 45056
    s_add_u32 s60, s72, 4096
    buffer_load_dwordx4 v2, s[4:7], s60 offen offset:0 sc1 lds
    buffer_load_dwordx4 v2, s[4:7], s60 offen offset:1024 sc1 lds
    buffer_load_dwordx4 v2, s[4:7], s60 offen offset:2048 sc1 lds
    buffer_load_dwordx4 v2, s[4:7], s60 offen offset:3072 sc1 lds
    s_add_u32 m0, s64, 49152
    s_add_u32 s60, s72, 8192
    buffer_load_dwordx4 v2, s[4:7], s60 offen offset:0 sc1 lds
    buffer_load_dwordx4 v2, s[4:7], s60 offen offset:1024 sc1 lds
    s_add_u32 s72, s72, 122880
    s_mov_b32 s67, 1
Ln_62:
    s_waitcnt lgkmcnt(2)
    v_mfma_f32_16x16x32_bf16 v[40:43], a[0:3], v[56:59], 0
    ds_read_b128 v[68:71], v12 offset:3072
    v_mfma_f32_16x16x32_bf16 v[44:47], a[4:7], v[56:59], 0
    s_cmp_lg_u32 s68, 0
    s_cbranch_scc1 Lw_71
    v_mfma_f32_16x16x32_bf16 v[48:51], v[20:23], v[56:59], v[48:51]
    v_mfma_f32_16x16x32_bf16 v[52:55], v[56:59], v[56:59], v[52:55]
Lw_71:
    s_waitcnt lgkmcnt(2)
    v_mfma_f32_16x16x32_bf16 v[40:43], a[8:11], v[60:63], v[40:43]
    ds_read_b128 v[56:59], v12 offset:4096
    v_mfma_f32_16x16x32_bf16 v[44:47], a[12:15], v[60:63], v[44:47]
    s_cmp_lg_u32 s68, 1
    s_cbranch_scc1 Lw_72
    v_mfma_f32_16x16x32_bf16 v[48:51], v[20:23], v[60:63], v[48:51]
    v_mfma_f32_16x16x32_bf16 v[52:55], v[60:63], v[60:63], v[52:55]
Lw_72:
    s_waitcnt lgkmcnt(2)
    v_mfma_f32_16x16x32_bf16 v[40:43], a[16:19], v[64:67], v[40:43]
    ds_read_b128 v[60:63], v12 offset:5120
    v_mfma_f32_16x16x32_bf16 v[44:47], a[20:23], v[64:67], v[44:47]
    s_cmp_lg_u32 s68, 0
    s_cbranch_scc1 Lw_73
    v_mfma_f32_16x16x32_bf16 v[48:51], v[20:23], v[64:67], v[48:51]
    v_mfma_f32_16x16x32_bf16 v[52:55], v[64:67], v[64:67], v[52:55]
Lw_73:
    s_waitcnt lgkmcnt(2)
    v_mfma_f32_16x16x32_bf16 v[40:43], a[24:27], v[68:71], v[40:43]
    ds_read_b128 v[64:67], v12 offset:6144
    v_mfma_f32_16x16x32_bf16 v[44:47], a[28:31], v[68:71], v[44:47]
    s_cmp_lg_u32 s68, 1
    s_cbranch_scc1 Lw_74
    v_mfma_f32_16x16x32_bf16 v[48:51], v[20:23], v[68:71], v[48:51]
    v_mfma_f32_16x16x32_bf16 v[52:55], v[68:71], v[68:71], v[52:55]
Lw_74:
    s_waitcnt lgkmcnt(2)
    v_mfma_f32_16x16x32_bf16 v[40:43], a[32:35], v[56:59], v[40:43]
    ds_read_b128 v[68:71], v12 offset:7168
    v_mfma_f32_16x16x32_bf16 v[44:47], a[36:39], v[56:59], v[44:47]
    s_cmp_lg_u32 s68, 0
    s_cbranch_scc1 Lw_75
    v_mfma_f32_16x16x32_bf16 v[48:51], v[20:23], v[56:59], v[48:51]
    v_mfma_f32_16x16x32_bf16 v[52:55], v[56:59], v[56:59], v[52:55]
Lw_75:
    s_waitcnt lgkmcnt(2)
    v_mfma_f32_16x16x32_bf16 v[40:43], a[40:43], v[60:63], v[40:43]
    ds_read_b128 v[56:59], v12 offset:8192
    v_mfma_f32_16x16x32_bf16 v[44:47], a[44:47], v[60:63], v[44:47]
    s_cmp_lg_u32 s68, 1
    s_cbranch_scc1 Lw_76
    v_mfma_f32_16x16x32_bf16 v[48:51], v[20:23], v[60:63], v[48:51]
    v_mfma_f32_16x16x32_bf16 v[52:55], v[60:63], v[60:63], v[52:55]
Lw_76:
    s_waitcnt lgkmcnt(2)
    v_mfma_f32_16x16x32_bf16 v[40:43], a[48:51], v[64:67], v[40:43]
    ds_read_b128 v[60:63], v12 offset:9216
    v_mfma_f32_16x16x32_bf16 v[44:47], a[52:55], v[64:67], v[44:47]
    s_cmp_lg_u32 s68, 0
    s_cbranch_scc1 Lw_77
    v_mfma_f32_16x16x32_bf16 v[48:51], v[20:23], v[64:67], v[48:51]
    v_mfma_f32_16x16x32_bf16 v[52:55], v[64:67], v[64:67], v[52:55]
Lw_77:
    s_waitcnt lgkmcnt(2)
    v_mfma_f32_16x16x32_bf16 v[40:43], a[56:59], v[68:71], v[40:43]
    ds_read_b128 v[64:67], v12 offset:10240
    v_mfma_f32_16x16x32_bf16 v[44:47], a[60:63], v[68:71], v[44:47]
    s_cmp_lg_u32 s68, 1
    s_cbranch_scc1 Lw_78
    v_mfma_f32_16x16x32_bf16 v[48:51], v[20:23], v[68:71], v[48:51]
    v_mfma_f32_16x16x32_bf16 v[52:55], v[68:71], v[68:71], v[52:55]
Lw_78:
    s_waitcnt lgkmcnt(2)
    v_mfma_f32_16x16x32_bf16 v[40:43], a[64:67], v[56:59], v[40:43]
    ds_read_b128 v[68:71], v12 offset:11264
    v_mfma_f32_16x16x32_bf16 v[44:47], a[68:71], v[56:59], v[44:47]
    s_cmp_lg_u32 s68, 0
    s_cbranch_scc1 Lw_79
    v_mfma_f32_16x16x32_bf16 v[48:51], v[20:23], v[56:59], v[48:51]
    v_mfma_f32_16x16x32_bf16 v[52:55], v[56:59], v[56:59], v[52:55]
Lw_79:
    s_waitcnt lgkmcnt(2)
    v_mfma_f32_16x16x32_bf16 v[40:43], a[72:75], v[60:63], v[40:43]
    ds_read_b128 v[56:59], v12 offset:12288
    v_mfma_f32_16x16x32_bf16 v[44:47], a[76:79], v[60:63], v[44:47]
    s_cmp_lg_u32 s68, 1
    s_cbranch_scc1 Lw_80
    v_mfma_f32_16x16x32_bf16 v[48:51], v[20:23], v[60:63], v[48:51]
    v_mfma_f32_16x16x32_bf16 v[52:55], v[60:63], v[60:63], v[52:55]
Lw_80:
    s_waitcnt lgkmcnt(2)
    v_mfma_f32_16x16x32_bf16 v[40:43], a[80:83], v[64:67], v[40:43]
    ds_read_b128 v[60:63], v12 offset:13312
    v_mfma_f32_16x16x32_bf16 v[44:47], a[84:87], v[64:67], v[44:47]
    s_cmp_lg_u32 s68, 0
    s_cbranch_scc1 Lw_81
    v_mfma_f32_16x16x32_bf16 v[48:51], v[20:23], v[64:67], v[48:51]
    v_mfma_f32_16x16x32_bf16 v[52:55], v[64:67], v[64:67], v[52:55]
Lw_81:
    s_waitcnt lgkmcnt(2)
    v_mfma_f32_16x16x32_bf16 v[40:43], a[88:91], v[68:71], v[40:43]
    ds_read_b128 v[64:67], v12 offset:14336
    v_mfma_f32_16x16x32_bf16 v[44:47], a[92:95], v[68:71], v[44:47]
    s_cmp_lg_u32 s68, 1
    s_cbranch_scc1 Lw_82
    v_mfma_f32_16x16x32_bf16 v[48:51], v[20:23], v[68:71], v[48:51]
    v_mfma_f32_16x16x32_bf16 v[52:55], v[68:71], v[68:71], v[52:55]
Lw_82:
    s_waitcnt lgkmcnt(2)
    v_mfma_f32_16x16x32_bf16 v[40:43], a[96:99], v[56:59], v[40:43]
    ds_read_b128 v[68:71], v12 offset:15360
    v_mfma_f32_16x16x32_bf16 v[44:47], a[100:103], v[56:59], v[44:47]
    s_cmp_lg_u32 s68, 0
    s_cbranch_scc1 Lw_83
    v_mfma_f32_16x16x32_bf16 v[48:51], v[20:23], v[56:59], v[48:51]
    v_mfma_f32_16x16x32_bf16 v[52:55], v[56:59], v[56:59], v[52:55]
Lw_83:
    s_waitcnt lgkmcnt(2)
    v_mfma_f32_16x16x32_bf16 v[40:43], a[104:107], v[60:63], v[40:43]
    ds_read_b128 v[56:59], v12 offset:16384
    v_mfma_f32_16x16x32_bf16 v[44:47], a[108:111], v[60:63], v[44:47]
    s_cmp_lg_u32 s68, 1
    s_cbranch_scc1 Lw_84
    v_mfma_f32_16x16x32_bf16 v[48:51], v[20:23], v[60:63], v[48:51]
    v_mfma_f32_16x16x32_bf16 v[52:55], v[60:63], v[60:63], v[52:55]
Lw_84:
    s_waitcnt lgkmcnt(2)
    v_mfma_f32_16x16x32_bf16 v[40:43], a[112:115], v[64:67], v[40:43]
    ds_read_b128 v[60:63], v12 offset:17408
    v_mfma_f32_16x16x32_bf16 v[44:47], a[116:119], v[64:67], v[44:47]
    s_cmp_lg_u32 s68, 0
    s_cbranch_scc1 Lw_85
    v_mfma_f32_16x16x32_bf16 v[48:51], v[20:23], v[64:67], v[48:51]
    v_mfma_f32_16x16x32_bf16 v[52:55], v[64:67], v[64:67], v[52:55]
Lw_85:
    s_waitcnt lgkmcnt(2)
    v_mfma_f32_16x16x32_bf16 v[40:43], a[120:123], v[68:71], v[40:43]
    ds_read_b128 v[64:67], v12 offset:18432
    v_mfma_f32_16x16x32_bf16 v[44:47], a[124:127], v[68:71], v[44:47]
    s_cmp_lg_u32 s68, 1
    s_cbranch_scc1 Lw_86
    v_mfma_f32_16x16x32_bf16 v[48:51], v[20:23], v[68:71], v[48:51]
    v_mfma_f32_16x16x32_bf16 v[52:55], v[68:71], v[68:71], v[52:55]
Lw_86:
    s_waitcnt lgkmcnt(2)
    v_mfma_f32_16x16x32_bf16 v[40:43], a[128:131], v[56:59], v[40:43]
    ds_read_b128 v[68:71], v12 offset:19456
    v_mfma_f32_16x16x32_bf16 v[44:47], a[132:135], v[56:59], v[44:47]
    s_cmp_lg_u32 s68, 0
    s_cbranch_scc1 Lw_87
    v_mfma_f32_16x16x32_bf16 v[48:51], v[20:23], v[56:59], v[48:51]
    v_mfma_f32_16x16x32_bf16 v[52:55], v[56:59], v[56:59], v[52:55]
Lw_87:
    s_waitcnt lgkmcnt(2)
    v_mfma_f32_16x16x32_bf16 v[40:43], a[136:139], v[60:63], v[40:43]
    v_mfma_f32_16x16x32_bf16 v[44:47], a[140:143], v[60:63], v[44:47]
    s_cmp_lg_u32 s68, 1
    s_cbranch_scc1 Lw_88
    v_mfma_f32_16x16x32_bf16 v[48:51], v[20:23], v[60:63], v[48:51]
    v_mfma_f32_16x16x32_bf16 v[52:55], v[60:63], v[60:63], v[52:55]
Lw_88:
    s_waitcnt lgkmcnt(1)
    v_mfma_f32_16x16x32_bf16 v[40:43], a[144:147], v[64:67], v[40:43]
    v_mfma_f32_16x16x32_bf16 v[44:47], a[148:151], v[64:67], v[44:47]
    s_cmp_lg_u32 s68, 0
    s_cbranch_scc1 Lw_89
    v_mfma_f32_16x16x32_bf16 v[48:51], v[20:23], v[64:67], v[48:51]
    v_mfma_f32_16x16x32_bf16 v[52:55], v[64:67], v[64:67], v[52:55]
Lw_89:
    s_waitcnt lgkmcnt(0)
    v_mfma_f32_16x16x32_bf16 v[40:43], a[152:155], v[68:71], v[40:43]
    v_mfma_f32_16x16x32_bf16 v[44:47], a[156:159], v[68:71], v[44:47]
    s_cmp_lg_u32 s68, 1
    s_cbranch_scc1 Lw_90
    v_mfma_f32_16x16x32_bf16 v[48:51], v[20:23], v[68:71], v[48:51]
    v_mfma_f32_16x16x32_bf16 v[52:55], v[68:71], v[68:71], v[52:55]
Lw_90:
    s_nop 7
    v_cndmask_b32 v52, v52, v53, s[76:77]
    v_cndmask_b32 v54, v54, v55, s[76:77]
    v_cndmask_b32 v52, v52, v54, s[78:79]
    s_mov_b64 exec, s[74:75]
    ds_write2_b32 v15, v48, v52 offset0:0 offset1:1
    s_mov_b64 exec, -1
    s_waitcnt vmcnt(10)
    s_cmp_eq_u32 s67, 1
    s_cbranch_scc1 Ly_91
    s_waitcnt vmcnt(0)
Ly_91:
    s_waitcnt lgkmcnt(0)
    s_barrier
    s_add_u32 s29, s25, 1
    s_cmp_ge_u32 s25, 58
    s_cselect_b32 s69, s29, s69
    s_cmp_eq_u32 s69, 0
    s_cbranch_scc1 Lx_92
    s_cmp_lg_u32 s3, 1
    s_cbranch_scc1 Lf_93
    v_mov_b32 v4, s69
    s_mov_b64 exec, 1
    buffer_store_dword v4, v3, s[4:7], s62 offen sc1
    s_mov_b64 exec, -1
Lf_93:
Lx_92:
    buffer_load_dword v100, v14, s[4:7], s63 offen sc1
    ds_read_b64 v[72:73], v16 offset:0
    ds_read_b64 v[74:75], v16 offset:256
    s_waitcnt lgkmcnt(0)
    v_pk_add_f32 v[72:73], v[72:73], v[74:75]
    v_mul_f32 v76, 0x3acccccd, v72
    v_mul_f32 v77, 0x3acccccd, v73
    v_fma_f32 v77, -v76, v76, v77
    v_max_f32 v77, 0, v77
    v_cvt_pk_bf16_f32 v76, v76, v76
    v_and_b32 v76, 0xffff0000, v76
    v_cvt_pk_bf16_f32 v77, v77, v77
    v_and_b32 v77, 0xffff0000, v77
    v_add_f32 v77, 0x3727c5ac, v77
    v_cvt_pk_bf16_f32 v77, v77, v77
    v_and_b32 v77, 0xffff0000, v77
    v_sqrt_f32 v77, v77
    s_nop 0
    v_cvt_pk_bf16_f32 v77, v77, v77
    v_and_b32 v77, 0xffff0000, v77
    v_rcp_f32 v77, v77
    s_nop 0
    v_pk_fma_f32 v[40:41], v[76:77], v[24:25], v[40:41] op_sel_hi:[0,1,1] neg_lo:[1,0,0] neg_hi:[1,0,0]
    v_pk_fma_f32 v[42:43], v[76:77], v[26:27], v[42:43] op_sel_hi:[0,1,1] neg_lo:[1,0,0] neg_hi:[1,0,0]
    v_pk_fma_f32 v[44:45], v[76:77], v[28:29], v[44:45] op_sel_hi:[0,1,1] neg_lo:[1,0,0] neg_hi:[1,0,0]
    v_pk_fma_f32 v[46:47], v[76:77], v[30:31], v[46:47] op_sel_hi:[0,1,1] neg_lo:[1,0,0] neg_hi:[1,0,0]
    v_pk_fma_f32 v[40:41], v[40:41], v[76:77], v[32:33] op_sel:[0,1,0] op_sel_hi:[1,1,1]
    v_pk_fma_f32 v[42:43], v[42:43], v[76:77], v[34:35] op_sel:[0,1,0] op_sel_hi:[1,1,1]
    v_pk_fma_f32 v[44:45], v[44:45], v[76:77], v[36:37] op_sel:[0,1,0] op_sel_hi:[1,1,1]
    v_pk_fma_f32 v[46:47], v[46:47], v[76:77], v[38:39] op_sel:[0,1,0] op_sel_hi:[1,1,1]
    v_mul_f32 v84, 0x3fb8aa3b, v40
    v_mul_f32 v85, 0x3fb8aa3b, v41
    v_mul_f32 v86, 0x3fb8aa3b, v42
    v_mul_f32 v87, 0x3fb8aa3b, v43
    v_mul_f32 v88, 0x3fb8aa3b, v44
    v_mul_f32 v89, 0x3fb8aa3b, v45
    v_mul_f32 v90, 0x3fb8aa3b, v46
    v_mul_f32 v91, 0x3fb8aa3b, v47
    v_min_f32 v84, 0x42200000, v84
    v_min_f32 v85, 0x42200000, v85
    v_min_f32 v86, 0x42200000, v86
    v_min_f32 v87, 0x42200000, v87
    v_min_f32 v88, 0x42200000, v88
    v_min_f32 v89, 0x42200000, v89
    v_min_f32 v90, 0x42200000, v90
    v_min_f32 v91, 0x42200000, v91
    v_exp_f32 v84, v84
    v_exp_f32 v85, v85
    v_exp_f32 v86, v86
    v_exp_f32 v87, v87
    v_exp_f32 v88, v88
    v_exp_f32 v89, v89
    v_exp_f32 v90, v90
    v_exp_f32 v91, v91
    v_pk_add_f32 v[92:93], v[84:85], 2.0 op_sel_hi:[1,0]
    v_pk_add_f32 v[94:95], v[86:87], 2.0 op_sel_hi:[1,0]
    v_pk_add_f32 v[96:97], v[88:89], 2.0 op_sel_hi:[1,0]
    v_pk_add_f32 v[98:99], v[90:91], 2.0 op_sel_hi:[1,0]
    v_pk_mul_f32 v[84:85], v[84:85], v[92:93]
    v_pk_mul_f32 v[86:87], v[86:87], v[94:95]
    v_pk_mul_f32 v[88:89], v[88:89], v[96:97]
    v_pk_mul_f32 v[90:91], v[90:91], v[98:99]
    v_pk_add_f32 v[92:93], v[84:85], 2.0 op_sel_hi:[1,0]
    v_pk_add_f32 v[94:95], v[86:87], 2.0 op_sel_hi:[1,0]
    v_pk_add_f32 v[96:97], v[88:89], 2.0 op_sel_hi:[1,0]
    v_pk_add_f32 v[98:99], v[90:91], 2.0 op_sel_hi:[1,0]
    v_rcp_f32 v92, v92
    v_rcp_f32 v93, v93
    v_rcp_f32 v94, v94
    v_rcp_f32 v95, v95
    v_rcp_f32 v96, v96
    v_rcp_f32 v97, v97
    v_rcp_f32 v98, v98
    v_rcp_f32 v99, v99
    v_pk_mul_f32 v[84:85], v[84:85], v[92:93]
    v_pk_mul_f32 v[86:87], v[86:87], v[94:95]
    v_pk_mul_f32 v[88:89], v[88:89], v[96:97]
    v_pk_mul_f32 v[90:91], v[90:91], v[98:99]
    v_pk_mul_f32 v[40:41], v[40:41], v[84:85]
    v_pk_mul_f32 v[42:43], v[42:43], v[86:87]
    v_pk_mul_f32 v[44:45], v[44:45], v[88:89]
    v_pk_mul_f32 v[46:47], v[46:47], v[90:91]
    v_cvt_pk_bf16_f32 v80, v40, v41
    v_cvt_pk_bf16_f32 v81, v42, v43
    v_cvt_pk_bf16_f32 v82, v44, v45
    v_cvt_pk_bf16_f32 v83, v46, v47
    v_min_u32 v80, 0xfffffffe, v80
    v_min_u32 v81, 0xfffffffe, v81
    v_min_u32 v82, 0xfffffffe, v82
    v_min_u32 v83, 0xfffffffe, v83
    buffer_store_dwordx4 v[80:83], v2, s[4:7], s73 offen sc1
    s_add_u32 s73, s73, 294912
    s_add_u32 s25, s25, 1
    s_mov_b32 s69, s25
    s_cmp_eq_u32 s67, 1
    s_cbranch_scc1 Lz_94
    s_cmp_gt_u32 s25, 58
    s_cbranch_scc1 Lz_94
    s_waitcnt vmcnt(0)
    s_barrier
    s_cmp_lg_u32 s3, 1
    s_cbranch_scc1 Lf_95
    v_mov_b32 v4, s25
    s_mov_b64 exec, 1
    buffer_store_dword v4, v3, s[4:7], s62 offen sc1
    s_mov_b64 exec, -1
Lf_95:
Lz_94:
    s_add_u32 s25, s25, 2
    s_cmp_ge_u32 s25, 64
    s_cbranch_scc1 L_exit
    s_cmp_eq_u32 s67, 1
    s_cbranch_scc1 Lq_96
    s_mul_i32 s29, s25, 5
    s_add_u32 s29, s29, 5
    s_cmp_lt_u32 s25, 58
    s_cbranch_scc1 Lt_97
    s_cmp_lg_u32 s3, 0
    s_cbranch_scc1 Lw_99
    s_add_u32 s30, s26, 0x151400
    s_cmp_lt_u32 s25, 62
    s_cbranch_scc1 Lw_100
    v_cmp_gt_u32 vcc, 40, v1
    v_lshlrev_b32 v14, 7, v1
    s_nop 0
    v_cndmask_b32 v14, 0, v14, vcc
    s_add_u32 s30, s26, 0x150000
    s_sub_u32 s29, s25, 61
Lw_100:
    s_mov_b32 s27, 0x100000
Lp_101:
    buffer_load_dword v100, v14, s[4:7], s30 offen sc1
    s_waitcnt vmcnt(0)
    v_cmp_gt_u32 vcc, s29, v100
    s_nop 0
    s_cbranch_vccz Ld_102
    s_sub_u32 s27, s27, 1
    s_cbranch_scc1 L_abort
    s_sleep 2
    s_branch Lp_101
Ld_102:
Lw_99:
    s_mov_b32 s27, 0x100000
    s_barrier
    s_add_u32 s28, s64, 40960
    v_add_u32 v5, s28, v2
Ld_103:
    s_add_u32 s60, s72, 0
    buffer_load_dwordx4 v[104:107], v2, s[4:7], s60 offen offset:0 sc1
    buffer_load_dwordx4 v[108:111], v2, s[4:7], s60 offen offset:1024 sc1
    buffer_load_dwordx4 v[112:115], v2, s[4:7], s60 offen offset:2048 sc1
    buffer_load_dwordx4 v[116:119], v2, s[4:7], s60 offen offset:3072 sc1
    s_add_u32 s60, s72, 4096
    buffer_load_dwordx4 v[120:123], v2, s[4:7], s60 offen offset:0 sc1
    buffer_load_dwordx4 v[124:127], v2, s[4:7], s60 offen offset:1024 sc1
    buffer_load_dwordx4 v[128:131], v2, s[4:7], s60 offen offset:2048 sc1
    buffer_load_dwordx4 v[132:135], v2, s[4:7], s60 offen offset:3072 sc1
    s_add_u32 s60, s72, 8192
    buffer_load_dwordx4 v[136:139], v2, s[4:7], s60 offen offset:0 sc1
    buffer_load_dwordx4 v[140:143], v2, s[4:7], s60 offen offset:1024 sc1
    s_sub_u32 s27, s27, 1
    s_cbranch_scc1 L_abort
    v_mov_b32 v4, 0
    s_waitcnt vmcnt(9)
    ds_write_b128 v5, v[104:107] offset:0
    v_max3_u32 v4, v4, v104, v105
    v_max3_u32 v4, v4, v106, v107
    s_waitcnt vmcnt(8)
    ds_write_b128 v5, v[108:111] offset:1024
    v_max3_u32 v4, v4, v108, v109
    v_max3_u32 v4, v4, v110, v111
    s_waitcnt vmcnt(7)
    ds_write_b128 v5, v[112:115] offset:2048
    v_max3_u32 v4, v4, v112, v113
    v_max3_u32 v4, v4, v114, v115
    s_waitcnt vmcnt(6)
    ds_write_b128 v5, v[116:119] offset:3072
    v_max3_u32 v4, v4, v116, v117
    v_max3_u32 v4, v4, v118, v119
    s_waitcnt vmcnt(5)
    ds_write_b128 v5, v[120:123] offset:4096
    v_max3_u32 v4, v4, v120, v121
    v_max3_u32 v4, v4, v122, v123
    s_waitcnt vmcnt(4)
    ds_write_b128 v5, v[124:127] offset:5120
    v_max3_u32 v4, v4, v124, v125
    v_max3_u32 v4, v4, v126, v127
    s_waitcnt vmcnt(3)
    ds_write_b128 v5, v[128:131] offset:6144
    v_max3_u32 v4, v4, v128, v129
    v_max3_u32 v4, v4, v130, v131
    s_waitcnt vmcnt(2)
    ds_write_b128 v5, v[132:135] offset:7168
    v_max3_u32 v4, v4, v132, v133
    v_max3_u32 v4, v4, v134, v135
    s_waitcnt vmcnt(1)
    ds_write_b128 v5, v[136:139] offset:8192
    v_max3_u32 v4, v4, v136, v137
    v_max3_u32 v4, v4, v138, v139
    s_waitcnt vmcnt(0)
    ds_write_b128 v5, v[140:143] offset:9216
    v_max3_u32 v4, v4, v140, v141
    v_max3_u32 v4, v4, v142, v143
    v_cmp_eq_u32 vcc, -1, v4
    s_waitcnt lgkmcnt(0)
    s_cbranch_vccnz Ld_103
    v_mov_b32 v100, 0
    s_add_u32 s72, s72, 122880
    s_branch Lq_96x
Lt_97:
    s_cmp_lg_u32 s3, 0
    s_cbranch_scc1 Lw_104
    s_mov_b32 s27, 0x100000
Lp_105:
    buffer_load_dword v100, v14, s[4:7], s63 offen sc1
    s_waitcnt vmcnt(0)
    v_cmp_gt_u32 vcc, s29, v100
    s_nop 0
    s_cbranch_vccz Ld_106
    s_sub_u32 s27, s27, 1
    s_cbranch_scc1 L_abort
    s_sleep 3
    s_branch Lp_105
Ld_106:
Lw_104:
    s_barrier
    s_add_u32 m0, s64, 40960
    s_add_u32 s60, s72, 0
    buffer_load_dwordx4 v2, s[4:7], s60 offen offset:0 sc1 lds
    buffer_load_dwordx4 v2, s[4:7], s60 offen offset:1024 sc1 lds
    buffer_load_dwordx4 v2, s[4:7], s60 offen offset:2048 sc1 lds
    buffer_load_dwordx4 v2, s[4:7], s60 offen offset:3072 sc1 lds
    s_add_u32 m0, s64, 45056
    s_add_u32 s60, s72, 4096
    buffer_load_dwordx4 v2, s[4:7], s60 offen offset:0 sc1 lds
    buffer_load_dwordx4 v2, s[4:7], s60 offen offset:1024 sc1 lds
    buffer_load_dwordx4 v2, s[4:7], s60 offen offset:2048 sc1 lds
    buffer_load_dwordx4 v2, s[4:7], s60 offen offset:3072 sc1 lds
    s_add_u32 m0, s64, 49152
    s_add_u32 s60, s72, 8192
    buffer_load_dwordx4 v2, s[4:7], s60 offen offset:0 sc1 lds
    buffer_load_dwordx4 v2, s[4:7], s60 offen offset:1024 sc1 lds
    s_add_u32 s72, s72, 122880
    buffer_load_dword v100, v14, s[4:7], s63 offen sc1
Lq_96x:
    s_waitcnt vmcnt(0)
Lq_96:
    v_pk_mov_b32 v[48:49], 0, 0
    v_pk_mov_b32 v[50:51], 0, 0
    v_pk_mov_b32 v[52:53], 0, 0
    v_pk_mov_b32 v[54:55], 0, 0
    s_mul_i32 s29, s25, 5
    s_add_u32 s29, s29, 20
    s_waitcnt vmcnt(1)
    ds_write_b32 v17, v100
    s_waitcnt lgkmcnt(0)
    s_barrier
    ds_read_b32 v100, v18
    s_waitcnt lgkmcnt(0)
    v_cmp_gt_u32 vcc, s29, v100
    ds_read_b128 v[56:59], v13 offset:0
    ds_read_b128 v[60:63], v13 offset:1024
    ds_read_b128 v[64:67], v13 offset:2048
    s_mov_b32 s67, 0
    s_cbranch_vccnz Ln_98
    s_add_u32 m0, s64, 0
    s_add_u32 s60, s72, 0
    buffer_load_dwordx4 v2, s[4:7], s60 offen offset:0 sc1 lds
    buffer_load_dwordx4 v2, s[4:7], s60 offen offset:1024 sc1 lds
    buffer_load_dwordx4 v2, s[4:7], s60 offen offset:2048 sc1 lds
    buffer_load_dwordx4 v2, s[4:7], s60 offen offset:3072 sc1 lds
    s_add_u32 m0, s64, 4096
    s_add_u32 s60, s72, 4096
    buffer_load_dwordx4 v2, s[4:7], s60 offen offset:0 sc1 lds
    buffer_load_dwordx4 v2, s[4:7], s60 offen offset:1024 sc1 lds
    buffer_load_dwordx4 v2, s[4:7], s60 offen offset:2048 sc1 lds
    buffer_load_dwordx4 v2, s[4:7], s60 offen offset:3072 sc1 lds
    s_add_u32 m0, s64, 8192
    s_add_u32 s60, s72, 8192
    buffer_load_dwordx4 v2, s[4:7], s60 offen offset:0 sc1 lds
    buffer_load_dwordx4 v2, s[4:7], s60 offen offset:1024 sc1 lds
    s_add_u32 s72, s72, 122880
    s_mov_b32 s67, 1
Ln_98:
    s_waitcnt lgkmcnt(2)
    v_mfma_f32_16x16x32_bf16 v[40:43], a[0:3], v[56:59], 0
    ds_read_b128 v[68:71], v13 offset:3072
    v_mfma_f32_16x16x32_bf16 v[44:47], a[4:7], v[56:59], 0
    s_cmp_lg_u32 s68, 0
    s_cbranch_scc1 Lw_107
    v_mfma_f32_16x16x32_bf16 v[48:51], v[20:23], v[56:59], v[48:51]
    v_mfma_f32_16x16x32_bf16 v[52:55], v[56:59], v[56:59], v[52:55]
Lw_107:
    s_waitcnt lgkmcnt(2)
    v_mfma_f32_16x16x32_bf16 v[40:43], a[8:11], v[60:63], v[40:43]
    ds_read_b128 v[56:59], v13 offset:4096
    v_mfma_f32_16x16x32_bf16 v[44:47], a[12:15], v[60:63], v[44:47]
    s_cmp_lg_u32 s68, 1
    s_cbranch_scc1 Lw_108
    v_mfma_f32_16x16x32_bf16 v[48:51], v[20:23], v[60:63], v[48:51]
    v_mfma_f32_16x16x32_bf16 v[52:55], v[60:63], v[60:63], v[52:55]
Lw_108:
    s_waitcnt lgkmcnt(2)
    v_mfma_f32_16x16x32_bf16 v[40:43], a[16:19], v[64:67], v[40:43]
    ds_read_b128 v[60:63], v13 offset:5120
    v_mfma_f32_16x16x32_bf16 v[44:47], a[20:23], v[64:67], v[44:47]
    s_cmp_lg_u32 s68, 0
    s_cbranch_scc1 Lw_109
    v_mfma_f32_16x16x32_bf16 v[48:51], v[20:23], v[64:67], v[48:51]
    v_mfma_f32_16x16x32_bf16 v[52:55], v[64:67], v[64:67], v[52:55]
Lw_109:
    s_waitcnt lgkmcnt(2)
    v_mfma_f32_16x16x32_bf16 v[40:43], a[24:27], v[68:71], v[40:43]
    ds_read_b128 v[64:67], v13 offset:6144
    v_mfma_f32_16x16x32_bf16 v[44:47], a[28:31], v[68:71], v[44:47]
    s_cmp_lg_u32 s68, 1
    s_cbranch_scc1 Lw_110
    v_mfma_f32_16x16x32_bf16 v[48:51], v[20:23], v[68:71], v[48:51]
    v_mfma_f32_16x16x32_bf16 v[52:55], v[68:71], v[68:71], v[52:55]
Lw_110:
    s_waitcnt lgkmcnt(2)
    v_mfma_f32_16x16x32_bf16 v[40:43], a[32:35], v[56:59], v[40:43]
    ds_read_b128 v[68:71], v13 offset:7168
    v_mfma_f32_16x16x32_bf16 v[44:47], a[36:39], v[56:59], v[44:47]
    s_cmp_lg_u32 s68, 0
    s_cbranch_scc1 Lw_111
    v_mfma_f32_16x16x32_bf16 v[48:51], v[20:23], v[56:59], v[48:51]
    v_mfma_f32_16x16x32_bf16 v[52:55], v[56:59], v[56:59], v[52:55]
Lw_111:
    s_waitcnt lgkmcnt(2)
    v_mfma_f32_16x16x32_bf16 v[40:43], a[40:43], v[60:63], v[40:43]
    ds_read_b128 v[56:59], v13 offset:8192
    v_mfma_f32_16x16x32_bf16 v[44:47], a[44:47], v[60:63], v[44:47]
    s_cmp_lg_u32 s68, 1
    s_cbranch_scc1 Lw_112
    v_mfma_f32_16x16x32_bf16 v[48:51], v[20:23], v[60:63], v[48:51]
    v_mfma_f32_16x16x32_bf16 v[52:55], v[60:63], v[60:63], v[52:55]
Lw_112:
    s_waitcnt lgkmcnt(2)
    v_mfma_f32_16x16x32_bf16 v[40:43], a[48:51], v[64:67], v[40:43]
    ds_read_b128 v[60:63], v13 offset:9216
    v_mfma_f32_16x16x32_bf16 v[44:47], a[52:55], v[64:67], v[44:47]
    s_cmp_lg_u32 s68, 0
    s_cbranch_scc1 Lw_113
    v_mfma_f32_16x16x32_bf16 v[48:51], v[20:23], v[64:67], v[48:51]
    v_mfma_f32_16x16x32_bf16 v[52:55], v[64:67], v[64:67], v[52:55]
Lw_113:
    s_waitcnt lgkmcnt(2)
    v_mfma_f32_16x16x32_bf16 v[40:43], a[56:59], v[68:71], v[40:43]
    ds_read_b128 v[64:67], v13 offset:10240
    v_mfma_f32_16x16x32_bf16 v[44:47], a[60:63], v[68:71], v[44:47]
    s_cmp_lg_u32 s68, 1
    s_cbranch_scc1 Lw_114
    v_mfma_f32_16x16x32_bf16 v[48:51], v[20:23], v[68:71], v[48:51]
    v_mfma_f32_16x16x32_bf16 v[52:55], v[68:71], v[68:71], v[52:55]
Lw_114:
    s_waitcnt lgkmcnt(2)
    v_mfma_f32_16x16x32_bf16 v[40:43], a[64:67], v[56:59], v[40:43]
    ds_read_b128 v[68:71], v13 offset:11264
    v_mfma_f32_16x16x32_bf16 v[44:47], a[68:71], v[56:59], v[44:47]
    s_cmp_lg_u32 s68, 0
    s_cbranch_scc1 Lw_115
    v_mfma_f32_16x16x32_bf16 v[48:51], v[20:23], v[56:59], v[48:51]
    v_mfma_f32_16x16x32_bf16 v[52:55], v[56:59], v[56:59], v[52:55]
Lw_115:
    s_waitcnt lgkmcnt(2)
    v_mfma_f32_16x16x32_bf16 v[40:43], a[72:75], v[60:63], v[40:43]
    ds_read_b128 v[56:59], v13 offset:12288
    v_mfma_f32_16x16x32_bf16 v[44:47], a[76:79], v[60:63], v[44:47]
    s_cmp_lg_u32 s68, 1
    s_cbranch_scc1 Lw_116
    v_mfma_f32_16x16x32_bf16 v[48:51], v[20:23], v[60:63], v[48:51]
    v_mfma_f32_16x16x32_bf16 v[52:55], v[60:63], v[60:63], v[52:55]
Lw_116:
    s_waitcnt lgkmcnt(2)
    v_mfma_f32_16x16x32_bf16 v[40:43], a[80:83], v[64:67], v[40:43]
    ds_read_b128 v[60:63], v13 offset:13312
    v_mfma_f32_16x16x32_bf16 v[44:47], a[84:87], v[64:67], v[44:47]
    s_cmp_lg_u32 s68, 0
    s_cbranch_scc1 Lw_117
    v_mfma_f32_16x16x32_bf16 v[48:51], v[20:23], v[64:67], v[48:51]
    v_mfma_f32_16x16x32_bf16 v[52:55], v[64:67], v[64:67], v[52:55]
Lw_117:
    s_waitcnt lgkmcnt(2)
    v_mfma_f32_16x16x32_bf16 v[40:43], a[88:91], v[68:71], v[40:43]
    ds_read_b128 v[64:67], v13 offset:14336
    v_mfma_f32_16x16x32_bf16 v[44:47], a[92:95], v[68:71], v[44:47]
    s_cmp_lg_u32 s68, 1
    s_cbranch_scc1 Lw_118
    v_mfma_f32_16x16x32_bf16 v[48:51], v[20:23], v[68:71], v[48:51]
    v_mfma_f32_16x16x32_bf16 v[52:55], v[68:71], v[68:71], v[52:55]
Lw_118:
    s_waitcnt lgkmcnt(2)
    v_mfma_f32_16x16x32_bf16 v[40:43], a[96:99], v[56:59], v[40:43]
    ds_read_b128 v[68:71], v13 offset:15360
    v_mfma_f32_16x16x32_bf16 v[44:47], a[100:103], v[56:59], v[44:47]
    s_cmp_lg_u32 s68, 0
    s_cbranch_scc1 Lw_119
    v_mfma_f32_16x16x32_bf16 v[48:51], v[20:23], v[56:59], v[48:51]
    v_mfma_f32_16x16x32_bf16 v[52:55], v[56:59], v[56:59], v[52:55]
Lw_119:
    s_waitcnt lgkmcnt(2)
    v_mfma_f32_16x16x32_bf16 v[40:43], a[104:107], v[60:63], v[40:43]
    ds_read_b128 v[56:59], v13 offset:16384
    v_mfma_f32_16x16x32_bf16 v[44:47], a[108:111], v[60:63], v[44:47]
    s_cmp_lg_u32 s68, 1
    s_cbranch_scc1 Lw_120
    v_mfma_f32_16x16x32_bf16 v[48:51], v[20:23], v[60:63], v[48:51]
    v_mfma_f32_16x16x32_bf16 v[52:55], v[60:63], v[60:63], v[52:55]
Lw_120:
    s_waitcnt lgkmcnt(2)
    v_mfma_f32_16x16x32_bf16 v[40:43], a[112:115], v[64:67], v[40:43]
    ds_read_b128 v[60:63], v13 offset:17408
    v_mfma_f32_16x16x32_bf16 v[44:47], a[116:119], v[64:67], v[44:47]
    s_cmp_lg_u32 s68, 0
    s_cbranch_scc1 Lw_121
    v_mfma_f32_16x16x32_bf16 v[48:51], v[20:23], v[64:67], v[48:51]
    v_mfma_f32_16x16x32_bf16 v[52:55], v[64:67], v[64:67], v[52:55]
Lw_121:
    s_waitcnt lgkmcnt(2)
    v_mfma_f32_16x16x32_bf16 v[40:43], a[120:123], v[68:71], v[40:43]
    ds_read_b128 v[64:67], v13 offset:18432
    v_mfma_f32_16x16x32_bf16 v[44:47], a[124:127], v[68:71], v[44:47]
    s_cmp_lg_u32 s68, 1
    s_cbranch_scc1 Lw_122
    v_mfma_f32_16x16x32_bf16 v[48:51], v[20:23], v[68:71], v[48:51]
    v_mfma_f32_16x16x32_bf16 v[52:55], v[68:71], v[68:71], v[52:55]
Lw_122:
    s_waitcnt lgkmcnt(2)
    v_mfma_f32_16x16x32_bf16 v[40:43], a[128:131], v[56:59], v[40:43]
    ds_read_b128 v[68:71], v13 offset:19456
    v_mfma_f32_16x16x32_bf16 v[44:47], a[132:135], v[56:59], v[44:47]
    s_cmp_lg_u32 s68, 0
    s_cbranch_scc1 Lw_123
    v_mfma_f32_16x16x32_bf16 v[48:51], v[20:23], v[56:59], v[48:51]
    v_mfma_f32_16x16x32_bf16 v[52:55], v[56:59], v[56:59], v[52:55]
Lw_123:
    s_waitcnt lgkmcnt(2)
    v_mfma_f32_16x16x32_bf16 v[40:43], a[136:139], v[60:63], v[40:43]
    v_mfma_f32_16x16x32_bf16 v[44:47], a[140:143], v[60:63], v[44:47]
    s_cmp_lg_u32 s68, 1
    s_cbranch_scc1 Lw_124
    v_mfma_f32_16x16x32_bf16 v[48:51], v[20:23], v[60:63], v[48:51]
    v_mfma_f32_16x16x32_bf16 v[52:55], v[60:63], v[60:63], v[52:55]
Lw_124:
    s_waitcnt lgkmcnt(1)
    v_mfma_f32_16x16x32_bf16 v[40:43], a[144:147], v[64:67], v[40:43]
    v_mfma_f32_16x16x32_bf16 v[44:47], a[148:151], v[64:67], v[44:47]
    s_cmp_lg_u32 s68, 0
    s_cbranch_scc1 Lw_125
    v_mfma_f32_16x16x32_bf16 v[48:51], v[20:23], v[64:67], v[48:51]
    v_mfma_f32_16x16x32_bf16 v[52:55], v[64:67], v[64:67], v[52:55]
Lw_125:
    s_waitcnt lgkmcnt(0)
    v_mfma_f32_16x16x32_bf16 v[40:43], a[152:155], v[68:71], v[40:43]
    v_mfma_f32_16x16x32_bf16 v[44:47], a[156:159], v[68:71], v[44:47]
    s_cmp_lg_u32 s68, 1
    s_cbranch_scc1 Lw_126
    v_mfma_f32_16x16x32_bf16 v[48:51], v[20:23], v[68:71], v[48:51]
    v_mfma_f32_16x16x32_bf16 v[52:55], v[68:71], v[68:71], v[52:55]
Lw_126:
    s_nop 7
    v_cndmask_b32 v52, v52, v53, s[76:77]
    v_cndmask_b32 v54, v54, v55, s[76:77]
    v_cndmask_b32 v52, v52, v54, s[78:79]
    s_mov_b64 exec, s[74:75]
    ds_write2_b32 v15, v48, v52 offset0:0 offset1:1
    s_mov_b64 exec, -1
    s_waitcnt vmcnt(10)
    s_cmp_eq_u32 s67, 1
    s_cbranch_scc1 Ly_127
    s_waitcnt vmcnt(0)
Ly_127:
    s_waitcnt lgkmcnt(0)
    s_barrier
    s_add_u32 s29, s25, 1
    s_cmp_ge_u32 s25, 58
    s_cselect_b32 s69, s29, s69
    s_cmp_eq_u32 s69, 0
    s_cbranch_scc1 Lx_128
    s_cmp_lg_u32 s3, 1
    s_cbranch_scc1 Lf_129
    v_mov_b32 v4, s69
    s_mov_b64 exec, 1
    buffer_store_dword v4, v3, s[4:7], s62 offen sc1
    s_mov_b64 exec, -1
Lf_129:
Lx_128:
    buffer_load_dword v100, v14, s[4:7], s63 offen sc1
    ds_read_b64 v[72:73], v16 offset:0
    ds_read_b64 v[74:75], v16 offset:256
    s_waitcnt lgkmcnt(0)
    v_pk_add_f32 v[72:73], v[72:73], v[74:75]
    v_mul_f32 v76, 0x3acccccd, v72
    v_mul_f32 v77, 0x3acccccd, v73
    v_fma_f32 v77, -v76, v76, v77
    v_max_f32 v77, 0, v77
    v_cvt_pk_bf16_f32 v76, v76, v76
    v_and_b32 v76, 0xffff0000, v76
    v_cvt_pk_bf16_f32 v77, v77, v77
    v_and_b32 v77, 0xffff0000, v77
    v_add_f32 v77, 0x3727c5ac, v77
    v_cvt_pk_bf16_f32 v77, v77, v77
    v_and_b32 v77, 0xffff0000, v77
    v_sqrt_f32 v77, v77
    s_nop 0
    v_cvt_pk_bf16_f32 v77, v77, v77
    v_and_b32 v77, 0xffff0000, v77
    v_rcp_f32 v77, v77
    s_nop 0
    v_pk_fma_f32 v[40:41], v[76:77], v[24:25], v[40:41] op_sel_hi:[0,1,1] neg_lo:[1,0,0] neg_hi:[1,0,0]
    v_pk_fma_f32 v[42:43], v[76:77], v[26:27], v[42:43] op_sel_hi:[0,1,1] neg_lo:[1,0,0] neg_hi:[1,0,0]
    v_pk_fma_f32 v[44:45], v[76:77], v[28:29], v[44:45] op_sel_hi:[0,1,1] neg_lo:[1,0,0] neg_hi:[1,0,0]
    v_pk_fma_f32 v[46:47], v[76:77], v[30:31], v[46:47] op_sel_hi:[0,1,1] neg_lo:[1,0,0] neg_hi:[1,0,0]
    v_pk_fma_f32 v[40:41], v[40:41], v[76:77], v[32:33] op_sel:[0,1,0] op_sel_hi:[1,1,1]
    v_pk_fma_f32 v[42:43], v[42:43], v[76:77], v[34:35] op_sel:[0,1,0] op_sel_hi:[1,1,1]
    v_pk_fma_f32 v[44:45], v[44:45], v[76:77], v[36:37] op_sel:[0,1,0] op_sel_hi:[1,1,1]
    v_pk_fma_f32 v[46:47], v[46:47], v[76:77], v[38:39] op_sel:[0,1,0] op_sel_hi:[1,1,1]
    v_mul_f32 v84, 0x3fb8aa3b, v40
    v_mul_f32 v85, 0x3fb8aa3b, v41
    v_mul_f32 v86, 0x3fb8aa3b, v42
    v_mul_f32 v87, 0x3fb8aa3b, v43
    v_mul_f32 v88, 0x3fb8aa3b, v44
    v_mul_f32 v89, 0x3fb8aa3b, v45
    v_mul_f32 v90, 0x3fb8aa3b, v46
    v_mul_f32 v91, 0x3fb8aa3b, v47
    v_min_f32 v84, 0x42200000, v84
    v_min_f32 v85, 0x42200000, v85
    v_min_f32 v86, 0x42200000, v86
    v_min_f32 v87, 0x42200000, v87
    v_min_f32 v88, 0x42200000, v88
    v_min_f32 v89, 0x42200000, v89
    v_min_f32 v90, 0x42200000, v90
    v_min_f32 v91, 0x42200000, v91
    v_exp_f32 v84, v84
    v_exp_f32 v85, v85
    v_exp_f32 v86, v86
    v_exp_f32 v87, v87
    v_exp_f32 v88, v88
    v_exp_f32 v89, v89
    v_exp_f32 v90, v90
    v_exp_f32 v91, v91
    v_pk_add_f32 v[92:93], v[84:85], 2.0 op_sel_hi:[1,0]
    v_pk_add_f32 v[94:95], v[86:87], 2.0 op_sel_hi:[1,0]
    v_pk_add_f32 v[96:97], v[88:89], 2.0 op_sel_hi:[1,0]
    v_pk_add_f32 v[98:99], v[90:91], 2.0 op_sel_hi:[1,0]
    v_pk_mul_f32 v[84:85], v[84:85], v[92:93]
    v_pk_mul_f32 v[86:87], v[86:87], v[94:95]
    v_pk_mul_f32 v[88:89], v[88:89], v[96:97]
    v_pk_mul_f32 v[90:91], v[90:91], v[98:99]
    v_pk_add_f32 v[92:93], v[84:85], 2.0 op_sel_hi:[1,0]
    v_pk_add_f32 v[94:95], v[86:87], 2.0 op_sel_hi:[1,0]
    v_pk_add_f32 v[96:97], v[88:89], 2.0 op_sel_hi:[1,0]
    v_pk_add_f32 v[98:99], v[90:91], 2.0 op_sel_hi:[1,0]
    v_rcp_f32 v92, v92
    v_rcp_f32 v93, v93
    v_rcp_f32 v94, v94
    v_rcp_f32 v95, v95
    v_rcp_f32 v96, v96
    v_rcp_f32 v97, v97
    v_rcp_f32 v98, v98
    v_rcp_f32 v99, v99
    v_pk_mul_f32 v[84:85], v[84:85], v[92:93]
    v_pk_mul_f32 v[86:87], v[86:87], v[94:95]
    v_pk_mul_f32 v[88:89], v[88:89], v[96:97]
    v_pk_mul_f32 v[90:91], v[90:91], v[98:99]
    v_pk_mul_f32 v[40:41], v[40:41], v[84:85]
    v_pk_mul_f32 v[42:43], v[42:43], v[86:87]
    v_pk_mul_f32 v[44:45], v[44:45], v[88:89]
    v_pk_mul_f32 v[46:47], v[46:47], v[90:91]
    v_cvt_pk_bf16_f32 v80, v40, v41
    v_cvt_pk_bf16_f32 v81, v42, v43
    v_cvt_pk_bf16_f32 v82, v44, v45
    v_cvt_pk_bf16_f32 v83, v46, v47
    v_min_u32 v80, 0xfffffffe, v80
    v_min_u32 v81, 0xfffffffe, v81
    v_min_u32 v82, 0xfffffffe, v82
    v_min_u32 v83, 0xfffffffe, v83
    buffer_store_dwordx4 v[80:83], v2, s[4:7], s73 offen sc1
    s_add_u32 s73, s73, 294912
    s_add_u32 s25, s25, 1
    s_mov_b32 s69, s25
    s_cmp_eq_u32 s67, 1
    s_cbranch_scc1 Lz_130
    s_cmp_gt_u32 s25, 58
    s_cbranch_scc1 Lz_130
    s_waitcnt vmcnt(0)
    s_barrier
    s_cmp_lg_u32 s3, 1
    s_cbranch_scc1 Lf_131
    v_mov_b32 v4, s25
    s_mov_b64 exec, 1
    buffer_store_dword v4, v3, s[4:7], s62 offen sc1
    s_mov_b64 exec, -1
Lf_131:
Lz_130:
    s_add_u32 s25, s25, 2
    s_cmp_ge_u32 s25, 64
    s_cbranch_scc1 L_exit
    s_branch L_loop_F1
L_role_QK:
    s_mov_b32 s8, s36
    s_and_b32 s9, s37, 0xffff
    s_mov_b32 s10, 0x780000
    s_mov_b32 s11, 0x20000
    s_mov_b32 s20, s38
    s_and_b32 s21, s39, 0xffff
    s_mov_b32 s22, 0x780000
    s_mov_b32 s23, 0x20000
    s_mul_i32 s62, s24, 384
    s_mul_i32 s28, s3, 196608
    s_add_u32 s62, s62, s28
    v_lshrrev_b32 v12, 4, v1
    v_bfe_u32 v13, v1, 2, 2
    v_and_b32 v14, 3, v1
    v_add_u32 v4, 0, v1
    v_mul_u32_u24 v5, 2731, v4
    v_lshrrev_b32 v5, 16, v5
    v_mul_u32_u24 v20, 24, v5
    v_sub_u32 v4, v4, v20
    v_bfe_u32 v20, v5, 2, 1
    v_lshlrev_b32 v20, 1, v20
    v_xor_b32 v4, v4, v20
    v_lshlrev_b32 v4, 4, v4
    v_mul_u32_u24 v5, 12288, v5
    v_add_u32 v20, v4, v5
    v_add_u32 v4, 64, v1
    v_mul_u32_u24 v5, 2731, v4
    v_lshrrev_b32 v5, 16, v5
    v_mul_u32_u24 v21, 24, v5
    v_sub_u32 v4, v4, v21
    v_bfe_u32 v21, v5, 2, 1
    v_lshlrev_b32 v21, 1, v21
    v_xor_b32 v4, v4, v21
    v_lshlrev_b32 v4, 4, v4
    v_mul_u32_u24 v5, 12288, v5
    v_add_u32 v21, v4, v5
    v_add_u32 v4, 128, v1
    v_mul_u32_u24 v5, 2731, v4
    v_lshrrev_b32 v5, 16, v5
    v_mul_u32_u24 v22, 24, v5
    v_sub_u32 v4, v4, v22
    v_bfe_u32 v22, v5, 2, 1
    v_lshlrev_b32 v22, 1, v22
    v_xor_b32 v4, v4, v22
    v_lshlrev_b32 v4, 4, v4
    v_mul_u32_u24 v5, 12288, v5
    v_add_u32 v22, v4, v5
    v_add_u32 v4, 192, v1
    v_mul_u32_u24 v5, 2731, v4
    v_lshrrev_b32 v5, 16, v5
    v_mul_u32_u24 v23, 24, v5
    v_sub_u32 v4, v4, v23
    v_bfe_u32 v23, v5, 2, 1
    v_lshlrev_b32 v23, 1, v23
    v_or_b32 v23, 4, v23
    v_xor_b32 v4, v4, v23
    v_lshlrev_b32 v4, 4, v4
    v_mul_u32_u24 v5, 12288, v5
    v_add_u32 v23, v4, v5
    v_add_u32 v4, 256, v1
    v_mul_u32_u24 v5, 2731, v4
    v_lshrrev_b32 v5, 16, v5
    v_mul_u32_u24 v24, 24, v5
    v_sub_u32 v4, v4, v24
    v_bfe_u32 v24, v5, 2, 1
    v_lshlrev_b32 v24, 1, v24
    v_or_b32 v24, 4, v24
    v_xor_b32 v4, v4, v24
    v_lshlrev_b32 v4, 4, v4
    v_mul_u32_u24 v5, 12288, v5
    v_add_u32 v24, v4, v5
    v_add_u32 v4, 320, v1
    v_mul_u32_u24 v5, 2731, v4
    v_lshrrev_b32 v5, 16, v5
    v_mul_u32_u24 v25, 24, v5
    v_sub_u32 v4, v4, v25
    v_bfe_u32 v25, v5, 2, 1
    v_lshlrev_b32 v25, 1, v25
    v_or_b32 v25, 4, v25
    v_xor_b32 v4, v4, v25
    v_lshlrev_b32 v4, 4, v4
    v_mul_u32_u24 v5, 12288, v5
    v_add_u32 v25, v4, v5
    v_lshrrev_b32 v10, 1, v12
    v_lshlrev_b32 v10, 4, v10
    v_and_b32 v4, 1, v12
    v_lshl_add_u32 v10, v4, 2, v10
    v_lshrrev_b32 v4, 1, v13
    v_lshl_add_u32 v10, v4, 3, v10
    v_and_b32 v4, 1, v13
    v_add_u32 v10, v4, v10
    v_mul_u32_u24 v10, 384, v10
    v_lshl_add_u32 v10, v14, 3, v10
    s_mul_i32 s68, s3, 96
    v_and_b32 v6, 1, v12
    v_and_b32 v7, 2, v13
    v_or_b32 v6, v6, v7
    v_lshlrev_b32 v6, 5, v6
    s_and_b32 s64, s2, 3
    s_lshl_b32 s64, s64, 2
    s_lshr_b32 s64, 0x0, s64
    s_and_b32 s64, s64, 15
    s_lshl_b32 s101, s64, 10
    s_add_u32 s101, s101, 0x4fd800
    s_add_u32 s63, s64, 0
    s_cmp_ge_u32 s63, 10
    s_cselect_b32 s65, 10, 0
    s_sub_u32 s63, s63, s65
    s_lshl_b32 s63, s63, 10
    s_add_u32 s63, s63, 20480
    s_lshr_b32 s65, s63, 13
    s_mul_i32 s65, s65, 8192
    s_add_u32 s90, s63, s65
    s_add_u32 s63, s64, 1
    s_cmp_ge_u32 s63, 10
    s_cselect_b32 s65, 10, 0
    s_sub_u32 s63, s63, s65
    s_lshl_b32 s63, s63, 10
    s_add_u32 s63, s63, 20480
    s_lshr_b32 s65, s63, 13
    s_mul_i32 s65, s65, 8192
    s_add_u32 s91, s63, s65
    s_add_u32 s63, s64, 2
    s_cmp_ge_u32 s63, 10
    s_cselect_b32 s65, 10, 0
    s_sub_u32 s63, s63, s65
    s_lshl_b32 s63, s63, 10
    s_add_u32 s63, s63, 20480
    s_lshr_b32 s65, s63, 13
    s_mul_i32 s65, s65, 8192
    s_add_u32 s92, s63, s65
    s_add_u32 s63, s64, 3
    s_cmp_ge_u32 s63, 10
    s_cselect_b32 s65, 10, 0
    s_sub_u32 s63, s63, s65
    s_lshl_b32 s63, s63, 10
    s_add_u32 s63, s63, 20480
    s_lshr_b32 s65, s63, 13
    s_mul_i32 s65, s65, 8192
    s_add_u32 s93, s63, s65
    s_add_u32 s63, s64, 4
    s_cmp_ge_u32 s63, 10
    s_cselect_b32 s65, 10, 0
    s_sub_u32 s63, s63, s65
    s_lshl_b32 s63, s63, 10
    s_add_u32 s63, s63, 20480
    s_lshr_b32 s65, s63, 13
    s_mul_i32 s65, s65, 8192
    s_add_u32 s94, s63, s65
    s_add_u32 s63, s64, 5
    s_cmp_ge_u32 s63, 10
    s_cselect_b32 s65, 10, 0
    s_sub_u32 s63, s63, s65
    s_lshl_b32 s63, s63, 10
    s_add_u32 s63, s63, 20480
    s_lshr_b32 s65, s63, 13
    s_mul_i32 s65, s65, 8192
    s_add_u32 s95, s63, s65
    s_add_u32 s63, s64, 6
    s_cmp_ge_u32 s63, 10
    s_cselect_b32 s65, 10, 0
    s_sub_u32 s63, s63, s65
    s_lshl_b32 s63, s63, 10
    s_add_u32 s63, s63, 20480
    s_lshr_b32 s65, s63, 13
    s_mul_i32 s65, s65, 8192
    s_add_u32 s96, s63, s65
    s_add_u32 s63, s64, 7
    s_cmp_ge_u32 s63, 10
    s_cselect_b32 s65, 10, 0
    s_sub_u32 s63, s63, s65
    s_lshl_b32 s63, s63, 10
    s_add_u32 s63, s63, 20480
    s_lshr_b32 s65, s63, 13
    s_mul_i32 s65, s65, 8192
    s_add_u32 s97, s63, s65
    s_add_u32 s63, s64, 8
    s_cmp_ge_u32 s63, 10
    s_cselect_b32 s65, 10, 0
    s_sub_u32 s63, s63, s65
    s_lshl_b32 s63, s63, 10
    s_add_u32 s63, s63, 20480
    s_lshr_b32 s65, s63, 13
    s_mul_i32 s65, s65, 8192
    s_add_u32 s98, s63, s65
    s_add_u32 s63, s64, 9
    s_cmp_ge_u32 s63, 10
    s_cselect_b32 s65, 10, 0
    s_sub_u32 s63, s63, s65
    s_lshl_b32 s63, s63, 10
    s_add_u32 s63, s63, 20480
    s_lshr_b32 s65, s63, 13
    s_mul_i32 s65, s65, 8192
    s_add_u32 s99, s63, s65
    s_mul_i32 s61, s3, 6144
    s_add_u32 s63, s64, 9
    s_cmp_ge_u32 s63, 10
    s_cselect_b32 s65, 10, 0
    s_sub_u32 s63, s63, s65
    s_mul_i32 s63, s63, 786432
    s_add_u32 s63, s63, s62
    s_add_u32 m0, s61, 0
    s_add_u32 s60, s63, 0x0
    buffer_load_dwordx4 v20, s[20:23], s60 offen lds
    s_add_u32 m0, s61, 1024
    s_add_u32 s60, s63, 0x0
    buffer_load_dwordx4 v21, s[20:23], s60 offen lds
    s_add_u32 m0, s61, 2048
    s_add_u32 s60, s63, 0x0
    buffer_load_dwordx4 v22, s[20:23], s60 offen lds
    s_add_u32 m0, s61, 3072
    s_add_u32 s60, s63, 0x0
    buffer_load_dwordx4 v23, s[20:23], s60 offen lds
    s_add_u32 m0, s61, 4096
    s_add_u32 s60, s63, 0x0
    buffer_load_dwordx4 v24, s[20:23], s60 offen lds
    s_add_u32 m0, s61, 5120
    s_add_u32 s60, s63, 0x0
    buffer_load_dwordx4 v25, s[20:23], s60 offen lds
    s_add_u32 s63, s64, 9
    s_cmp_ge_u32 s63, 10
    s_cselect_b32 s65, 10, 0
    s_sub_u32 s63, s63, s65
    s_mul_i32 s63, s63, 786432
    s_add_u32 s63, s63, s62
    s_add_u32 m0, s61, 24576
    s_add_u32 s60, s63, 0x0
    buffer_load_dwordx4 v20, s[8:11], s60 offen lds
    s_add_u32 m0, s61, 25600
    s_add_u32 s60, s63, 0x0
    buffer_load_dwordx4 v21, s[8:11], s60 offen lds
    s_add_u32 m0, s61, 26624
    s_add_u32 s60, s63, 0x0
    buffer_load_dwordx4 v22, s[8:11], s60 offen lds
    s_add_u32 m0, s61, 27648
    s_add_u32 s60, s63, 0x0
    buffer_load_dwordx4 v23, s[8:11], s60 offen lds
    s_add_u32 m0, s61, 28672
    s_add_u32 s60, s63, 0x0
    buffer_load_dwordx4 v24, s[8:11], s60 offen lds
    s_add_u32 m0, s61, 29696
    s_add_u32 s60, s63, 0x0
    buffer_load_dwordx4 v25, s[8:11], s60 offen lds
    s_add_u32 s63, s64, 8
    s_cmp_ge_u32 s63, 10
    s_cselect_b32 s65, 10, 0
    s_sub_u32 s63, s63, s65
    s_mul_i32 s63, s63, 786432
    s_add_u32 s63, s63, s62
    s_add_u32 m0, s61, 49152
    s_add_u32 s60, s63, 0x0
    buffer_load_dwordx4 v20, s[20:23], s60 offen lds
    s_add_u32 m0, s61, 50176
    s_add_u32 s60, s63, 0x0
    buffer_load_dwordx4 v21, s[20:23], s60 offen lds
    s_add_u32 m0, s61, 51200
    s_add_u32 s60, s63, 0x0
    buffer_load_dwordx4 v22, s[20:23], s60 offen lds
    s_add_u32 m0, s61, 52224
    s_add_u32 s60, s63, 0x0
    buffer_load_dwordx4 v23, s[20:23], s60 offen lds
    s_add_u32 m0, s61, 53248
    s_add_u32 s60, s63, 0x0
    buffer_load_dwordx4 v24, s[20:23], s60 offen lds
    s_add_u32 m0, s61, 54272
    s_add_u32 s60, s63, 0x0
    buffer_load_dwordx4 v25, s[20:23], s60 offen lds
    s_add_u32 s63, s64, 8
    s_cmp_ge_u32 s63, 10
    s_cselect_b32 s65, 10, 0
    s_sub_u32 s63, s63, s65
    s_mul_i32 s63, s63, 786432
    s_add_u32 s63, s63, s62
    s_add_u32 m0, s61, 73728
    s_add_u32 s60, s63, 0x0
    buffer_load_dwordx4 v20, s[8:11], s60 offen lds
    s_add_u32 m0, s61, 74752
    s_add_u32 s60, s63, 0x0
    buffer_load_dwordx4 v21, s[8:11], s60 offen lds
    s_add_u32 m0, s61, 75776
    s_add_u32 s60, s63, 0x0
    buffer_load_dwordx4 v22, s[8:11], s60 offen lds
    s_add_u32 m0, s61, 76800
    s_add_u32 s60, s63, 0x0
    buffer_load_dwordx4 v23, s[8:11], s60 offen lds
    s_add_u32 m0, s61, 77824
    s_add_u32 s60, s63, 0x0
    buffer_load_dwordx4 v24, s[8:11], s60 offen lds
    s_add_u32 m0, s61, 78848
    s_add_u32 s60, s63, 0x0
    buffer_load_dwordx4 v25, s[8:11], s60 offen lds
    s_add_u32 s63, s64, 7
    s_cmp_ge_u32 s63, 10
    s_cselect_b32 s65, 10, 0
    s_sub_u32 s63, s63, s65
    s_mul_i32 s63, s63, 786432
    s_add_u32 s63, s63, s62
    s_add_u32 m0, s61, 98304
    s_add_u32 s60, s63, 0x0
    buffer_load_dwordx4 v20, s[20:23], s60 offen lds
    s_add_u32 m0, s61, 99328
    s_add_u32 s60, s63, 0x0
    buffer_load_dwordx4 v21, s[20:23], s60 offen lds
    s_add_u32 m0, s61, 100352
    s_add_u32 s60, s63, 0x0
    buffer_load_dwordx4 v22, s[20:23], s60 offen lds
    s_add_u32 m0, s61, 101376
    s_add_u32 s60, s63, 0x0
    buffer_load_dwordx4 v23, s[20:23], s60 offen lds
    s_add_u32 m0, s61, 102400
    s_add_u32 s60, s63, 0x0
    buffer_load_dwordx4 v24, s[20:23], s60 offen lds
    s_add_u32 m0, s61, 103424
    s_add_u32 s60, s63, 0x0
    buffer_load_dwordx4 v25, s[20:23], s60 offen lds
    s_waitcnt vmcnt(24)
    s_barrier
    s_add_u32 s63, s64, 7
    s_cmp_ge_u32 s63, 10
    s_cselect_b32 s65, 10, 0
    s_sub_u32 s63, s63, s65
    s_mul_i32 s63, s63, 786432
    s_add_u32 s63, s63, s62
    s_add_u32 m0, s61, 122880
    s_add_u32 s60, s63, 0x0
    buffer_load_dwordx4 v20, s[8:11], s60 offen lds
    s_add_u32 m0, s61, 123904
    s_add_u32 s60, s63, 0x0
    buffer_load_dwordx4 v21, s[8:11], s60 offen lds
    s_add_u32 m0, s61, 124928
    s_add_u32 s60, s63, 0x0
    buffer_load_dwordx4 v22, s[8:11], s60 offen lds
    s_add_u32 m0, s61, 125952
    s_add_u32 s60, s63, 0x0
    buffer_load_dwordx4 v23, s[8:11], s60 offen lds
    s_add_u32 m0, s61, 126976
    s_add_u32 s60, s63, 0x0
    buffer_load_dwordx4 v24, s[8:11], s60 offen lds
    s_add_u32 m0, s61, 128000
    s_add_u32 s60, s63, 0x0
    buffer_load_dwordx4 v25, s[8:11], s60 offen lds
    v_add_u32 v11, 0x0, v10
    s_add_u32 s60, s68, 0
    v_xad_u32 v8, s60, v6, v11
    ds_read_b64_tr_b16 v[88:89], v8 offset:0
    ds_read_b64_tr_b16 v[90:91], v8 offset:768
    ds_read_b64_tr_b16 v[92:93], v8 offset:12288
    ds_read_b64_tr_b16 v[94:95], v8 offset:13056
    s_add_u32 s60, s68, 32
    v_xad_u32 v9, s60, v6, v11
    ds_read_b64_tr_b16 v[136:137], v9 offset:0
    ds_read_b64_tr_b16 v[138:139], v9 offset:768
    ds_read_b64_tr_b16 v[140:141], v9 offset:12288
    ds_read_b64_tr_b16 v[142:143], v9 offset:13056
    s_add_u32 s60, s68, 64
    v_xad_u32 v8, s60, v6, v11
    ds_read_b64_tr_b16 v[120:121], v8 offset:0
    ds_read_b64_tr_b16 v[122:123], v8 offset:768
    ds_read_b64_tr_b16 v[124:125], v8 offset:12288
    ds_read_b64_tr_b16 v[126:127], v8 offset:13056
    s_waitcnt lgkmcnt(0)
    s_waitcnt vmcnt(24)
    s_barrier
    s_add_u32 s63, s64, 6
    s_cmp_ge_u32 s63, 10
    s_cselect_b32 s65, 10, 0
    s_sub_u32 s63, s63, s65
    s_mul_i32 s63, s63, 786432
    s_add_u32 s63, s63, s62
    s_add_u32 m0, s61, 0
    s_add_u32 s60, s63, 0x0
    buffer_load_dwordx4 v20, s[20:23], s60 offen lds
    s_add_u32 m0, s61, 1024
    s_add_u32 s60, s63, 0x0
    buffer_load_dwordx4 v21, s[20:23], s60 offen lds
    s_add_u32 m0, s61, 2048
    s_add_u32 s60, s63, 0x0
    buffer_load_dwordx4 v22, s[20:23], s60 offen lds
    s_add_u32 m0, s61, 3072
    s_add_u32 s60, s63, 0x0
    buffer_load_dwordx4 v23, s[20:23], s60 offen lds
    s_add_u32 m0, s61, 4096
    s_add_u32 s60, s63, 0x0
    buffer_load_dwordx4 v24, s[20:23], s60 offen lds
    s_add_u32 m0, s61, 5120
    s_add_u32 s60, s63, 0x0
    buffer_load_dwordx4 v25, s[20:23], s60 offen lds
    v_add_u32 v11, 0x6000, v10
    s_add_u32 s60, s68, 0
    v_xad_u32 v8, s60, v6, v11
    ds_read_b64_tr_b16 v[80:81], v8 offset:0
    ds_read_b64_tr_b16 v[82:83], v8 offset:768
    ds_read_b64_tr_b16 v[84:85], v8 offset:12288
    ds_read_b64_tr_b16 v[86:87], v8 offset:13056
    s_add_u32 s60, s68, 32
    v_xad_u32 v9, s60, v6, v11
    ds_read_b64_tr_b16 v[128:129], v9 offset:0
    ds_read_b64_tr_b16 v[130:131], v9 offset:768
    ds_read_b64_tr_b16 v[132:133], v9 offset:12288
    ds_read_b64_tr_b16 v[134:135], v9 offset:13056
    s_add_u32 s60, s68, 64
    v_xad_u32 v8, s60, v6, v11
    ds_read_b64_tr_b16 v[112:113], v8 offset:0
    ds_read_b64_tr_b16 v[114:115], v8 offset:768
    ds_read_b64_tr_b16 v[116:117], v8 offset:12288
    ds_read_b64_tr_b16 v[118:119], v8 offset:13056
    s_waitcnt lgkmcnt(0)
    s_waitcnt vmcnt(24)
    s_barrier
    s_add_u32 s63, s64, 6
    s_cmp_ge_u32 s63, 10
    s_cselect_b32 s65, 10, 0
    s_sub_u32 s63, s63, s65
    s_mul_i32 s63, s63, 786432
    s_add_u32 s63, s63, s62
    s_add_u32 m0, s61, 24576
    s_add_u32 s60, s63, 0x0
    buffer_load_dwordx4 v20, s[8:11], s60 offen lds
    s_add_u32 m0, s61, 25600
    s_add_u32 s60, s63, 0x0
    buffer_load_dwordx4 v21, s[8:11], s60 offen lds
    s_add_u32 m0, s61, 26624
    s_add_u32 s60, s63, 0x0
    buffer_load_dwordx4 v22, s[8:11], s60 offen lds
    s_add_u32 m0, s61, 27648
    s_add_u32 s60, s63, 0x0
    buffer_load_dwordx4 v23, s[8:11], s60 offen lds
    s_add_u32 m0, s61, 28672
    s_add_u32 s60, s63, 0x0
    buffer_load_dwordx4 v24, s[8:11], s60 offen lds
    s_add_u32 m0, s61, 29696
    s_add_u32 s60, s63, 0x0
    buffer_load_dwordx4 v25, s[8:11], s60 offen lds
    v_add_u32 v11, 0xc000, v10
    s_add_u32 s60, s68, 0
    v_xad_u32 v8, s60, v6, v11
    ds_read_b64_tr_b16 a[232:233], v8 offset:0
    ds_read_b64_tr_b16 a[234:235], v8 offset:768
    ds_read_b64_tr_b16 a[236:237], v8 offset:12288
    ds_read_b64_tr_b16 a[238:239], v8 offset:13056
    s_add_u32 s60, s68, 32
    v_xad_u32 v9, s60, v6, v11
    ds_read_b64_tr_b16 a[248:249], v9 offset:0
    ds_read_b64_tr_b16 a[250:251], v9 offset:768
    ds_read_b64_tr_b16 a[252:253], v9 offset:12288
    ds_read_b64_tr_b16 a[254:255], v9 offset:13056
    s_add_u32 s60, s68, 64
    v_xad_u32 v8, s60, v6, v11
    ds_read_b64_tr_b16 v[248:249], v8 offset:0
    ds_read_b64_tr_b16 v[250:251], v8 offset:768
    ds_read_b64_tr_b16 v[252:253], v8 offset:12288
    ds_read_b64_tr_b16 v[254:255], v8 offset:13056
    s_waitcnt lgkmcnt(0)
    s_waitcnt vmcnt(24)
    s_barrier
    s_add_u32 s63, s64, 5
    s_cmp_ge_u32 s63, 10
    s_cselect_b32 s65, 10, 0
    s_sub_u32 s63, s63, s65
    s_mul_i32 s63, s63, 786432
    s_add_u32 s63, s63, s62
    s_add_u32 m0, s61, 49152
    s_add_u32 s60, s63, 0x0
    buffer_load_dwordx4 v20, s[20:23], s60 offen lds
    s_add_u32 m0, s61, 50176
    s_add_u32 s60, s63, 0x0
    buffer_load_dwordx4 v21, s[20:23], s60 offen lds
    s_add_u32 m0, s61, 51200
    s_add_u32 s60, s63, 0x0
    buffer_load_dwordx4 v22, s[20:23], s60 offen lds
    s_add_u32 m0, s61, 52224
    s_add_u32 s60, s63, 0x0
    buffer_load_dwordx4 v23, s[20:23], s60 offen lds
    s_add_u32 m0, s61, 53248
    s_add_u32 s60, s63, 0x0
    buffer_load_dwordx4 v24, s[20:23], s60 offen lds
    s_add_u32 m0, s61, 54272
    s_add_u32 s60, s63, 0x0
    buffer_load_dwordx4 v25, s[20:23], s60 offen lds
    v_add_u32 v11, 0x12000, v10
    s_add_u32 s60, s68, 0
    v_xad_u32 v8, s60, v6, v11
    ds_read_b64_tr_b16 a[224:225], v8 offset:0
    ds_read_b64_tr_b16 a[226:227], v8 offset:768
    ds_read_b64_tr_b16 a[228:229], v8 offset:12288
    ds_read_b64_tr_b16 a[230:231], v8 offset:13056
    s_add_u32 s60, s68, 32
    v_xad_u32 v9, s60, v6, v11
    ds_read_b64_tr_b16 a[240:241], v9 offset:0
    ds_read_b64_tr_b16 a[242:243], v9 offset:768
    ds_read_b64_tr_b16 a[244:245], v9 offset:12288
    ds_read_b64_tr_b16 a[246:247], v9 offset:13056
    s_add_u32 s60, s68, 64
    v_xad_u32 v8, s60, v6, v11
    ds_read_b64_tr_b16 v[240:241], v8 offset:0
    ds_read_b64_tr_b16 v[242:243], v8 offset:768
    ds_read_b64_tr_b16 v[244:245], v8 offset:12288
    ds_read_b64_tr_b16 v[246:247], v8 offset:13056
    s_waitcnt lgkmcnt(0)
    s_waitcnt vmcnt(24)
    s_barrier
    s_add_u32 s63, s64, 5
    s_cmp_ge_u32 s63, 10
    s_cselect_b32 s65, 10, 0
    s_sub_u32 s63, s63, s65
    s_mul_i32 s63, s63, 786432
    s_add_u32 s63, s63, s62
    s_add_u32 m0, s61, 73728
    s_add_u32 s60, s63, 0x0
    buffer_load_dwordx4 v20, s[8:11], s60 offen lds
    s_add_u32 m0, s61, 74752
    s_add_u32 s60, s63, 0x0
    buffer_load_dwordx4 v21, s[8:11], s60 offen lds
    s_add_u32 m0, s61, 75776
    s_add_u32 s60, s63, 0x0
    buffer_load_dwordx4 v22, s[8:11], s60 offen lds
    s_add_u32 m0, s61, 76800
    s_add_u32 s60, s63, 0x0
    buffer_load_dwordx4 v23, s[8:11], s60 offen lds
    s_add_u32 m0, s61, 77824
    s_add_u32 s60, s63, 0x0
    buffer_load_dwordx4 v24, s[8:11], s60 offen lds
    s_add_u32 m0, s61, 78848
    s_add_u32 s60, s63, 0x0
    buffer_load_dwordx4 v25, s[8:11], s60 offen lds
    v_add_u32 v11, 0x18000, v10
    s_add_u32 s60, s68, 0
    v_xad_u32 v8, s60, v6, v11
    ds_read_b64_tr_b16 a[200:201], v8 offset:0
    ds_read_b64_tr_b16 a[202:203], v8 offset:768
    ds_read_b64_tr_b16 a[204:205], v8 offset:12288
    ds_read_b64_tr_b16 a[206:207], v8 offset:13056
    s_add_u32 s60, s68, 32
    v_xad_u32 v9, s60, v6, v11
    ds_read_b64_tr_b16 a[216:217], v9 offset:0
    ds_read_b64_tr_b16 a[218:219], v9 offset:768
    ds_read_b64_tr_b16 a[220:221], v9 offset:12288
    ds_read_b64_tr_b16 a[222:223], v9 offset:13056
    s_add_u32 s60, s68, 64
    v_xad_u32 v8, s60, v6, v11
    ds_read_b64_tr_b16 v[232:233], v8 offset:0
    ds_read_b64_tr_b16 v[234:235], v8 offset:768
    ds_read_b64_tr_b16 v[236:237], v8 offset:12288
    ds_read_b64_tr_b16 v[238:239], v8 offset:13056
    s_waitcnt lgkmcnt(0)
    s_waitcnt vmcnt(24)
    s_barrier
    s_add_u32 s63, s64, 4
    s_cmp_ge_u32 s63, 10
    s_cselect_b32 s65, 10, 0
    s_sub_u32 s63, s63, s65
    s_mul_i32 s63, s63, 786432
    s_add_u32 s63, s63, s62
    s_add_u32 m0, s61, 98304
    s_add_u32 s60, s63, 0x0
    buffer_load_dwordx4 v20, s[20:23], s60 offen lds
    s_add_u32 m0, s61, 99328
    s_add_u32 s60, s63, 0x0
    buffer_load_dwordx4 v21, s[20:23], s60 offen lds
    s_add_u32 m0, s61, 100352
    s_add_u32 s60, s63, 0x0
    buffer_load_dwordx4 v22, s[20:23], s60 offen lds
    s_add_u32 m0, s61, 101376
    s_add_u32 s60, s63, 0x0
    buffer_load_dwordx4 v23, s[20:23], s60 offen lds
    s_add_u32 m0, s61, 102400
    s_add_u32 s60, s63, 0x0
    buffer_load_dwordx4 v24, s[20:23], s60 offen lds
    s_add_u32 m0, s61, 103424
    s_add_u32 s60, s63, 0x0
    buffer_load_dwordx4 v25, s[20:23], s60 offen lds
    v_add_u32 v11, 0x1e000, v10
    s_add_u32 s60, s68, 0
    v_xad_u32 v8, s60, v6, v11
    ds_read_b64_tr_b16 a[192:193], v8 offset:0
    ds_read_b64_tr_b16 a[194:195], v8 offset:768
    ds_read_b64_tr_b16 a[196:197], v8 offset:12288
    ds_read_b64_tr_b16 a[198:199], v8 offset:13056
    s_add_u32 s60, s68, 32
    v_xad_u32 v9, s60, v6, v11
    ds_read_b64_tr_b16 a[208:209], v9 offset:0
    ds_read_b64_tr_b16 a[210:211], v9 offset:768
    ds_read_b64_tr_b16 a[212:213], v9 offset:12288
    ds_read_b64_tr_b16 a[214:215], v9 offset:13056
    s_add_u32 s60, s68, 64
    v_xad_u32 v8, s60, v6, v11
    ds_read_b64_tr_b16 v[224:225], v8 offset:0
    ds_read_b64_tr_b16 v[226:227], v8 offset:768
    ds_read_b64_tr_b16 v[228:229], v8 offset:12288
    ds_read_b64_tr_b16 v[230:231], v8 offset:13056
    s_waitcnt lgkmcnt(0)
    s_waitcnt vmcnt(24)
    s_barrier
    s_add_u32 s63, s64, 4
    s_cmp_ge_u32 s63, 10
    s_cselect_b32 s65, 10, 0
    s_sub_u32 s63, s63, s65
    s_mul_i32 s63, s63, 786432
    s_add_u32 s63, s63, s62
    s_add_u32 m0, s61, 122880
    s_add_u32 s60, s63, 0x0
    buffer_load_dwordx4 v20, s[8:11], s60 offen lds
    s_add_u32 m0, s61, 123904
    s_add_u32 s60, s63, 0x0
    buffer_load_dwordx4 v21, s[8:11], s60 offen lds
    s_add_u32 m0, s61, 124928
    s_add_u32 s60, s63, 0x0
    buffer_load_dwordx4 v22, s[8:11], s60 offen lds
    s_add_u32 m0, s61, 125952
    s_add_u32 s60, s63, 0x0
    buffer_load_dwordx4 v23, s[8:11], s60 offen lds
    s_add_u32 m0, s61, 126976
    s_add_u32 s60, s63, 0x0
    buffer_load_dwordx4 v24, s[8:11], s60 offen lds
    s_add_u32 m0, s61, 128000
    s_add_u32 s60, s63, 0x0
    buffer_load_dwordx4 v25, s[8:11], s60 offen lds
    v_add_u32 v11, 0x0, v10
    s_add_u32 s60, s68, 0
    v_xad_u32 v8, s60, v6, v11
    ds_read_b64_tr_b16 a[184:185], v8 offset:0
    ds_read_b64_tr_b16 a[186:187], v8 offset:768
    ds_read_b64_tr_b16 a[188:189], v8 offset:12288
    ds_read_b64_tr_b16 a[190:191], v8 offset:13056
    s_add_u32 s60, s68, 32
    v_xad_u32 v9, s60, v6, v11
    ds_read_b64_tr_b16 v[72:73], v9 offset:0
    ds_read_b64_tr_b16 v[74:75], v9 offset:768
    ds_read_b64_tr_b16 v[76:77], v9 offset:12288
    ds_read_b64_tr_b16 v[78:79], v9 offset:13056
    s_add_u32 s60, s68, 64
    v_xad_u32 v8, s60, v6, v11
    ds_read_b64_tr_b16 v[216:217], v8 offset:0
    ds_read_b64_tr_b16 v[218:219], v8 offset:768
    ds_read_b64_tr_b16 v[220:221], v8 offset:12288
    ds_read_b64_tr_b16 v[222:223], v8 offset:13056
    s_waitcnt lgkmcnt(0)
    s_waitcnt vmcnt(24)
    s_barrier
    s_add_u32 s63, s64, 3
    s_cmp_ge_u32 s63, 10
    s_cselect_b32 s65, 10, 0
    s_sub_u32 s63, s63, s65
    s_mul_i32 s63, s63, 786432
    s_add_u32 s63, s63, s62
    s_add_u32 m0, s61, 0
    s_add_u32 s60, s63, 0x0
    buffer_load_dwordx4 v20, s[20:23], s60 offen lds
    s_add_u32 m0, s61, 1024
    s_add_u32 s60, s63, 0x0
    buffer_load_dwordx4 v21, s[20:23], s60 offen lds
    s_add_u32 m0, s61, 2048
    s_add_u32 s60, s63, 0x0
    buffer_load_dwordx4 v22, s[20:23], s60 offen lds
    s_add_u32 m0, s61, 3072
    s_add_u32 s60, s63, 0x0
    buffer_load_dwordx4 v23, s[20:23], s60 offen lds
    s_add_u32 m0, s61, 4096
    s_add_u32 s60, s63, 0x0
    buffer_load_dwordx4 v24, s[20:23], s60 offen lds
    s_add_u32 m0, s61, 5120
    s_add_u32 s60, s63, 0x0
    buffer_load_dwordx4 v25, s[20:23], s60 offen lds
    v_add_u32 v11, 0x6000, v10
    s_add_u32 s60, s68, 0
    v_xad_u32 v8, s60, v6, v11
    ds_read_b64_tr_b16 a[176:177], v8 offset:0
    ds_read_b64_tr_b16 a[178:179], v8 offset:768
    ds_read_b64_tr_b16 a[180:181], v8 offset:12288
    ds_read_b64_tr_b16 a[182:183], v8 offset:13056
    s_add_u32 s60, s68, 32
    v_xad_u32 v9, s60, v6, v11
    ds_read_b64_tr_b16 v[64:65], v9 offset:0
    ds_read_b64_tr_b16 v[66:67], v9 offset:768
    ds_read_b64_tr_b16 v[68:69], v9 offset:12288
    ds_read_b64_tr_b16 v[70:71], v9 offset:13056
    s_add_u32 s60, s68, 64
    v_xad_u32 v8, s60, v6, v11
    ds_read_b64_tr_b16 v[208:209], v8 offset:0
    ds_read_b64_tr_b16 v[210:211], v8 offset:768
    ds_read_b64_tr_b16 v[212:213], v8 offset:12288
    ds_read_b64_tr_b16 v[214:215], v8 offset:13056
    s_waitcnt lgkmcnt(0)
    s_waitcnt vmcnt(24)
    s_barrier
    s_add_u32 s63, s64, 3
    s_cmp_ge_u32 s63, 10
    s_cselect_b32 s65, 10, 0
    s_sub_u32 s63, s63, s65
    s_mul_i32 s63, s63, 786432
    s_add_u32 s63, s63, s62
    s_add_u32 m0, s61, 24576
    s_add_u32 s60, s63, 0x0
    buffer_load_dwordx4 v20, s[8:11], s60 offen lds
    s_add_u32 m0, s61, 25600
    s_add_u32 s60, s63, 0x0
    buffer_load_dwordx4 v21, s[8:11], s60 offen lds
    s_add_u32 m0, s61, 26624
    s_add_u32 s60, s63, 0x0
    buffer_load_dwordx4 v22, s[8:11], s60 offen lds
    s_add_u32 m0, s61, 27648
    s_add_u32 s60, s63, 0x0
    buffer_load_dwordx4 v23, s[8:11], s60 offen lds
    s_add_u32 m0, s61, 28672
    s_add_u32 s60, s63, 0x0
    buffer_load_dwordx4 v24, s[8:11], s60 offen lds
    s_add_u32 m0, s61, 29696
    s_add_u32 s60, s63, 0x0
    buffer_load_dwordx4 v25, s[8:11], s60 offen lds
    v_add_u32 v11, 0xc000, v10
    s_add_u32 s60, s68, 0
    v_xad_u32 v8, s60, v6, v11
    ds_read_b64_tr_b16 a[152:153], v8 offset:0
    ds_read_b64_tr_b16 a[154:155], v8 offset:768
    ds_read_b64_tr_b16 a[156:157], v8 offset:12288
    ds_read_b64_tr_b16 a[158:159], v8 offset:13056
    s_add_u32 s60, s68, 32
    v_xad_u32 v9, s60, v6, v11
    ds_read_b64_tr_b16 a[168:169], v9 offset:0
    ds_read_b64_tr_b16 a[170:171], v9 offset:768
    ds_read_b64_tr_b16 a[172:173], v9 offset:12288
    ds_read_b64_tr_b16 a[174:175], v9 offset:13056
    s_add_u32 s60, s68, 64
    v_xad_u32 v8, s60, v6, v11
    ds_read_b64_tr_b16 v[200:201], v8 offset:0
    ds_read_b64_tr_b16 v[202:203], v8 offset:768
    ds_read_b64_tr_b16 v[204:205], v8 offset:12288
    ds_read_b64_tr_b16 v[206:207], v8 offset:13056
    s_waitcnt lgkmcnt(0)
    s_waitcnt vmcnt(24)
    s_barrier
    s_add_u32 s63, s64, 2
    s_cmp_ge_u32 s63, 10
    s_cselect_b32 s65, 10, 0
    s_sub_u32 s63, s63, s65
    s_mul_i32 s63, s63, 786432
    s_add_u32 s63, s63, s62
    s_add_u32 m0, s61, 49152
    s_add_u32 s60, s63, 0x0
    buffer_load_dwordx4 v20, s[20:23], s60 offen lds
    s_add_u32 m0, s61, 50176
    s_add_u32 s60, s63, 0x0
    buffer_load_dwordx4 v21, s[20:23], s60 offen lds
    s_add_u32 m0, s61, 51200
    s_add_u32 s60, s63, 0x0
    buffer_load_dwordx4 v22, s[20:23], s60 offen lds
    s_add_u32 m0, s61, 52224
    s_add_u32 s60, s63, 0x0
    buffer_load_dwordx4 v23, s[20:23], s60 offen lds
    s_add_u32 m0, s61, 53248
    s_add_u32 s60, s63, 0x0
    buffer_load_dwordx4 v24, s[20:23], s60 offen lds
    s_add_u32 m0, s61, 54272
    s_add_u32 s60, s63, 0x0
    buffer_load_dwordx4 v25, s[20:23], s60 offen lds
    v_add_u32 v11, 0x12000, v10
    s_add_u32 s60, s68, 0
    v_xad_u32 v8, s60, v6, v11
    ds_read_b64_tr_b16 a[144:145], v8 offset:0
    ds_read_b64_tr_b16 a[146:147], v8 offset:768
    ds_read_b64_tr_b16 a[148:149], v8 offset:12288
    ds_read_b64_tr_b16 a[150:151], v8 offset:13056
    s_add_u32 s60, s68, 32
    v_xad_u32 v9, s60, v6, v11
    ds_read_b64_tr_b16 a[160:161], v9 offset:0
    ds_read_b64_tr_b16 a[162:163], v9 offset:768
    ds_read_b64_tr_b16 a[164:165], v9 offset:12288
    ds_read_b64_tr_b16 a[166:167], v9 offset:13056
    s_add_u32 s60, s68, 64
    v_xad_u32 v8, s60, v6, v11
    ds_read_b64_tr_b16 v[192:193], v8 offset:0
    ds_read_b64_tr_b16 v[194:195], v8 offset:768
    ds_read_b64_tr_b16 v[196:197], v8 offset:12288
    ds_read_b64_tr_b16 v[198:199], v8 offset:13056
    s_waitcnt lgkmcnt(0)
    s_waitcnt vmcnt(24)
    s_barrier
    s_add_u32 s63, s64, 2
    s_cmp_ge_u32 s63, 10
    s_cselect_b32 s65, 10, 0
    s_sub_u32 s63, s63, s65
    s_mul_i32 s63, s63, 786432
    s_add_u32 s63, s63, s62
    s_add_u32 m0, s61, 73728
    s_add_u32 s60, s63, 0x0
    buffer_load_dwordx4 v20, s[8:11], s60 offen lds
    s_add_u32 m0, s61, 74752
    s_add_u32 s60, s63, 0x0
    buffer_load_dwordx4 v21, s[8:11], s60 offen lds
    s_add_u32 m0, s61, 75776
    s_add_u32 s60, s63, 0x0
    buffer_load_dwordx4 v22, s[8:11], s60 offen lds
    s_add_u32 m0, s61, 76800
    s_add_u32 s60, s63, 0x0
    buffer_load_dwordx4 v23, s[8:11], s60 offen lds
    s_add_u32 m0, s61, 77824
    s_add_u32 s60, s63, 0x0
    buffer_load_dwordx4 v24, s[8:11], s60 offen lds
    s_add_u32 m0, s61, 78848
    s_add_u32 s60, s63, 0x0
    buffer_load_dwordx4 v25, s[8:11], s60 offen lds
    v_add_u32 v11, 0x18000, v10
    s_add_u32 s60, s68, 0
    v_xad_u32 v8, s60, v6, v11
    ds_read_b64_tr_b16 v[56:57], v8 offset:0
    ds_read_b64_tr_b16 v[58:59], v8 offset:768
    ds_read_b64_tr_b16 v[60:61], v8 offset:12288
    ds_read_b64_tr_b16 v[62:63], v8 offset:13056
    s_add_u32 s60, s68, 32
    v_xad_u32 v9, s60, v6, v11
    ds_read_b64_tr_b16 a[136:137], v9 offset:0
    ds_read_b64_tr_b16 a[138:139], v9 offset:768
    ds_read_b64_tr_b16 a[140:141], v9 offset:12288
    ds_read_b64_tr_b16 a[142:143], v9 offset:13056
    s_add_u32 s60, s68, 64
    v_xad_u32 v8, s60, v6, v11
    ds_read_b64_tr_b16 v[104:105], v8 offset:0
    ds_read_b64_tr_b16 v[106:107], v8 offset:768
    ds_read_b64_tr_b16 v[108:109], v8 offset:12288
    ds_read_b64_tr_b16 v[110:111], v8 offset:13056
    s_waitcnt lgkmcnt(0)
    s_waitcnt vmcnt(24)
    s_barrier
    s_add_u32 s63, s64, 1
    s_cmp_ge_u32 s63, 10
    s_cselect_b32 s65, 10, 0
    s_sub_u32 s63, s63, s65
    s_mul_i32 s63, s63, 786432
    s_add_u32 s63, s63, s62
    s_add_u32 m0, s61, 98304
    s_add_u32 s60, s63, 0x0
    buffer_load_dwordx4 v20, s[20:23], s60 offen lds
    s_add_u32 m0, s61, 99328
    s_add_u32 s60, s63, 0x0
    buffer_load_dwordx4 v21, s[20:23], s60 offen lds
    s_add_u32 m0, s61, 100352
    s_add_u32 s60, s63, 0x0
    buffer_load_dwordx4 v22, s[20:23], s60 offen lds
    s_add_u32 m0, s61, 101376
    s_add_u32 s60, s63, 0x0
    buffer_load_dwordx4 v23, s[20:23], s60 offen lds
    s_add_u32 m0, s61, 102400
    s_add_u32 s60, s63, 0x0
    buffer_load_dwordx4 v24, s[20:23], s60 offen lds
    s_add_u32 m0, s61, 103424
    s_add_u32 s60, s63, 0x0
    buffer_load_dwordx4 v25, s[20:23], s60 offen lds
    v_add_u32 v11, 0x1e000, v10
    s_add_u32 s60, s68, 0
    v_xad_u32 v8, s60, v6, v11
    ds_read_b64_tr_b16 v[48:49], v8 offset:0
    ds_read_b64_tr_b16 v[50:51], v8 offset:768
    ds_read_b64_tr_b16 v[52:53], v8 offset:12288
    ds_read_b64_tr_b16 v[54:55], v8 offset:13056
    s_add_u32 s60, s68, 32
    v_xad_u32 v9, s60, v6, v11
    ds_read_b64_tr_b16 a[128:129], v9 offset:0
    ds_read_b64_tr_b16 a[130:131], v9 offset:768
    ds_read_b64_tr_b16 a[132:133], v9 offset:12288
    ds_read_b64_tr_b16 a[134:135], v9 offset:13056
    s_add_u32 s60, s68, 64
    v_xad_u32 v8, s60, v6, v11
    ds_read_b64_tr_b16 v[96:97], v8 offset:0
    ds_read_b64_tr_b16 v[98:99], v8 offset:768
    ds_read_b64_tr_b16 v[100:101], v8 offset:12288
    ds_read_b64_tr_b16 v[102:103], v8 offset:13056
    s_waitcnt lgkmcnt(0)
    s_waitcnt vmcnt(24)
    s_barrier
    s_add_u32 s63, s64, 1
    s_cmp_ge_u32 s63, 10
    s_cselect_b32 s65, 10, 0
    s_sub_u32 s63, s63, s65
    s_mul_i32 s63, s63, 786432
    s_add_u32 s63, s63, s62
    s_add_u32 m0, s61, 122880
    s_add_u32 s60, s63, 0x0
    buffer_load_dwordx4 v20, s[8:11], s60 offen lds
    s_add_u32 m0, s61, 123904
    s_add_u32 s60, s63, 0x0
    buffer_load_dwordx4 v21, s[8:11], s60 offen lds
    s_add_u32 m0, s61, 124928
    s_add_u32 s60, s63, 0x0
    buffer_load_dwordx4 v22, s[8:11], s60 offen lds
    s_add_u32 m0, s61, 125952
    s_add_u32 s60, s63, 0x0
    buffer_load_dwordx4 v23, s[8:11], s60 offen lds
    s_add_u32 m0, s61, 126976
    s_add_u32 s60, s63, 0x0
    buffer_load_dwordx4 v24, s[8:11], s60 offen lds
    s_add_u32 m0, s61, 128000
    s_add_u32 s60, s63, 0x0
    buffer_load_dwordx4 v25, s[8:11], s60 offen lds
    v_add_u32 v11, 0x0, v10
    s_add_u32 s60, s68, 0
    v_xad_u32 v8, s60, v6, v11
    ds_read_b64_tr_b16 a[104:105], v8 offset:0
    ds_read_b64_tr_b16 a[106:107], v8 offset:768
    ds_read_b64_tr_b16 a[108:109], v8 offset:12288
    ds_read_b64_tr_b16 a[110:111], v8 offset:13056
    s_add_u32 s60, s68, 32
    v_xad_u32 v9, s60, v6, v11
    ds_read_b64_tr_b16 a[120:121], v9 offset:0
    ds_read_b64_tr_b16 a[122:123], v9 offset:768
    ds_read_b64_tr_b16 a[124:125], v9 offset:12288
    ds_read_b64_tr_b16 a[126:127], v9 offset:13056
    s_add_u32 s60, s68, 64
    v_xad_u32 v8, s60, v6, v11
    ds_read_b64_tr_b16 v[184:185], v8 offset:0
    ds_read_b64_tr_b16 v[186:187], v8 offset:768
    ds_read_b64_tr_b16 v[188:189], v8 offset:12288
    ds_read_b64_tr_b16 v[190:191], v8 offset:13056
    s_waitcnt lgkmcnt(0)
    s_waitcnt vmcnt(24)
    s_barrier
    s_add_u32 s63, s64, 0
    s_cmp_ge_u32 s63, 10
    s_cselect_b32 s65, 10, 0
    s_sub_u32 s63, s63, s65
    s_mul_i32 s63, s63, 786432
    s_add_u32 s63, s63, s62
    s_add_u32 m0, s61, 0
    s_add_u32 s60, s63, 0x0
    buffer_load_dwordx4 v20, s[20:23], s60 offen lds
    s_add_u32 m0, s61, 1024
    s_add_u32 s60, s63, 0x0
    buffer_load_dwordx4 v21, s[20:23], s60 offen lds
    s_add_u32 m0, s61, 2048
    s_add_u32 s60, s63, 0x0
    buffer_load_dwordx4 v22, s[20:23], s60 offen lds
    s_add_u32 m0, s61, 3072
    s_add_u32 s60, s63, 0x0
    buffer_load_dwordx4 v23, s[20:23], s60 offen lds
    s_add_u32 m0, s61, 4096
    s_add_u32 s60, s63, 0x0
    buffer_load_dwordx4 v24, s[20:23], s60 offen lds
    s_add_u32 m0, s61, 5120
    s_add_u32 s60, s63, 0x0
    buffer_load_dwordx4 v25, s[20:23], s60 offen lds
    v_add_u32 v11, 0x6000, v10
    s_add_u32 s60, s68, 0
    v_xad_u32 v8, s60, v6, v11
    ds_read_b64_tr_b16 a[96:97], v8 offset:0
    ds_read_b64_tr_b16 a[98:99], v8 offset:768
    ds_read_b64_tr_b16 a[100:101], v8 offset:12288
    ds_read_b64_tr_b16 a[102:103], v8 offset:13056
    s_add_u32 s60, s68, 32
    v_xad_u32 v9, s60, v6, v11
    ds_read_b64_tr_b16 a[112:113], v9 offset:0
    ds_read_b64_tr_b16 a[114:115], v9 offset:768
    ds_read_b64_tr_b16 a[116:117], v9 offset:12288
    ds_read_b64_tr_b16 a[118:119], v9 offset:13056
    s_add_u32 s60, s68, 64
    v_xad_u32 v8, s60, v6, v11
    ds_read_b64_tr_b16 v[176:177], v8 offset:0
    ds_read_b64_tr_b16 v[178:179], v8 offset:768
    ds_read_b64_tr_b16 v[180:181], v8 offset:12288
    ds_read_b64_tr_b16 v[182:183], v8 offset:13056
    s_waitcnt lgkmcnt(0)
    s_waitcnt vmcnt(24)
    s_barrier
    s_add_u32 s63, s64, 0
    s_cmp_ge_u32 s63, 10
    s_cselect_b32 s65, 10, 0
    s_sub_u32 s63, s63, s65
    s_mul_i32 s63, s63, 786432
    s_add_u32 s63, s63, s62
    s_add_u32 m0, s61, 24576
    s_add_u32 s60, s63, 0x0
    buffer_load_dwordx4 v20, s[8:11], s60 offen lds
    s_add_u32 m0, s61, 25600
    s_add_u32 s60, s63, 0x0
    buffer_load_dwordx4 v21, s[8:11], s60 offen lds
    s_add_u32 m0, s61, 26624
    s_add_u32 s60, s63, 0x0
    buffer_load_dwordx4 v22, s[8:11], s60 offen lds
    s_add_u32 m0, s61, 27648
    s_add_u32 s60, s63, 0x0
    buffer_load_dwordx4 v23, s[8:11], s60 offen lds
    s_add_u32 m0, s61, 28672
    s_add_u32 s60, s63, 0x0
    buffer_load_dwordx4 v24, s[8:11], s60 offen lds
    s_add_u32 m0, s61, 29696
    s_add_u32 s60, s63, 0x0
    buffer_load_dwordx4 v25, s[8:11], s60 offen lds
    v_add_u32 v11, 0xc000, v10
    s_add_u32 s60, s68, 0
    v_xad_u32 v8, s60, v6, v11
    ds_read_b64_tr_b16 a[72:73], v8 offset:0
    ds_read_b64_tr_b16 a[74:75], v8 offset:768
    ds_read_b64_tr_b16 a[76:77], v8 offset:12288
    ds_read_b64_tr_b16 a[78:79], v8 offset:13056
    s_add_u32 s60, s68, 32
    v_xad_u32 v9, s60, v6, v11
    ds_read_b64_tr_b16 a[88:89], v9 offset:0
    ds_read_b64_tr_b16 a[90:91], v9 offset:768
    ds_read_b64_tr_b16 a[92:93], v9 offset:12288
    ds_read_b64_tr_b16 a[94:95], v9 offset:13056
    s_add_u32 s60, s68, 64
    v_xad_u32 v8, s60, v6, v11
    ds_read_b64_tr_b16 v[168:169], v8 offset:0
    ds_read_b64_tr_b16 v[170:171], v8 offset:768
    ds_read_b64_tr_b16 v[172:173], v8 offset:12288
    ds_read_b64_tr_b16 v[174:175], v8 offset:13056
    s_waitcnt lgkmcnt(0)
    s_waitcnt vmcnt(24)
    s_barrier
    v_add_u32 v11, 0x12000, v10
    s_add_u32 s60, s68, 0
    v_xad_u32 v8, s60, v6, v11
    ds_read_b64_tr_b16 a[64:65], v8 offset:0
    ds_read_b64_tr_b16 a[66:67], v8 offset:768
    ds_read_b64_tr_b16 a[68:69], v8 offset:12288
    ds_read_b64_tr_b16 a[70:71], v8 offset:13056
    s_add_u32 s60, s68, 32
    v_xad_u32 v9, s60, v6, v11
    ds_read_b64_tr_b16 a[80:81], v9 offset:0
    ds_read_b64_tr_b16 a[82:83], v9 offset:768
    ds_read_b64_tr_b16 a[84:85], v9 offset:12288
    ds_read_b64_tr_b16 a[86:87], v9 offset:13056
    s_add_u32 s60, s68, 64
    v_xad_u32 v8, s60, v6, v11
    ds_read_b64_tr_b16 v[160:161], v8 offset:0
    ds_read_b64_tr_b16 v[162:163], v8 offset:768
    ds_read_b64_tr_b16 v[164:165], v8 offset:12288
    ds_read_b64_tr_b16 v[166:167], v8 offset:13056
    s_waitcnt lgkmcnt(0)
    s_waitcnt vmcnt(18)
    s_barrier
    v_add_u32 v11, 0x18000, v10
    s_add_u32 s60, s68, 0
    v_xad_u32 v8, s60, v6, v11
    ds_read_b64_tr_b16 a[56:57], v8 offset:0
    ds_read_b64_tr_b16 a[58:59], v8 offset:768
    ds_read_b64_tr_b16 a[60:61], v8 offset:12288
    ds_read_b64_tr_b16 a[62:63], v8 offset:13056
    s_add_u32 s60, s68, 32
    v_xad_u32 v9, s60, v6, v11
    ds_read_b64_tr_b16 v[40:41], v9 offset:0
    ds_read_b64_tr_b16 v[42:43], v9 offset:768
    ds_read_b64_tr_b16 v[44:45], v9 offset:12288
    ds_read_b64_tr_b16 v[46:47], v9 offset:13056
    s_add_u32 s60, s68, 64
    v_xad_u32 v8, s60, v6, v11
    ds_read_b64_tr_b16 v[152:153], v8 offset:0
    ds_read_b64_tr_b16 v[154:155], v8 offset:768
    ds_read_b64_tr_b16 v[156:157], v8 offset:12288
    ds_read_b64_tr_b16 v[158:159], v8 offset:13056
    s_waitcnt lgkmcnt(0)
    s_waitcnt vmcnt(12)
    s_barrier
    v_add_u32 v11, 0x1e000, v10
    s_add_u32 s60, s68, 0
    v_xad_u32 v8, s60, v6, v11
    ds_read_b64_tr_b16 a[48:49], v8 offset:0
    ds_read_b64_tr_b16 a[50:51], v8 offset:768
    ds_read_b64_tr_b16 a[52:53], v8 offset:12288
    ds_read_b64_tr_b16 a[54:55], v8 offset:13056
    s_add_u32 s60, s68, 32
    v_xad_u32 v9, s60, v6, v11
    ds_read_b64_tr_b16 v[32:33], v9 offset:0
    ds_read_b64_tr_b16 v[34:35], v9 offset:768
    ds_read_b64_tr_b16 v[36:37], v9 offset:12288
    ds_read_b64_tr_b16 v[38:39], v9 offset:13056
    s_add_u32 s60, s68, 64
    v_xad_u32 v8, s60, v6, v11
    ds_read_b64_tr_b16 v[144:145], v8 offset:0
    ds_read_b64_tr_b16 v[146:147], v8 offset:768
    ds_read_b64_tr_b16 v[148:149], v8 offset:12288
    ds_read_b64_tr_b16 v[150:151], v8 offset:13056
    s_waitcnt lgkmcnt(0)
    s_waitcnt vmcnt(6)
    s_barrier
    v_add_u32 v11, 0x0, v10
    s_add_u32 s60, s68, 0
    v_xad_u32 v8, s60, v6, v11
    ds_read_b64_tr_b16 a[8:9], v8 offset:0
    ds_read_b64_tr_b16 a[10:11], v8 offset:768
    ds_read_b64_tr_b16 a[12:13], v8 offset:12288
    ds_read_b64_tr_b16 a[14:15], v8 offset:13056
    s_add_u32 s60, s68, 32
    v_xad_u32 v9, s60, v6, v11
    ds_read_b64_tr_b16 a[24:25], v9 offset:0
    ds_read_b64_tr_b16 a[26:27], v9 offset:768
    ds_read_b64_tr_b16 a[28:29], v9 offset:12288
    ds_read_b64_tr_b16 a[30:31], v9 offset:13056
    s_add_u32 s60, s68, 64
    v_xad_u32 v8, s60, v6, v11
    ds_read_b64_tr_b16 a[40:41], v8 offset:0
    ds_read_b64_tr_b16 a[42:43], v8 offset:768
    ds_read_b64_tr_b16 a[44:45], v8 offset:12288
    ds_read_b64_tr_b16 a[46:47], v8 offset:13056
    s_waitcnt lgkmcnt(0)
    s_waitcnt vmcnt(0)
    s_barrier
    v_add_u32 v11, 0x6000, v10
    s_add_u32 s60, s68, 0
    v_xad_u32 v8, s60, v6, v11
    ds_read_b64_tr_b16 a[0:1], v8 offset:0
    ds_read_b64_tr_b16 a[2:3], v8 offset:768
    ds_read_b64_tr_b16 a[4:5], v8 offset:12288
    ds_read_b64_tr_b16 a[6:7], v8 offset:13056
    s_add_u32 s60, s68, 32
    v_xad_u32 v9, s60, v6, v11
    ds_read_b64_tr_b16 a[16:17], v9 offset:0
    ds_read_b64_tr_b16 a[18:19], v9 offset:768
    ds_read_b64_tr_b16 a[20:21], v9 offset:12288
    ds_read_b64_tr_b16 a[22:23], v9 offset:13056
    s_add_u32 s60, s68, 64
    v_xad_u32 v8, s60, v6, v11
    ds_read_b64_tr_b16 a[32:33], v8 offset:0
    ds_read_b64_tr_b16 a[34:35], v8 offset:768
    ds_read_b64_tr_b16 a[36:37], v8 offset:12288
    ds_read_b64_tr_b16 a[38:39], v8 offset:13056
    s_waitcnt lgkmcnt(0)
    s_barrier
    s_mul_i32 s28, s3, 24576
    s_add_u32 s28, s28, 38400
    v_add_u32 v20, s28, v2
    ds_write_b128 v20, v[32:35] offset:0
    ds_write_b128 v20, v[36:39] offset:1024
    ds_write_b128 v20, v[40:43] offset:2048
    ds_write_b128 v20, v[44:47] offset:3072
    ds_write_b128 v20, v[48:51] offset:4096
    ds_write_b128 v20, v[52:55] offset:5120
    ds_write_b128 v20, v[56:59] offset:6144
    ds_write_b128 v20, v[60:63] offset:7168
    ds_write_b128 v20, v[64:67] offset:8192
    ds_write_b128 v20, v[68:71] offset:9216
    ds_write_b128 v20, v[72:75] offset:10240
    ds_write_b128 v20, v[76:79] offset:11264
    ds_write_b128 v20, v[80:83] offset:12288
    ds_write_b128 v20, v[84:87] offset:13312
    ds_write_b128 v20, v[88:91] offset:14336
    ds_write_b128 v20, v[92:95] offset:15360
    ds_write_b128 v20, v[96:99] offset:16384
    ds_write_b128 v20, v[100:103] offset:17408
    ds_write_b128 v20, v[104:107] offset:18432
    ds_write_b128 v20, v[108:111] offset:19456
    ds_write_b128 v20, v[112:115] offset:20480
    ds_write_b128 v20, v[116:119] offset:21504
    ds_write_b128 v20, v[120:123] offset:22528
    ds_write_b128 v20, v[124:127] offset:23552
    s_waitcnt lgkmcnt(0)
    v_lshrrev_b32 v30, 4, v1
    v_and_b32 v31, 15, v1
    v_and_b32 v4, 2, v1
    v_cmp_eq_u32 vcc, 0, v4
    v_mov_b32 v11, 0xeeee
    v_mov_b32 v4, 0x4444
    v_cndmask_b32 v11, v11, v4, vcc
    v_lshlrev_b32 v10, 2, v1
    v_lshlrev_b32 v4, 2, v30
    v_sub_u32 v4, v31, v4
    v_mov_b32 v124, 0
    v_mov_b32 v5, 0x3f80
    v_cmp_eq_u32 vcc, 2, v4
    s_nop 1
    v_cndmask_b32 v124, v124, v5, vcc
    v_mov_b32 v5, 0x3f800000
    v_cmp_eq_u32 vcc, 3, v4
    s_nop 1
    v_cndmask_b32 v124, v124, v5, vcc
    v_mov_b32 v125, 0
    v_mov_b32 v5, 0x3f80
    v_cmp_eq_u32 vcc, 0, v4
    s_nop 1
    v_cndmask_b32 v125, v125, v5, vcc
    v_mov_b32 v5, 0x3f800000
    v_cmp_eq_u32 vcc, 1, v4
    s_nop 1
    v_cndmask_b32 v125, v125, v5, vcc
    s_mul_i32 s28, s3, 7040
    s_add_u32 s28, s28, 10240
    v_mul_u32_u24 v4, 176, v31
    v_add_u32 v4, s28, v4
    v_lshl_add_u32 v21, v30, 4, v4
    v_lshl_add_u32 v22, v30, 3, v4
    v_lshrrev_b32 v4, 2, v31
    v_and_b32 v5, 1, v31
    v_lshl_add_u32 v4, v4, 1, v5
    v_mul_u32_u24 v4, 176, v4
    v_add_u32 v4, s28, v4
    v_bfe_u32 v5, v31, 1, 1
    v_xor_b32 v5, 1, v5
    v_lshl_add_u32 v6, v30, 4, v4
    v_lshl_add_u32 v6, v5, 6, v6
    v_lshl_add_u32 v7, v30, 3, v4
    v_lshl_add_u32 v7, v5, 2, v7
    v_lshrrev_b32 v30, 3, v1
    v_and_b32 v31, 7, v1
    v_mul_u32_u24 v4, 176, v30
    v_add_u32 v4, 10240, v4
    v_lshl_add_u32 v23, v31, 4, v4
    v_lshl_add_u32 v24, v31, 2, v4
    s_add_u32 s28, s3, 1
    s_mul_i32 s28, s28, 1408
    v_add_u32 v25, s28, v23
    v_add_u32 v26, s28, v24
    v_bfe_u32 v4, v31, 1, 1
    v_lshl_add_u32 v27, v4, 4, v30
    v_lshrrev_b32 v4, 2, v31
    v_lshl_add_u32 v27, v4, 3, v27
    v_lshlrev_b32 v27, 4, v27
    v_and_b32 v4, 1, v31
    v_lshl_add_u32 v27, v4, 3, v27
    v_bfe_u32 v4, v31, 1, 1
    v_lshl_add_u32 v28, v4, 3, v30
    v_lshlrev_b32 v28, 4, v28
    v_lshrrev_b32 v4, 2, v31
    v_lshl_add_u32 v28, v4, 2, v28
    s_lshr_b32 s28, s24, 1
    s_lshl_b32 s28, s28, 8
    s_and_b32 s29, s24, 1
    s_lshl_b32 s29, s29, 3
    s_add_u32 s28, s28, s29
    v_add_u32 v28, s28, v28
    v_and_b32 v4, 0x60, v27
    v_lshlrev_b32 v4, 1, v4
    v_and_b32 v126, 0x80, v27
    v_lshrrev_b32 v126, 2, v126
    v_or_b32 v4, v4, v126
    v_and_b32 v126, 0xffffff1f, v27
    v_or_b32 v126, v126, v4
    v_and_b32 v4, 0x60, v28
    v_lshlrev_b32 v4, 1, v4
    v_and_b32 v127, 0x80, v28
    v_lshrrev_b32 v127, 2, v127
    v_or_b32 v4, v4, v127
    v_and_b32 v127, 0xffffff1f, v28
    v_or_b32 v127, v127, v4
    v_bfe_u32 v4, v31, 1, 1
    v_lshl_add_u32 v28, v4, 3, v30
    v_lshlrev_b32 v28, 3, v28
    v_lshrrev_b32 v4, 2, v31
    v_lshl_add_u32 v28, v4, 2, v28
    s_lshl_b32 s28, s24, 7
    v_add_u32 v28, s28, v28
    s_lshl_b32 s28, s3, 3
    v_add_u32 v4, s28, v30
    v_lshlrev_b32 v5, 2, v31
    v_sub_u32 v4, v4, v5
    v_cmp_le_i32 s[74:75], 0, v4
    v_cmp_le_i32 s[76:77], 1, v4
    v_cmp_le_i32 s[78:79], 2, v4
    v_cmp_le_i32 s[80:81], 3, v4
    v_lshlrev_b32 v29, 3, v1
    s_mul_i32 s65, s24, 12288
    s_mul_i32 s28, s3, 3072
    s_add_u32 s65, s65, s28
    s_add_u32 s65, s65, 0x2000000
    s_add_u32 s64, s65, 0x2000000
    s_lshl_b32 s66, s24, 7
    s_add_u32 s66, s66, 0x600000
    s_lshl_b32 s69, s24, 9
    s_lshr_b32 s29, s69, 13
    s_mul_i32 s29, s29, 8192
    s_add_u32 s68, s69, s29
    s_mul_i32 s67, s3, 20480
    s_add_u32 s67, s67, 0x700000
    v_and_b32 v4, 3, v1
    v_lshlrev_b32 v4, 2, v4
    v_bfe_u32 v30, v1, 2, 1
    v_lshl_add_u32 v30, v30, 12, v4
    v_mov_b32 v31, 0xff800000
    s_mov_b32 s61, 0x3dd53b95
    s_cmp_eq_u32 s3, 1
    s_cselect_b32 s72, 1, 0
    s_mov_b32 s73, 0
    v_mov_b32 v3, 0
    s_mov_b32 s29, 128
    s_mov_b32 s27, 0x100000
Lp_132:
    buffer_load_dword v4, v3, s[16:19], s29 offen sc1
    s_waitcnt vmcnt(0)
    v_cmp_gt_u32 vcc, 1, v4
    s_nop 0
    s_cbranch_vccz Ld_133
    s_sub_u32 s27, s27, 1
    s_cbranch_scc1 L_abort
    s_sleep 6
    s_branch Lp_132
Ld_133:
    v_readfirstlane_b32 s26, v4
    s_nop 0
    s_and_b32 s26, s26, 0xffff
    s_cmp_gt_u32 s26, 512
    s_cselect_b32 s26, 8192, 0
    s_lshl_b32 s70, s24, 7
    s_add_u32 s70, s70, s26
    s_add_u32 s70, s70, 0x140000
    s_mov_b32 s53, 32
    s_and_b32 s60, s2, 3
    s_lshl_b32 s60, s60, 11
    s_lshr_b32 s28, s2, 3
    s_lshl_b32 s28, s28, 2
    s_add_u32 s28, s28, s3
    s_and_b32 s28, s28, 7
    s_lshl_b32 s28, s28, 7
    s_add_u32 s60, s60, s28
    s_add_u32 s60, s60, 0x144000
    v_mov_b32 v5, 0x40000000
    v_and_b32 v4, 1, v1
    v_cmp_eq_u32 vcc, 0, v4
    s_nop 1
    v_cndmask_b32 v28, v5, v28, vcc
    v_cndmask_b32 v127, v5, v127, vcc
    v_and_b32 v4, 4, v1
    v_cmp_eq_u32 vcc, 0, v4
    s_nop 1
    v_cndmask_b32 v4, v5, v127, vcc
    v_add_u32 v4, 32768, v4
    v_add_u32 v9, s68, v126
    s_cmp_eq_u32 s3, 2
    s_cselect_b64 vcc, -1, 0
    v_cndmask_b32 v9, v9, v4, vcc
    s_cmp_eq_u32 s3, 3
    s_cselect_b64 vcc, -1, 0
    v_cndmask_b32 v9, v9, v5, vcc
    s_cselect_b64 vcc, 1, 0
    v_cndmask_b32 v9, v9, v3, vcc
    s_cmp_eq_u32 s3, 0
    s_cselect_b64 vcc, -1, 0
    v_cndmask_b32 v9, v9, v5, vcc
    s_cmp_eq_u32 s3, 1
    s_cselect_b64 vcc, 1, 0
    v_cndmask_b32 v0, v5, v3, vcc
    s_sub_u32 s67, s67, 81920
    s_mul_i32 s42, s3, 3072
    s_add_u32 s42, s42, 136704
    v_mov_b32 v13, 0
    s_lshl_b32 s43, s24, 7
    s_add_u32 s43, s43, s26
    s_add_u32 s43, s43, 0x148000
    s_cmp_eq_u32 s3, 3
    s_cselect_b64 s[44:45], 1, 0
    s_mov_b32 s25, 0
    s_add_u32 s29, s25, 1
    s_mov_b32 s27, 0x100000
Lp_135:
    buffer_load_dword v13, v30, s[4:7], s66 offen sc1
    s_waitcnt vmcnt(0)
    v_cmp_gt_u32 vcc, s29, v13
    s_nop 0
    s_cbranch_vccz Ld_136
    s_sub_u32 s27, s27, 1
    s_cbranch_scc1 L_abort
    s_sleep 2
    s_branch Lp_135
Ld_136:
Lk_134:
    s_add_u32 s29, s25, 2
    s_min_u32 s29, s29, 64
    v_cmp_gt_u32 vcc, s29, v13
    s_nop 0
    s_and_b32 vcc_lo, vcc_lo, 0xf0
    s_cselect_b64 s[56:57], 0, -1
    v_mov_b32 v17, 0
    buffer_load_dwordx4 v[112:115], v2, s[4:7], s64 offen offset:0 sc1
    buffer_load_dwordx2 v[116:117], v29, s[4:7], s64 offen offset:1024 sc1
    buffer_load_dwordx4 v[118:121], v2, s[4:7], s64 offen offset:1536 sc1
    buffer_load_dwordx2 v[122:123], v29, s[4:7], s64 offen offset:2560 sc1
    s_add_u32 s64, s64, 524288
    s_bitset0_b32 s64, 24
    s_mov_b32 s25, 0
L_loop_QK:
    s_and_b32 s63, s25, 3
    s_lshl_b32 s63, s63, 16
    s_add_u32 s63, s63, s26
    s_add_u32 s63, s63, 0x180000
    s_add_u32 s38, s67, s69
    s_add_u32 s39, s67, 16384
    s_add_u32 s67, s67, 81920
    v_add_u32 v8, s63, v2
    s_add_u32 s101, s101, 10240
    s_mov_b64 exec, 0x3ff
    s_cmp_lt_u32 s25, 6
    s_cselect_b32 s27, 128, 24
    buffer_load_dword v68, v10, s[4:7], s60 offen sc1
    s_nop 15
    buffer_load_dword v69, v10, s[4:7], s60 offen sc1
    s_nop 15
    buffer_load_dword v70, v10, s[4:7], s60 offen sc1
    s_nop 15
Lp_137:
    buffer_load_dword v71, v10, s[4:7], s60 offen sc1
    s_waitcnt vmcnt(3)
    v_cmp_gt_u32 vcc, s25, v68
    s_cbranch_vccz Ld_138
    buffer_load_dword v68, v10, s[4:7], s60 offen sc1
    s_waitcnt vmcnt(3)
    v_cmp_gt_u32 vcc, s25, v69
    s_cbranch_vccz Ld_138
    buffer_load_dword v69, v10, s[4:7], s60 offen sc1
    s_waitcnt vmcnt(3)
    v_cmp_gt_u32 vcc, s25, v70
    s_cbranch_vccz Ld_138
    buffer_load_dword v70, v10, s[4:7], s60 offen sc1
    s_waitcnt vmcnt(3)
    v_cmp_gt_u32 vcc, s25, v71
    s_cbranch_vccz Ld_138
    s_sub_u32 s27, s27, 1
    s_cbranch_scc0 Lp_137
Ld_138:
    s_mov_b32 s27, 0x100000
    s_mov_b64 exec, -1
    s_nop 3
    buffer_load_dwordx4 v[32:35], v8, s[4:7], s90 offen sc1
    ds_read_b128 v[72:75], v20 offset:0
    ds_read_b128 v[76:79], v20 offset:1024
    ds_read_b128 v[80:83], v20 offset:2048
    ds_read_b128 v[84:87], v20 offset:3072
    s_add_u32 s71, s25, 1
    v_pk_mov_b32 v[88:89], 0, 0
    buffer_load_dwordx4 v[36:39], v8, s[4:7], s91 offen sc1
    v_pk_mov_b32 v[90:91], 0, 0
    v_pk_mov_b32 v[92:93], 0, 0
    v_pk_mov_b32 v[94:95], 0, 0
    v_pk_mov_b32 v[96:97], 0, 0
    v_pk_mov_b32 v[98:99], 0, 0
    v_pk_mov_b32 v[100:101], 0, 0
    buffer_load_dwordx4 v[40:43], v8, s[4:7], s92 offen sc1
    v_pk_mov_b32 v[102:103], 0, 0
    v_pk_mov_b32 v[104:105], 0, 0
    v_pk_mov_b32 v[106:107], 0, 0
    v_pk_mov_b32 v[108:109], 0, 0
    v_pk_mov_b32 v[110:111], 0, 0
    s_add_u32 s41, s25, 2
    buffer_load_dwordx4 v[44:47], v8, s[4:7], s93 offen sc1
    s_and_b32 s41, s41, 3
    s_lshl_b32 s41, s41, 16
    s_add_u32 s41, s41, s26
    s_add_u32 s41, s41, 0x180000
    s_max_u32 s40, s25, 1
    s_sub_u32 s40, s40, 1
    buffer_load_dwordx4 v[48:51], v8, s[4:7], s94 offen sc1
    s_cmp_eq_u32 s3, 3
    s_cselect_b32 s41, s43, s41
    s_cselect_b32 s40, s40, -1
    s_add_u32 m0, s42, 12288
    s_add_u32 s30, s63, s68
    s_add_u32 s31, s63, 32768
    buffer_load_dwordx4 v[52:55], v8, s[4:7], s95 offen sc1
    s_cmp_ge_u32 s71, 64
    s_cselect_b32 s62, 1, s3
    v_mov_b32 v18, s40
    v_mov_b32 v19, s40
    v_mov_b32 v5, s71
    s_nop 0
    buffer_load_dwordx4 v[56:59], v8, s[4:7], s96 offen sc1
    s_nop 5
    buffer_load_dwordx4 v[60:63], v8, s[4:7], s97 offen sc1
    s_nop 5
    buffer_load_dwordx4 v[64:67], v8, s[4:7], s98 offen sc1
    s_nop 5
    buffer_load_dwordx4 v[68:71], v8, s[4:7], s99 offen sc1
    s_nop 1
    s_waitcnt vmcnt(9)
    v_fma_f32 v4, v32, v33, v34
    v_cmp_u_f32 vcc, v4, v35
    s_cbranch_vccnz L_QK_redo0
L_QK_ok0:
    v_smfmac_f32_16x16x64_bf16 v[88:91], v[32:35], a[0:7], v11
    v_smfmac_f32_16x16x64_bf16 v[92:95], v[32:35], a[8:15], v11
    v_smfmac_f32_16x16x64_bf16 v[96:99], v[32:35], a[16:23], v11
    s_waitcnt vmcnt(8)
    v_fma_f32 v4, v36, v37, v38
    v_smfmac_f32_16x16x64_bf16 v[100:103], v[32:35], a[24:31], v11
    v_cmp_u_f32 vcc, v4, v39
    v_smfmac_f32_16x16x64_bf16 v[104:107], v[32:35], a[32:39], v11
    v_smfmac_f32_16x16x64_bf16 v[108:111], v[32:35], a[40:47], v11
    s_cbranch_vccnz L_QK_redo1
L_QK_ok1:
    v_smfmac_f32_16x16x64_bf16 v[88:91], v[36:39], a[48:55], v11
    s_waitcnt vmcnt(7)
    v_fma_f32 v4, v40, v41, v42
    v_smfmac_f32_16x16x64_bf16 v[92:95], v[36:39], a[56:63], v11
    v_cmp_u_f32 vcc, v4, v43
    s_waitcnt lgkmcnt(0)
    v_smfmac_f32_16x16x64_bf16 v[96:99], v[36:39], v[72:79], v11
    v_smfmac_f32_16x16x64_bf16 v[100:103], v[36:39], v[80:87], v11
    s_cbranch_vccnz L_QK_redo2
L_QK_ok2:
    v_smfmac_f32_16x16x64_bf16 v[88:91], v[40:43], a[64:71], v11
    s_waitcnt vmcnt(6)
    ds_read_b128 v[72:75], v20 offset:4096
    v_fma_f32 v4, v44, v45, v46
    v_smfmac_f32_16x16x64_bf16 v[92:95], v[40:43], a[72:79], v11
    ds_read_b128 v[76:79], v20 offset:5120
    v_cmp_u_f32 vcc, v4, v47
    v_smfmac_f32_16x16x64_bf16 v[96:99], v[40:43], a[80:87], v11
    ds_read_b128 v[80:83], v20 offset:6144
    v_smfmac_f32_16x16x64_bf16 v[100:103], v[40:43], a[88:95], v11
    s_cbranch_vccnz L_QK_redo3
L_QK_ok3:
    ds_read_b128 v[84:87], v20 offset:7168
    v_smfmac_f32_16x16x64_bf16 v[88:91], v[44:47], a[96:103], v11
    s_waitcnt vmcnt(5)
    v_fma_f32 v4, v48, v49, v50
    v_smfmac_f32_16x16x64_bf16 v[92:95], v[44:47], a[104:111], v11
    v_cmp_u_f32 vcc, v4, v51
    v_smfmac_f32_16x16x64_bf16 v[96:99], v[44:47], a[112:119], v11
    buffer_load_dwordx4 v2, s[4:7], s65 offen sc1 lds
    v_smfmac_f32_16x16x64_bf16 v[100:103], v[44:47], a[120:127], v11
    s_cbranch_vccnz L_QK_redo4
L_QK_ok4:
    s_waitcnt lgkmcnt(0)
    v_smfmac_f32_16x16x64_bf16 v[88:91], v[48:51], v[72:79], v11
    buffer_store_dwordx2 v[14:15], v27, s[4:7], s38 offen sc1
    s_waitcnt vmcnt(6)
    v_fma_f32 v4, v52, v53, v54
    v_smfmac_f32_16x16x64_bf16 v[92:95], v[48:51], v[80:87], v11
    v_cmp_u_f32 vcc, v4, v55
    v_smfmac_f32_16x16x64_bf16 v[96:99], v[48:51], a[128:135], v11
    buffer_load_dwordx4 v2, s[4:7], s65 offen offset:1024 sc1 lds
    ds_read_b128 v[72:75], v20 offset:8192
    v_smfmac_f32_16x16x64_bf16 v[100:103], v[48:51], a[136:143], v11
    s_cbranch_vccnz L_QK_redo5
L_QK_ok5:
    ds_read_b128 v[76:79], v20 offset:9216
    v_smfmac_f32_16x16x64_bf16 v[88:91], v[52:55], a[144:151], v11
    s_waitcnt vmcnt(6)
    ds_read_b128 v[80:83], v20 offset:10240
    v_fma_f32 v4, v56, v57, v58
    v_smfmac_f32_16x16x64_bf16 v[92:95], v[52:55], a[152:159], v11
    ds_read_b128 v[84:87], v20 offset:11264
    v_cmp_u_f32 vcc, v4, v59
    v_smfmac_f32_16x16x64_bf16 v[96:99], v[52:55], a[160:167], v11
    buffer_load_dwordx4 v2, s[4:7], s65 offen offset:2048 sc1 lds
    s_add_u32 s65, s65, 524288
    s_bitset0_b32 s65, 24
    s_add_u32 m0, s42, 0
    v_smfmac_f32_16x16x64_bf16 v[100:103], v[52:55], a[168:175], v11
    s_cbranch_vccnz L_QK_redo6
L_QK_ok6:
    v_smfmac_f32_16x16x64_bf16 v[88:91], v[56:59], a[176:183], v11
    buffer_store_dword v16, v28, s[4:7], s39 offen sc1
    s_waitcnt vmcnt(7)
    v_fma_f32 v4, v60, v61, v62
    v_smfmac_f32_16x16x64_bf16 v[92:95], v[56:59], a[184:191], v11
    v_cmp_u_f32 vcc, v4, v63
    s_waitcnt lgkmcnt(0)
    v_smfmac_f32_16x16x64_bf16 v[96:99], v[56:59], v[72:79], v11
    buffer_load_dwordx4 v2, s[4:7], s64 offen sc1 lds
    v_smfmac_f32_16x16x64_bf16 v[100:103], v[56:59], v[80:87], v11
    s_cbranch_vccnz L_QK_redo7
L_QK_ok7:
    v_smfmac_f32_16x16x64_bf16 v[88:91], v[60:63], a[192:199], v11
    s_waitcnt vmcnt(7)
    ds_read_b128 v[72:75], v20 offset:12288
    v_fma_f32 v4, v64, v65, v66
    v_smfmac_f32_16x16x64_bf16 v[92:95], v[60:63], a[200:207], v11
    ds_read_b128 v[76:79], v20 offset:13312
    v_cmp_u_f32 vcc, v4, v67
    v_smfmac_f32_16x16x64_bf16 v[96:99], v[60:63], a[208:215], v11
    buffer_load_dwordx4 v2, s[4:7], s64 offen offset:1024 sc1 lds
    ds_read_b128 v[80:83], v20 offset:14336
    v_smfmac_f32_16x16x64_bf16 v[100:103], v[60:63], a[216:223], v11
    s_cbranch_vccnz L_QK_redo8
L_QK_ok8:
    ds_read_b128 v[84:87], v20 offset:15360
    v_smfmac_f32_16x16x64_bf16 v[88:91], v[64:67], a[224:231], v11
    s_waitcnt vmcnt(7)
    v_fma_f32 v4, v68, v69, v70
    v_smfmac_f32_16x16x64_bf16 v[92:95], v[64:67], a[232:239], v11
    v_cmp_u_f32 vcc, v4, v71
    v_smfmac_f32_16x16x64_bf16 v[96:99], v[64:67], a[240:247], v11
    buffer_load_dwordx4 v2, s[4:7], s64 offen offset:2048 sc1 lds
    s_add_u32 s64, s64, 524288
    s_bitset0_b32 s64, 24
    v_smfmac_f32_16x16x64_bf16 v[100:103], v[64:67], a[248:255], v11
    s_cbranch_vccnz L_QK_redo9
L_QK_ok9:
    s_waitcnt lgkmcnt(0)
    v_smfmac_f32_16x16x64_bf16 v[88:91], v[68:71], v[72:79], v11
    v_smfmac_f32_16x16x64_bf16 v[92:95], v[68:71], v[80:87], v11
    v_smfmac_f32_16x16x64_bf16 v[96:99], v[68:71], v[128:135], v11
    buffer_store_dwordx2 v[18:19], v9, s[4:7], s41 offen sc1
    ds_read_b128 v[72:75], v20 offset:16384
    v_smfmac_f32_16x16x64_bf16 v[100:103], v[68:71], v[136:143], v11
    ds_read_b128 v[76:79], v20 offset:17408
    v_add_f32 v88, v88, v90
    v_smfmac_f32_16x16x64_bf16 v[104:107], v[36:39], v[144:151], v11
    ds_read_b128 v[80:83], v20 offset:18432
    v_add_f32 v89, v89, v91
    v_smfmac_f32_16x16x64_bf16 v[108:111], v[36:39], v[152:159], v11
    ds_read_b128 v[84:87], v20 offset:19456
    v_cvt_pk_bf16_f32 v88, v88, v89
    v_smfmac_f32_16x16x64_bf16 v[104:107], v[40:43], v[160:167], v11
    v_add_f32 v92, v92, v94
    v_smfmac_f32_16x16x64_bf16 v[108:111], v[40:43], v[168:175], v11
    v_add_f32 v93, v93, v95
    v_smfmac_f32_16x16x64_bf16 v[104:107], v[44:47], v[176:183], v11
    v_cvt_pk_bf16_f32 v89, v92, v93
    v_smfmac_f32_16x16x64_bf16 v[108:111], v[44:47], v[184:191], v11
    s_waitcnt lgkmcnt(0)
    v_smfmac_f32_16x16x64_bf16 v[104:107], v[48:51], v[72:79], v11
    v_add_f32 v96, v96, v98
    v_mfma_f32_16x16x16_bf16 v[92:95], v[88:89], v[124:125], 0
    v_smfmac_f32_16x16x64_bf16 v[108:111], v[48:51], v[80:87], v11
    v_add_f32 v97, v97, v99
    v_smfmac_f32_16x16x64_bf16 v[104:107], v[52:55], v[192:199], v11
    ds_read_b128 v[72:75], v20 offset:20480
    v_cvt_pk_bf16_f32 v96, v96, v97
    v_smfmac_f32_16x16x64_bf16 v[108:111], v[52:55], v[200:207], v11
    ds_read_b128 v[76:79], v20 offset:21504
    v_add_f32 v100, v100, v102
    v_smfmac_f32_16x16x64_bf16 v[104:107], v[56:59], v[208:215], v11
    ds_read_b128 v[80:83], v20 offset:22528
    v_add_f32 v101, v101, v103
    v_smfmac_f32_16x16x64_bf16 v[108:111], v[56:59], v[216:223], v11
    ds_read_b128 v[84:87], v20 offset:23552
    v_cvt_pk_bf16_f32 v97, v100, v101
    v_smfmac_f32_16x16x64_bf16 v[104:107], v[60:63], v[224:231], v11
    v_cvt_pk_bf16_f32 v14, v92, v93
    v_mfma_f32_16x16x16_bf16 v[100:103], v[96:97], v[124:125], 0
    v_smfmac_f32_16x16x64_bf16 v[108:111], v[60:63], v[232:239], v11
    v_cvt_pk_bf16_f32 v15, v94, v95
    v_smfmac_f32_16x16x64_bf16 v[104:107], v[64:67], v[240:247], v11
    v_smfmac_f32_16x16x64_bf16 v[108:111], v[64:67], v[248:255], v11
    s_waitcnt lgkmcnt(0)
    v_smfmac_f32_16x16x64_bf16 v[104:107], v[68:71], v[72:79], v11
    v_cvt_pk_bf16_f32 v16, v100, v101
    v_smfmac_f32_16x16x64_bf16 v[108:111], v[68:71], v[80:87], v11
    v_cvt_pk_bf16_f32 v17, v102, v103
    s_nop 2
    v_add_f32 v104, v104, v106
    v_add_f32 v105, v105, v107
    v_cvt_pk_bf16_f32 v104, v104, v105
    v_mfma_f32_16x16x32_bf16 v[88:91], v[112:115], v[14:17], 0
    v_add_f32 v108, v108, v110
    v_add_f32 v109, v109, v111
    v_cvt_pk_bf16_f32 v105, v108, v109
    s_nop 1
    v_mfma_f32_16x16x16_bf16 v[108:111], v[104:105], v[124:125], 0
    v_mfma_f32_16x16x32_bf16 v[92:95], v[118:121], v[14:17], 0
    buffer_store_dword v5, v0, s[4:7], s70 offen sc1
    v_mfma_f32_16x16x32_bf16 v[96:99], v[14:17], v[14:17], 0
    v_cvt_pk_bf16_f32 v18, v108, v109
    v_cvt_pk_bf16_f32 v19, v110, v111
    s_nop 1
    v_mfma_f32_16x16x16_bf16 v[88:91], v[116:117], v[18:19], v[88:91]
    s_mov_b32 vcc_lo, 0xcccccccc
    s_mov_b32 vcc_hi, 0xcccccccc
    v_mfma_f32_16x16x16_bf16 v[92:95], v[122:123], v[18:19], v[92:95]
    v_mfma_f32_16x16x16_bf16 v[96:99], v[18:19], v[18:19], v[96:99]
    s_nop 3
    v_cndmask_b32_dpp v88, v92, v88, vcc quad_perm:[2,3,2,3] row_mask:0xf bank_mask:0xf
    v_cndmask_b32_dpp v89, v93, v89, vcc quad_perm:[2,3,2,3] row_mask:0xf bank_mask:0xf
    v_cndmask_b32_dpp v90, v94, v90, vcc quad_perm:[2,3,2,3] row_mask:0xf bank_mask:0xf
    v_cndmask_b32_dpp v91, v95, v91, vcc quad_perm:[2,3,2,3] row_mask:0xf bank_mask:0xf
    ds_write_b128 v6, v[88:91]
    v_cndmask_b32_dpp v96, v97, v96, vcc quad_perm:[2,3,2,3] row_mask:0xf bank_mask:0xf
    ds_write_b32 v7, v96 offset:128
    s_cmp_lg_u32 s62, 0
    s_waitcnt lgkmcnt(0)
    s_barrier
    s_cbranch_scc1 L_QK_x
    ds_read_b128 v[72:75], v23 offset:0
    ds_read_b32 v88, v24 offset:128
    ds_read_b128 v[76:79], v23 offset:7040
    ds_read_b32 v89, v24 offset:7168
    ds_read_b128 v[80:83], v23 offset:14080
    ds_read_b32 v90, v24 offset:14208
    ds_read_b128 v[84:87], v23 offset:21120
    ds_read_b32 v91, v24 offset:21248
    s_waitcnt lgkmcnt(5)
    v_pk_add_f32 v[72:73], v[72:73], v[76:77]
    v_pk_add_f32 v[74:75], v[74:75], v[78:79]
    s_waitcnt lgkmcnt(1)
    v_pk_add_f32 v[80:81], v[80:81], v[84:85]
    v_pk_add_f32 v[82:83], v[82:83], v[86:87]
    s_waitcnt lgkmcnt(0)
    v_pk_add_f32 v[88:89], v[88:89], v[90:91]
    v_pk_add_f32 v[72:73], v[72:73], v[80:81]
    v_pk_add_f32 v[74:75], v[74:75], v[82:83]
    v_add_f32 v88, v88, v89
    v_max3_f32 v92, v72, v73, v74
    v_max3_f32 v92, v75, v88, v92
    s_nop 1
    v_max_f32_dpp v92, v92, v92 quad_perm:[1,0,3,2] row_mask:0xf bank_mask:0xf
    s_nop 1
    v_max_f32_dpp v92, v92, v92 quad_perm:[2,3,0,1] row_mask:0xf bank_mask:0xf
    s_nop 1
    v_max_f32_dpp v92, v92, v92 row_half_mirror row_mask:0xf bank_mask:0xf
    v_mul_f32 v92, s61, v92
    v_fma_f32 v72, v72, s61, -v92
    v_fma_f32 v73, v73, s61, -v92
    v_fma_f32 v74, v74, s61, -v92
    v_fma_f32 v75, v75, s61, -v92
    v_fma_f32 v88, v88, s61, -v92
    v_exp_f32 v72, v72
    v_exp_f32 v73, v73
    v_exp_f32 v74, v74
    v_exp_f32 v75, v75
    v_exp_f32 v88, v88
    v_pk_add_f32 v[76:77], v[72:73], v[74:75]
    v_add_f32 v93, v76, v88
    v_add_f32 v93, v93, v77
    v_mov_b32_dpp v89, v88 quad_perm:[1,0,3,2] row_mask:0xf bank_mask:0xf
    s_nop 0
    v_add_f32_dpp v93, v93, v93 quad_perm:[1,0,3,2] row_mask:0xf bank_mask:0xf
    s_nop 1
    v_add_f32_dpp v93, v93, v93 quad_perm:[2,3,0,1] row_mask:0xf bank_mask:0xf
    s_nop 1
    v_add_f32_dpp v93, v93, v93 row_half_mirror row_mask:0xf bank_mask:0xf
    v_rcp_f32 v92, v93
    s_nop 0
    v_pk_mul_f32 v[72:73], v[72:73], v[92:93] op_sel_hi:[1,0]
    v_pk_mul_f32 v[74:75], v[74:75], v[92:93] op_sel_hi:[1,0]
    v_pk_mul_f32 v[88:89], v[88:89], v[92:93] op_sel_hi:[1,0]
    v_cvt_pk_bf16_f32 v94, |v72|, |v73|
    v_cvt_pk_bf16_f32 v95, |v74|, |v75|
    v_cvt_pk_bf16_f32 v96, |v88|, |v89|
    buffer_store_dwordx2 v[94:95], v126, s[4:7], s30 offen sc1
    buffer_store_dword v96, v127, s[4:7], s31 offen sc1
    s_waitcnt vmcnt(8)
    s_branch L_QK_x2
L_QK_x:
    s_nop 15
    s_waitcnt vmcnt(6)
L_QK_x2:
    v_add_u32 v4, s42, v2
    v_add_u32 v12, s42, v29
    ds_read_b128 v[32:35], v4 offset:12288
    ds_read_b128 v[38:41], v4 offset:13824
    ds_read_b64 v[36:37], v12 offset:13312
    ds_read_b64 v[42:43], v12 offset:14848
    s_waitcnt lgkmcnt(3)
    v_mfma_f32_16x16x32_bf16 v[44:47], v[112:115], v[32:35], 0
    v_mfma_f32_16x16x32_bf16 v[52:55], v[14:17], v[32:35], 0
    s_waitcnt lgkmcnt(2)
    v_mfma_f32_16x16x32_bf16 v[56:59], v[112:115], v[38:41], 0
    v_mfma_f32_16x16x32_bf16 v[60:63], v[118:121], v[38:41], 0
    v_mfma_f32_16x16x32_bf16 v[64:67], v[14:17], v[38:41], 0
    s_waitcnt lgkmcnt(0)
    v_mfma_f32_16x16x16_bf16 v[44:47], v[116:117], v[36:37], v[44:47]
    v_mfma_f32_16x16x16_bf16 v[52:55], v[18:19], v[36:37], v[52:55]
    v_mfma_f32_16x16x16_bf16 v[56:59], v[116:117], v[42:43], v[56:59]
    v_mfma_f32_16x16x16_bf16 v[60:63], v[122:123], v[42:43], v[60:63]
    v_mfma_f32_16x16x16_bf16 v[64:67], v[18:19], v[42:43], v[64:67]
    s_nop 3
    ds_write_b128 v21, v[44:47] offset:1408
    ds_write_b64 v22, v[52:53] offset:1536
    ds_write_b128 v21, v[56:59] offset:4224
    ds_write_b128 v21, v[60:63] offset:4288
    ds_write_b64 v22, v[64:65] offset:4352
    v_mov_b32 v17, s25
    s_add_u32 s29, s25, 3
    s_min_u32 s29, s29, 64
    v_cmp_gt_u32 vcc, s29, v13
    s_waitcnt lgkmcnt(0)
    s_barrier
    s_cbranch_vccz L_QK_nf
    buffer_load_dword v13, v30, s[4:7], s66 offen sc1
L_QK_nf:
    ds_read_b128 v[72:75], v25 offset:0
    ds_read_b32 v88, v26 offset:128
    ds_read_b128 v[76:79], v25 offset:7040
    ds_read_b32 v89, v26 offset:7168
    ds_read_b128 v[80:83], v25 offset:14080
    ds_read_b32 v90, v26 offset:14208
    ds_read_b128 v[84:87], v25 offset:21120
    ds_read_b32 v91, v26 offset:21248
    s_waitcnt lgkmcnt(5)
    v_pk_add_f32 v[72:73], v[72:73], v[76:77]
    v_pk_add_f32 v[74:75], v[74:75], v[78:79]
    s_waitcnt lgkmcnt(1)
    v_pk_add_f32 v[80:81], v[80:81], v[84:85]
    v_pk_add_f32 v[82:83], v[82:83], v[86:87]
    s_waitcnt lgkmcnt(0)
    v_pk_add_f32 v[88:89], v[88:89], v[90:91]
    v_pk_add_f32 v[72:73], v[72:73], v[80:81]
    v_pk_add_f32 v[74:75], v[74:75], v[82:83]
    v_add_f32 v88, v88, v89
    v_cndmask_b32 v72, v31, v72, s[74:75]
    v_cndmask_b32 v73, v31, v73, s[76:77]
    v_cndmask_b32 v74, v31, v74, s[78:79]
    v_cndmask_b32 v75, v31, v75, s[80:81]
    v_max3_f32 v92, v72, v73, v74
    v_max3_f32 v92, v75, v88, v92
    s_nop 1
    v_max_f32_dpp v92, v92, v92 quad_perm:[1,0,3,2] row_mask:0xf bank_mask:0xf
    s_nop 1
    v_max_f32_dpp v92, v92, v92 quad_perm:[2,3,0,1] row_mask:0xf bank_mask:0xf
    s_nop 1
    v_max_f32_dpp v92, v92, v92 row_half_mirror row_mask:0xf bank_mask:0xf
    v_mul_f32 v92, s61, v92
    v_fma_f32 v72, v72, s61, -v92
    v_fma_f32 v73, v73, s61, -v92
    v_fma_f32 v74, v74, s61, -v92
    v_fma_f32 v75, v75, s61, -v92
    v_fma_f32 v88, v88, s61, -v92
    v_exp_f32 v72, v72
    v_exp_f32 v73, v73
    v_exp_f32 v74, v74
    v_exp_f32 v75, v75
    v_exp_f32 v88, v88
    v_pk_add_f32 v[76:77], v[72:73], v[74:75]
    v_add_f32 v93, v76, v88
    v_add_f32 v93, v93, v77
    v_mov_b32_dpp v89, v88 quad_perm:[1,0,3,2] row_mask:0xf bank_mask:0xf
    s_nop 0
    v_add_f32_dpp v93, v93, v93 quad_perm:[1,0,3,2] row_mask:0xf bank_mask:0xf
    s_nop 1
    v_add_f32_dpp v93, v93, v93 quad_perm:[2,3,0,1] row_mask:0xf bank_mask:0xf
    s_nop 1
    v_add_f32_dpp v93, v93, v93 row_half_mirror row_mask:0xf bank_mask:0xf
    v_rcp_f32 v92, v93
    s_nop 0
    v_pk_mul_f32 v[72:73], v[72:73], v[92:93] op_sel_hi:[1,0]
    v_pk_mul_f32 v[74:75], v[74:75], v[92:93] op_sel_hi:[1,0]
    v_pk_mul_f32 v[88:89], v[88:89], v[92:93] op_sel_hi:[1,0]
    v_cvt_pk_bf16_f32 v14, |v72|, |v73|
    v_cvt_pk_bf16_f32 v15, |v74|, |v75|
    v_cvt_pk_bf16_f32 v16, |v88|, |v89|
    s_waitcnt vmcnt(0)
    s_barrier
    s_cmp_lt_u32 s25, 56
    s_cbranch_scc1 L_QK_n
    s_mov_b64 exec, s[44:45]
    buffer_store_dword v17, v3, s[4:7], s43 offen sc1
    s_mov_b64 exec, -1
    s_cmp_lg_u32 s25, 62
    s_cbranch_scc1 L_QK_n
    s_add_u32 s38, s67, s69
    s_add_u32 s39, s67, 16384
    buffer_store_dwordx2 v[14:15], v27, s[4:7], s38 offen sc1
    buffer_store_dword v16, v28, s[4:7], s39 offen sc1
L_QK_n:
    ds_read_b128 v[112:115], v4 offset:0
    ds_read_b64 v[116:117], v12 offset:1024
    ds_read_b128 v[118:121], v4 offset:1536
    ds_read_b64 v[122:123], v12 offset:2560
    s_mov_b32 s25, s71
    s_cmp_ge_u32 s25, 64
    s_cbranch_scc1 L_QK_fin
    s_add_u32 s29, s25, 1
    v_cmp_gt_u32 vcc, s29, v13
    s_nop 0
    s_cbranch_vccz Lk_139
    s_mov_b32 s27, 0x100000
Lp_140:
    buffer_load_dword v13, v30, s[4:7], s66 offen sc1
    s_waitcnt vmcnt(0)
    v_cmp_gt_u32 vcc, s29, v13
    s_nop 0
    s_cbranch_vccz Ld_141
    s_sub_u32 s27, s27, 1
    s_cbranch_scc1 L_abort
    s_sleep 2
    s_branch Lp_140
Ld_141:
Lk_139:
    s_cmp_lg_u64 s[56:57], 0
    s_cbranch_scc1 Lk_142
    s_add_u32 s64, s64, 16252928
    s_bitset0_b32 s64, 24
    s_waitcnt lgkmcnt(0)
    buffer_load_dwordx4 v[112:115], v2, s[4:7], s64 offen offset:0 sc1
    buffer_load_dwordx2 v[116:117], v29, s[4:7], s64 offen offset:1024 sc1
    buffer_load_dwordx4 v[118:121], v2, s[4:7], s64 offen offset:1536 sc1
    buffer_load_dwordx2 v[122:123], v29, s[4:7], s64 offen offset:2560 sc1
    s_add_u32 s64, s64, 524288
    s_bitset0_b32 s64, 24
Lk_142:
    s_add_u32 s29, s25, 2
    s_min_u32 s29, s29, 64
    v_cmp_gt_u32 vcc, s29, v13
    s_nop 0
    s_and_b32 vcc_lo, vcc_lo, 0xf0
    s_cselect_b64 s[56:57], 0, -1
    s_branch L_loop_QK
L_QK_fin:
    s_add_u32 s38, s67, s69
    s_add_u32 s39, s67, 16384
    buffer_store_dwordx2 v[14:15], v27, s[4:7], s38 offen sc1
    buffer_store_dword v16, v28, s[4:7], s39 offen sc1
    s_branch L_exit
L_QK_redo0:
    buffer_load_dwordx4 v[32:35], v8, s[4:7], s90 offen sc1
    buffer_load_dwordx4 v[36:39], v8, s[4:7], s91 offen sc1
    buffer_load_dwordx4 v[40:43], v8, s[4:7], s92 offen sc1
    s_sub_u32 s27, s27, 1
    s_cbranch_scc1 L_abort
    s_waitcnt vmcnt(0)
    v_max3_u32 v4, v32, v33, v34
    v_max_u32 v4, v4, v35
    v_cmp_eq_u32 vcc, -1, v4
    s_nop 0
    s_cbranch_vccnz L_QK_redo0
    s_branch L_QK_ok0
L_QK_redo1:
    buffer_load_dwordx4 v[36:39], v8, s[4:7], s91 offen sc1
    buffer_load_dwordx4 v[40:43], v8, s[4:7], s92 offen sc1
    buffer_load_dwordx4 v[44:47], v8, s[4:7], s93 offen sc1
    s_sub_u32 s27, s27, 1
    s_cbranch_scc1 L_abort
    s_waitcnt vmcnt(0)
    v_max3_u32 v4, v36, v37, v38
    v_max_u32 v4, v4, v39
    v_cmp_eq_u32 vcc, -1, v4
    s_nop 0
    s_cbranch_vccnz L_QK_redo1
    s_branch L_QK_ok1
L_QK_redo2:
    buffer_load_dwordx4 v[40:43], v8, s[4:7], s92 offen sc1
    buffer_load_dwordx4 v[44:47], v8, s[4:7], s93 offen sc1
    buffer_load_dwordx4 v[48:51], v8, s[4:7], s94 offen sc1
    s_sub_u32 s27, s27, 1
    s_cbranch_scc1 L_abort
    s_waitcnt vmcnt(0)
    v_max3_u32 v4, v40, v41, v42
    v_max_u32 v4, v4, v43
    v_cmp_eq_u32 vcc, -1, v4
    s_nop 0
    s_cbranch_vccnz L_QK_redo2
    s_branch L_QK_ok2
L_QK_redo3:
    buffer_load_dwordx4 v[44:47], v8, s[4:7], s93 offen sc1
    buffer_load_dwordx4 v[48:51], v8, s[4:7], s94 offen sc1
    buffer_load_dwordx4 v[52:55], v8, s[4:7], s95 offen sc1
    s_sub_u32 s27, s27, 1
    s_cbranch_scc1 L_abort
    s_waitcnt vmcnt(0)
    v_max3_u32 v4, v44, v45, v46
    v_max_u32 v4, v4, v47
    v_cmp_eq_u32 vcc, -1, v4
    s_nop 0
    s_cbranch_vccnz L_QK_redo3
    s_branch L_QK_ok3
L_QK_redo4:
    buffer_load_dwordx4 v[48:51], v8, s[4:7], s94 offen sc1
    buffer_load_dwordx4 v[52:55], v8, s[4:7], s95 offen sc1
    buffer_load_dwordx4 v[56:59], v8, s[4:7], s96 offen sc1
    s_sub_u32 s27, s27, 1
    s_cbranch_scc1 L_abort
    s_waitcnt vmcnt(0)
    v_max3_u32 v4, v48, v49, v50
    v_max_u32 v4, v4, v51
    v_cmp_eq_u32 vcc, -1, v4
    s_nop 0
    s_cbranch_vccnz L_QK_redo4
    s_branch L_QK_ok4
L_QK_redo5:
    buffer_load_dwordx4 v[52:55], v8, s[4:7], s95 offen sc1
    buffer_load_dwordx4 v[56:59], v8, s[4:7], s96 offen sc1
    buffer_load_dwordx4 v[60:63], v8, s[4:7], s97 offen sc1
    s_sub_u32 s27, s27, 1
    s_cbranch_scc1 L_abort
    s_waitcnt vmcnt(0)
    v_max3_u32 v4, v52, v53, v54
    v_max_u32 v4, v4, v55
    v_cmp_eq_u32 vcc, -1, v4
    s_nop 0
    s_cbranch_vccnz L_QK_redo5
    s_branch L_QK_ok5
L_QK_redo6:
    buffer_load_dwordx4 v[56:59], v8, s[4:7], s96 offen sc1
    buffer_load_dwordx4 v[60:63], v8, s[4:7], s97 offen sc1
    buffer_load_dwordx4 v[64:67], v8, s[4:7], s98 offen sc1
    s_sub_u32 s27, s27, 1
    s_cbranch_scc1 L_abort
    s_waitcnt vmcnt(0)
    v_max3_u32 v4, v56, v57, v58
    v_max_u32 v4, v4, v59
    v_cmp_eq_u32 vcc, -1, v4
    s_nop 0
    s_cbranch_vccnz L_QK_redo6
    s_branch L_QK_ok6
L_QK_redo7:
    buffer_load_dwordx4 v[60:63], v8, s[4:7], s97 offen sc1
    buffer_load_dwordx4 v[64:67], v8, s[4:7], s98 offen sc1
    buffer_load_dwordx4 v[68:71], v8, s[4:7], s99 offen sc1
    s_sub_u32 s27, s27, 1
    s_cbranch_scc1 L_abort
    s_waitcnt vmcnt(0)
    v_max3_u32 v4, v60, v61, v62
    v_max_u32 v4, v4, v63
    v_cmp_eq_u32 vcc, -1, v4
    s_nop 0
    s_cbranch_vccnz L_QK_redo7
    s_branch L_QK_ok7
L_QK_redo8:
    buffer_load_dwordx4 v[64:67], v8, s[4:7], s98 offen sc1
    buffer_load_dwordx4 v[68:71], v8, s[4:7], s99 offen sc1
    s_sub_u32 s27, s27, 1
    s_cbranch_scc1 L_abort
    s_waitcnt vmcnt(0)
    v_max3_u32 v4, v64, v65, v66
    v_max_u32 v4, v4, v67
    v_cmp_eq_u32 vcc, -1, v4
    s_nop 0
    s_cbranch_vccnz L_QK_redo8
    s_branch L_QK_ok8
L_QK_redo9:
    buffer_load_dwordx4 v[68:71], v8, s[4:7], s99 offen sc1
    s_sub_u32 s27, s27, 1
    s_cbranch_scc1 L_abort
    s_waitcnt vmcnt(0)
    v_max3_u32 v4, v68, v69, v70
    v_max_u32 v4, v4, v71
    v_cmp_eq_u32 vcc, -1, v4
    s_nop 0
    s_cbranch_vccnz L_QK_redo9
    s_branch L_QK_ok9
L_role_VO:
    s_mov_b32 s8, s40
    s_and_b32 s9, s41, 0xffff
    s_mov_b32 s10, 0x780000
    s_mov_b32 s11, 0x20000
    s_mov_b32 s20, s42
    s_and_b32 s21, s43, 0xffff
    s_mov_b32 s22, 0x780000
    s_mov_b32 s23, 0x20000
    s_mul_i32 s71, s24, 384
    s_mul_i32 s28, s3, 196608
    s_add_u32 s71, s71, s28
    s_mul_i32 s72, s24, 245760
    s_mul_i32 s28, s3, 5120
    s_add_u32 s72, s72, s28
    v_lshrrev_b32 v12, 4, v1
    v_bfe_u32 v13, v1, 2, 2
    v_and_b32 v14, 3, v1
    v_add_u32 v4, 0, v1
    v_mul_u32_u24 v5, 2731, v4
    v_lshrrev_b32 v5, 16, v5
    v_mul_u32_u24 v20, 24, v5
    v_sub_u32 v4, v4, v20
    v_bfe_u32 v20, v5, 2, 1
    v_lshlrev_b32 v20, 1, v20
    v_xor_b32 v4, v4, v20
    v_lshlrev_b32 v4, 4, v4
    v_mul_u32_u24 v5, 12288, v5
    v_add_u32 v20, v4, v5
    v_add_u32 v4, 64, v1
    v_mul_u32_u24 v5, 2731, v4
    v_lshrrev_b32 v5, 16, v5
    v_mul_u32_u24 v21, 24, v5
    v_sub_u32 v4, v4, v21
    v_bfe_u32 v21, v5, 2, 1
    v_lshlrev_b32 v21, 1, v21
    v_xor_b32 v4, v4, v21
    v_lshlrev_b32 v4, 4, v4
    v_mul_u32_u24 v5, 12288, v5
    v_add_u32 v21, v4, v5
    v_add_u32 v4, 128, v1
    v_mul_u32_u24 v5, 2731, v4
    v_lshrrev_b32 v5, 16, v5
    v_mul_u32_u24 v22, 24, v5
    v_sub_u32 v4, v4, v22
    v_bfe_u32 v22, v5, 2, 1
    v_lshlrev_b32 v22, 1, v22
    v_xor_b32 v4, v4, v22
    v_lshlrev_b32 v4, 4, v4
    v_mul_u32_u24 v5, 12288, v5
    v_add_u32 v22, v4, v5
    v_add_u32 v4, 192, v1
    v_mul_u32_u24 v5, 2731, v4
    v_lshrrev_b32 v5, 16, v5
    v_mul_u32_u24 v23, 24, v5
    v_sub_u32 v4, v4, v23
    v_bfe_u32 v23, v5, 2, 1
    v_lshlrev_b32 v23, 1, v23
    v_or_b32 v23, 4, v23
    v_xor_b32 v4, v4, v23
    v_lshlrev_b32 v4, 4, v4
    v_mul_u32_u24 v5, 12288, v5
    v_add_u32 v23, v4, v5
    v_add_u32 v4, 256, v1
    v_mul_u32_u24 v5, 2731, v4
    v_lshrrev_b32 v5, 16, v5
    v_mul_u32_u24 v24, 24, v5
    v_sub_u32 v4, v4, v24
    v_bfe_u32 v24, v5, 2, 1
    v_lshlrev_b32 v24, 1, v24
    v_or_b32 v24, 4, v24
    v_xor_b32 v4, v4, v24
    v_lshlrev_b32 v4, 4, v4
    v_mul_u32_u24 v5, 12288, v5
    v_add_u32 v24, v4, v5
    v_add_u32 v4, 320, v1
    v_mul_u32_u24 v5, 2731, v4
    v_lshrrev_b32 v5, 16, v5
    v_mul_u32_u24 v25, 24, v5
    v_sub_u32 v4, v4, v25
    v_bfe_u32 v25, v5, 2, 1
    v_lshlrev_b32 v25, 1, v25
    v_or_b32 v25, 4, v25
    v_xor_b32 v4, v4, v25
    v_lshlrev_b32 v4, 4, v4
    v_mul_u32_u24 v5, 12288, v5
    v_add_u32 v25, v4, v5
    v_lshrrev_b32 v10, 1, v12
    v_lshlrev_b32 v10, 4, v10
    v_and_b32 v4, 1, v12
    v_lshl_add_u32 v10, v4, 2, v10
    v_lshrrev_b32 v4, 1, v13
    v_lshl_add_u32 v10, v4, 3, v10
    v_and_b32 v4, 1, v13
    v_add_u32 v10, v4, v10
    v_mul_u32_u24 v10, 384, v10
    v_lshl_add_u32 v10, v14, 3, v10
    s_mul_i32 s68, s3, 96
    v_and_b32 v6, 1, v12
    v_and_b32 v7, 2, v13
    v_or_b32 v6, v6, v7
    v_lshlrev_b32 v6, 5, v6
    v_lshl_add_u32 v15, v12, 2, v13
    v_and_b32 v16, 7, v15
    v_lshlrev_b32 v16, 5, v16
    v_mul_u32_u24 v15, 1280, v15
    v_lshl_add_u32 v15, v14, 3, v15
    s_mul_i32 s69, s3, 320
    s_lshl_b32 s28, s3, 2
    v_add_u32 v4, 0, v1
    v_mul_u32_u24 v5, 820, v4
    v_lshrrev_b32 v5, 16, v5
    v_mul_u32_u24 v26, 80, v5
    v_sub_u32 v4, v4, v26
    v_add_u32 v5, s28, v5
    v_and_b32 v5, 7, v5
    v_lshlrev_b32 v5, 1, v5
    v_xor_b32 v4, v4, v5
    v_add_lshl_u32 v26, v26, v4, 4
    v_add_u32 v4, 64, v1
    v_mul_u32_u24 v5, 820, v4
    v_lshrrev_b32 v5, 16, v5
    v_mul_u32_u24 v27, 80, v5
    v_sub_u32 v4, v4, v27
    v_add_u32 v5, s28, v5
    v_and_b32 v5, 7, v5
    v_lshlrev_b32 v5, 1, v5
    v_xor_b32 v4, v4, v5
    v_add_lshl_u32 v27, v27, v4, 4
    v_add_u32 v4, 128, v1
    v_mul_u32_u24 v5, 820, v4
    v_lshrrev_b32 v5, 16, v5
    v_mul_u32_u24 v28, 80, v5
    v_sub_u32 v4, v4, v28
    v_add_u32 v5, s28, v5
    v_and_b32 v5, 7, v5
    v_lshlrev_b32 v5, 1, v5
    v_xor_b32 v4, v4, v5
    v_add_lshl_u32 v28, v28, v4, 4
    v_add_u32 v4, 192, v1
    v_mul_u32_u24 v5, 820, v4
    v_lshrrev_b32 v5, 16, v5
    v_mul_u32_u24 v29, 80, v5
    v_sub_u32 v4, v4, v29
    v_add_u32 v5, s28, v5
    v_and_b32 v5, 7, v5
    v_lshlrev_b32 v5, 1, v5
    v_xor_b32 v4, v4, v5
    v_add_lshl_u32 v29, v29, v4, 4
    v_add_u32 v4, 256, v1
    v_mul_u32_u24 v5, 820, v4
    v_lshrrev_b32 v5, 16, v5
    v_mul_u32_u24 v30, 80, v5
    v_sub_u32 v4, v4, v30
    v_add_u32 v5, s28, v5
    v_and_b32 v5, 7, v5
    v_lshlrev_b32 v5, 1, v5
    v_xor_b32 v4, v4, v5
    v_add_lshl_u32 v30, v30, v4, 4
    s_mul_i32 s61, s3, 5120
    s_mul_i32 s62, s3, 6144
    s_add_u32 m0, s62, 0
    s_add_u32 s60, s71, 0x0
    buffer_load_dwordx4 v20, s[8:11], s60 offen lds
    s_add_u32 m0, s62, 1024
    s_add_u32 s60, s71, 0x0
    buffer_load_dwordx4 v21, s[8:11], s60 offen lds
    s_add_u32 m0, s62, 2048
    s_add_u32 s60, s71, 0x0
    buffer_load_dwordx4 v22, s[8:11], s60 offen lds
    s_add_u32 m0, s62, 3072
    s_add_u32 s60, s71, 0x0
    buffer_load_dwordx4 v23, s[8:11], s60 offen lds
    s_add_u32 m0, s62, 4096
    s_add_u32 s60, s71, 0x0
    buffer_load_dwordx4 v24, s[8:11], s60 offen lds
    s_add_u32 m0, s62, 5120
    s_add_u32 s60, s71, 0x0
    buffer_load_dwordx4 v25, s[8:11], s60 offen lds
    s_add_u32 m0, s62, 24576
    s_add_u32 s60, s71, 0xc0000
    buffer_load_dwordx4 v20, s[8:11], s60 offen lds
    s_add_u32 m0, s62, 25600
    s_add_u32 s60, s71, 0xc0000
    buffer_load_dwordx4 v21, s[8:11], s60 offen lds
    s_add_u32 m0, s62, 26624
    s_add_u32 s60, s71, 0xc0000
    buffer_load_dwordx4 v22, s[8:11], s60 offen lds
    s_add_u32 m0, s62, 27648
    s_add_u32 s60, s71, 0xc0000
    buffer_load_dwordx4 v23, s[8:11], s60 offen lds
    s_add_u32 m0, s62, 28672
    s_add_u32 s60, s71, 0xc0000
    buffer_load_dwordx4 v24, s[8:11], s60 offen lds
    s_add_u32 m0, s62, 29696
    s_add_u32 s60, s71, 0xc0000
    buffer_load_dwordx4 v25, s[8:11], s60 offen lds
    s_add_u32 m0, s62, 49152
    s_add_u32 s60, s71, 0x180000
    buffer_load_dwordx4 v20, s[8:11], s60 offen lds
    s_add_u32 m0, s62, 50176
    s_add_u32 s60, s71, 0x180000
    buffer_load_dwordx4 v21, s[8:11], s60 offen lds
    s_add_u32 m0, s62, 51200
    s_add_u32 s60, s71, 0x180000
    buffer_load_dwordx4 v22, s[8:11], s60 offen lds
    s_add_u32 m0, s62, 52224
    s_add_u32 s60, s71, 0x180000
    buffer_load_dwordx4 v23, s[8:11], s60 offen lds
    s_add_u32 m0, s62, 53248
    s_add_u32 s60, s71, 0x180000
    buffer_load_dwordx4 v24, s[8:11], s60 offen lds
    s_add_u32 m0, s62, 54272
    s_add_u32 s60, s71, 0x180000
    buffer_load_dwordx4 v25, s[8:11], s60 offen lds
    s_add_u32 m0, s62, 73728
    s_add_u32 s60, s71, 0x240000
    buffer_load_dwordx4 v20, s[8:11], s60 offen lds
    s_add_u32 m0, s62, 74752
    s_add_u32 s60, s71, 0x240000
    buffer_load_dwordx4 v21, s[8:11], s60 offen lds
    s_add_u32 m0, s62, 75776
    s_add_u32 s60, s71, 0x240000
    buffer_load_dwordx4 v22, s[8:11], s60 offen lds
    s_add_u32 m0, s62, 76800
    s_add_u32 s60, s71, 0x240000
    buffer_load_dwordx4 v23, s[8:11], s60 offen lds
    s_add_u32 m0, s62, 77824
    s_add_u32 s60, s71, 0x240000
    buffer_load_dwordx4 v24, s[8:11], s60 offen lds
    s_add_u32 m0, s62, 78848
    s_add_u32 s60, s71, 0x240000
    buffer_load_dwordx4 v25, s[8:11], s60 offen lds
    s_add_u32 m0, s62, 98304
    s_add_u32 s60, s71, 0x300000
    buffer_load_dwordx4 v20, s[8:11], s60 offen lds
    s_add_u32 m0, s62, 99328
    s_add_u32 s60, s71, 0x300000
    buffer_load_dwordx4 v21, s[8:11], s60 offen lds
    s_add_u32 m0, s62, 100352
    s_add_u32 s60, s71, 0x300000
    buffer_load_dwordx4 v22, s[8:11], s60 offen lds
    s_add_u32 m0, s62, 101376
    s_add_u32 s60, s71, 0x300000
    buffer_load_dwordx4 v23, s[8:11], s60 offen lds
    s_add_u32 m0, s62, 102400
    s_add_u32 s60, s71, 0x300000
    buffer_load_dwordx4 v24, s[8:11], s60 offen lds
    s_add_u32 m0, s62, 103424
    s_add_u32 s60, s71, 0x300000
    buffer_load_dwordx4 v25, s[8:11], s60 offen lds
    s_waitcnt vmcnt(24)
    s_barrier
    s_add_u32 m0, s62, 122880
    s_add_u32 s60, s71, 0x3c0000
    buffer_load_dwordx4 v20, s[8:11], s60 offen lds
    s_add_u32 m0, s62, 123904
    s_add_u32 s60, s71, 0x3c0000
    buffer_load_dwordx4 v21, s[8:11], s60 offen lds
    s_add_u32 m0, s62, 124928
    s_add_u32 s60, s71, 0x3c0000
    buffer_load_dwordx4 v22, s[8:11], s60 offen lds
    s_add_u32 m0, s62, 125952
    s_add_u32 s60, s71, 0x3c0000
    buffer_load_dwordx4 v23, s[8:11], s60 offen lds
    s_add_u32 m0, s62, 126976
    s_add_u32 s60, s71, 0x3c0000
    buffer_load_dwordx4 v24, s[8:11], s60 offen lds
    s_add_u32 m0, s62, 128000
    s_add_u32 s60, s71, 0x3c0000
    buffer_load_dwordx4 v25, s[8:11], s60 offen lds
    v_add_u32 v11, 0x0, v10
    s_add_u32 s60, s68, 0
    v_xad_u32 v8, s60, v6, v11
    ds_read_b64_tr_b16 a[0:1], v8 offset:0
    ds_read_b64_tr_b16 a[2:3], v8 offset:768
    ds_read_b64_tr_b16 a[4:5], v8 offset:12288
    ds_read_b64_tr_b16 a[6:7], v8 offset:13056
    s_add_u32 s60, s68, 32
    v_xad_u32 v9, s60, v6, v11
    ds_read_b64_tr_b16 a[8:9], v9 offset:0
    ds_read_b64_tr_b16 a[10:11], v9 offset:768
    ds_read_b64_tr_b16 a[12:13], v9 offset:12288
    ds_read_b64_tr_b16 a[14:15], v9 offset:13056
    s_add_u32 s60, s68, 64
    v_xad_u32 v8, s60, v6, v11
    ds_read_b64_tr_b16 a[128:129], v8 offset:0
    ds_read_b64_tr_b16 a[130:131], v8 offset:768
    ds_read_b64_tr_b16 a[132:133], v8 offset:12288
    ds_read_b64_tr_b16 a[134:135], v8 offset:13056
    s_waitcnt lgkmcnt(0)
    s_waitcnt vmcnt(24)
    s_barrier
    s_add_u32 m0, s62, 0
    s_add_u32 s60, s71, 0x480000
    buffer_load_dwordx4 v20, s[8:11], s60 offen lds
    s_add_u32 m0, s62, 1024
    s_add_u32 s60, s71, 0x480000
    buffer_load_dwordx4 v21, s[8:11], s60 offen lds
    s_add_u32 m0, s62, 2048
    s_add_u32 s60, s71, 0x480000
    buffer_load_dwordx4 v22, s[8:11], s60 offen lds
    s_add_u32 m0, s62, 3072
    s_add_u32 s60, s71, 0x480000
    buffer_load_dwordx4 v23, s[8:11], s60 offen lds
    s_add_u32 m0, s62, 4096
    s_add_u32 s60, s71, 0x480000
    buffer_load_dwordx4 v24, s[8:11], s60 offen lds
    s_add_u32 m0, s62, 5120
    s_add_u32 s60, s71, 0x480000
    buffer_load_dwordx4 v25, s[8:11], s60 offen lds
    v_add_u32 v11, 0x6000, v10
    s_add_u32 s60, s68, 0
    v_xad_u32 v8, s60, v6, v11
    ds_read_b64_tr_b16 a[16:17], v8 offset:0
    ds_read_b64_tr_b16 a[18:19], v8 offset:768
    ds_read_b64_tr_b16 a[20:21], v8 offset:12288
    ds_read_b64_tr_b16 a[22:23], v8 offset:13056
    s_add_u32 s60, s68, 32
    v_xad_u32 v9, s60, v6, v11
    ds_read_b64_tr_b16 a[24:25], v9 offset:0
    ds_read_b64_tr_b16 a[26:27], v9 offset:768
    ds_read_b64_tr_b16 a[28:29], v9 offset:12288
    ds_read_b64_tr_b16 a[30:31], v9 offset:13056
    s_add_u32 s60, s68, 64
    v_xad_u32 v8, s60, v6, v11
    ds_read_b64_tr_b16 a[136:137], v8 offset:0
    ds_read_b64_tr_b16 a[138:139], v8 offset:768
    ds_read_b64_tr_b16 a[140:141], v8 offset:12288
    ds_read_b64_tr_b16 a[142:143], v8 offset:13056
    s_waitcnt lgkmcnt(0)
    s_waitcnt vmcnt(24)
    s_barrier
    s_add_u32 m0, s62, 24576
    s_add_u32 s60, s71, 0x540000
    buffer_load_dwordx4 v20, s[8:11], s60 offen lds
    s_add_u32 m0, s62, 25600
    s_add_u32 s60, s71, 0x540000
    buffer_load_dwordx4 v21, s[8:11], s60 offen lds
    s_add_u32 m0, s62, 26624
    s_add_u32 s60, s71, 0x540000
    buffer_load_dwordx4 v22, s[8:11], s60 offen lds
    s_add_u32 m0, s62, 27648
    s_add_u32 s60, s71, 0x540000
    buffer_load_dwordx4 v23, s[8:11], s60 offen lds
    s_add_u32 m0, s62, 28672
    s_add_u32 s60, s71, 0x540000
    buffer_load_dwordx4 v24, s[8:11], s60 offen lds
    s_add_u32 m0, s62, 29696
    s_add_u32 s60, s71, 0x540000
    buffer_load_dwordx4 v25, s[8:11], s60 offen lds
    v_add_u32 v11, 0xc000, v10
    s_add_u32 s60, s68, 0
    v_xad_u32 v8, s60, v6, v11
    ds_read_b64_tr_b16 a[32:33], v8 offset:0
    ds_read_b64_tr_b16 a[34:35], v8 offset:768
    ds_read_b64_tr_b16 a[36:37], v8 offset:12288
    ds_read_b64_tr_b16 a[38:39], v8 offset:13056
    s_add_u32 s60, s68, 32
    v_xad_u32 v9, s60, v6, v11
    ds_read_b64_tr_b16 a[40:41], v9 offset:0
    ds_read_b64_tr_b16 a[42:43], v9 offset:768
    ds_read_b64_tr_b16 a[44:45], v9 offset:12288
    ds_read_b64_tr_b16 a[46:47], v9 offset:13056
    s_add_u32 s60, s68, 64
    v_xad_u32 v8, s60, v6, v11
    ds_read_b64_tr_b16 a[144:145], v8 offset:0
    ds_read_b64_tr_b16 a[146:147], v8 offset:768
    ds_read_b64_tr_b16 a[148:149], v8 offset:12288
    ds_read_b64_tr_b16 a[150:151], v8 offset:13056
    s_waitcnt lgkmcnt(0)
    s_waitcnt vmcnt(24)
    s_barrier
    s_add_u32 m0, s62, 49152
    s_add_u32 s60, s71, 0x600000
    buffer_load_dwordx4 v20, s[8:11], s60 offen lds
    s_add_u32 m0, s62, 50176
    s_add_u32 s60, s71, 0x600000
    buffer_load_dwordx4 v21, s[8:11], s60 offen lds
    s_add_u32 m0, s62, 51200
    s_add_u32 s60, s71, 0x600000
    buffer_load_dwordx4 v22, s[8:11], s60 offen lds
    s_add_u32 m0, s62, 52224
    s_add_u32 s60, s71, 0x600000
    buffer_load_dwordx4 v23, s[8:11], s60 offen lds
    s_add_u32 m0, s62, 53248
    s_add_u32 s60, s71, 0x600000
    buffer_load_dwordx4 v24, s[8:11], s60 offen lds
    s_add_u32 m0, s62, 54272
    s_add_u32 s60, s71, 0x600000
    buffer_load_dwordx4 v25, s[8:11], s60 offen lds
    v_add_u32 v11, 0x12000, v10
    s_add_u32 s60, s68, 0
    v_xad_u32 v8, s60, v6, v11
    ds_read_b64_tr_b16 a[48:49], v8 offset:0
    ds_read_b64_tr_b16 a[50:51], v8 offset:768
    ds_read_b64_tr_b16 a[52:53], v8 offset:12288
    ds_read_b64_tr_b16 a[54:55], v8 offset:13056
    s_add_u32 s60, s68, 32
    v_xad_u32 v9, s60, v6, v11
    ds_read_b64_tr_b16 a[56:57], v9 offset:0
    ds_read_b64_tr_b16 a[58:59], v9 offset:768
    ds_read_b64_tr_b16 a[60:61], v9 offset:12288
    ds_read_b64_tr_b16 a[62:63], v9 offset:13056
    s_add_u32 s60, s68, 64
    v_xad_u32 v8, s60, v6, v11
    ds_read_b64_tr_b16 a[152:153], v8 offset:0
    ds_read_b64_tr_b16 a[154:155], v8 offset:768
    ds_read_b64_tr_b16 a[156:157], v8 offset:12288
    ds_read_b64_tr_b16 a[158:159], v8 offset:13056
    s_waitcnt lgkmcnt(0)
    s_waitcnt vmcnt(24)
    s_barrier
    s_add_u32 m0, s62, 73728
    s_add_u32 s60, s71, 0x6c0000
    buffer_load_dwordx4 v20, s[8:11], s60 offen lds
    s_add_u32 m0, s62, 74752
    s_add_u32 s60, s71, 0x6c0000
    buffer_load_dwordx4 v21, s[8:11], s60 offen lds
    s_add_u32 m0, s62, 75776
    s_add_u32 s60, s71, 0x6c0000
    buffer_load_dwordx4 v22, s[8:11], s60 offen lds
    s_add_u32 m0, s62, 76800
    s_add_u32 s60, s71, 0x6c0000
    buffer_load_dwordx4 v23, s[8:11], s60 offen lds
    s_add_u32 m0, s62, 77824
    s_add_u32 s60, s71, 0x6c0000
    buffer_load_dwordx4 v24, s[8:11], s60 offen lds
    s_add_u32 m0, s62, 78848
    s_add_u32 s60, s71, 0x6c0000
    buffer_load_dwordx4 v25, s[8:11], s60 offen lds
    v_add_u32 v11, 0x18000, v10
    s_add_u32 s60, s68, 0
    v_xad_u32 v8, s60, v6, v11
    ds_read_b64_tr_b16 v[32:33], v8 offset:0
    ds_read_b64_tr_b16 v[34:35], v8 offset:768
    ds_read_b64_tr_b16 v[36:37], v8 offset:12288
    ds_read_b64_tr_b16 v[38:39], v8 offset:13056
    s_add_u32 s60, s68, 32
    v_xad_u32 v9, s60, v6, v11
    ds_read_b64_tr_b16 v[40:41], v9 offset:0
    ds_read_b64_tr_b16 v[42:43], v9 offset:768
    ds_read_b64_tr_b16 v[44:45], v9 offset:12288
    ds_read_b64_tr_b16 v[46:47], v9 offset:13056
    s_add_u32 s60, s68, 64
    v_xad_u32 v8, s60, v6, v11
    ds_read_b64_tr_b16 a[160:161], v8 offset:0
    ds_read_b64_tr_b16 a[162:163], v8 offset:768
    ds_read_b64_tr_b16 a[164:165], v8 offset:12288
    ds_read_b64_tr_b16 a[166:167], v8 offset:13056
    s_waitcnt lgkmcnt(0)
    s_waitcnt vmcnt(24)
    s_barrier
    s_add_u32 m0, s61, 98304
    s_add_u32 s60, s72, 0x0
    buffer_load_dwordx4 v26, s[20:23], s60 offen lds
    s_add_u32 m0, s61, 99328
    s_add_u32 s60, s72, 0x0
    buffer_load_dwordx4 v27, s[20:23], s60 offen lds
    s_add_u32 m0, s61, 100352
    s_add_u32 s60, s72, 0x0
    buffer_load_dwordx4 v28, s[20:23], s60 offen lds
    s_add_u32 m0, s61, 101376
    s_add_u32 s60, s72, 0x0
    buffer_load_dwordx4 v29, s[20:23], s60 offen lds
    s_add_u32 m0, s61, 102400
    s_add_u32 s60, s72, 0x0
    buffer_load_dwordx4 v30, s[20:23], s60 offen lds
    v_add_u32 v11, 0x1e000, v10
    s_add_u32 s60, s68, 0
    v_xad_u32 v8, s60, v6, v11
    ds_read_b64_tr_b16 a[64:65], v8 offset:0
    ds_read_b64_tr_b16 a[66:67], v8 offset:768
    ds_read_b64_tr_b16 a[68:69], v8 offset:12288
    ds_read_b64_tr_b16 a[70:71], v8 offset:13056
    s_add_u32 s60, s68, 32
    v_xad_u32 v9, s60, v6, v11
    ds_read_b64_tr_b16 a[72:73], v9 offset:0
    ds_read_b64_tr_b16 a[74:75], v9 offset:768
    ds_read_b64_tr_b16 a[76:77], v9 offset:12288
    ds_read_b64_tr_b16 a[78:79], v9 offset:13056
    s_add_u32 s60, s68, 64
    v_xad_u32 v8, s60, v6, v11
    ds_read_b64_tr_b16 a[168:169], v8 offset:0
    ds_read_b64_tr_b16 a[170:171], v8 offset:768
    ds_read_b64_tr_b16 a[172:173], v8 offset:12288
    ds_read_b64_tr_b16 a[174:175], v8 offset:13056
    s_waitcnt lgkmcnt(0)
    s_waitcnt vmcnt(23)
    s_barrier
    s_add_u32 m0, s61, 122880
    s_add_u32 s60, s72, 0x5000
    buffer_load_dwordx4 v26, s[20:23], s60 offen lds
    s_add_u32 m0, s61, 123904
    s_add_u32 s60, s72, 0x5000
    buffer_load_dwordx4 v27, s[20:23], s60 offen lds
    s_add_u32 m0, s61, 124928
    s_add_u32 s60, s72, 0x5000
    buffer_load_dwordx4 v28, s[20:23], s60 offen lds
    s_add_u32 m0, s61, 125952
    s_add_u32 s60, s72, 0x5000
    buffer_load_dwordx4 v29, s[20:23], s60 offen lds
    s_add_u32 m0, s61, 126976
    s_add_u32 s60, s72, 0x5000
    buffer_load_dwordx4 v30, s[20:23], s60 offen lds
    v_add_u32 v11, 0x0, v10
    s_add_u32 s60, s68, 0
    v_xad_u32 v8, s60, v6, v11
    ds_read_b64_tr_b16 a[80:81], v8 offset:0
    ds_read_b64_tr_b16 a[82:83], v8 offset:768
    ds_read_b64_tr_b16 a[84:85], v8 offset:12288
    ds_read_b64_tr_b16 a[86:87], v8 offset:13056
    s_add_u32 s60, s68, 32
    v_xad_u32 v9, s60, v6, v11
    ds_read_b64_tr_b16 a[88:89], v9 offset:0
    ds_read_b64_tr_b16 a[90:91], v9 offset:768
    ds_read_b64_tr_b16 a[92:93], v9 offset:12288
    ds_read_b64_tr_b16 a[94:95], v9 offset:13056
    s_add_u32 s60, s68, 64
    v_xad_u32 v8, s60, v6, v11
    ds_read_b64_tr_b16 a[176:177], v8 offset:0
    ds_read_b64_tr_b16 a[178:179], v8 offset:768
    ds_read_b64_tr_b16 a[180:181], v8 offset:12288
    ds_read_b64_tr_b16 a[182:183], v8 offset:13056
    s_waitcnt lgkmcnt(0)
    s_waitcnt vmcnt(22)
    s_barrier
    s_add_u32 m0, s61, 0
    s_add_u32 s60, s72, 0xa000
    buffer_load_dwordx4 v26, s[20:23], s60 offen lds
    s_add_u32 m0, s61, 1024
    s_add_u32 s60, s72, 0xa000
    buffer_load_dwordx4 v27, s[20:23], s60 offen lds
    s_add_u32 m0, s61, 2048
    s_add_u32 s60, s72, 0xa000
    buffer_load_dwordx4 v28, s[20:23], s60 offen lds
    s_add_u32 m0, s61, 3072
    s_add_u32 s60, s72, 0xa000
    buffer_load_dwordx4 v29, s[20:23], s60 offen lds
    s_add_u32 m0, s61, 4096
    s_add_u32 s60, s72, 0xa000
    buffer_load_dwordx4 v30, s[20:23], s60 offen lds
    v_add_u32 v11, 0x6000, v10
    s_add_u32 s60, s68, 0
    v_xad_u32 v8, s60, v6, v11
    ds_read_b64_tr_b16 a[96:97], v8 offset:0
    ds_read_b64_tr_b16 a[98:99], v8 offset:768
    ds_read_b64_tr_b16 a[100:101], v8 offset:12288
    ds_read_b64_tr_b16 a[102:103], v8 offset:13056
    s_add_u32 s60, s68, 32
    v_xad_u32 v9, s60, v6, v11
    ds_read_b64_tr_b16 a[104:105], v9 offset:0
    ds_read_b64_tr_b16 a[106:107], v9 offset:768
    ds_read_b64_tr_b16 a[108:109], v9 offset:12288
    ds_read_b64_tr_b16 a[110:111], v9 offset:13056
    s_add_u32 s60, s68, 64
    v_xad_u32 v8, s60, v6, v11
    ds_read_b64_tr_b16 a[184:185], v8 offset:0
    ds_read_b64_tr_b16 a[186:187], v8 offset:768
    ds_read_b64_tr_b16 a[188:189], v8 offset:12288
    ds_read_b64_tr_b16 a[190:191], v8 offset:13056
    s_waitcnt lgkmcnt(0)
    s_waitcnt vmcnt(21)
    s_barrier
    s_add_u32 m0, s61, 24576
    s_add_u32 s60, s72, 0xf000
    buffer_load_dwordx4 v26, s[20:23], s60 offen lds
    s_add_u32 m0, s61, 25600
    s_add_u32 s60, s72, 0xf000
    buffer_load_dwordx4 v27, s[20:23], s60 offen lds
    s_add_u32 m0, s61, 26624
    s_add_u32 s60, s72, 0xf000
    buffer_load_dwordx4 v28, s[20:23], s60 offen lds
    s_add_u32 m0, s61, 27648
    s_add_u32 s60, s72, 0xf000
    buffer_load_dwordx4 v29, s[20:23], s60 offen lds
    s_add_u32 m0, s61, 28672
    s_add_u32 s60, s72, 0xf000
    buffer_load_dwordx4 v30, s[20:23], s60 offen lds
    v_add_u32 v11, 0xc000, v10
    s_add_u32 s60, s68, 0
    v_xad_u32 v8, s60, v6, v11
    ds_read_b64_tr_b16 a[112:113], v8 offset:0
    ds_read_b64_tr_b16 a[114:115], v8 offset:768
    ds_read_b64_tr_b16 a[116:117], v8 offset:12288
    ds_read_b64_tr_b16 a[118:119], v8 offset:13056
    s_add_u32 s60, s68, 32
    v_xad_u32 v9, s60, v6, v11
    ds_read_b64_tr_b16 a[120:121], v9 offset:0
    ds_read_b64_tr_b16 a[122:123], v9 offset:768
    ds_read_b64_tr_b16 a[124:125], v9 offset:12288
    ds_read_b64_tr_b16 a[126:127], v9 offset:13056
    s_add_u32 s60, s68, 64
    v_xad_u32 v8, s60, v6, v11
    ds_read_b64_tr_b16 v[64:65], v8 offset:0
    ds_read_b64_tr_b16 v[66:67], v8 offset:768
    ds_read_b64_tr_b16 v[68:69], v8 offset:12288
    ds_read_b64_tr_b16 v[70:71], v8 offset:13056
    s_waitcnt lgkmcnt(0)
    s_waitcnt vmcnt(20)
    s_barrier
    s_add_u32 m0, s61, 49152
    s_add_u32 s60, s72, 0x14000
    buffer_load_dwordx4 v26, s[20:23], s60 offen lds
    s_add_u32 m0, s61, 50176
    s_add_u32 s60, s72, 0x14000
    buffer_load_dwordx4 v27, s[20:23], s60 offen lds
    s_add_u32 m0, s61, 51200
    s_add_u32 s60, s72, 0x14000
    buffer_load_dwordx4 v28, s[20:23], s60 offen lds
    s_add_u32 m0, s61, 52224
    s_add_u32 s60, s72, 0x14000
    buffer_load_dwordx4 v29, s[20:23], s60 offen lds
    s_add_u32 m0, s61, 53248
    s_add_u32 s60, s72, 0x14000
    buffer_load_dwordx4 v30, s[20:23], s60 offen lds
    v_add_u32 v11, 0x12000, v10
    s_add_u32 s60, s68, 0
    v_xad_u32 v8, s60, v6, v11
    ds_read_b64_tr_b16 v[48:49], v8 offset:0
    ds_read_b64_tr_b16 v[50:51], v8 offset:768
    ds_read_b64_tr_b16 v[52:53], v8 offset:12288
    ds_read_b64_tr_b16 v[54:55], v8 offset:13056
    s_add_u32 s60, s68, 32
    v_xad_u32 v9, s60, v6, v11
    ds_read_b64_tr_b16 v[56:57], v9 offset:0
    ds_read_b64_tr_b16 v[58:59], v9 offset:768
    ds_read_b64_tr_b16 v[60:61], v9 offset:12288
    ds_read_b64_tr_b16 v[62:63], v9 offset:13056
    s_add_u32 s60, s68, 64
    v_xad_u32 v8, s60, v6, v11
    ds_read_b64_tr_b16 v[72:73], v8 offset:0
    ds_read_b64_tr_b16 v[74:75], v8 offset:768
    ds_read_b64_tr_b16 v[76:77], v8 offset:12288
    ds_read_b64_tr_b16 v[78:79], v8 offset:13056
    s_waitcnt lgkmcnt(0)
    s_waitcnt vmcnt(20)
    s_barrier
    s_add_u32 m0, s61, 73728
    s_add_u32 s60, s72, 0x19000
    buffer_load_dwordx4 v26, s[20:23], s60 offen lds
    s_add_u32 m0, s61, 74752
    s_add_u32 s60, s72, 0x19000
    buffer_load_dwordx4 v27, s[20:23], s60 offen lds
    s_add_u32 m0, s61, 75776
    s_add_u32 s60, s72, 0x19000
    buffer_load_dwordx4 v28, s[20:23], s60 offen lds
    s_add_u32 m0, s61, 76800
    s_add_u32 s60, s72, 0x19000
    buffer_load_dwordx4 v29, s[20:23], s60 offen lds
    s_add_u32 m0, s61, 77824
    s_add_u32 s60, s72, 0x19000
    buffer_load_dwordx4 v30, s[20:23], s60 offen lds
    v_add_u32 v11, 0x18000, v15
    s_add_u32 s60, s69, 0
    v_xad_u32 v8, s60, v16, v11
    ds_read_b64_tr_b16 a[192:193], v8 offset:0
    s_add_u32 s60, s69, 32
    v_xad_u32 v9, s60, v16, v11
    ds_read_b64_tr_b16 a[216:217], v9 offset:0
    s_add_u32 s60, s69, 64
    v_xad_u32 v8, s60, v16, v11
    ds_read_b64_tr_b16 a[240:241], v8 offset:0
    s_add_u32 s60, s69, 96
    v_xad_u32 v9, s60, v16, v11
    ds_read_b64_tr_b16 v[88:89], v9 offset:0
    s_add_u32 s60, s69, 128
    v_xad_u32 v8, s60, v16, v11
    ds_read_b64_tr_b16 v[144:145], v8 offset:0
    s_add_u32 s60, s69, 160
    v_xad_u32 v9, s60, v16, v11
    ds_read_b64_tr_b16 v[168:169], v9 offset:0
    s_add_u32 s60, s69, 192
    v_xad_u32 v8, s60, v16, v11
    ds_read_b64_tr_b16 v[96:97], v8 offset:0
    s_add_u32 s60, s69, 224
    v_xad_u32 v9, s60, v16, v11
    ds_read_b64_tr_b16 v[200:201], v9 offset:0
    s_add_u32 s60, s69, 256
    v_xad_u32 v8, s60, v16, v11
    ds_read_b64_tr_b16 v[224:225], v8 offset:0
    s_add_u32 s60, s69, 288
    v_xad_u32 v9, s60, v16, v11
    ds_read_b64_tr_b16 v[248:249], v9 offset:0
    s_waitcnt lgkmcnt(0)
    s_waitcnt vmcnt(20)
    s_barrier
    s_add_u32 m0, s61, 98304
    s_add_u32 s60, s72, 0x1e000
    buffer_load_dwordx4 v26, s[20:23], s60 offen lds
    s_add_u32 m0, s61, 99328
    s_add_u32 s60, s72, 0x1e000
    buffer_load_dwordx4 v27, s[20:23], s60 offen lds
    s_add_u32 m0, s61, 100352
    s_add_u32 s60, s72, 0x1e000
    buffer_load_dwordx4 v28, s[20:23], s60 offen lds
    s_add_u32 m0, s61, 101376
    s_add_u32 s60, s72, 0x1e000
    buffer_load_dwordx4 v29, s[20:23], s60 offen lds
    s_add_u32 m0, s61, 102400
    s_add_u32 s60, s72, 0x1e000
    buffer_load_dwordx4 v30, s[20:23], s60 offen lds
    v_add_u32 v11, 0x1e000, v15
    s_add_u32 s60, s69, 0
    v_xad_u32 v8, s60, v16, v11
    ds_read_b64_tr_b16 a[194:195], v8 offset:0
    s_add_u32 s60, s69, 32
    v_xad_u32 v9, s60, v16, v11
    ds_read_b64_tr_b16 a[218:219], v9 offset:0
    s_add_u32 s60, s69, 64
    v_xad_u32 v8, s60, v16, v11
    ds_read_b64_tr_b16 a[242:243], v8 offset:0
    s_add_u32 s60, s69, 96
    v_xad_u32 v9, s60, v16, v11
    ds_read_b64_tr_b16 v[90:91], v9 offset:0
    s_add_u32 s60, s69, 128
    v_xad_u32 v8, s60, v16, v11
    ds_read_b64_tr_b16 v[146:147], v8 offset:0
    s_add_u32 s60, s69, 160
    v_xad_u32 v9, s60, v16, v11
    ds_read_b64_tr_b16 v[170:171], v9 offset:0
    s_add_u32 s60, s69, 192
    v_xad_u32 v8, s60, v16, v11
    ds_read_b64_tr_b16 v[98:99], v8 offset:0
    s_add_u32 s60, s69, 224
    v_xad_u32 v9, s60, v16, v11
    ds_read_b64_tr_b16 v[202:203], v9 offset:0
    s_add_u32 s60, s69, 256
    v_xad_u32 v8, s60, v16, v11
    ds_read_b64_tr_b16 v[226:227], v8 offset:0
    s_add_u32 s60, s69, 288
    v_xad_u32 v9, s60, v16, v11
    ds_read_b64_tr_b16 v[250:251], v9 offset:0
    s_waitcnt lgkmcnt(0)
    s_waitcnt vmcnt(20)
    s_barrier
    s_add_u32 m0, s61, 122880
    s_add_u32 s60, s72, 0x23000
    buffer_load_dwordx4 v26, s[20:23], s60 offen lds
    s_add_u32 m0, s61, 123904
    s_add_u32 s60, s72, 0x23000
    buffer_load_dwordx4 v27, s[20:23], s60 offen lds
    s_add_u32 m0, s61, 124928
    s_add_u32 s60, s72, 0x23000
    buffer_load_dwordx4 v28, s[20:23], s60 offen lds
    s_add_u32 m0, s61, 125952
    s_add_u32 s60, s72, 0x23000
    buffer_load_dwordx4 v29, s[20:23], s60 offen lds
    s_add_u32 m0, s61, 126976
    s_add_u32 s60, s72, 0x23000
    buffer_load_dwordx4 v30, s[20:23], s60 offen lds
    v_add_u32 v11, 0x0, v15
    s_add_u32 s60, s69, 0
    v_xad_u32 v8, s60, v16, v11
    ds_read_b64_tr_b16 a[196:197], v8 offset:0
    s_add_u32 s60, s69, 32
    v_xad_u32 v9, s60, v16, v11
    ds_read_b64_tr_b16 a[220:221], v9 offset:0
    s_add_u32 s60, s69, 64
    v_xad_u32 v8, s60, v16, v11
    ds_read_b64_tr_b16 a[244:245], v8 offset:0
    s_add_u32 s60, s69, 96
    v_xad_u32 v9, s60, v16, v11
    ds_read_b64_tr_b16 v[92:93], v9 offset:0
    s_add_u32 s60, s69, 128
    v_xad_u32 v8, s60, v16, v11
    ds_read_b64_tr_b16 v[148:149], v8 offset:0
    s_add_u32 s60, s69, 160
    v_xad_u32 v9, s60, v16, v11
    ds_read_b64_tr_b16 v[172:173], v9 offset:0
    s_add_u32 s60, s69, 192
    v_xad_u32 v8, s60, v16, v11
    ds_read_b64_tr_b16 v[100:101], v8 offset:0
    s_add_u32 s60, s69, 224
    v_xad_u32 v9, s60, v16, v11
    ds_read_b64_tr_b16 v[204:205], v9 offset:0
    s_add_u32 s60, s69, 256
    v_xad_u32 v8, s60, v16, v11
    ds_read_b64_tr_b16 v[228:229], v8 offset:0
    s_add_u32 s60, s69, 288
    v_xad_u32 v9, s60, v16, v11
    ds_read_b64_tr_b16 v[252:253], v9 offset:0
    s_waitcnt lgkmcnt(0)
    s_waitcnt vmcnt(20)
    s_barrier
    s_add_u32 m0, s61, 0
    s_add_u32 s60, s72, 0x28000
    buffer_load_dwordx4 v26, s[20:23], s60 offen lds
    s_add_u32 m0, s61, 1024
    s_add_u32 s60, s72, 0x28000
    buffer_load_dwordx4 v27, s[20:23], s60 offen lds
    s_add_u32 m0, s61, 2048
    s_add_u32 s60, s72, 0x28000
    buffer_load_dwordx4 v28, s[20:23], s60 offen lds
    s_add_u32 m0, s61, 3072
    s_add_u32 s60, s72, 0x28000
    buffer_load_dwordx4 v29, s[20:23], s60 offen lds
    s_add_u32 m0, s61, 4096
    s_add_u32 s60, s72, 0x28000
    buffer_load_dwordx4 v30, s[20:23], s60 offen lds
    v_add_u32 v11, 0x6000, v15
    s_add_u32 s60, s69, 0
    v_xad_u32 v8, s60, v16, v11
    ds_read_b64_tr_b16 a[198:199], v8 offset:0
    s_add_u32 s60, s69, 32
    v_xad_u32 v9, s60, v16, v11
    ds_read_b64_tr_b16 a[222:223], v9 offset:0
    s_add_u32 s60, s69, 64
    v_xad_u32 v8, s60, v16, v11
    ds_read_b64_tr_b16 a[246:247], v8 offset:0
    s_add_u32 s60, s69, 96
    v_xad_u32 v9, s60, v16, v11
    ds_read_b64_tr_b16 v[94:95], v9 offset:0
    s_add_u32 s60, s69, 128
    v_xad_u32 v8, s60, v16, v11
    ds_read_b64_tr_b16 v[150:151], v8 offset:0
    s_add_u32 s60, s69, 160
    v_xad_u32 v9, s60, v16, v11
    ds_read_b64_tr_b16 v[174:175], v9 offset:0
    s_add_u32 s60, s69, 192
    v_xad_u32 v8, s60, v16, v11
    ds_read_b64_tr_b16 v[102:103], v8 offset:0
    s_add_u32 s60, s69, 224
    v_xad_u32 v9, s60, v16, v11
    ds_read_b64_tr_b16 v[206:207], v9 offset:0
    s_add_u32 s60, s69, 256
    v_xad_u32 v8, s60, v16, v11
    ds_read_b64_tr_b16 v[230:231], v8 offset:0
    s_add_u32 s60, s69, 288
    v_xad_u32 v9, s60, v16, v11
    ds_read_b64_tr_b16 v[254:255], v9 offset:0
    s_waitcnt lgkmcnt(0)
    s_waitcnt vmcnt(20)
    s_barrier
    s_add_u32 m0, s61, 24576
    s_add_u32 s60, s72, 0x2d000
    buffer_load_dwordx4 v26, s[20:23], s60 offen lds
    s_add_u32 m0, s61, 25600
    s_add_u32 s60, s72, 0x2d000
    buffer_load_dwordx4 v27, s[20:23], s60 offen lds
    s_add_u32 m0, s61, 26624
    s_add_u32 s60, s72, 0x2d000
    buffer_load_dwordx4 v28, s[20:23], s60 offen lds
    s_add_u32 m0, s61, 27648
    s_add_u32 s60, s72, 0x2d000
    buffer_load_dwordx4 v29, s[20:23], s60 offen lds
    s_add_u32 m0, s61, 28672
    s_add_u32 s60, s72, 0x2d000
    buffer_load_dwordx4 v30, s[20:23], s60 offen lds
    v_add_u32 v11, 0xc000, v15
    s_add_u32 s60, s69, 0
    v_xad_u32 v8, s60, v16, v11
    ds_read_b64_tr_b16 a[200:201], v8 offset:0
    s_add_u32 s60, s69, 32
    v_xad_u32 v9, s60, v16, v11
    ds_read_b64_tr_b16 a[224:225], v9 offset:0
    s_add_u32 s60, s69, 64
    v_xad_u32 v8, s60, v16, v11
    ds_read_b64_tr_b16 a[248:249], v8 offset:0
    s_add_u32 s60, s69, 96
    v_xad_u32 v9, s60, v16, v11
    ds_read_b64_tr_b16 v[128:129], v9 offset:0
    s_add_u32 s60, s69, 128
    v_xad_u32 v8, s60, v16, v11
    ds_read_b64_tr_b16 v[152:153], v8 offset:0
    s_add_u32 s60, s69, 160
    v_xad_u32 v9, s60, v16, v11
    ds_read_b64_tr_b16 v[176:177], v9 offset:0
    s_add_u32 s60, s69, 192
    v_xad_u32 v8, s60, v16, v11
    ds_read_b64_tr_b16 v[104:105], v8 offset:0
    s_add_u32 s60, s69, 224
    v_xad_u32 v9, s60, v16, v11
    ds_read_b64_tr_b16 v[208:209], v9 offset:0
    s_add_u32 s60, s69, 256
    v_xad_u32 v8, s60, v16, v11
    ds_read_b64_tr_b16 v[232:233], v8 offset:0
    s_add_u32 s60, s69, 288
    v_xad_u32 v9, s60, v16, v11
    ds_read_b64_tr_b16 v[112:113], v9 offset:0
    s_waitcnt lgkmcnt(0)
    s_waitcnt vmcnt(20)
    s_barrier
    s_add_u32 m0, s61, 49152
    s_add_u32 s60, s72, 0x32000
    buffer_load_dwordx4 v26, s[20:23], s60 offen lds
    s_add_u32 m0, s61, 50176
    s_add_u32 s60, s72, 0x32000
    buffer_load_dwordx4 v27, s[20:23], s60 offen lds
    s_add_u32 m0, s61, 51200
    s_add_u32 s60, s72, 0x32000
    buffer_load_dwordx4 v28, s[20:23], s60 offen lds
    s_add_u32 m0, s61, 52224
    s_add_u32 s60, s72, 0x32000
    buffer_load_dwordx4 v29, s[20:23], s60 offen lds
    s_add_u32 m0, s61, 53248
    s_add_u32 s60, s72, 0x32000
    buffer_load_dwordx4 v30, s[20:23], s60 offen lds
    v_add_u32 v11, 0x12000, v15
    s_add_u32 s60, s69, 0
    v_xad_u32 v8, s60, v16, v11
    ds_read_b64_tr_b16 a[202:203], v8 offset:0
    s_add_u32 s60, s69, 32
    v_xad_u32 v9, s60, v16, v11
    ds_read_b64_tr_b16 a[226:227], v9 offset:0
    s_add_u32 s60, s69, 64
    v_xad_u32 v8, s60, v16, v11
    ds_read_b64_tr_b16 a[250:251], v8 offset:0
    s_add_u32 s60, s69, 96
    v_xad_u32 v9, s60, v16, v11
    ds_read_b64_tr_b16 v[130:131], v9 offset:0
    s_add_u32 s60, s69, 128
    v_xad_u32 v8, s60, v16, v11
    ds_read_b64_tr_b16 v[154:155], v8 offset:0
    s_add_u32 s60, s69, 160
    v_xad_u32 v9, s60, v16, v11
    ds_read_b64_tr_b16 v[178:179], v9 offset:0
    s_add_u32 s60, s69, 192
    v_xad_u32 v8, s60, v16, v11
    ds_read_b64_tr_b16 v[106:107], v8 offset:0
    s_add_u32 s60, s69, 224
    v_xad_u32 v9, s60, v16, v11
    ds_read_b64_tr_b16 v[210:211], v9 offset:0
    s_add_u32 s60, s69, 256
    v_xad_u32 v8, s60, v16, v11
    ds_read_b64_tr_b16 v[234:235], v8 offset:0
    s_add_u32 s60, s69, 288
    v_xad_u32 v9, s60, v16, v11
    ds_read_b64_tr_b16 v[114:115], v9 offset:0
    s_waitcnt lgkmcnt(0)
    s_waitcnt vmcnt(20)
    s_barrier
    s_add_u32 m0, s61, 73728
    s_add_u32 s60, s72, 0x37000
    buffer_load_dwordx4 v26, s[20:23], s60 offen lds
    s_add_u32 m0, s61, 74752
    s_add_u32 s60, s72, 0x37000
    buffer_load_dwordx4 v27, s[20:23], s60 offen lds
    s_add_u32 m0, s61, 75776
    s_add_u32 s60, s72, 0x37000
    buffer_load_dwordx4 v28, s[20:23], s60 offen lds
    s_add_u32 m0, s61, 76800
    s_add_u32 s60, s72, 0x37000
    buffer_load_dwordx4 v29, s[20:23], s60 offen lds
    s_add_u32 m0, s61, 77824
    s_add_u32 s60, s72, 0x37000
    buffer_load_dwordx4 v30, s[20:23], s60 offen lds
    v_add_u32 v11, 0x18000, v15
    s_add_u32 s60, s69, 0
    v_xad_u32 v8, s60, v16, v11
    ds_read_b64_tr_b16 a[204:205], v8 offset:0
    s_add_u32 s60, s69, 32
    v_xad_u32 v9, s60, v16, v11
    ds_read_b64_tr_b16 a[228:229], v9 offset:0
    s_add_u32 s60, s69, 64
    v_xad_u32 v8, s60, v16, v11
    ds_read_b64_tr_b16 a[252:253], v8 offset:0
    s_add_u32 s60, s69, 96
    v_xad_u32 v9, s60, v16, v11
    ds_read_b64_tr_b16 v[132:133], v9 offset:0
    s_add_u32 s60, s69, 128
    v_xad_u32 v8, s60, v16, v11
    ds_read_b64_tr_b16 v[156:157], v8 offset:0
    s_add_u32 s60, s69, 160
    v_xad_u32 v9, s60, v16, v11
    ds_read_b64_tr_b16 v[180:181], v9 offset:0
    s_add_u32 s60, s69, 192
    v_xad_u32 v8, s60, v16, v11
    ds_read_b64_tr_b16 v[108:109], v8 offset:0
    s_add_u32 s60, s69, 224
    v_xad_u32 v9, s60, v16, v11
    ds_read_b64_tr_b16 v[212:213], v9 offset:0
    s_add_u32 s60, s69, 256
    v_xad_u32 v8, s60, v16, v11
    ds_read_b64_tr_b16 v[236:237], v8 offset:0
    s_add_u32 s60, s69, 288
    v_xad_u32 v9, s60, v16, v11
    ds_read_b64_tr_b16 v[116:117], v9 offset:0
    s_waitcnt lgkmcnt(0)
    s_waitcnt vmcnt(20)
    s_barrier
    v_add_u32 v11, 0x1e000, v15
    s_add_u32 s60, s69, 0
    v_xad_u32 v8, s60, v16, v11
    ds_read_b64_tr_b16 a[206:207], v8 offset:0
    s_add_u32 s60, s69, 32
    v_xad_u32 v9, s60, v16, v11
    ds_read_b64_tr_b16 a[230:231], v9 offset:0
    s_add_u32 s60, s69, 64
    v_xad_u32 v8, s60, v16, v11
    ds_read_b64_tr_b16 a[254:255], v8 offset:0
    s_add_u32 s60, s69, 96
    v_xad_u32 v9, s60, v16, v11
    ds_read_b64_tr_b16 v[134:135], v9 offset:0
    s_add_u32 s60, s69, 128
    v_xad_u32 v8, s60, v16, v11
    ds_read_b64_tr_b16 v[158:159], v8 offset:0
    s_add_u32 s60, s69, 160
    v_xad_u32 v9, s60, v16, v11
    ds_read_b64_tr_b16 v[182:183], v9 offset:0
    s_add_u32 s60, s69, 192
    v_xad_u32 v8, s60, v16, v11
    ds_read_b64_tr_b16 v[110:111], v8 offset:0
    s_add_u32 s60, s69, 224
    v_xad_u32 v9, s60, v16, v11
    ds_read_b64_tr_b16 v[214:215], v9 offset:0
    s_add_u32 s60, s69, 256
    v_xad_u32 v8, s60, v16, v11
    ds_read_b64_tr_b16 v[238:239], v8 offset:0
    s_add_u32 s60, s69, 288
    v_xad_u32 v9, s60, v16, v11
    ds_read_b64_tr_b16 v[118:119], v9 offset:0
    s_waitcnt lgkmcnt(0)
    s_waitcnt vmcnt(15)
    s_barrier
    v_add_u32 v11, 0x0, v15
    s_add_u32 s60, s69, 0
    v_xad_u32 v8, s60, v16, v11
    ds_read_b64_tr_b16 a[208:209], v8 offset:0
    s_add_u32 s60, s69, 32
    v_xad_u32 v9, s60, v16, v11
    ds_read_b64_tr_b16 a[232:233], v9 offset:0
    s_add_u32 s60, s69, 64
    v_xad_u32 v8, s60, v16, v11
    ds_read_b64_tr_b16 v[80:81], v8 offset:0
    s_add_u32 s60, s69, 96
    v_xad_u32 v9, s60, v16, v11
    ds_read_b64_tr_b16 v[136:137], v9 offset:0
    s_add_u32 s60, s69, 128
    v_xad_u32 v8, s60, v16, v11
    ds_read_b64_tr_b16 v[160:161], v8 offset:0
    s_add_u32 s60, s69, 160
    v_xad_u32 v9, s60, v16, v11
    ds_read_b64_tr_b16 v[184:185], v9 offset:0
    s_add_u32 s60, s69, 192
    v_xad_u32 v8, s60, v16, v11
    ds_read_b64_tr_b16 v[192:193], v8 offset:0
    s_add_u32 s60, s69, 224
    v_xad_u32 v9, s60, v16, v11
    ds_read_b64_tr_b16 v[216:217], v9 offset:0
    s_add_u32 s60, s69, 256
    v_xad_u32 v8, s60, v16, v11
    ds_read_b64_tr_b16 v[240:241], v8 offset:0
    s_add_u32 s60, s69, 288
    v_xad_u32 v9, s60, v16, v11
    ds_read_b64_tr_b16 v[120:121], v9 offset:0
    s_waitcnt lgkmcnt(0)
    s_waitcnt vmcnt(10)
    s_barrier
    v_add_u32 v11, 0x6000, v15
    s_add_u32 s60, s69, 0
    v_xad_u32 v8, s60, v16, v11
    ds_read_b64_tr_b16 a[210:211], v8 offset:0
    s_add_u32 s60, s69, 32
    v_xad_u32 v9, s60, v16, v11
    ds_read_b64_tr_b16 a[234:235], v9 offset:0
    s_add_u32 s60, s69, 64
    v_xad_u32 v8, s60, v16, v11
    ds_read_b64_tr_b16 v[82:83], v8 offset:0
    s_add_u32 s60, s69, 96
    v_xad_u32 v9, s60, v16, v11
    ds_read_b64_tr_b16 v[138:139], v9 offset:0
    s_add_u32 s60, s69, 128
    v_xad_u32 v8, s60, v16, v11
    ds_read_b64_tr_b16 v[162:163], v8 offset:0
    s_add_u32 s60, s69, 160
    v_xad_u32 v9, s60, v16, v11
    ds_read_b64_tr_b16 v[186:187], v9 offset:0
    s_add_u32 s60, s69, 192
    v_xad_u32 v8, s60, v16, v11
    ds_read_b64_tr_b16 v[194:195], v8 offset:0
    s_add_u32 s60, s69, 224
    v_xad_u32 v9, s60, v16, v11
    ds_read_b64_tr_b16 v[218:219], v9 offset:0
    s_add_u32 s60, s69, 256
    v_xad_u32 v8, s60, v16, v11
    ds_read_b64_tr_b16 v[242:243], v8 offset:0
    s_add_u32 s60, s69, 288
    v_xad_u32 v9, s60, v16, v11
    ds_read_b64_tr_b16 v[122:123], v9 offset:0
    s_waitcnt lgkmcnt(0)
    s_waitcnt vmcnt(5)
    s_barrier
    v_add_u32 v11, 0xc000, v15
    s_add_u32 s60, s69, 0
    v_xad_u32 v8, s60, v16, v11
    ds_read_b64_tr_b16 a[212:213], v8 offset:0
    s_add_u32 s60, s69, 32
    v_xad_u32 v9, s60, v16, v11
    ds_read_b64_tr_b16 a[236:237], v9 offset:0
    s_add_u32 s60, s69, 64
    v_xad_u32 v8, s60, v16, v11
    ds_read_b64_tr_b16 v[84:85], v8 offset:0
    s_add_u32 s60, s69, 96
    v_xad_u32 v9, s60, v16, v11
    ds_read_b64_tr_b16 v[140:141], v9 offset:0
    s_add_u32 s60, s69, 128
    v_xad_u32 v8, s60, v16, v11
    ds_read_b64_tr_b16 v[164:165], v8 offset:0
    s_add_u32 s60, s69, 160
    v_xad_u32 v9, s60, v16, v11
    ds_read_b64_tr_b16 v[188:189], v9 offset:0
    s_add_u32 s60, s69, 192
    v_xad_u32 v8, s60, v16, v11
    ds_read_b64_tr_b16 v[196:197], v8 offset:0
    s_add_u32 s60, s69, 224
    v_xad_u32 v9, s60, v16, v11
    ds_read_b64_tr_b16 v[220:221], v9 offset:0
    s_add_u32 s60, s69, 256
    v_xad_u32 v8, s60, v16, v11
    ds_read_b64_tr_b16 v[244:245], v8 offset:0
    s_add_u32 s60, s69, 288
    v_xad_u32 v9, s60, v16, v11
    ds_read_b64_tr_b16 v[124:125], v9 offset:0
    s_waitcnt lgkmcnt(0)
    s_waitcnt vmcnt(0)
    s_barrier
    v_add_u32 v11, 0x12000, v15
    s_add_u32 s60, s69, 0
    v_xad_u32 v8, s60, v16, v11
    ds_read_b64_tr_b16 a[214:215], v8 offset:0
    s_add_u32 s60, s69, 32
    v_xad_u32 v9, s60, v16, v11
    ds_read_b64_tr_b16 a[238:239], v9 offset:0
    s_add_u32 s60, s69, 64
    v_xad_u32 v8, s60, v16, v11
    ds_read_b64_tr_b16 v[86:87], v8 offset:0
    s_add_u32 s60, s69, 96
    v_xad_u32 v9, s60, v16, v11
    ds_read_b64_tr_b16 v[142:143], v9 offset:0
    s_add_u32 s60, s69, 128
    v_xad_u32 v8, s60, v16, v11
    ds_read_b64_tr_b16 v[166:167], v8 offset:0
    s_add_u32 s60, s69, 160
    v_xad_u32 v9, s60, v16, v11
    ds_read_b64_tr_b16 v[190:191], v9 offset:0
    s_add_u32 s60, s69, 192
    v_xad_u32 v8, s60, v16, v11
    ds_read_b64_tr_b16 v[198:199], v8 offset:0
    s_add_u32 s60, s69, 224
    v_xad_u32 v9, s60, v16, v11
    ds_read_b64_tr_b16 v[222:223], v9 offset:0
    s_add_u32 s60, s69, 256
    v_xad_u32 v8, s60, v16, v11
    ds_read_b64_tr_b16 v[246:247], v8 offset:0
    s_add_u32 s60, s69, 288
    v_xad_u32 v9, s60, v16, v11
    ds_read_b64_tr_b16 v[126:127], v9 offset:0
    s_waitcnt lgkmcnt(0)
    s_barrier
    v_lshrrev_b32 v28, 4, v1
    v_bfe_u32 v29, v1, 2, 2
    v_and_b32 v30, 3, v1
    s_mul_i32 s28, s3, 24576
    s_add_u32 s28, s28, 40960
    v_add_u32 v12, s28, v2
    ds_write_b128 v12, v[32:35] offset:0
    ds_write_b128 v12, v[36:39] offset:1024
    ds_write_b128 v12, v[40:43] offset:2048
    ds_write_b128 v12, v[44:47] offset:3072
    ds_write_b128 v12, v[48:51] offset:4096
    ds_write_b128 v12, v[52:55] offset:5120
    ds_write_b128 v12, v[56:59] offset:6144
    ds_write_b128 v12, v[60:63] offset:7168
    ds_write_b128 v12, v[64:67] offset:8192
    ds_write_b128 v12, v[68:71] offset:9216
    ds_write_b128 v12, v[72:75] offset:10240
    ds_write_b128 v12, v[76:79] offset:11264
    ds_write_b128 v12, v[80:83] offset:12288
    ds_write_b128 v12, v[84:87] offset:13312
    ds_write_b128 v12, v[88:91] offset:14336
    ds_write_b128 v12, v[92:95] offset:15360
    ds_write_b128 v12, v[96:99] offset:16384
    ds_write_b128 v12, v[100:103] offset:17408
    ds_write_b128 v12, v[104:107] offset:18432
    ds_write_b128 v12, v[108:111] offset:19456
    ds_write_b128 v12, v[112:115] offset:20480
    ds_write_b128 v12, v[116:119] offset:21504
    ds_write_b128 v12, v[120:123] offset:22528
    ds_write_b128 v12, v[124:127] offset:23552
    s_waitcnt lgkmcnt(0)
    v_and_b32 v4, 2, v1
    v_cmp_eq_u32 vcc, 0, v4
    v_mov_b32 v11, 0xeeee
    v_mov_b32 v4, 0x4444
    v_cndmask_b32 v11, v11, v4, vcc
    s_mul_i32 s28, s3, 2560
    v_add_u32 v9, s28, v2
    v_lshlrev_b32 v4, 3, v1
    v_add_u32 v10, s28, v4
    v_add_u32 v6, 20480, v9
    v_add_u32 v7, 21504, v9
    v_add_u32 v8, 22528, v10
    v_lshrrev_b32 v4, 13, v6
    v_mul_u32_u24 v4, 8192, v4
    v_add_u32 v6, v4, v6
    v_lshrrev_b32 v4, 13, v7
    v_mul_u32_u24 v4, 8192, v4
    v_add_u32 v7, v4, v7
    v_lshrrev_b32 v4, 13, v8
    v_mul_u32_u24 v4, 8192, v4
    v_add_u32 v8, v4, v8
    v_lshlrev_b32 v13, 6, v29
    v_and_b32 v4, 1, v1
    v_lshl_add_u32 v13, v4, 5, v13
    v_lshl_add_u32 v13, v28, 3, v13
    v_and_b32 v4, 2, v1
    v_lshl_add_u32 v13, v4, 1, v13
    s_mul_i32 s28, s3, 768
    s_add_u32 s28, s28, 10240
    v_add_u32 v13, s28, v13
    v_lshrrev_b32 v14, 1, v28
    v_lshlrev_b32 v14, 9, v14
    v_and_b32 v4, 1, v28
    v_lshl_add_u32 v14, v4, 7, v14
    v_lshrrev_b32 v4, 1, v29
    v_lshl_add_u32 v14, v4, 8, v14
    v_and_b32 v4, 1, v29
    v_lshl_add_u32 v14, v4, 5, v14
    v_lshl_add_u32 v14, v30, 3, v14
    v_add_u32 v14, 10240, v14
    v_and_b32 v15, 15, v1
    v_lshlrev_b32 v15, 4, v15
    v_lshrrev_b32 v4, 1, v28
    v_lshl_add_u32 v15, v4, 3, v15
    v_and_b32 v4, 1, v28
    v_lshl_add_u32 v15, v4, 14, v15
    v_mov_b32 v3, 0
    s_mov_b32 s29, 128
    s_mov_b32 s27, 0x100000
Lp_143:
    buffer_load_dword v4, v3, s[16:19], s29 offen sc1
    s_waitcnt vmcnt(0)
    v_cmp_gt_u32 vcc, 1, v4
    s_nop 0
    s_cbranch_vccz Ld_144
    s_sub_u32 s27, s27, 1
    s_cbranch_scc1 L_abort
    s_sleep 6
    s_branch Lp_143
Ld_144:
    v_readfirstlane_b32 s26, v4
    s_nop 0
    s_and_b32 s26, s26, 0xffff
    s_cmp_gt_u32 s26, 512
    s_cselect_b32 s26, 8192, 0
    v_mov_b32 v4, 0x40000000
    s_cmp_eq_u32 s3, 1
    s_cselect_b64 vcc, 1, 0
    v_cndmask_b32 v0, v4, v3, vcc
    s_lshl_b32 s66, s24, 7
    s_add_u32 s66, s66, s26
    s_add_u32 s66, s66, 0x141000
    s_mov_b32 s53, 32
    s_and_b32 s69, s2, 3
    s_lshl_b32 s69, s69, 11
    s_lshr_b32 s28, s2, 3
    s_lshl_b32 s28, s28, 2
    s_add_u32 s28, s28, s3
    s_and_b32 s28, s28, 7
    s_lshl_b32 s28, s28, 7
    s_add_u32 s69, s69, s28
    s_add_u32 s69, s69, 0x144000
    s_mul_i32 s68, s3, 163840
    s_add_u32 s68, s68, s26
    s_lshl_b32 s28, s24, 8
    s_add_u32 s68, s68, s28
    s_add_u32 s68, s68, 0x0
    s_mov_b32 s25, 0
L_loop_VO:
    ds_read_b128 v[72:75], v12 offset:0
    ds_read_b128 v[76:79], v12 offset:1024
    ds_read_b128 v[80:83], v12 offset:2048
    ds_read_b128 v[84:87], v12 offset:3072
    v_pk_mov_b32 v[88:89], 0, 0
    v_pk_mov_b32 v[90:91], 0, 0
    v_pk_mov_b32 v[92:93], 0, 0
    v_pk_mov_b32 v[94:95], 0, 0
    v_pk_mov_b32 v[96:97], 0, 0
    v_pk_mov_b32 v[98:99], 0, 0
    v_pk_mov_b32 v[100:101], 0, 0
    v_pk_mov_b32 v[102:103], 0, 0
    v_pk_mov_b32 v[104:105], 0, 0
    v_pk_mov_b32 v[106:107], 0, 0
    v_pk_mov_b32 v[108:109], 0, 0
    v_pk_mov_b32 v[110:111], 0, 0
    v_pk_mov_b32 v[112:113], 0, 0
    v_pk_mov_b32 v[114:115], 0, 0
    v_pk_mov_b32 v[116:117], 0, 0
    v_pk_mov_b32 v[118:119], 0, 0
    v_pk_mov_b32 v[120:121], 0, 0
    v_pk_mov_b32 v[122:123], 0, 0
    v_pk_mov_b32 v[124:125], 0, 0
    v_pk_mov_b32 v[126:127], 0, 0
    v_pk_mov_b32 v[16:17], 0, 0
    v_pk_mov_b32 v[18:19], 0, 0
    v_pk_mov_b32 v[20:21], 0, 0
    v_pk_mov_b32 v[22:23], 0, 0
    v_pk_mov_b32 v[24:25], 0, 0
    v_pk_mov_b32 v[26:27], 0, 0
    s_and_b32 s64, s25, 3
    s_lshl_b32 s64, s64, 16
    s_add_u32 s64, s64, s26
    s_add_u32 s64, s64, 0x180000
    s_add_u32 s67, s25, 1
    v_mov_b32 v5, s67
    s_and_b32 s65, s25, 1
    s_mul_i32 s65, s65, 655360
    s_add_u32 s65, s65, s68
    s_add_u32 s32, s65, 0
    s_add_u32 s33, s65, 32768
    s_add_u32 s34, s65, 65536
    s_add_u32 s35, s65, 98304
    s_add_u32 s36, s65, 131072
    v_lshlrev_b32 v43, 2, v1
    s_mov_b64 exec, 0x3ff
    s_cmp_lt_u32 s25, 6
    s_cselect_b32 s27, 128, 24
    buffer_load_dword v44, v43, s[4:7], s69 offen sc1
    s_nop 15
    buffer_load_dword v45, v43, s[4:7], s69 offen sc1
    s_nop 15
    buffer_load_dword v46, v43, s[4:7], s69 offen sc1
    s_nop 15
Lp_147:
    buffer_load_dword v47, v43, s[4:7], s69 offen sc1
    s_waitcnt vmcnt(3)
    v_cmp_gt_u32 vcc, s25, v44
    s_cbranch_vccz Ld_148
    buffer_load_dword v44, v43, s[4:7], s69 offen sc1
    s_waitcnt vmcnt(3)
    v_cmp_gt_u32 vcc, s25, v45
    s_cbranch_vccz Ld_148
    buffer_load_dword v45, v43, s[4:7], s69 offen sc1
    s_waitcnt vmcnt(3)
    v_cmp_gt_u32 vcc, s25, v46
    s_cbranch_vccz Ld_148
    buffer_load_dword v46, v43, s[4:7], s69 offen sc1
    s_waitcnt vmcnt(3)
    v_cmp_gt_u32 vcc, s25, v47
    s_cbranch_vccz Ld_148
    s_sub_u32 s27, s27, 1
    s_cbranch_scc0 Lp_147
Ld_148:
    s_mov_b32 s27, 0x100000
    s_nop 15
    s_nop 3
    s_mov_b64 exec, -1
Lm_145:
    buffer_load_dwordx4 v[32:35], v6, s[4:7], s64 offen sc1
    buffer_load_dwordx4 v[36:39], v7, s[4:7], s64 offen sc1
    buffer_load_dwordx2 v[40:41], v8, s[4:7], s64 offen sc1
    s_sub_u32 s27, s27, 1
    s_cbranch_scc1 L_abort
    s_waitcnt vmcnt(2)
    ds_write_b128 v9, v[32:35]
    s_waitcnt vmcnt(1)
    ds_write_b128 v9, v[36:39] offset:1024
    s_waitcnt vmcnt(0)
    ds_write_b64 v10, v[40:41] offset:2048
    v_max3_u32 v4, v32, v33, v34
    v_max3_u32 v4, v4, v35, v36
    v_max3_u32 v4, v4, v37, v38
    v_max3_u32 v4, v4, v39, v40
    v_max_u32 v4, v4, v41
    v_cmp_eq_u32 vcc, -1, v4
    s_waitcnt lgkmcnt(0)
    s_cbranch_vccnz Lm_145f
    s_barrier
    ds_read_b128 v[32:35], v2 offset:0
    ds_read_b128 v[36:39], v2 offset:1024
    s_waitcnt lgkmcnt(1)
    v_smfmac_f32_16x16x64_bf16 v[16:19], v[32:35], a[0:7], v11
    ds_read_b128 v[40:43], v2 offset:2048
    v_smfmac_f32_16x16x64_bf16 v[20:23], v[32:35], a[8:15], v11
    ds_read_b128 v[44:47], v2 offset:3072
    s_waitcnt lgkmcnt(2)
    v_smfmac_f32_16x16x64_bf16 v[16:19], v[36:39], a[16:23], v11
    ds_read_b128 v[48:51], v2 offset:4096
    v_smfmac_f32_16x16x64_bf16 v[20:23], v[36:39], a[24:31], v11
    ds_read_b128 v[52:55], v2 offset:5120
    s_waitcnt lgkmcnt(3)
    v_smfmac_f32_16x16x64_bf16 v[16:19], v[40:43], a[32:39], v11
    ds_read_b128 v[56:59], v2 offset:6144
    v_smfmac_f32_16x16x64_bf16 v[20:23], v[40:43], a[40:47], v11
    ds_read_b128 v[60:63], v2 offset:7168
    s_waitcnt lgkmcnt(4)
    v_smfmac_f32_16x16x64_bf16 v[16:19], v[44:47], a[48:55], v11
    ds_read_b128 v[64:67], v2 offset:8192
    v_smfmac_f32_16x16x64_bf16 v[20:23], v[44:47], a[56:63], v11
    ds_read_b128 v[68:71], v2 offset:9216
    s_waitcnt lgkmcnt(5)
    v_smfmac_f32_16x16x64_bf16 v[16:19], v[48:51], v[72:79], v11
    v_smfmac_f32_16x16x64_bf16 v[20:23], v[48:51], v[80:87], v11
    s_waitcnt lgkmcnt(4)
    v_smfmac_f32_16x16x64_bf16 v[16:19], v[52:55], a[64:71], v11
    ds_read_b128 v[72:75], v12 offset:4096
    v_smfmac_f32_16x16x64_bf16 v[20:23], v[52:55], a[72:79], v11
    ds_read_b128 v[76:79], v12 offset:5120
    s_waitcnt lgkmcnt(5)
    v_smfmac_f32_16x16x64_bf16 v[16:19], v[56:59], a[80:87], v11
    ds_read_b128 v[80:83], v12 offset:6144
    v_smfmac_f32_16x16x64_bf16 v[20:23], v[56:59], a[88:95], v11
    ds_read_b128 v[84:87], v12 offset:7168
    s_waitcnt lgkmcnt(6)
    v_smfmac_f32_16x16x64_bf16 v[16:19], v[60:63], a[96:103], v11
    v_smfmac_f32_16x16x64_bf16 v[20:23], v[60:63], a[104:111], v11
    s_waitcnt lgkmcnt(5)
    v_smfmac_f32_16x16x64_bf16 v[16:19], v[64:67], a[112:119], v11
    v_smfmac_f32_16x16x64_bf16 v[20:23], v[64:67], a[120:127], v11
    s_waitcnt lgkmcnt(4)
    s_waitcnt lgkmcnt(0)
    v_smfmac_f32_16x16x64_bf16 v[16:19], v[68:71], v[72:79], v11
    v_smfmac_f32_16x16x64_bf16 v[20:23], v[68:71], v[80:87], v11
    v_smfmac_f32_16x16x64_bf16 v[24:27], v[32:35], a[128:135], v11
    ds_read_b128 v[72:75], v12 offset:8192
    v_smfmac_f32_16x16x64_bf16 v[24:27], v[36:39], a[136:143], v11
    ds_read_b128 v[76:79], v12 offset:9216
    v_add_f32 v16, v16, v18
    v_smfmac_f32_16x16x64_bf16 v[24:27], v[40:43], a[144:151], v11
    ds_read_b128 v[80:83], v12 offset:10240
    v_add_f32 v17, v17, v19
    v_smfmac_f32_16x16x64_bf16 v[24:27], v[44:47], a[152:159], v11
    ds_read_b128 v[84:87], v12 offset:11264
    v_cvt_pk_bf16_f32 v16, v16, v17
    v_smfmac_f32_16x16x64_bf16 v[24:27], v[48:51], a[160:167], v11
    ds_write_b32 v13, v16 offset:0
    v_add_f32 v20, v20, v22
    v_smfmac_f32_16x16x64_bf16 v[24:27], v[52:55], a[168:175], v11
    v_add_f32 v21, v21, v23
    v_smfmac_f32_16x16x64_bf16 v[24:27], v[56:59], a[176:183], v11
    v_cvt_pk_bf16_f32 v20, v20, v21
    v_smfmac_f32_16x16x64_bf16 v[24:27], v[60:63], a[184:191], v11
    s_waitcnt lgkmcnt(1)
    v_smfmac_f32_16x16x64_bf16 v[24:27], v[64:67], v[72:79], v11
    ds_write_b32 v13, v20 offset:256
    v_smfmac_f32_16x16x64_bf16 v[24:27], v[68:71], v[80:87], v11
    s_nop 7
    v_add_f32 v24, v24, v26
    v_add_f32 v25, v25, v27
    v_cvt_pk_bf16_f32 v24, v24, v25
    ds_write_b32 v13, v24 offset:512
    s_waitcnt lgkmcnt(0)
    s_barrier
    ds_read_b64_tr_b16 v[16:17], v14 offset:0
    ds_read_b64_tr_b16 v[18:19], v14 offset:64
    ds_read_b64_tr_b16 v[20:21], v14 offset:1024
    ds_read_b64_tr_b16 v[22:23], v14 offset:1088
    ds_read_b64_tr_b16 v[24:25], v14 offset:2048
    ds_read_b64_tr_b16 v[26:27], v14 offset:2112
    s_waitcnt lgkmcnt(4)
    v_smfmac_f32_16x16x64_bf16 v[88:91], v[16:19], a[192:199], v11
    ds_read_b128 v[72:75], v12 offset:12288
    s_waitcnt lgkmcnt(3)
    v_smfmac_f32_16x16x64_bf16 v[88:91], v[20:23], a[200:207], v11
    ds_read_b128 v[76:79], v12 offset:13312
    s_waitcnt lgkmcnt(2)
    v_smfmac_f32_16x16x64_bf16 v[88:91], v[24:27], a[208:215], v11
    ds_read_b128 v[80:83], v12 offset:14336
    v_smfmac_f32_16x16x64_bf16 v[92:95], v[16:19], a[216:223], v11
    ds_read_b128 v[84:87], v12 offset:15360
    v_smfmac_f32_16x16x64_bf16 v[92:95], v[20:23], a[224:231], v11
    v_add_f32 v88, v88, v90
    v_smfmac_f32_16x16x64_bf16 v[92:95], v[24:27], a[232:239], v11
    v_add_f32 v89, v89, v91
    v_smfmac_f32_16x16x64_bf16 v[96:99], v[16:19], a[240:247], v11
    v_cvt_pk_bf16_f32 v88, v88, v89
    v_smfmac_f32_16x16x64_bf16 v[96:99], v[20:23], a[248:255], v11
    v_add_f32 v92, v92, v94
    v_min_u32 v88, 0xfffffffe, v88
    s_waitcnt lgkmcnt(0)
    v_smfmac_f32_16x16x64_bf16 v[96:99], v[24:27], v[72:79], v11
    v_add_f32 v93, v93, v95
    v_cvt_pk_bf16_f32 v89, v92, v93
    v_smfmac_f32_16x16x64_bf16 v[100:103], v[16:19], v[80:87], v11
    v_min_u32 v89, 0xfffffffe, v89
    v_smfmac_f32_16x16x64_bf16 v[100:103], v[20:23], v[128:135], v11
    ds_read_b128 v[72:75], v12 offset:16384
    v_add_f32 v96, v96, v98
    v_smfmac_f32_16x16x64_bf16 v[100:103], v[24:27], v[136:143], v11
    ds_read_b128 v[76:79], v12 offset:17408
    buffer_store_dword v5, v0, s[4:7], s66 offen sc1
    v_permlane16_swap_b32 v88, v89
    v_add_f32 v97, v97, v99
    v_smfmac_f32_16x16x64_bf16 v[104:107], v[16:19], v[144:151], v11
    ds_read_b128 v[80:83], v12 offset:18432
    buffer_store_dwordx2 v[88:89], v15, s[4:7], s32 offen sc1
    v_cvt_pk_bf16_f32 v96, v96, v97
    v_smfmac_f32_16x16x64_bf16 v[104:107], v[20:23], v[152:159], v11
    ds_read_b128 v[84:87], v12 offset:19456
    v_add_f32 v100, v100, v102
    v_min_u32 v96, 0xfffffffe, v96
    v_smfmac_f32_16x16x64_bf16 v[104:107], v[24:27], v[160:167], v11
    v_add_f32 v101, v101, v103
    v_cvt_pk_bf16_f32 v97, v100, v101
    v_smfmac_f32_16x16x64_bf16 v[108:111], v[16:19], v[168:175], v11
    v_min_u32 v97, 0xfffffffe, v97
    v_smfmac_f32_16x16x64_bf16 v[108:111], v[20:23], v[176:183], v11
    v_add_f32 v104, v104, v106
    v_smfmac_f32_16x16x64_bf16 v[108:111], v[24:27], v[184:191], v11
    v_permlane16_swap_b32 v96, v97
    v_add_f32 v105, v105, v107
    s_waitcnt lgkmcnt(0)
    v_smfmac_f32_16x16x64_bf16 v[112:115], v[16:19], v[72:79], v11
    buffer_store_dwordx2 v[96:97], v15, s[4:7], s33 offen sc1
    v_cvt_pk_bf16_f32 v104, v104, v105
    v_smfmac_f32_16x16x64_bf16 v[112:115], v[20:23], v[80:87], v11
    v_add_f32 v108, v108, v110
    v_min_u32 v104, 0xfffffffe, v104
    v_smfmac_f32_16x16x64_bf16 v[112:115], v[24:27], v[192:199], v11
    ds_read_b128 v[72:75], v12 offset:20480
    v_add_f32 v109, v109, v111
    v_cvt_pk_bf16_f32 v105, v108, v109
    v_smfmac_f32_16x16x64_bf16 v[116:119], v[16:19], v[200:207], v11
    ds_read_b128 v[76:79], v12 offset:21504
    v_min_u32 v105, 0xfffffffe, v105
    v_smfmac_f32_16x16x64_bf16 v[116:119], v[20:23], v[208:215], v11
    ds_read_b128 v[80:83], v12 offset:22528
    v_add_f32 v112, v112, v114
    v_smfmac_f32_16x16x64_bf16 v[116:119], v[24:27], v[216:223], v11
    ds_read_b128 v[84:87], v12 offset:23552
    v_permlane16_swap_b32 v104, v105
    v_add_f32 v113, v113, v115
    v_smfmac_f32_16x16x64_bf16 v[120:123], v[16:19], v[224:231], v11
    buffer_store_dwordx2 v[104:105], v15, s[4:7], s34 offen sc1
    v_cvt_pk_bf16_f32 v112, v112, v113
    v_smfmac_f32_16x16x64_bf16 v[120:123], v[20:23], v[232:239], v11
    v_add_f32 v116, v116, v118
    v_min_u32 v112, 0xfffffffe, v112
    v_smfmac_f32_16x16x64_bf16 v[120:123], v[24:27], v[240:247], v11
    v_add_f32 v117, v117, v119
    v_cvt_pk_bf16_f32 v113, v116, v117
    v_smfmac_f32_16x16x64_bf16 v[124:127], v[16:19], v[248:255], v11
    v_min_u32 v113, 0xfffffffe, v113
    s_waitcnt lgkmcnt(0)
    v_smfmac_f32_16x16x64_bf16 v[124:127], v[20:23], v[72:79], v11
    v_add_f32 v120, v120, v122
    v_smfmac_f32_16x16x64_bf16 v[124:127], v[24:27], v[80:87], v11
    v_permlane16_swap_b32 v112, v113
    v_add_f32 v121, v121, v123
    buffer_store_dwordx2 v[112:113], v15, s[4:7], s35 offen sc1
    v_cvt_pk_bf16_f32 v120, v120, v121
    s_nop 3
    v_add_f32 v124, v124, v126
    v_min_u32 v120, 0xfffffffe, v120
    v_add_f32 v125, v125, v127
    v_cvt_pk_bf16_f32 v121, v124, v125
    v_min_u32 v121, 0xfffffffe, v121
    s_nop 1
    v_permlane16_swap_b32 v120, v121
    buffer_store_dwordx2 v[120:121], v15, s[4:7], s36 offen sc1
    s_mov_b32 s25, s67
    s_cmp_lt_u32 s25, 64
    s_cbranch_scc1 L_loop_VO
    s_branch L_exit
Lm_145f:
    s_branch Lm_145
L_role_S2:
    v_and_b32 v4, 2, v1
    v_cmp_eq_u32 vcc, 0, v4
    v_mov_b32 v6, 0xeeee
    v_mov_b32 v4, 0x4444
    v_cndmask_b32 v6, v6, v4, vcc
    v_lshrrev_b32 v28, 4, v1
    v_lshlrev_b32 v28, 1, v28
    v_and_b32 v4, 1, v1
    v_add_u32 v28, v4, v28
    v_bfe_u32 v29, v1, 1, 3
    v_and_b32 v4, 3, v29
    v_lshlrev_b32 v4, 2, v4
    v_lshl_add_u32 v4, v28, 4, v4
    v_lshrrev_b32 v5, 2, v29
    v_lshl_add_u32 v28, v5, 7, v4
    v_and_b32 v4, 0x60, v28
    v_lshlrev_b32 v4, 1, v4
    v_and_b32 v8, 0x80, v28
    v_lshrrev_b32 v8, 2, v8
    v_or_b32 v4, v4, v8
    v_and_b32 v8, 0xffffff1f, v28
    v_or_b32 v8, v8, v4
    v_mul_u32_u24 v11, 512, v1
    v_subrev_u32 v4, 8, v1
    v_mul_u32_u24 v4, 1024, v4
    v_add_u32 v4, 4096, v4
    v_cmp_gt_u32 vcc, 8, v1
    s_nop 1
    v_cndmask_b32 v11, v4, v11, vcc
    v_add_u32 v7, 65536, v2
    s_and_b32 s28, s2, 3
    s_lshl_b32 s71, s28, 11
    v_lshlrev_b32 v10, 7, v1
    v_mov_b32 v9, 0x40000000
    v_cmp_gt_u32 vcc, 8, v1
    s_nop 1
    v_cndmask_b32 v10, v9, v10, vcc
    s_mul_i32 s28, s28, 10
    s_sub_u32 s28, s24, s28
    s_lshl_b32 s28, s28, 2
    s_add_u32 s71, s71, s28
    s_add_u32 s71, s71, 0x144000
    v_cmp_gt_u32 vcc, 32, v1
    v_lshlrev_b32 v12, 7, v1
    s_nop 0
    v_cndmask_b32 v12, 0, v12, vcc
    v_mov_b32 v20, -1
    v_mov_b32 v21, -1
    v_mov_b32 v22, -1
    v_mov_b32 v23, -1
    s_mov_b32 s74, 0x55555555
    s_mov_b32 s75, 0x55555555
    s_mov_b32 s76, 0xaaaaaaaa
    s_mov_b32 s77, 0xaaaaaaaa
    s_mov_b32 s68, 0x603000
    s_mul_i32 s67, s24, 40960
    s_add_u32 s67, s67, 0x8000000
    s_lshl_b32 s73, s24, 8
    s_add_u32 s73, s73, 20480
    s_lshr_b32 s28, s73, 13
    s_mul_i32 s28, s28, 8192
    s_add_u32 s73, s73, s28
    v_lshrrev_b32 v15, 4, v1
    v_lshlrev_b32 v15, 8, v15
    v_and_b32 v4, 15, v1
    v_lshl_add_u32 v15, v4, 3, v15
    v_and_b32 v4, 8, v1
    v_cmp_eq_u32 vcc, 0, v4
    v_mov_b32 v14, 0xeeee
    v_mov_b32 v4, 0x4444
    v_cndmask_b32 v14, v14, v4, vcc
    v_bfe_u32 v28, v1, 4, 1
    v_lshlrev_b32 v28, 2, v28
    v_lshrrev_b32 v4, 5, v1
    v_lshl_add_u32 v28, v4, 1, v28
    v_and_b32 v4, 1, v1
    v_add_u32 v28, v4, v28
    v_bfe_u32 v29, v1, 1, 3
    v_and_b32 v4, 3, v29
    v_lshlrev_b32 v4, 2, v4
    v_lshl_add_u32 v4, v28, 4, v4
    v_lshrrev_b32 v5, 2, v29
    v_lshl_add_u32 v13, v5, 8, v4
    v_mul_u32_u24 v28, 1280, v28
    v_lshl_add_u32 v28, v29, 2, v28
    s_mul_i32 s28, s3, 10240
    s_lshl_b32 s29, s24, 5
    s_add_u32 s28, s28, s29
    s_add_u32 s29, s28, 2539520
    buffer_load_dword v26, v28, s[12:15], s29 offen
    s_add_u32 s29, s28, 2580480
    buffer_load_dword v27, v28, s[12:15], s29 offen
    v_pk_mov_b32 v[176:177], 0, 0
    v_pk_mov_b32 v[178:179], 0, 0
    v_pk_mov_b32 v[180:181], 0, 0
    v_pk_mov_b32 v[182:183], 0, 0
    v_pk_mov_b32 v[184:185], 0, 0
    v_pk_mov_b32 v[186:187], 0, 0
    v_pk_mov_b32 v[188:189], 0, 0
    v_pk_mov_b32 v[190:191], 0, 0
    v_pk_mov_b32 v[192:193], 0, 0
    v_pk_mov_b32 v[194:195], 0, 0
    v_pk_mov_b32 v[196:197], 0, 0
    v_pk_mov_b32 v[198:199], 0, 0
    v_pk_mov_b32 v[200:201], 0, 0
    v_pk_mov_b32 v[202:203], 0, 0
    v_pk_mov_b32 v[204:205], 0, 0
    v_pk_mov_b32 v[206:207], 0, 0
    v_pk_mov_b32 v[208:209], 0, 0
    v_pk_mov_b32 v[210:211], 0, 0
    v_pk_mov_b32 v[212:213], 0, 0
    v_pk_mov_b32 v[214:215], 0, 0
    v_pk_mov_b32 v[216:217], 0, 0
    v_pk_mov_b32 v[218:219], 0, 0
    v_pk_mov_b32 v[220:221], 0, 0
    v_pk_mov_b32 v[222:223], 0, 0
    v_pk_mov_b32 v[224:225], 0, 0
    v_pk_mov_b32 v[226:227], 0, 0
    v_pk_mov_b32 v[228:229], 0, 0
    v_pk_mov_b32 v[230:231], 0, 0
    v_pk_mov_b32 v[232:233], 0, 0
    v_pk_mov_b32 v[234:235], 0, 0
    v_pk_mov_b32 v[236:237], 0, 0
    v_pk_mov_b32 v[238:239], 0, 0
    v_pk_mov_b32 v[240:241], 0, 0
    v_pk_mov_b32 v[242:243], 0, 0
    v_pk_mov_b32 v[244:245], 0, 0
    v_pk_mov_b32 v[246:247], 0, 0
    v_pk_mov_b32 v[248:249], 0, 0
    v_pk_mov_b32 v[250:251], 0, 0
    v_pk_mov_b32 v[252:253], 0, 0
    v_pk_mov_b32 v[254:255], 0, 0
    v_bfe_u32 v4, v1, 3, 1
    v_bfe_u32 v5, v1, 4, 1
    v_lshl_add_u32 v4, v4, 1, v5
    v_cmp_ge_u32 s[32:33], s3, v4
    s_lshr_b32 s28, s3, 1
    s_mul_i32 s34, s28, 20480
    s_lshl_b32 s28, s24, 9
    s_add_u32 s34, s34, s28
    s_and_b32 s28, s3, 1
    s_lshl_b32 s28, s28, 7
    s_add_u32 s34, s34, s28
    s_add_u32 s34, s34, 0xf6c000
    s_mul_i32 s35, s3, 20480
    s_add_u32 s35, s35, 0xbd8000
    v_mov_b32 v4, 0x40000000
    s_cmp_eq_u32 s3, 3
    s_cselect_b64 vcc, 1, 0
    v_cndmask_b32 v0, v4, 0, vcc
    v_mov_b32 v3, 0
    s_mov_b32 s29, 128
    s_mov_b32 s27, 0x100000
Lp_149:
    buffer_load_dword v4, v3, s[16:19], s29 offen sc1
    s_waitcnt vmcnt(0)
    v_cmp_gt_u32 vcc, 1, v4
    s_nop 0
    s_cbranch_vccz Ld_150
    s_sub_u32 s27, s27, 1
    s_cbranch_scc1 L_abort
    s_sleep 6
    s_branch Lp_149
Ld_150:
    v_readfirstlane_b32 s26, v4
    s_nop 0
    s_and_b32 s26, s26, 0xffff
    s_cmp_gt_u32 s26, 512
    s_cselect_b32 s26, 8192, 0
    s_lshl_b32 s36, s24, 7
    s_add_u32 s36, s36, s26
    s_add_u32 s36, s36, 0x150000
    s_lshl_b32 s69, s24, 7
    s_add_u32 s69, s69, s26
    s_add_u32 s69, s69, 0x14c000
    s_add_u32 s65, s26, 0x140000
    s_lshl_b32 s64, s24, 14
    s_add_u32 s64, s64, s26
    s_add_u32 s64, s64, 0x0
    s_mov_b32 s25, 0
    s_lshl_b32 s37, s24, 8
    s_add_u32 s37, s37, 0x500000
    s_cmp_ge_u32 s3, 2
    s_cbranch_scc1 L_S2_dma0
    s_barrier
    s_cmp_eq_u32 s3, 1
    s_cbranch_scc1 L_S2_st
    v_lshlrev_b32 v64, 7, v1
    s_mov_b32 s27, 0x100000
Lp_151:
    buffer_load_dword v4, v64, s[4:7], s65 offen sc1
    s_waitcnt vmcnt(0)
    v_cmp_gt_u32 vcc, 1, v4
    s_nop 0
    s_cbranch_vccz Ld_152
    s_sub_u32 s27, s27, 1
    s_cbranch_scc1 L_abort
    s_sleep 1
    s_branch Lp_151
Ld_152:
L_loop_S2:
    s_and_b32 s28, s25, 1
    s_lshl_b32 s28, s28, 15
    v_add_u32 v4, s28, v2
    ds_read_b128 a[0:3], v4 offset:0
    ds_read_b128 a[4:7], v4 offset:1024
    ds_read_b128 a[8:11], v4 offset:2048
    ds_read_b128 a[12:15], v4 offset:3072
    ds_read_b128 a[16:19], v4 offset:4096
    ds_read_b128 a[20:23], v4 offset:5120
    ds_read_b128 a[24:27], v4 offset:6144
    ds_read_b128 a[28:31], v4 offset:7168
    ds_read_b128 a[32:35], v4 offset:8192
    ds_read_b128 a[36:39], v4 offset:9216
    ds_read_b128 a[40:43], v4 offset:10240
    ds_read_b128 a[44:47], v4 offset:11264
    ds_read_b128 a[48:51], v4 offset:12288
    ds_read_b128 a[52:55], v4 offset:13312
    ds_read_b128 a[56:59], v4 offset:14336
    ds_read_b128 a[60:63], v4 offset:15360
    ds_read_b128 a[64:67], v4 offset:16384
    ds_read_b128 a[68:71], v4 offset:17408
    ds_read_b128 a[72:75], v4 offset:18432
    ds_read_b128 a[76:79], v4 offset:19456
    ds_read_b128 a[80:83], v4 offset:20480
    ds_read_b128 a[84:87], v4 offset:21504
    ds_read_b128 a[88:91], v4 offset:22528
    ds_read_b128 a[92:95], v4 offset:23552
    ds_read_b128 a[96:99], v4 offset:24576
    ds_read_b128 a[100:103], v4 offset:25600
    ds_read_b128 a[104:107], v4 offset:26624
    ds_read_b128 a[108:111], v4 offset:27648
    ds_read_b128 a[112:115], v4 offset:28672
    ds_read_b128 a[116:119], v4 offset:29696
    ds_read_b128 a[120:123], v4 offset:30720
    ds_read_b128 a[124:127], v4 offset:31744
    s_add_u32 s66, s25, 1
    s_and_b32 s62, s25, 3
    s_lshl_b32 s62, s62, 16
    s_add_u32 s62, s62, s26
    s_add_u32 s62, s62, 0x180000
    s_and_b32 s63, s25, 1
    s_mul_i32 s63, s63, 655360
    s_add_u32 s63, s63, s64
    s_add_u32 s30, s63, 4096
    s_add_u32 s37, s37, 10240
    s_and_b32 s31, s66, 3
    s_lshl_b32 s31, s31, 16
    s_add_u32 s31, s31, s26
    s_add_u32 s31, s31, 0x180000
    s_add_u32 s31, s31, s73
    s_waitcnt lgkmcnt(0)
    v_mov_b32 v9, s66
    s_mov_b32 exec_lo, 0xfff
    s_mov_b32 exec_hi, 0x0
    s_mov_b32 s72, 3
    s_mov_b32 s27, 0x40000
    buffer_load_dword v136, v11, s[4:7], s65 offen sc1
    s_nop 13
    buffer_load_dword v137, v11, s[4:7], s65 offen sc1
    s_nop 13
    buffer_load_dword v138, v11, s[4:7], s65 offen sc1
    s_nop 13
Lp_153:
    buffer_load_dword v139, v11, s[4:7], s65 offen sc1
    s_waitcnt vmcnt(3)
    v_cmp_gt_u32 vcc, s66, v136
    s_cbranch_vccz Ld_154
    buffer_load_dword v136, v11, s[4:7], s65 offen sc1
    s_waitcnt vmcnt(3)
    v_cmp_gt_u32 vcc, s66, v137
    s_cbranch_vccz Ld_154
    buffer_load_dword v137, v11, s[4:7], s65 offen sc1
    s_waitcnt vmcnt(3)
    v_cmp_gt_u32 vcc, s66, v138
    s_cbranch_vccz Ld_154
    buffer_load_dword v138, v11, s[4:7], s65 offen sc1
    s_waitcnt vmcnt(3)
    v_cmp_gt_u32 vcc, s66, v139
    s_cbranch_vccz Ld_154
    s_sub_u32 s27, s27, 1
    s_cbranch_scc1 L_abort
    s_branch Lp_153
Ld_154:
    s_mov_b64 exec, -1
    buffer_load_dwordx4 v[32:35], v2, s[4:7], s63 offen offset:0 sc1
    buffer_load_dwordx4 v[36:39], v2, s[4:7], s63 offen offset:1024 sc1
    buffer_load_dwordx4 v[40:43], v2, s[4:7], s63 offen offset:2048 sc1
    buffer_load_dwordx4 v[44:47], v2, s[4:7], s63 offen offset:3072 sc1
    buffer_load_dwordx4 v[48:51], v2, s[4:7], s30 offen offset:0 sc1
    buffer_load_dwordx4 v[52:55], v2, s[4:7], s30 offen offset:1024 sc1
    buffer_load_dwordx4 v[56:59], v2, s[4:7], s30 offen offset:2048 sc1
    buffer_load_dwordx4 v[60:63], v2, s[4:7], s30 offen offset:3072 sc1
    s_add_u32 s60, s62, 0
    buffer_load_dwordx4 v[64:67], v2, s[4:7], s60 offen offset:0 sc1
    buffer_load_dwordx4 v[68:71], v2, s[4:7], s60 offen offset:1024 sc1
    buffer_load_dwordx4 v[72:75], v2, s[4:7], s60 offen offset:2048 sc1
    buffer_load_dwordx4 v[76:79], v2, s[4:7], s60 offen offset:3072 sc1
    s_add_u32 s60, s62, 4096
    buffer_load_dwordx4 v[80:83], v2, s[4:7], s60 offen offset:0 sc1
    buffer_load_dwordx4 v[84:87], v2, s[4:7], s60 offen offset:1024 sc1
    buffer_load_dwordx4 v[88:91], v2, s[4:7], s60 offen offset:2048 sc1
    buffer_load_dwordx4 v[92:95], v2, s[4:7], s60 offen offset:3072 sc1
    s_add_u32 s60, s62, 16384
    buffer_load_dwordx4 v[96:99], v2, s[4:7], s60 offen offset:0 sc1
    buffer_load_dwordx4 v[100:103], v2, s[4:7], s60 offen offset:1024 sc1
    buffer_load_dwordx4 v[104:107], v2, s[4:7], s60 offen offset:2048 sc1
    buffer_load_dwordx4 v[108:111], v2, s[4:7], s60 offen offset:3072 sc1
    s_add_u32 s60, s62, 20480
    buffer_load_dwordx4 v[112:115], v2, s[4:7], s60 offen offset:0 sc1
    buffer_load_dwordx4 v[116:119], v2, s[4:7], s60 offen offset:1024 sc1
    buffer_load_dwordx4 v[120:123], v2, s[4:7], s60 offen offset:2048 sc1
    buffer_load_dwordx4 v[124:127], v2, s[4:7], s60 offen offset:3072 sc1
    s_add_u32 s60, s62, 32768
    buffer_load_dwordx4 v[128:131], v2, s[4:7], s60 offen offset:0 sc1
    buffer_load_dwordx4 v[132:135], v2, s[4:7], s60 offen offset:1024 sc1
    buffer_load_dwordx4 v[136:139], v2, s[4:7], s60 offen offset:2048 sc1
    buffer_load_dwordx4 v[140:143], v2, s[4:7], s60 offen offset:3072 sc1
    s_barrier
L_S2_go:
    v_mov_b32 v16, 0
    v_mov_b32 v17, 0
    v_mov_b32 v18, 0
    v_mov_b32 v19, 0
    s_waitcnt vmcnt(19)
    s_nop 0
    v_smfmac_f32_16x16x64_bf16 v[16:19], v[64:67], a[0:7], v6
    s_waitcnt vmcnt(18)
    v_smfmac_f32_16x16x64_bf16 v[16:19], v[68:71], a[8:15], v6
    s_waitcnt vmcnt(17)
    v_smfmac_f32_16x16x64_bf16 v[16:19], v[72:75], a[16:23], v6
    s_waitcnt vmcnt(16)
    v_smfmac_f32_16x16x64_bf16 v[16:19], v[76:79], a[24:31], v6
    s_waitcnt vmcnt(15)
    v_smfmac_f32_16x16x64_bf16 v[16:19], v[80:83], a[32:39], v6
    s_waitcnt vmcnt(14)
    v_smfmac_f32_16x16x64_bf16 v[16:19], v[84:87], a[40:47], v6
    s_waitcnt vmcnt(13)
    v_smfmac_f32_16x16x64_bf16 v[16:19], v[88:91], a[48:55], v6
    s_waitcnt vmcnt(12)
    v_smfmac_f32_16x16x64_bf16 v[16:19], v[92:95], a[56:63], v6
    s_waitcnt vmcnt(11)
    v_smfmac_f32_16x16x64_bf16 v[16:19], v[96:99], a[64:71], v6
    s_waitcnt vmcnt(10)
    v_smfmac_f32_16x16x64_bf16 v[16:19], v[100:103], a[72:79], v6
    s_waitcnt vmcnt(9)
    v_smfmac_f32_16x16x64_bf16 v[16:19], v[104:107], a[80:87], v6
    s_waitcnt vmcnt(8)
    v_smfmac_f32_16x16x64_bf16 v[16:19], v[108:111], a[88:95], v6
    s_waitcnt vmcnt(7)
    v_smfmac_f32_16x16x64_bf16 v[16:19], v[112:115], a[96:103], v6
    s_waitcnt vmcnt(6)
    v_smfmac_f32_16x16x64_bf16 v[16:19], v[116:119], a[104:111], v6
    s_waitcnt vmcnt(5)
    v_smfmac_f32_16x16x64_bf16 v[16:19], v[120:123], a[112:119], v6
    s_waitcnt vmcnt(4)
    v_smfmac_f32_16x16x64_bf16 v[16:19], v[124:127], a[120:127], v6
    s_waitcnt vmcnt(3)
    v_smfmac_f32_16x16x64_bf16 v[16:19], v[128:131], v[32:39], v6
    s_waitcnt vmcnt(2)
    v_smfmac_f32_16x16x64_bf16 v[16:19], v[132:135], v[40:47], v6
    s_waitcnt vmcnt(1)
    v_smfmac_f32_16x16x64_bf16 v[16:19], v[136:139], v[48:55], v6
    s_waitcnt vmcnt(0)
    v_smfmac_f32_16x16x64_bf16 v[16:19], v[140:143], v[56:63], v6
    s_mov_b64 vcc, s[74:75]
    s_nop 6
    v_pk_add_f32 v[16:17], v[16:17], v[18:19]
    v_cmp_u_f32 s[78:79], v16, v17
    s_nop 0
    v_cndmask_b32_dpp v18, v17, v16, vcc quad_perm:[1,0,3,2] row_mask:0xf bank_mask:0xf
    s_mov_b64 vcc, s[76:77]
    v_cndmask_b32_dpp v19, v16, v17, vcc quad_perm:[1,0,3,2] row_mask:0xf bank_mask:0xf
    s_cmp_lg_u64 s[78:79], 0
    v_cvt_pk_bf16_f32 v16, v18, v19
    s_cbranch_scc1 L_S2_slow
L_S2_ok:
    buffer_store_dword v16, v8, s[4:7], s31 offen sc1
    buffer_store_dword v9, v10, s[4:7], s71 offen
    ds_write_b128 v7, v[32:35] offset:0
    ds_write_b128 v7, v[36:39] offset:1024
    ds_write_b128 v7, v[40:43] offset:2048
    ds_write_b128 v7, v[44:47] offset:3072
    ds_write_b128 v7, v[48:51] offset:4096
    ds_write_b128 v7, v[52:55] offset:5120
    ds_write_b128 v7, v[56:59] offset:6144
    ds_write_b128 v7, v[60:63] offset:7168
    s_mov_b32 s25, s66
    s_waitcnt lgkmcnt(0)
    s_barrier
    s_cmp_lt_u32 s25, 63
    s_cbranch_scc1 L_loop_S2
    s_branch L_S2_fin
L_S2_slow:
    s_sub_u32 s72, s72, 1
    s_cbranch_scc0 L_S2_again
    s_mov_b32 s72, 0
    v_mov_b32 v4, 0
    v_max3_u32 v4, v4, v32, v33
    v_max3_u32 v4, v4, v34, v35
    v_max3_u32 v4, v4, v36, v37
    v_max3_u32 v4, v4, v38, v39
    v_max3_u32 v4, v4, v40, v41
    v_max3_u32 v4, v4, v42, v43
    v_max3_u32 v4, v4, v44, v45
    v_max3_u32 v4, v4, v46, v47
    v_max3_u32 v4, v4, v48, v49
    v_max3_u32 v4, v4, v50, v51
    v_max3_u32 v4, v4, v52, v53
    v_max3_u32 v4, v4, v54, v55
    v_max3_u32 v4, v4, v56, v57
    v_max3_u32 v4, v4, v58, v59
    v_max3_u32 v4, v4, v60, v61
    v_max3_u32 v4, v4, v62, v63
    v_max3_u32 v4, v4, v64, v65
    v_max3_u32 v4, v4, v66, v67
    v_max3_u32 v4, v4, v68, v69
    v_max3_u32 v4, v4, v70, v71
    v_max3_u32 v4, v4, v72, v73
    v_max3_u32 v4, v4, v74, v75
    v_max3_u32 v4, v4, v76, v77
    v_max3_u32 v4, v4, v78, v79
    v_max3_u32 v4, v4, v80, v81
    v_max3_u32 v4, v4, v82, v83
    v_max3_u32 v4, v4, v84, v85
    v_max3_u32 v4, v4, v86, v87
    v_max3_u32 v4, v4, v88, v89
    v_max3_u32 v4, v4, v90, v91
    v_max3_u32 v4, v4, v92, v93
    v_max3_u32 v4, v4, v94, v95
    v_max3_u32 v4, v4, v96, v97
    v_max3_u32 v4, v4, v98, v99
    v_max3_u32 v4, v4, v100, v101
    v_max3_u32 v4, v4, v102, v103
    v_max3_u32 v4, v4, v104, v105
    v_max3_u32 v4, v4, v106, v107
    v_max3_u32 v4, v4, v108, v109
    v_max3_u32 v4, v4, v110, v111
    v_max3_u32 v4, v4, v112, v113
    v_max3_u32 v4, v4, v114, v115
    v_max3_u32 v4, v4, v116, v117
    v_max3_u32 v4, v4, v118, v119
    v_max3_u32 v4, v4, v120, v121
    v_max3_u32 v4, v4, v122, v123
    v_max3_u32 v4, v4, v124, v125
    v_max3_u32 v4, v4, v126, v127
    v_max3_u32 v4, v4, v128, v129
    v_max3_u32 v4, v4, v130, v131
    v_max3_u32 v4, v4, v132, v133
    v_max3_u32 v4, v4, v134, v135
    v_max3_u32 v4, v4, v136, v137
    v_max3_u32 v4, v4, v138, v139
    v_max3_u32 v4, v4, v140, v141
    v_max3_u32 v4, v4, v142, v143
    v_cmp_eq_u32 vcc, -1, v4
    v_min_u32 v16, 0xfffffffe, v16
    s_nop 0
    s_cbranch_vccz L_S2_ok
    s_sub_u32 s27, s27, 1
    s_cbranch_scc1 L_abort
L_S2_again:
    buffer_load_dwordx4 v[32:35], v2, s[4:7], s63 offen offset:0 sc1
    buffer_load_dwordx4 v[36:39], v2, s[4:7], s63 offen offset:1024 sc1
    buffer_load_dwordx4 v[40:43], v2, s[4:7], s63 offen offset:2048 sc1
    buffer_load_dwordx4 v[44:47], v2, s[4:7], s63 offen offset:3072 sc1
    buffer_load_dwordx4 v[48:51], v2, s[4:7], s30 offen offset:0 sc1
    buffer_load_dwordx4 v[52:55], v2, s[4:7], s30 offen offset:1024 sc1
    buffer_load_dwordx4 v[56:59], v2, s[4:7], s30 offen offset:2048 sc1
    buffer_load_dwordx4 v[60:63], v2, s[4:7], s30 offen offset:3072 sc1
    s_add_u32 s60, s62, 0
    buffer_load_dwordx4 v[64:67], v2, s[4:7], s60 offen offset:0 sc1
    buffer_load_dwordx4 v[68:71], v2, s[4:7], s60 offen offset:1024 sc1
    buffer_load_dwordx4 v[72:75], v2, s[4:7], s60 offen offset:2048 sc1
    buffer_load_dwordx4 v[76:79], v2, s[4:7], s60 offen offset:3072 sc1
    s_add_u32 s60, s62, 4096
    buffer_load_dwordx4 v[80:83], v2, s[4:7], s60 offen offset:0 sc1
    buffer_load_dwordx4 v[84:87], v2, s[4:7], s60 offen offset:1024 sc1
    buffer_load_dwordx4 v[88:91], v2, s[4:7], s60 offen offset:2048 sc1
    buffer_load_dwordx4 v[92:95], v2, s[4:7], s60 offen offset:3072 sc1
    s_add_u32 s60, s62, 16384
    buffer_load_dwordx4 v[96:99], v2, s[4:7], s60 offen offset:0 sc1
    buffer_load_dwordx4 v[100:103], v2, s[4:7], s60 offen offset:1024 sc1
    buffer_load_dwordx4 v[104:107], v2, s[4:7], s60 offen offset:2048 sc1
    buffer_load_dwordx4 v[108:111], v2, s[4:7], s60 offen offset:3072 sc1
    s_add_u32 s60, s62, 20480
    buffer_load_dwordx4 v[112:115], v2, s[4:7], s60 offen offset:0 sc1
    buffer_load_dwordx4 v[116:119], v2, s[4:7], s60 offen offset:1024 sc1
    buffer_load_dwordx4 v[120:123], v2, s[4:7], s60 offen offset:2048 sc1
    buffer_load_dwordx4 v[124:127], v2, s[4:7], s60 offen offset:3072 sc1
    s_add_u32 s60, s62, 32768
    buffer_load_dwordx4 v[128:131], v2, s[4:7], s60 offen offset:0 sc1
    buffer_load_dwordx4 v[132:135], v2, s[4:7], s60 offen offset:1024 sc1
    buffer_load_dwordx4 v[136:139], v2, s[4:7], s60 offen offset:2048 sc1
    buffer_load_dwordx4 v[140:143], v2, s[4:7], s60 offen offset:3072 sc1
    s_branch L_S2_go
L_S2_st:
    s_add_u32 s66, s25, 1
    s_and_b32 s62, s25, 3
    s_lshl_b32 s62, s62, 16
    s_add_u32 s62, s62, s26
    s_add_u32 s62, s62, 0x180000
    s_and_b32 s63, s25, 1
    s_mul_i32 s63, s63, 655360
    s_add_u32 s63, s63, s64
    s_add_u32 s30, s63, 4096
    s_add_u32 s37, s37, 10240
    s_add_u32 s31, s62, s73
    s_barrier
    s_barrier
    s_cmp_ge_u32 s66, 63
    s_cbranch_scc1 L_S2_fin
    ds_read_b128 v[32:35], v7 offset:0
    ds_read_b128 v[36:39], v7 offset:1024
    ds_read_b128 v[40:43], v7 offset:2048
    ds_read_b128 v[44:47], v7 offset:3072
    ds_read_b128 v[48:51], v7 offset:4096
    ds_read_b128 v[52:55], v7 offset:5120
    ds_read_b128 v[56:59], v7 offset:6144
    ds_read_b128 v[60:63], v7 offset:7168
    s_waitcnt lgkmcnt(0)
    s_add_u32 s60, s67, 32768
    buffer_store_dwordx4 v[32:35], v2, s[4:7], s60 offen offset:0 sc1
    buffer_store_dwordx4 v[36:39], v2, s[4:7], s60 offen offset:1024 sc1
    buffer_store_dwordx4 v[40:43], v2, s[4:7], s60 offen offset:2048 sc1
    buffer_store_dwordx4 v[44:47], v2, s[4:7], s60 offen offset:3072 sc1
    s_add_u32 s60, s67, 36864
    buffer_store_dwordx4 v[48:51], v2, s[4:7], s60 offen offset:0 sc1
    buffer_store_dwordx4 v[52:55], v2, s[4:7], s60 offen offset:1024 sc1
    buffer_store_dwordx4 v[56:59], v2, s[4:7], s60 offen offset:2048 sc1
    buffer_store_dwordx4 v[60:63], v2, s[4:7], s60 offen offset:3072 sc1
    buffer_store_dwordx4 v[20:23], v2, s[4:7], s63 offen offset:0 sc1
    buffer_store_dwordx4 v[20:23], v2, s[4:7], s63 offen offset:1024 sc1
    buffer_store_dwordx4 v[20:23], v2, s[4:7], s63 offen offset:2048 sc1
    buffer_store_dwordx4 v[20:23], v2, s[4:7], s63 offen offset:3072 sc1
    buffer_store_dwordx4 v[20:23], v2, s[4:7], s30 offen offset:0 sc1
    buffer_store_dwordx4 v[20:23], v2, s[4:7], s30 offen offset:1024 sc1
    buffer_store_dwordx4 v[20:23], v2, s[4:7], s30 offen offset:2048 sc1
    buffer_store_dwordx4 v[20:23], v2, s[4:7], s30 offen offset:3072 sc1
    buffer_store_dword v20, v8, s[4:7], s31 offen sc1
    s_add_u32 s67, s67, 2097152
    s_bitset0_b32 s67, 26
    s_waitcnt vmcnt(0)
    v_mov_b32 v4, s66
    s_mov_b64 exec, 1
    buffer_store_dword v4, v3, s[4:7], s69 offen sc1
    s_mov_b64 exec, -1
    s_mov_b32 s25, s66
    s_branch L_S2_st
L_S2_dma0:
    v_cmp_gt_u32 vcc, 16, v1
    v_lshlrev_b32 v12, 7, v1
    s_nop 0
    v_cndmask_b32 v12, 0, v12, vcc
    s_and_b32 s28, s3, 1
    s_lshl_b32 s28, s28, 11
    s_add_u32 s68, s68, s28
    s_mov_b32 s72, 0
    s_and_b32 s70, s3, 1
    s_lshl_b32 s70, s70, 14
    s_add_u32 s67, s67, s70
    s_add_u32 s66, s25, 1
    s_mov_b32 s27, 0x100000
Lp_155:
    buffer_load_dwordx4 v[68:71], v12, s[4:7], s68 offen sc1
    s_waitcnt vmcnt(0)
    v_min3_u32 v68, v68, v69, v70
    v_min_u32 v68, v68, v71
    v_cmp_gt_u32 vcc, s66, v68
    s_nop 0
    s_cbranch_vccz Ld_156
    s_sub_u32 s27, s27, 1
    s_cbranch_scc1 L_abort
    s_sleep 4
    s_branch Lp_155
Ld_156:
    s_add_u32 s28, s72, s70
    s_add_u32 m0, s28, 0
    s_add_u32 s60, s67, 0
    buffer_load_dwordx4 v2, s[4:7], s60 offen offset:0 sc1 lds
    buffer_load_dwordx4 v2, s[4:7], s60 offen offset:1024 sc1 lds
    buffer_load_dwordx4 v2, s[4:7], s60 offen offset:2048 sc1 lds
    buffer_load_dwordx4 v2, s[4:7], s60 offen offset:3072 sc1 lds
    s_add_u32 m0, s28, 4096
    s_add_u32 s60, s67, 4096
    buffer_load_dwordx4 v2, s[4:7], s60 offen offset:0 sc1 lds
    buffer_load_dwordx4 v2, s[4:7], s60 offen offset:1024 sc1 lds
    buffer_load_dwordx4 v2, s[4:7], s60 offen offset:2048 sc1 lds
    buffer_load_dwordx4 v2, s[4:7], s60 offen offset:3072 sc1 lds
    s_add_u32 m0, s28, 8192
    s_add_u32 s60, s67, 8192
    buffer_load_dwordx4 v2, s[4:7], s60 offen offset:0 sc1 lds
    buffer_load_dwordx4 v2, s[4:7], s60 offen offset:1024 sc1 lds
    buffer_load_dwordx4 v2, s[4:7], s60 offen offset:2048 sc1 lds
    buffer_load_dwordx4 v2, s[4:7], s60 offen offset:3072 sc1 lds
    s_add_u32 m0, s28, 12288
    s_add_u32 s60, s67, 12288
    buffer_load_dwordx4 v2, s[4:7], s60 offen offset:0 sc1 lds
    buffer_load_dwordx4 v2, s[4:7], s60 offen offset:1024 sc1 lds
    buffer_load_dwordx4 v2, s[4:7], s60 offen offset:2048 sc1 lds
    buffer_load_dwordx4 v2, s[4:7], s60 offen offset:3072 sc1 lds
    s_add_u32 s67, s67, 2097152
    s_bitset0_b32 s67, 26
    s_mov_b32 s25, s66
    s_xor_b32 s72, s72, 32768
    v_cmp_ge_u32 vcc, s25, v68
    s_nop 0
    s_and_saveexec_b64 s[78:79], vcc
    buffer_load_dwordx4 v[68:71], v12, s[4:7], s68 offen sc1
    s_mov_b64 exec, -1
    s_waitcnt vmcnt(0)
    s_barrier
    s_barrier
    s_add_u32 s66, s25, 1
    s_mov_b32 s27, 0x100000
Lp_157:
    buffer_load_dwordx4 v[68:71], v12, s[4:7], s68 offen sc1
    s_waitcnt vmcnt(0)
    v_min3_u32 v68, v68, v69, v70
    v_min_u32 v68, v68, v71
    v_cmp_gt_u32 vcc, s66, v68
    s_nop 0
    s_cbranch_vccz Ld_158
    s_sub_u32 s27, s27, 1
    s_cbranch_scc1 L_abort
    s_sleep 4
    s_branch Lp_157
Ld_158:
    s_add_u32 s28, s72, s70
    s_add_u32 m0, s28, 0
    s_add_u32 s60, s67, 0
    buffer_load_dwordx4 v2, s[4:7], s60 offen offset:0 sc1 lds
    buffer_load_dwordx4 v2, s[4:7], s60 offen offset:1024 sc1 lds
    buffer_load_dwordx4 v2, s[4:7], s60 offen offset:2048 sc1 lds
    buffer_load_dwordx4 v2, s[4:7], s60 offen offset:3072 sc1 lds
    s_add_u32 m0, s28, 4096
    s_add_u32 s60, s67, 4096
    buffer_load_dwordx4 v2, s[4:7], s60 offen offset:0 sc1 lds
    buffer_load_dwordx4 v2, s[4:7], s60 offen offset:1024 sc1 lds
    buffer_load_dwordx4 v2, s[4:7], s60 offen offset:2048 sc1 lds
    buffer_load_dwordx4 v2, s[4:7], s60 offen offset:3072 sc1 lds
    s_add_u32 m0, s28, 8192
    s_add_u32 s60, s67, 8192
    buffer_load_dwordx4 v2, s[4:7], s60 offen offset:0 sc1 lds
    buffer_load_dwordx4 v2, s[4:7], s60 offen offset:1024 sc1 lds
    buffer_load_dwordx4 v2, s[4:7], s60 offen offset:2048 sc1 lds
    buffer_load_dwordx4 v2, s[4:7], s60 offen offset:3072 sc1 lds
    s_add_u32 m0, s28, 12288
    s_add_u32 s60, s67, 12288
    buffer_load_dwordx4 v2, s[4:7], s60 offen offset:0 sc1 lds
    buffer_load_dwordx4 v2, s[4:7], s60 offen offset:1024 sc1 lds
    buffer_load_dwordx4 v2, s[4:7], s60 offen offset:2048 sc1 lds
    buffer_load_dwordx4 v2, s[4:7], s60 offen offset:3072 sc1 lds
    s_add_u32 s67, s67, 2097152
    s_bitset0_b32 s67, 26
    s_mov_b32 s25, s66
    s_xor_b32 s72, s72, 32768
    v_cmp_ge_u32 vcc, s25, v68
    s_nop 0
    s_and_saveexec_b64 s[78:79], vcc
    buffer_load_dwordx4 v[68:71], v12, s[4:7], s68 offen sc1
    s_mov_b64 exec, -1
    s_waitcnt vmcnt(0)
    v_min3_u32 v68, v68, v69, v70
    v_min_u32 v68, v68, v71
    s_barrier
L_S2_dma:
    v_cmp_ge_u32 vcc, s25, v68
    s_nop 0
    s_cbranch_vccz L_S2_now
    buffer_load_dwordx4 v[68:71], v12, s[4:7], s68 offen sc1
    s_waitcnt vmcnt(0)
    v_min3_u32 v68, v68, v69, v70
    v_min_u32 v68, v68, v71
    v_cmp_ge_u32 vcc, s25, v68
    s_nop 0
    s_cbranch_vccz L_S2_now
    s_sleep 2
    s_branch L_S2_late
L_S2_now:
    s_add_u32 s66, s25, 1
    s_add_u32 s28, s72, s70
    s_add_u32 m0, s28, 0
    s_add_u32 s60, s67, 0
    buffer_load_dwordx4 v2, s[4:7], s60 offen offset:0 sc1 lds
    buffer_load_dwordx4 v2, s[4:7], s60 offen offset:1024 sc1 lds
    buffer_load_dwordx4 v2, s[4:7], s60 offen offset:2048 sc1 lds
    buffer_load_dwordx4 v2, s[4:7], s60 offen offset:3072 sc1 lds
    s_add_u32 m0, s28, 4096
    s_add_u32 s60, s67, 4096
    buffer_load_dwordx4 v2, s[4:7], s60 offen offset:0 sc1 lds
    buffer_load_dwordx4 v2, s[4:7], s60 offen offset:1024 sc1 lds
    buffer_load_dwordx4 v2, s[4:7], s60 offen offset:2048 sc1 lds
    buffer_load_dwordx4 v2, s[4:7], s60 offen offset:3072 sc1 lds
    s_add_u32 m0, s28, 8192
    s_add_u32 s60, s67, 8192
    buffer_load_dwordx4 v2, s[4:7], s60 offen offset:0 sc1 lds
    buffer_load_dwordx4 v2, s[4:7], s60 offen offset:1024 sc1 lds
    buffer_load_dwordx4 v2, s[4:7], s60 offen offset:2048 sc1 lds
    buffer_load_dwordx4 v2, s[4:7], s60 offen offset:3072 sc1 lds
    s_add_u32 m0, s28, 12288
    s_add_u32 s60, s67, 12288
    buffer_load_dwordx4 v2, s[4:7], s60 offen offset:0 sc1 lds
    buffer_load_dwordx4 v2, s[4:7], s60 offen offset:1024 sc1 lds
    buffer_load_dwordx4 v2, s[4:7], s60 offen offset:2048 sc1 lds
    buffer_load_dwordx4 v2, s[4:7], s60 offen offset:3072 sc1 lds
    s_add_u32 s67, s67, 2097152
    s_bitset0_b32 s67, 26
    s_mov_b32 s25, s66
    s_xor_b32 s72, s72, 32768
    v_cmp_ge_u32 vcc, s25, v68
    s_nop 0
    s_and_saveexec_b64 s[78:79], vcc
    buffer_load_dwordx4 v[68:71], v12, s[4:7], s68 offen sc1
    s_mov_b64 exec, -1
    s_barrier
    s_branch L_S2_dm2
L_S2_late:
    s_barrier
    s_add_u32 s66, s25, 1
    s_mov_b32 s27, 0x100000
Lp_159:
    buffer_load_dwordx4 v[68:71], v12, s[4:7], s68 offen sc1
    s_waitcnt vmcnt(0)
    v_min3_u32 v68, v68, v69, v70
    v_min_u32 v68, v68, v71
    v_cmp_gt_u32 vcc, s66, v68
    s_nop 0
    s_cbranch_vccz Ld_160
    s_sub_u32 s27, s27, 1
    s_cbranch_scc1 L_abort
    s_sleep 4
    s_branch Lp_159
Ld_160:
    s_add_u32 s28, s72, s70
    s_add_u32 m0, s28, 0
    s_add_u32 s60, s67, 0
    buffer_load_dwordx4 v2, s[4:7], s60 offen offset:0 sc1 lds
    buffer_load_dwordx4 v2, s[4:7], s60 offen offset:1024 sc1 lds
    buffer_load_dwordx4 v2, s[4:7], s60 offen offset:2048 sc1 lds
    buffer_load_dwordx4 v2, s[4:7], s60 offen offset:3072 sc1 lds
    s_add_u32 m0, s28, 4096
    s_add_u32 s60, s67, 4096
    buffer_load_dwordx4 v2, s[4:7], s60 offen offset:0 sc1 lds
    buffer_load_dwordx4 v2, s[4:7], s60 offen offset:1024 sc1 lds
    buffer_load_dwordx4 v2, s[4:7], s60 offen offset:2048 sc1 lds
    buffer_load_dwordx4 v2, s[4:7], s60 offen offset:3072 sc1 lds
    s_add_u32 m0, s28, 8192
    s_add_u32 s60, s67, 8192
    buffer_load_dwordx4 v2, s[4:7], s60 offen offset:0 sc1 lds
    buffer_load_dwordx4 v2, s[4:7], s60 offen offset:1024 sc1 lds
    buffer_load_dwordx4 v2, s[4:7], s60 offen offset:2048 sc1 lds
    buffer_load_dwordx4 v2, s[4:7], s60 offen offset:3072 sc1 lds
    s_add_u32 m0, s28, 12288
    s_add_u32 s60, s67, 12288
    buffer_load_dwordx4 v2, s[4:7], s60 offen offset:0 sc1 lds
    buffer_load_dwordx4 v2, s[4:7], s60 offen offset:1024 sc1 lds
    buffer_load_dwordx4 v2, s[4:7], s60 offen offset:2048 sc1 lds
    buffer_load_dwordx4 v2, s[4:7], s60 offen offset:3072 sc1 lds
    s_add_u32 s67, s67, 2097152
    s_bitset0_b32 s67, 26
    s_mov_b32 s25, s66
    s_xor_b32 s72, s72, 32768
    v_cmp_ge_u32 vcc, s25, v68
    s_nop 0
    s_and_saveexec_b64 s[78:79], vcc
    buffer_load_dwordx4 v[68:71], v12, s[4:7], s68 offen sc1
    s_mov_b64 exec, -1
L_S2_dm2:
    s_waitcnt vmcnt(0)
    v_min3_u32 v68, v68, v69, v70
    v_min_u32 v68, v68, v71
L_S2_dm3:
    s_barrier
    s_cmp_lt_u32 s25, 64
    s_cbranch_scc1 L_S2_dma
L_S2_fin:
    s_mov_b32 s25, 62
L_S2_floop:
    s_add_u32 s66, s25, 1
    s_and_b32 s62, s25, 3
    s_lshl_b32 s62, s62, 16
    s_add_u32 s62, s62, s26
    s_add_u32 s62, s62, 0x180000
    s_and_b32 s63, s25, 1
    s_mul_i32 s63, s63, 655360
    s_add_u32 s63, s63, s64
    s_add_u32 s30, s63, 4096
    s_add_u32 s37, s37, 10240
    s_and_b32 s28, s25, 1
    s_lshl_b32 s28, s28, 15
    v_add_u32 v4, s28, v2
    ds_read_b128 a[0:3], v4 offset:0
    ds_read_b128 a[4:7], v4 offset:1024
    ds_read_b128 a[8:11], v4 offset:2048
    ds_read_b128 a[12:15], v4 offset:3072
    ds_read_b128 a[16:19], v4 offset:4096
    ds_read_b128 a[20:23], v4 offset:5120
    ds_read_b128 a[24:27], v4 offset:6144
    ds_read_b128 a[28:31], v4 offset:7168
    ds_read_b128 a[32:35], v4 offset:8192
    ds_read_b128 a[36:39], v4 offset:9216
    ds_read_b128 a[40:43], v4 offset:10240
    ds_read_b128 a[44:47], v4 offset:11264
    ds_read_b128 a[48:51], v4 offset:12288
    ds_read_b128 a[52:55], v4 offset:13312
    ds_read_b128 a[56:59], v4 offset:14336
    ds_read_b128 a[60:63], v4 offset:15360
    ds_read_b128 a[64:67], v4 offset:16384
    ds_read_b128 a[68:71], v4 offset:17408
    ds_read_b128 a[72:75], v4 offset:18432
    ds_read_b128 a[76:79], v4 offset:19456
    ds_read_b128 a[80:83], v4 offset:20480
    ds_read_b128 a[84:87], v4 offset:21504
    ds_read_b128 a[88:91], v4 offset:22528
    ds_read_b128 a[92:95], v4 offset:23552
    ds_read_b128 a[96:99], v4 offset:24576
    ds_read_b128 a[100:103], v4 offset:25600
    ds_read_b128 a[104:107], v4 offset:26624
    ds_read_b128 a[108:111], v4 offset:27648
    ds_read_b128 a[112:115], v4 offset:28672
    ds_read_b128 a[116:119], v4 offset:29696
    ds_read_b128 a[120:123], v4 offset:30720
    ds_read_b128 a[124:127], v4 offset:31744
    s_mov_b32 exec_lo, 0xfff
    s_mov_b32 exec_hi, 0x0
    s_mov_b32 s27, 0x100000
Lp_161:
    buffer_load_dword v4, v11, s[4:7], s65 offen sc1
    s_waitcnt vmcnt(0)
    v_cmp_gt_u32 vcc, s66, v4
    s_nop 0
    s_cbranch_vccz Ld_162
    s_sub_u32 s27, s27, 1
    s_cbranch_scc1 L_abort
    s_sleep 1
    s_branch Lp_161
Ld_162:
    s_mov_b64 exec, -1
    s_sub_u32 s29, s25, 61
    v_mov_b32 v5, s29
L_S2_fr:
    buffer_load_dwordx4 v[144:147], v2, s[4:7], s63 offen offset:0 sc1
    buffer_load_dwordx4 v[148:151], v2, s[4:7], s63 offen offset:1024 sc1
    buffer_load_dwordx4 v[152:155], v2, s[4:7], s63 offen offset:2048 sc1
    buffer_load_dwordx4 v[156:159], v2, s[4:7], s63 offen offset:3072 sc1
    buffer_load_dwordx4 v[160:163], v2, s[4:7], s30 offen offset:0 sc1
    buffer_load_dwordx4 v[164:167], v2, s[4:7], s30 offen offset:1024 sc1
    buffer_load_dwordx4 v[168:171], v2, s[4:7], s30 offen offset:2048 sc1
    buffer_load_dwordx4 v[172:175], v2, s[4:7], s30 offen offset:3072 sc1
    s_waitcnt vmcnt(4)
    s_mov_b64 exec, s[32:33]
    s_add_u32 s60, s35, 0
    buffer_load_dwordx4 v[176:179], v2, s[4:7], s60 offen offset:0 sc1
    buffer_load_dwordx4 v[180:183], v2, s[4:7], s60 offen offset:1024 sc1
    buffer_load_dwordx4 v[184:187], v2, s[4:7], s60 offen offset:2048 sc1
    buffer_load_dwordx4 v[188:191], v2, s[4:7], s60 offen offset:3072 sc1
    s_add_u32 s60, s35, 4096
    buffer_load_dwordx4 v[192:195], v2, s[4:7], s60 offen offset:0 sc1
    buffer_load_dwordx4 v[196:199], v2, s[4:7], s60 offen offset:1024 sc1
    buffer_load_dwordx4 v[200:203], v2, s[4:7], s60 offen offset:2048 sc1
    buffer_load_dwordx4 v[204:207], v2, s[4:7], s60 offen offset:3072 sc1
    s_add_u32 s60, s35, 8192
    buffer_load_dwordx4 v[208:211], v2, s[4:7], s60 offen offset:0 sc1
    buffer_load_dwordx4 v[212:215], v2, s[4:7], s60 offen offset:1024 sc1
    buffer_load_dwordx4 v[216:219], v2, s[4:7], s60 offen offset:2048 sc1
    buffer_load_dwordx4 v[220:223], v2, s[4:7], s60 offen offset:3072 sc1
    s_add_u32 s60, s35, 12288
    buffer_load_dwordx4 v[224:227], v2, s[4:7], s60 offen offset:0 sc1
    buffer_load_dwordx4 v[228:231], v2, s[4:7], s60 offen offset:1024 sc1
    buffer_load_dwordx4 v[232:235], v2, s[4:7], s60 offen offset:2048 sc1
    buffer_load_dwordx4 v[236:239], v2, s[4:7], s60 offen offset:3072 sc1
    s_mov_b64 exec, -1
    s_add_u32 s60, s35, 16384
    buffer_load_dwordx2 v[240:241], v15, s[4:7], s60 offen offset:0 sc1
    buffer_load_dwordx2 v[242:243], v15, s[4:7], s60 offen offset:128 sc1
    buffer_load_dwordx2 v[244:245], v15, s[4:7], s60 offen offset:1024 sc1
    buffer_load_dwordx2 v[246:247], v15, s[4:7], s60 offen offset:1152 sc1
    buffer_load_dwordx2 v[248:249], v15, s[4:7], s60 offen offset:2048 sc1
    buffer_load_dwordx2 v[250:251], v15, s[4:7], s60 offen offset:2176 sc1
    buffer_load_dwordx2 v[252:253], v15, s[4:7], s60 offen offset:3072 sc1
    buffer_load_dwordx2 v[254:255], v15, s[4:7], s60 offen offset:3200 sc1
    v_mov_b32 v16, 0
    v_mov_b32 v17, 0
    v_mov_b32 v18, 0
    v_mov_b32 v19, 0
    s_waitcnt lgkmcnt(0)
    s_waitcnt vmcnt(23)
    v_smfmac_f32_16x16x64_bf16 v[16:19], v[176:179], a[0:7], v14
    s_waitcnt vmcnt(22)
    v_smfmac_f32_16x16x64_bf16 v[16:19], v[180:183], a[8:15], v14
    s_waitcnt vmcnt(21)
    v_smfmac_f32_16x16x64_bf16 v[16:19], v[184:187], a[16:23], v14
    s_waitcnt vmcnt(20)
    v_smfmac_f32_16x16x64_bf16 v[16:19], v[188:191], a[24:31], v14
    s_waitcnt vmcnt(19)
    v_smfmac_f32_16x16x64_bf16 v[16:19], v[192:195], a[32:39], v14
    buffer_store_dword v5, v0, s[4:7], s36 offen sc1
    s_waitcnt vmcnt(19)
    v_smfmac_f32_16x16x64_bf16 v[16:19], v[196:199], a[40:47], v14
    s_waitcnt vmcnt(18)
    v_smfmac_f32_16x16x64_bf16 v[16:19], v[200:203], a[48:55], v14
    s_waitcnt vmcnt(17)
    v_smfmac_f32_16x16x64_bf16 v[16:19], v[204:207], a[56:63], v14
    s_waitcnt vmcnt(16)
    v_smfmac_f32_16x16x64_bf16 v[16:19], v[208:211], a[64:71], v14
    s_waitcnt vmcnt(15)
    v_smfmac_f32_16x16x64_bf16 v[16:19], v[212:215], a[72:79], v14
    s_waitcnt vmcnt(14)
    v_smfmac_f32_16x16x64_bf16 v[16:19], v[216:219], a[80:87], v14
    s_waitcnt vmcnt(13)
    v_smfmac_f32_16x16x64_bf16 v[16:19], v[220:223], a[88:95], v14
    s_waitcnt vmcnt(12)
    v_smfmac_f32_16x16x64_bf16 v[16:19], v[224:227], a[96:103], v14
    s_waitcnt vmcnt(11)
    v_smfmac_f32_16x16x64_bf16 v[16:19], v[228:231], a[104:111], v14
    s_waitcnt vmcnt(10)
    v_smfmac_f32_16x16x64_bf16 v[16:19], v[232:235], a[112:119], v14
    s_waitcnt vmcnt(9)
    v_smfmac_f32_16x16x64_bf16 v[16:19], v[236:239], a[120:127], v14
    s_waitcnt vmcnt(7)
    v_smfmac_f32_16x16x64_bf16 v[16:19], v[240:243], v[144:151], v14
    s_waitcnt vmcnt(5)
    v_smfmac_f32_16x16x64_bf16 v[16:19], v[244:247], v[152:159], v14
    s_waitcnt vmcnt(3)
    v_smfmac_f32_16x16x64_bf16 v[16:19], v[248:251], v[160:167], v14
    s_waitcnt vmcnt(1)
    v_smfmac_f32_16x16x64_bf16 v[16:19], v[252:255], v[168:175], v14
    s_nop 7
    v_permlane32_swap_b32 v16, v18
    v_permlane32_swap_b32 v17, v19
    v_pk_add_f32 v[16:17], v[16:17], v[18:19]
    v_cmp_u_f32 vcc, v16, v17
    s_nop 0
    s_cbranch_vccz L_S2_fo
    v_mov_b32 v4, 0
    v_max3_u32 v4, v4, v144, v145
    v_max3_u32 v4, v4, v146, v147
    v_max3_u32 v4, v4, v148, v149
    v_max3_u32 v4, v4, v150, v151
    v_max3_u32 v4, v4, v152, v153
    v_max3_u32 v4, v4, v154, v155
    v_max3_u32 v4, v4, v156, v157
    v_max3_u32 v4, v4, v158, v159
    v_max3_u32 v4, v4, v160, v161
    v_max3_u32 v4, v4, v162, v163
    v_max3_u32 v4, v4, v164, v165
    v_max3_u32 v4, v4, v166, v167
    v_max3_u32 v4, v4, v168, v169
    v_max3_u32 v4, v4, v170, v171
    v_max3_u32 v4, v4, v172, v173
    v_max3_u32 v4, v4, v174, v175
    v_max3_u32 v4, v4, v176, v177
    v_max3_u32 v4, v4, v178, v179
    v_max3_u32 v4, v4, v180, v181
    v_max3_u32 v4, v4, v182, v183
    v_max3_u32 v4, v4, v184, v185
    v_max3_u32 v4, v4, v186, v187
    v_max3_u32 v4, v4, v188, v189
    v_max3_u32 v4, v4, v190, v191
    v_max3_u32 v4, v4, v192, v193
    v_max3_u32 v4, v4, v194, v195
    v_max3_u32 v4, v4, v196, v197
    v_max3_u32 v4, v4, v198, v199
    v_max3_u32 v4, v4, v200, v201
    v_max3_u32 v4, v4, v202, v203
    v_max3_u32 v4, v4, v204, v205
    v_max3_u32 v4, v4, v206, v207
    v_max3_u32 v4, v4, v208, v209
    v_max3_u32 v4, v4, v210, v211
    v_max3_u32 v4, v4, v212, v213
    v_max3_u32 v4, v4, v214, v215
    v_max3_u32 v4, v4, v216, v217
    v_max3_u32 v4, v4, v218, v219
    v_max3_u32 v4, v4, v220, v221
    v_max3_u32 v4, v4, v222, v223
    v_max3_u32 v4, v4, v224, v225
    v_max3_u32 v4, v4, v226, v227
    v_max3_u32 v4, v4, v228, v229
    v_max3_u32 v4, v4, v230, v231
    v_max3_u32 v4, v4, v232, v233
    v_max3_u32 v4, v4, v234, v235
    v_max3_u32 v4, v4, v236, v237
    v_max3_u32 v4, v4, v238, v239
    v_max3_u32 v4, v4, v240, v241
    v_max3_u32 v4, v4, v242, v243
    v_max3_u32 v4, v4, v244, v245
    v_max3_u32 v4, v4, v246, v247
    v_max3_u32 v4, v4, v248, v249
    v_max3_u32 v4, v4, v250, v251
    v_max3_u32 v4, v4, v252, v253
    v_max3_u32 v4, v4, v254, v255
    v_cmp_eq_u32 vcc, -1, v4
    s_nop 0
    s_cbranch_vccz L_S2_fo
    s_sub_u32 s27, s27, 1
    s_cbranch_scc1 L_abort
    s_branch L_S2_fr
L_S2_fo:
    s_mov_b64 vcc, s[74:75]
    v_cndmask_b32_dpp v18, v17, v16, vcc quad_perm:[1,0,3,2] row_mask:0xf bank_mask:0xf
    s_mov_b64 vcc, s[76:77]
    v_cndmask_b32_dpp v19, v16, v17, vcc quad_perm:[1,0,3,2] row_mask:0xf bank_mask:0xf
    v_cvt_pk_bf16_f32 v16, v18, v19
    v_lshlrev_b32 v17, 16, v16
    v_and_b32 v16, 0xffff0000, v16
    v_lshlrev_b32 v18, 16, v26
    v_and_b32 v19, 0xffff0000, v26
    v_add_f32 v17, v17, v18
    v_add_f32 v16, v16, v19
    v_cvt_pk_bf16_f32 v16, v17, v16
    v_min_u32 v16, 0xfffffffe, v16
    buffer_store_dword v16, v13, s[4:7], s34 offen sc1
    v_mov_b32 v26, v27
    s_add_u32 s34, s34, 40960
    s_add_u32 s35, s35, 81920
    s_mov_b32 s25, s66
    s_cmp_le_u32 s25, 63
    s_cbranch_scc1 L_S2_floop
    s_branch L_exit
L_role_X2:
    v_and_b32 v4, 8, v1
    v_cmp_eq_u32 vcc, 0, v4
    v_mov_b32 v6, 0xeeee
    v_mov_b32 v4, 0x4444
    v_cndmask_b32 v6, v6, v4, vcc
    v_bfe_u32 v28, v1, 4, 1
    v_lshlrev_b32 v28, 2, v28
    v_lshrrev_b32 v4, 5, v1
    v_lshl_add_u32 v28, v4, 1, v28
    v_and_b32 v4, 1, v1
    v_add_u32 v28, v4, v28
    v_bfe_u32 v29, v1, 1, 3
    v_and_b32 v4, 3, v29
    v_lshlrev_b32 v4, 2, v4
    v_lshl_add_u32 v4, v28, 4, v4
    v_lshrrev_b32 v5, 2, v29
    v_lshl_add_u32 v8, v5, 8, v4
    v_mul_u32_u24 v9, 1280, v28
    v_lshl_add_u32 v9, v29, 2, v9
    s_mul_i32 s28, s80, 1280
    s_add_u32 s28, s28, 1355776
    s_mov_b32 s29, 1343488
    v_min_u32 v4, 41, v1
    v_lshlrev_b32 v4, 7, v4
    v_add_u32 v10, s28, v4
    v_add_u32 v4, s29, v4
    v_cmp_gt_u32 vcc, 32, v1
    s_nop 1
    v_cndmask_b32 v10, v10, v4, vcc
    v_cmp_gt_u32 vcc, 32, v1
    v_lshlrev_b32 v11, 7, v1
    s_nop 0
    v_cndmask_b32 v11, 0, v11, vcc
    v_lshrrev_b32 v7, 4, v1
    v_lshlrev_b32 v7, 8, v7
    v_and_b32 v4, 15, v1
    v_lshl_add_u32 v7, v4, 3, v7
    v_add_u32 v12, 0, v2
    v_add_u32 v13, 40960, v2
    v_add_u32 v14, 81920, v2
    v_add_u32 v15, 122880, v2
    v_pk_mov_b32 v[64:65], 0, 0
    v_pk_mov_b32 v[66:67], 0, 0
    v_pk_mov_b32 v[68:69], 0, 0
    v_pk_mov_b32 v[70:71], 0, 0
    v_pk_mov_b32 v[72:73], 0, 0
    v_pk_mov_b32 v[74:75], 0, 0
    v_pk_mov_b32 v[76:77], 0, 0
    v_pk_mov_b32 v[78:79], 0, 0
    v_pk_mov_b32 v[80:81], 0, 0
    v_pk_mov_b32 v[82:83], 0, 0
    v_pk_mov_b32 v[84:85], 0, 0
    v_pk_mov_b32 v[86:87], 0, 0
    v_pk_mov_b32 v[88:89], 0, 0
    v_pk_mov_b32 v[90:91], 0, 0
    v_pk_mov_b32 v[92:93], 0, 0
    v_pk_mov_b32 v[94:95], 0, 0
    v_pk_mov_b32 v[96:97], 0, 0
    v_pk_mov_b32 v[98:99], 0, 0
    v_pk_mov_b32 v[100:101], 0, 0
    v_pk_mov_b32 v[102:103], 0, 0
    v_pk_mov_b32 v[104:105], 0, 0
    v_pk_mov_b32 v[106:107], 0, 0
    v_pk_mov_b32 v[108:109], 0, 0
    v_pk_mov_b32 v[110:111], 0, 0
    v_pk_mov_b32 v[112:113], 0, 0
    v_pk_mov_b32 v[114:115], 0, 0
    v_pk_mov_b32 v[116:117], 0, 0
    v_pk_mov_b32 v[118:119], 0, 0
    v_pk_mov_b32 v[120:121], 0, 0
    v_pk_mov_b32 v[122:123], 0, 0
    v_pk_mov_b32 v[124:125], 0, 0
    v_pk_mov_b32 v[126:127], 0, 0
    v_pk_mov_b32 v[128:129], 0, 0
    v_pk_mov_b32 v[130:131], 0, 0
    v_pk_mov_b32 v[132:133], 0, 0
    v_pk_mov_b32 v[134:135], 0, 0
    v_pk_mov_b32 v[136:137], 0, 0
    v_pk_mov_b32 v[138:139], 0, 0
    v_pk_mov_b32 v[140:141], 0, 0
    v_pk_mov_b32 v[142:143], 0, 0
    s_mov_b32 s74, 0x55555555
    s_mov_b32 s75, 0x55555555
    s_mov_b32 s76, 0xaaaaaaaa
    s_mov_b32 s77, 0xaaaaaaaa
    v_bfe_u32 v4, v1, 3, 1
    v_bfe_u32 v5, v1, 4, 1
    v_lshl_add_u32 v4, v4, 1, v5
    v_cmp_ge_u32 s[78:79], s3, v4
    s_mul_i32 s70, s3, 20480
    s_mul_i32 s32, s80, 409600
    s_add_u32 s32, s32, 0x8000000
    s_lshr_b32 s28, s3, 1
    s_mul_i32 s28, s28, 40960
    s_and_b32 s29, s3, 1
    s_lshl_b32 s35, s29, 14
    s_add_u32 s35, s35, s28
    s_lshl_b32 s36, s29, 12
    s_add_u32 s36, s36, s28
    s_add_u32 s36, s36, 32768
    s_mov_b32 s37, 0
    s_lshr_b32 s28, s3, 1
    s_mul_i32 s33, s28, 20480
    s_mul_i32 s28, s80, 5120
    s_add_u32 s33, s33, s28
    s_and_b32 s28, s3, 1
    s_lshl_b32 s28, s28, 7
    s_add_u32 s33, s33, s28
    s_add_u32 s33, s33, 0xd00000
    s_mul_i32 s34, s3, 10240
    s_mul_i32 s28, s80, 320
    s_add_u32 s34, s34, s28
    s_mov_b32 s68, 0x603000
    v_mov_b32 v3, 0
    s_mov_b32 s29, 128
    s_mov_b32 s27, 0x100000
Lp_163:
    buffer_load_dword v4, v3, s[16:19], s29 offen sc1
    s_waitcnt vmcnt(0)
    v_cmp_gt_u32 vcc, 1, v4
    s_nop 0
    s_cbranch_vccz Ld_164
    s_sub_u32 s27, s27, 1
    s_cbranch_scc1 L_abort
    s_sleep 6
    s_branch Lp_163
Ld_164:
    v_readfirstlane_b32 s26, v4
    s_nop 0
    s_and_b32 s26, s26, 0xffff
    s_cmp_gt_u32 s26, 512
    s_cselect_b32 s26, 8192, 0
    s_mul_i32 s29, s80, 6
    s_add_u32 s29, s29, s24
    s_lshl_b32 s66, s29, 7
    s_add_u32 s66, s66, s26
    s_add_u32 s66, s66, 0x149000
    s_mov_b32 s67, s26
    s_lshl_b32 s39, s80, 11
    s_add_u32 s39, s39, 0x144000
    s_mov_b32 s71, s24
    v_mov_b32 v27, 0
    s_add_u32 s30, s71, 0
    s_mul_i32 s69, s30, 13108
    s_lshr_b32 s69, s69, 16
    s_mul_i32 s31, s69, 5
    s_sub_u32 s31, s30, s31
    s_and_b32 s62, s69, 31
    s_mul_i32 s62, s62, 2097152
    s_mul_i32 s30, s31, 81920
    s_add_u32 s62, s62, s30
    s_add_u32 s62, s62, s32
    s_mul_i32 s63, s69, 81920
    s_add_u32 s63, s63, s70
    s_add_u32 s63, s63, 0x700000
    s_mul_i32 s30, s69, 40960
    s_lshl_b32 s65, s31, 6
    s_add_u32 s65, s65, s30
    s_add_u32 s65, s65, s34
    s_lshl_b32 s72, s31, 10
    s_add_u32 s72, s72, s30
    s_add_u32 s72, s72, s33
    s_mov_b64 exec, 1
    s_add_u32 s30, s26, 0x14c000
    s_mov_b32 s27, 0x100000
Lp_165:
    buffer_load_dword v4, v3, s[4:7], s30 offen sc1
    s_waitcnt vmcnt(0)
    v_cmp_gt_u32 vcc, 1, v4
    s_nop 0
    s_cbranch_vccz Ld_166
    s_sub_u32 s27, s27, 1
    s_cbranch_scc1 L_abort
    s_sleep 16
    s_branch Lp_165
Ld_166:
    s_mov_b64 exec, -1
    s_add_u32 s38, s62, s35
    s_cmp_lt_u32 s69, s37
    s_cbranch_scc1 Lv_167
    s_add_u32 s37, s69, 1
    s_mov_b32 s27, 0x100000
Lp_168:
    buffer_load_dwordx4 v[28:31], v11, s[4:7], s68 offen sc1
    s_waitcnt vmcnt(0)
    v_min3_u32 v28, v28, v29, v30
    v_min_u32 v28, v28, v31
    v_cmp_gt_u32 vcc, s37, v28
    s_nop 0
    s_cbranch_vccz Ld_169
    s_sub_u32 s27, s27, 1
    s_cbranch_scc1 L_abort
    s_sleep 16
    s_branch Lp_168
Ld_169:
    s_add_u32 s29, s37, 8
    s_min_u32 s29, s29, 64
    v_cmp_gt_u32 vcc, s29, v28
    s_nop 0
    s_cmp_eq_u64 vcc, 0
    s_cselect_b32 s37, s29, s37
Lv_167:
    s_add_u32 m0, s35, 0
    s_add_u32 s60, s38, 0
    buffer_load_dwordx4 v2, s[4:7], s60 offen offset:0 sc1 lds
    s_mov_b64 exec, -1
    buffer_load_dwordx4 v2, s[4:7], s60 offen offset:1024 sc1 lds
    s_mov_b64 exec, -1
    buffer_load_dwordx4 v2, s[4:7], s60 offen offset:2048 sc1 lds
    s_mov_b64 exec, -1
    buffer_load_dwordx4 v2, s[4:7], s60 offen offset:3072 sc1 lds
    s_mov_b64 exec, -1
    s_add_u32 m0, s35, 4096
    s_add_u32 s60, s38, 4096
    buffer_load_dwordx4 v2, s[4:7], s60 offen offset:0 sc1 lds
    s_mov_b64 exec, -1
    buffer_load_dwordx4 v2, s[4:7], s60 offen offset:1024 sc1 lds
    s_mov_b64 exec, -1
    buffer_load_dwordx4 v2, s[4:7], s60 offen offset:2048 sc1 lds
    s_mov_b64 exec, -1
    buffer_load_dwordx4 v2, s[4:7], s60 offen offset:3072 sc1 lds
    s_mov_b64 exec, -1
    s_add_u32 m0, s35, 8192
    s_add_u32 s60, s38, 8192
    buffer_load_dwordx4 v2, s[4:7], s60 offen offset:0 sc1 lds
    s_mov_b64 exec, -1
    buffer_load_dwordx4 v2, s[4:7], s60 offen offset:1024 sc1 lds
    s_mov_b64 exec, -1
    buffer_load_dwordx4 v2, s[4:7], s60 offen offset:2048 sc1 lds
    s_mov_b64 exec, -1
    buffer_load_dwordx4 v2, s[4:7], s60 offen offset:3072 sc1 lds
    s_mov_b64 exec, -1
    s_add_u32 m0, s35, 12288
    s_add_u32 s60, s38, 12288
    buffer_load_dwordx4 v2, s[4:7], s60 offen offset:0 sc1 lds
    s_mov_b64 exec, -1
    buffer_load_dwordx4 v2, s[4:7], s60 offen offset:1024 sc1 lds
    s_mov_b64 exec, -1
    buffer_load_dwordx4 v2, s[4:7], s60 offen offset:2048 sc1 lds
    s_mov_b64 exec, -1
    buffer_load_dwordx4 v2, s[4:7], s60 offen offset:3072 sc1 lds
    s_mov_b64 exec, -1
L_loop_X2:
    s_cmp_ge_u32 s71, 304
    s_cbranch_scc1 L_X2_fin0
    s_mov_b32 s25, s69
    s_waitcnt vmcnt(0)
    s_barrier
    s_cmp_lg_u32 s3, 1
    s_cbranch_scc1 Lf_170
    v_mov_b32 v4, s71
    s_mov_b64 exec, 1
    buffer_store_dword v4, v3, s[4:7], s66 offen sc1
    s_mov_b64 exec, -1
Lf_170:
    s_cmp_lg_u32 s3, 0
    s_cbranch_scc1 Lw_171
    s_cmp_lt_u32 s69, 0
    s_cselect_b32 exec_lo, 0, -1
    s_cselect_b32 s29, 3, 1
    s_add_u32 s29, s29, s69
    v_cmp_gt_u32 vcc, s29, v27
    s_nop 0
    s_cbranch_vccz Lw_171
    s_mov_b32 s27, 0x100000
Lp_172:
    buffer_load_dword v4, v10, s[4:7], s67 offen sc1
    s_waitcnt vmcnt(0)
    v_cmp_gt_u32 vcc, s29, v4
    s_nop 0
    s_cbranch_vccz Ld_173
    s_sub_u32 s27, s27, 1
    s_cbranch_scc1 L_abort
    s_sleep 12
    s_branch Lp_172
Ld_173:
Lw_171:
    s_mov_b64 exec, -1
    s_barrier
    s_add_u32 m0, s36, 0
    s_add_u32 s60, s62, s36
    buffer_load_dwordx4 v2, s[4:7], s60 offen offset:0 sc1 lds
    buffer_load_dwordx4 v2, s[4:7], s60 offen offset:1024 sc1 lds
    buffer_load_dwordx4 v2, s[4:7], s60 offen offset:2048 sc1 lds
    buffer_load_dwordx4 v2, s[4:7], s60 offen offset:3072 sc1 lds
    s_mov_b64 exec, -1
    buffer_load_dword v24, v9, s[12:15], s65 offen offset:0
    buffer_load_dword v25, v9, s[12:15], s65 offen offset:32
    s_mov_b64 exec, s[78:79]
    s_add_u32 s61, s63, 0
    buffer_load_dwordx4 v[64:67], v2, s[4:7], s61 offen offset:0 sc1
    buffer_load_dwordx4 v[68:71], v2, s[4:7], s61 offen offset:1024 sc1
    buffer_load_dwordx4 v[72:75], v2, s[4:7], s61 offen offset:2048 sc1
    buffer_load_dwordx4 v[76:79], v2, s[4:7], s61 offen offset:3072 sc1
    s_add_u32 s61, s63, 4096
    buffer_load_dwordx4 v[80:83], v2, s[4:7], s61 offen offset:0 sc1
    buffer_load_dwordx4 v[84:87], v2, s[4:7], s61 offen offset:1024 sc1
    buffer_load_dwordx4 v[88:91], v2, s[4:7], s61 offen offset:2048 sc1
    buffer_load_dwordx4 v[92:95], v2, s[4:7], s61 offen offset:3072 sc1
    s_add_u32 s61, s63, 8192
    buffer_load_dwordx4 v[96:99], v2, s[4:7], s61 offen offset:0 sc1
    buffer_load_dwordx4 v[100:103], v2, s[4:7], s61 offen offset:1024 sc1
    buffer_load_dwordx4 v[104:107], v2, s[4:7], s61 offen offset:2048 sc1
    buffer_load_dwordx4 v[108:111], v2, s[4:7], s61 offen offset:3072 sc1
    s_add_u32 s61, s63, 12288
    buffer_load_dwordx4 v[112:115], v2, s[4:7], s61 offen offset:0 sc1
    buffer_load_dwordx4 v[116:119], v2, s[4:7], s61 offen offset:1024 sc1
    buffer_load_dwordx4 v[120:123], v2, s[4:7], s61 offen offset:2048 sc1
    buffer_load_dwordx4 v[124:127], v2, s[4:7], s61 offen offset:3072 sc1
    s_mov_b64 exec, -1
    s_add_u32 s61, s63, 16384
    buffer_load_dwordx2 v[128:129], v7, s[4:7], s61 offen offset:0 sc1
    buffer_load_dwordx2 v[130:131], v7, s[4:7], s61 offen offset:128 sc1
    buffer_load_dwordx2 v[132:133], v7, s[4:7], s61 offen offset:1024 sc1
    buffer_load_dwordx2 v[134:135], v7, s[4:7], s61 offen offset:1152 sc1
    buffer_load_dwordx2 v[136:137], v7, s[4:7], s61 offen offset:2048 sc1
    buffer_load_dwordx2 v[138:139], v7, s[4:7], s61 offen offset:2176 sc1
    buffer_load_dwordx2 v[140:141], v7, s[4:7], s61 offen offset:3072 sc1
    buffer_load_dwordx2 v[142:143], v7, s[4:7], s61 offen offset:3200 sc1
    s_mov_b32 s64, s72
    s_add_u32 s30, s71, 6
    s_mul_i32 s69, s30, 13108
    s_lshr_b32 s69, s69, 16
    s_mul_i32 s31, s69, 5
    s_sub_u32 s31, s30, s31
    s_and_b32 s62, s69, 31
    s_mul_i32 s62, s62, 2097152
    s_mul_i32 s30, s31, 81920
    s_add_u32 s62, s62, s30
    s_add_u32 s62, s62, s32
    s_mul_i32 s63, s69, 81920
    s_add_u32 s63, s63, s70
    s_add_u32 s63, s63, 0x700000
    s_mul_i32 s30, s69, 40960
    s_lshl_b32 s65, s31, 6
    s_add_u32 s65, s65, s30
    s_add_u32 s65, s65, s34
    s_lshl_b32 s72, s31, 10
    s_add_u32 s72, s72, s30
    s_add_u32 s72, s72, s33
    s_add_u32 s38, s62, s35
    s_cmp_lt_u32 s69, s37
    s_cbranch_scc1 Lv_174
    s_add_u32 s37, s69, 1
    s_mov_b32 s27, 0x100000
Lp_175:
    buffer_load_dwordx4 v[28:31], v11, s[4:7], s68 offen sc1
    s_waitcnt vmcnt(0)
    v_min3_u32 v28, v28, v29, v30
    v_min_u32 v28, v28, v31
    v_cmp_gt_u32 vcc, s37, v28
    s_nop 0
    s_cbranch_vccz Ld_176
    s_sub_u32 s27, s27, 1
    s_cbranch_scc1 L_abort
    s_sleep 16
    s_branch Lp_175
Ld_176:
    s_add_u32 s29, s37, 8
    s_min_u32 s29, s29, 64
    v_cmp_gt_u32 vcc, s29, v28
    s_nop 0
    s_cmp_eq_u64 vcc, 0
    s_cselect_b32 s37, s29, s37
Lv_174:
    v_pk_mov_b32 v[16:17], 0, 0
    v_pk_mov_b32 v[18:19], 0, 0
    v_pk_mov_b32 v[20:21], 0, 0
    v_pk_mov_b32 v[22:23], 0, 0
    ds_read_b128 v[32:35], v12 offset:0
    ds_read_b128 v[36:39], v12 offset:1024
    ds_read_b128 v[40:43], v13 offset:0
    ds_read_b128 v[44:47], v13 offset:1024
    ds_read_b128 v[48:51], v12 offset:2048
    ds_read_b128 v[52:55], v12 offset:3072
    s_waitcnt vmcnt(23)
    s_waitcnt lgkmcnt(4)
    v_smfmac_f32_16x16x64_bf16 v[16:19], v[64:67], v[32:39], v6
    ds_read_b128 v[56:59], v13 offset:2048
    ds_read_b128 v[60:63], v13 offset:3072
    s_waitcnt lgkmcnt(4)
    v_smfmac_f32_16x16x64_bf16 v[20:23], v[64:67], v[40:47], v6
    ds_read_b128 v[32:35], v12 offset:4096
    ds_read_b128 v[36:39], v12 offset:5120
    s_add_u32 m0, s35, 81920
    s_add_u32 s60, s38, 0
    buffer_load_dwordx4 v2, s[4:7], s60 offen offset:0 sc1 lds
    s_mov_b64 exec, -1
    s_waitcnt vmcnt(23)
    s_waitcnt lgkmcnt(4)
    v_smfmac_f32_16x16x64_bf16 v[16:19], v[68:71], v[48:55], v6
    ds_read_b128 v[40:43], v13 offset:4096
    ds_read_b128 v[44:47], v13 offset:5120
    s_waitcnt lgkmcnt(4)
    v_smfmac_f32_16x16x64_bf16 v[20:23], v[68:71], v[56:63], v6
    ds_read_b128 v[48:51], v12 offset:6144
    ds_read_b128 v[52:55], v12 offset:7168
    buffer_load_dwordx4 v2, s[4:7], s60 offen offset:1024 sc1 lds
    s_mov_b64 exec, -1
    s_waitcnt vmcnt(23)
    s_waitcnt lgkmcnt(4)
    v_smfmac_f32_16x16x64_bf16 v[16:19], v[72:75], v[32:39], v6
    ds_read_b128 v[56:59], v13 offset:6144
    ds_read_b128 v[60:63], v13 offset:7168
    s_waitcnt lgkmcnt(4)
    v_smfmac_f32_16x16x64_bf16 v[20:23], v[72:75], v[40:47], v6
    ds_read_b128 v[32:35], v12 offset:8192
    ds_read_b128 v[36:39], v12 offset:9216
    buffer_load_dwordx4 v2, s[4:7], s60 offen offset:2048 sc1 lds
    s_mov_b64 exec, -1
    s_waitcnt vmcnt(23)
    s_waitcnt lgkmcnt(4)
    v_smfmac_f32_16x16x64_bf16 v[16:19], v[76:79], v[48:55], v6
    ds_read_b128 v[40:43], v13 offset:8192
    ds_read_b128 v[44:47], v13 offset:9216
    s_waitcnt lgkmcnt(4)
    v_smfmac_f32_16x16x64_bf16 v[20:23], v[76:79], v[56:63], v6
    ds_read_b128 v[48:51], v12 offset:10240
    ds_read_b128 v[52:55], v12 offset:11264
    buffer_load_dwordx4 v2, s[4:7], s60 offen offset:3072 sc1 lds
    s_mov_b64 exec, -1
    s_waitcnt vmcnt(23)
    s_waitcnt lgkmcnt(4)
    v_smfmac_f32_16x16x64_bf16 v[16:19], v[80:83], v[32:39], v6
    ds_read_b128 v[56:59], v13 offset:10240
    ds_read_b128 v[60:63], v13 offset:11264
    s_waitcnt lgkmcnt(4)
    v_smfmac_f32_16x16x64_bf16 v[20:23], v[80:83], v[40:47], v6
    s_add_u32 s30, s66, 33792
    s_add_u32 s31, s71, 6
    v_mov_b32 v4, s31
    s_cmp_ge_u32 s25, 56
    s_cselect_b32 s31, s3, 0
    s_cmp_eq_u32 s31, 3
    s_cselect_b64 exec, 1, 0
    buffer_store_dword v4, v3, s[4:7], s30 offen sc1
    s_mov_b64 exec, -1
    ds_read_b128 v[32:35], v12 offset:12288
    ds_read_b128 v[36:39], v12 offset:13312
    s_add_u32 m0, s35, 86016
    s_add_u32 s60, s38, 4096
    buffer_load_dwordx4 v2, s[4:7], s60 offen offset:0 sc1 lds
    s_mov_b64 exec, -1
    s_waitcnt vmcnt(24)
    s_waitcnt lgkmcnt(4)
    v_smfmac_f32_16x16x64_bf16 v[16:19], v[84:87], v[48:55], v6
    ds_read_b128 v[40:43], v13 offset:12288
    ds_read_b128 v[44:47], v13 offset:13312
    s_waitcnt lgkmcnt(4)
    v_smfmac_f32_16x16x64_bf16 v[20:23], v[84:87], v[56:63], v6
    ds_read_b128 v[48:51], v12 offset:14336
    ds_read_b128 v[52:55], v12 offset:15360
    buffer_load_dwordx4 v2, s[4:7], s60 offen offset:1024 sc1 lds
    s_mov_b64 exec, -1
    s_waitcnt vmcnt(24)
    s_waitcnt lgkmcnt(4)
    v_smfmac_f32_16x16x64_bf16 v[16:19], v[88:91], v[32:39], v6
    ds_read_b128 v[56:59], v13 offset:14336
    ds_read_b128 v[60:63], v13 offset:15360
    s_waitcnt lgkmcnt(4)
    v_smfmac_f32_16x16x64_bf16 v[20:23], v[88:91], v[40:47], v6
    ds_read_b128 v[32:35], v12 offset:16384
    ds_read_b128 v[36:39], v12 offset:17408
    buffer_load_dwordx4 v2, s[4:7], s60 offen offset:2048 sc1 lds
    s_mov_b64 exec, -1
    s_waitcnt vmcnt(24)
    s_waitcnt lgkmcnt(4)
    v_smfmac_f32_16x16x64_bf16 v[16:19], v[92:95], v[48:55], v6
    ds_read_b128 v[40:43], v13 offset:16384
    ds_read_b128 v[44:47], v13 offset:17408
    s_waitcnt lgkmcnt(4)
    v_smfmac_f32_16x16x64_bf16 v[20:23], v[92:95], v[56:63], v6
    ds_read_b128 v[48:51], v12 offset:18432
    ds_read_b128 v[52:55], v12 offset:19456
    buffer_load_dwordx4 v2, s[4:7], s60 offen offset:3072 sc1 lds
    s_mov_b64 exec, -1
    s_waitcnt vmcnt(24)
    s_waitcnt lgkmcnt(4)
    v_smfmac_f32_16x16x64_bf16 v[16:19], v[96:99], v[32:39], v6
    ds_read_b128 v[56:59], v13 offset:18432
    ds_read_b128 v[60:63], v13 offset:19456
    s_waitcnt lgkmcnt(4)
    v_smfmac_f32_16x16x64_bf16 v[20:23], v[96:99], v[40:47], v6
    ds_read_b128 v[32:35], v12 offset:20480
    ds_read_b128 v[36:39], v12 offset:21504
    s_add_u32 m0, s35, 90112
    s_add_u32 s60, s38, 8192
    buffer_load_dwordx4 v2, s[4:7], s60 offen offset:0 sc1 lds
    s_mov_b64 exec, -1
    s_waitcnt vmcnt(24)
    s_waitcnt lgkmcnt(4)
    v_smfmac_f32_16x16x64_bf16 v[16:19], v[100:103], v[48:55], v6
    ds_read_b128 v[40:43], v13 offset:20480
    ds_read_b128 v[44:47], v13 offset:21504
    s_waitcnt lgkmcnt(4)
    v_smfmac_f32_16x16x64_bf16 v[20:23], v[100:103], v[56:63], v6
    ds_read_b128 v[48:51], v12 offset:22528
    ds_read_b128 v[52:55], v12 offset:23552
    buffer_load_dwordx4 v2, s[4:7], s60 offen offset:1024 sc1 lds
    s_mov_b64 exec, -1
    s_waitcnt vmcnt(24)
    s_waitcnt lgkmcnt(4)
    v_smfmac_f32_16x16x64_bf16 v[16:19], v[104:107], v[32:39], v6
    ds_read_b128 v[56:59], v13 offset:22528
    ds_read_b128 v[60:63], v13 offset:23552
    s_waitcnt lgkmcnt(4)
    v_smfmac_f32_16x16x64_bf16 v[20:23], v[104:107], v[40:47], v6
    ds_read_b128 v[32:35], v12 offset:24576
    ds_read_b128 v[36:39], v12 offset:25600
    buffer_load_dwordx4 v2, s[4:7], s60 offen offset:2048 sc1 lds
    s_mov_b64 exec, -1
    s_waitcnt vmcnt(24)
    s_waitcnt lgkmcnt(4)
    v_smfmac_f32_16x16x64_bf16 v[16:19], v[108:111], v[48:55], v6
    ds_read_b128 v[40:43], v13 offset:24576
    ds_read_b128 v[44:47], v13 offset:25600
    s_waitcnt lgkmcnt(4)
    v_smfmac_f32_16x16x64_bf16 v[20:23], v[108:111], v[56:63], v6
    ds_read_b128 v[48:51], v12 offset:26624
    ds_read_b128 v[52:55], v12 offset:27648
    buffer_load_dwordx4 v2, s[4:7], s60 offen offset:3072 sc1 lds
    s_mov_b64 exec, -1
    s_waitcnt vmcnt(24)
    s_waitcnt lgkmcnt(4)
    v_smfmac_f32_16x16x64_bf16 v[16:19], v[112:115], v[32:39], v6
    ds_read_b128 v[56:59], v13 offset:26624
    ds_read_b128 v[60:63], v13 offset:27648
    s_waitcnt lgkmcnt(4)
    v_smfmac_f32_16x16x64_bf16 v[20:23], v[112:115], v[40:47], v6
    ds_read_b128 v[32:35], v12 offset:28672
    ds_read_b128 v[36:39], v12 offset:29696
    s_add_u32 m0, s35, 94208
    s_add_u32 s60, s38, 12288
    buffer_load_dwordx4 v2, s[4:7], s60 offen offset:0 sc1 lds
    s_mov_b64 exec, -1
    s_waitcnt vmcnt(24)
    s_waitcnt lgkmcnt(4)
    v_smfmac_f32_16x16x64_bf16 v[16:19], v[116:119], v[48:55], v6
    ds_read_b128 v[40:43], v13 offset:28672
    ds_read_b128 v[44:47], v13 offset:29696
    s_waitcnt lgkmcnt(4)
    v_smfmac_f32_16x16x64_bf16 v[20:23], v[116:119], v[56:63], v6
    ds_read_b128 v[48:51], v12 offset:30720
    ds_read_b128 v[52:55], v12 offset:31744
    buffer_load_dwordx4 v2, s[4:7], s60 offen offset:1024 sc1 lds
    s_mov_b64 exec, -1
    s_waitcnt vmcnt(24)
    s_waitcnt lgkmcnt(4)
    v_smfmac_f32_16x16x64_bf16 v[16:19], v[120:123], v[32:39], v6
    ds_read_b128 v[56:59], v13 offset:30720
    ds_read_b128 v[60:63], v13 offset:31744
    s_waitcnt lgkmcnt(4)
    v_smfmac_f32_16x16x64_bf16 v[20:23], v[120:123], v[40:47], v6
    s_barrier
    ds_read_b128 v[32:35], v12 offset:32768
    ds_read_b128 v[36:39], v12 offset:33792
    buffer_load_dwordx4 v2, s[4:7], s60 offen offset:2048 sc1 lds
    s_mov_b64 exec, -1
    s_waitcnt vmcnt(24)
    s_waitcnt lgkmcnt(4)
    v_smfmac_f32_16x16x64_bf16 v[16:19], v[124:127], v[48:55], v6
    ds_read_b128 v[40:43], v13 offset:32768
    ds_read_b128 v[44:47], v13 offset:33792
    s_waitcnt lgkmcnt(4)
    v_smfmac_f32_16x16x64_bf16 v[20:23], v[124:127], v[56:63], v6
    ds_read_b128 v[48:51], v12 offset:34816
    ds_read_b128 v[52:55], v12 offset:35840
    buffer_load_dwordx4 v2, s[4:7], s60 offen offset:3072 sc1 lds
    s_mov_b64 exec, -1
    s_waitcnt vmcnt(23)
    s_waitcnt lgkmcnt(4)
    v_smfmac_f32_16x16x64_bf16 v[16:19], v[128:131], v[32:39], v6
    ds_read_b128 v[56:59], v13 offset:34816
    ds_read_b128 v[60:63], v13 offset:35840
    s_waitcnt lgkmcnt(4)
    v_smfmac_f32_16x16x64_bf16 v[20:23], v[128:131], v[40:47], v6
    ds_read_b128 v[32:35], v12 offset:36864
    ds_read_b128 v[36:39], v12 offset:37888
    s_waitcnt vmcnt(21)
    s_waitcnt lgkmcnt(4)
    v_smfmac_f32_16x16x64_bf16 v[16:19], v[132:135], v[48:55], v6
    ds_read_b128 v[40:43], v13 offset:36864
    ds_read_b128 v[44:47], v13 offset:37888
    s_waitcnt lgkmcnt(4)
    v_smfmac_f32_16x16x64_bf16 v[20:23], v[132:135], v[56:63], v6
    ds_read_b128 v[48:51], v12 offset:38912
    ds_read_b128 v[52:55], v12 offset:39936
    s_waitcnt vmcnt(19)
    s_waitcnt lgkmcnt(4)
    v_smfmac_f32_16x16x64_bf16 v[16:19], v[136:139], v[32:39], v6
    ds_read_b128 v[56:59], v13 offset:38912
    ds_read_b128 v[60:63], v13 offset:39936
    s_waitcnt lgkmcnt(4)
    v_smfmac_f32_16x16x64_bf16 v[20:23], v[136:139], v[40:47], v6
    s_waitcnt vmcnt(17)
    s_waitcnt lgkmcnt(2)
    v_smfmac_f32_16x16x64_bf16 v[16:19], v[140:143], v[48:55], v6
    s_waitcnt lgkmcnt(0)
    v_smfmac_f32_16x16x64_bf16 v[20:23], v[140:143], v[56:63], v6
    s_cmp_lg_u32 s3, 0
    s_nop 5
    s_cbranch_scc1 Lf_177
    s_cmp_lt_u32 s69, 0
    s_cselect_b32 exec_lo, 0, -1
    s_cselect_b32 s29, 3, 1
    s_add_u32 s29, s29, s69
    buffer_load_dword v27, v10, s[4:7], s67 offen sc1
    s_mov_b64 exec, -1
Lf_177:
    v_permlane32_swap_b32 v16, v18
    v_permlane32_swap_b32 v17, v19
    v_pk_add_f32 v[16:17], v[16:17], v[18:19]
    s_mov_b64 vcc, s[74:75]
    s_nop 0
    v_cndmask_b32_dpp v18, v17, v16, vcc quad_perm:[1,0,3,2] row_mask:0xf bank_mask:0xf
    s_mov_b64 vcc, s[76:77]
    v_cndmask_b32_dpp v19, v16, v17, vcc quad_perm:[1,0,3,2] row_mask:0xf bank_mask:0xf
    v_cvt_pk_bf16_f32 v16, v18, v19
    v_lshlrev_b32 v17, 16, v16
    v_and_b32 v16, 0xffff0000, v16
    v_lshlrev_b32 v18, 16, v24
    v_and_b32 v19, 0xffff0000, v24
    v_add_f32 v17, v17, v18
    v_add_f32 v16, v16, v19
    v_cvt_pk_bf16_f32 v16, v17, v16
    v_min_u32 v16, 0xfffffffe, v16
    buffer_store_dword v16, v8, s[4:7], s64 offen offset:0 sc1
    v_permlane32_swap_b32 v20, v22
    v_permlane32_swap_b32 v21, v23
    v_pk_add_f32 v[20:21], v[20:21], v[22:23]
    s_mov_b64 vcc, s[74:75]
    s_nop 0
    v_cndmask_b32_dpp v22, v21, v20, vcc quad_perm:[1,0,3,2] row_mask:0xf bank_mask:0xf
    s_mov_b64 vcc, s[76:77]
    v_cndmask_b32_dpp v23, v20, v21, vcc quad_perm:[1,0,3,2] row_mask:0xf bank_mask:0xf
    v_cvt_pk_bf16_f32 v20, v22, v23
    v_lshlrev_b32 v21, 16, v20
    v_and_b32 v20, 0xffff0000, v20
    v_lshlrev_b32 v22, 16, v25
    v_and_b32 v23, 0xffff0000, v25
    v_add_f32 v21, v21, v22
    v_add_f32 v20, v20, v23
    v_cvt_pk_bf16_f32 v20, v21, v20
    v_min_u32 v20, 0xfffffffe, v20
    buffer_store_dword v20, v8, s[4:7], s64 offen offset:512 sc1
    s_add_u32 s71, s71, 6
    s_cmp_ge_u32 s71, 304
    s_cbranch_scc1 L_X2_fin1
    s_mov_b32 s25, s69
    s_waitcnt vmcnt(0)
    s_barrier
    s_cmp_lg_u32 s3, 1
    s_cbranch_scc1 Lf_178
    v_mov_b32 v4, s71
    s_mov_b64 exec, 1
    buffer_store_dword v4, v3, s[4:7], s66 offen sc1
    s_mov_b64 exec, -1
Lf_178:
    s_cmp_lg_u32 s3, 0
    s_cbranch_scc1 Lw_179
    s_cmp_lt_u32 s69, 0
    s_cselect_b32 exec_lo, 0, -1
    s_cselect_b32 s29, 3, 1
    s_add_u32 s29, s29, s69
    v_cmp_gt_u32 vcc, s29, v27
    s_nop 0
    s_cbranch_vccz Lw_179
    s_mov_b32 s27, 0x100000
Lp_180:
    buffer_load_dword v4, v10, s[4:7], s67 offen sc1
    s_waitcnt vmcnt(0)
    v_cmp_gt_u32 vcc, s29, v4
    s_nop 0
    s_cbranch_vccz Ld_181
    s_sub_u32 s27, s27, 1
    s_cbranch_scc1 L_abort
    s_sleep 12
    s_branch Lp_180
Ld_181:
Lw_179:
    s_mov_b64 exec, -1
    s_barrier
    s_add_u32 m0, s36, 81920
    s_add_u32 s60, s62, s36
    buffer_load_dwordx4 v2, s[4:7], s60 offen offset:0 sc1 lds
    buffer_load_dwordx4 v2, s[4:7], s60 offen offset:1024 sc1 lds
    buffer_load_dwordx4 v2, s[4:7], s60 offen offset:2048 sc1 lds
    buffer_load_dwordx4 v2, s[4:7], s60 offen offset:3072 sc1 lds
    s_mov_b64 exec, -1
    buffer_load_dword v24, v9, s[12:15], s65 offen offset:0
    buffer_load_dword v25, v9, s[12:15], s65 offen offset:32
    s_mov_b64 exec, s[78:79]
    s_add_u32 s61, s63, 0
    buffer_load_dwordx4 v[64:67], v2, s[4:7], s61 offen offset:0 sc1
    buffer_load_dwordx4 v[68:71], v2, s[4:7], s61 offen offset:1024 sc1
    buffer_load_dwordx4 v[72:75], v2, s[4:7], s61 offen offset:2048 sc1
    buffer_load_dwordx4 v[76:79], v2, s[4:7], s61 offen offset:3072 sc1
    s_add_u32 s61, s63, 4096
    buffer_load_dwordx4 v[80:83], v2, s[4:7], s61 offen offset:0 sc1
    buffer_load_dwordx4 v[84:87], v2, s[4:7], s61 offen offset:1024 sc1
    buffer_load_dwordx4 v[88:91], v2, s[4:7], s61 offen offset:2048 sc1
    buffer_load_dwordx4 v[92:95], v2, s[4:7], s61 offen offset:3072 sc1
    s_add_u32 s61, s63, 8192
    buffer_load_dwordx4 v[96:99], v2, s[4:7], s61 offen offset:0 sc1
    buffer_load_dwordx4 v[100:103], v2, s[4:7], s61 offen offset:1024 sc1
    buffer_load_dwordx4 v[104:107], v2, s[4:7], s61 offen offset:2048 sc1
    buffer_load_dwordx4 v[108:111], v2, s[4:7], s61 offen offset:3072 sc1
    s_add_u32 s61, s63, 12288
    buffer_load_dwordx4 v[112:115], v2, s[4:7], s61 offen offset:0 sc1
    buffer_load_dwordx4 v[116:119], v2, s[4:7], s61 offen offset:1024 sc1
    buffer_load_dwordx4 v[120:123], v2, s[4:7], s61 offen offset:2048 sc1
    buffer_load_dwordx4 v[124:127], v2, s[4:7], s61 offen offset:3072 sc1
    s_mov_b64 exec, -1
    s_add_u32 s61, s63, 16384
    buffer_load_dwordx2 v[128:129], v7, s[4:7], s61 offen offset:0 sc1
    buffer_load_dwordx2 v[130:131], v7, s[4:7], s61 offen offset:128 sc1
    buffer_load_dwordx2 v[132:133], v7, s[4:7], s61 offen offset:1024 sc1
    buffer_load_dwordx2 v[134:135], v7, s[4:7], s61 offen offset:1152 sc1
    buffer_load_dwordx2 v[136:137], v7, s[4:7], s61 offen offset:2048 sc1
    buffer_load_dwordx2 v[138:139], v7, s[4:7], s61 offen offset:2176 sc1
    buffer_load_dwordx2 v[140:141], v7, s[4:7], s61 offen offset:3072 sc1
    buffer_load_dwordx2 v[142:143], v7, s[4:7], s61 offen offset:3200 sc1
    s_mov_b32 s64, s72
    s_add_u32 s30, s71, 6
    s_mul_i32 s69, s30, 13108
    s_lshr_b32 s69, s69, 16
    s_mul_i32 s31, s69, 5
    s_sub_u32 s31, s30, s31
    s_and_b32 s62, s69, 31
    s_mul_i32 s62, s62, 2097152
    s_mul_i32 s30, s31, 81920
    s_add_u32 s62, s62, s30
    s_add_u32 s62, s62, s32
    s_mul_i32 s63, s69, 81920
    s_add_u32 s63, s63, s70
    s_add_u32 s63, s63, 0x700000
    s_mul_i32 s30, s69, 40960
    s_lshl_b32 s65, s31, 6
    s_add_u32 s65, s65, s30
    s_add_u32 s65, s65, s34
    s_lshl_b32 s72, s31, 10
    s_add_u32 s72, s72, s30
    s_add_u32 s72, s72, s33
    s_add_u32 s38, s62, s35
    s_cmp_lt_u32 s69, s37
    s_cbranch_scc1 Lv_182
    s_add_u32 s37, s69, 1
    s_mov_b32 s27, 0x100000
Lp_183:
    buffer_load_dwordx4 v[28:31], v11, s[4:7], s68 offen sc1
    s_waitcnt vmcnt(0)
    v_min3_u32 v28, v28, v29, v30
    v_min_u32 v28, v28, v31
    v_cmp_gt_u32 vcc, s37, v28
    s_nop 0
    s_cbranch_vccz Ld_184
    s_sub_u32 s27, s27, 1
    s_cbranch_scc1 L_abort
    s_sleep 16
    s_branch Lp_183
Ld_184:
    s_add_u32 s29, s37, 8
    s_min_u32 s29, s29, 64
    v_cmp_gt_u32 vcc, s29, v28
    s_nop 0
    s_cmp_eq_u64 vcc, 0
    s_cselect_b32 s37, s29, s37
Lv_182:
    v_pk_mov_b32 v[16:17], 0, 0
    v_pk_mov_b32 v[18:19], 0, 0
    v_pk_mov_b32 v[20:21], 0, 0
    v_pk_mov_b32 v[22:23], 0, 0
    ds_read_b128 v[32:35], v14 offset:0
    ds_read_b128 v[36:39], v14 offset:1024
    ds_read_b128 v[40:43], v15 offset:0
    ds_read_b128 v[44:47], v15 offset:1024
    ds_read_b128 v[48:51], v14 offset:2048
    ds_read_b128 v[52:55], v14 offset:3072
    s_waitcnt vmcnt(23)
    s_waitcnt lgkmcnt(4)
    v_smfmac_f32_16x16x64_bf16 v[16:19], v[64:67], v[32:39], v6
    ds_read_b128 v[56:59], v15 offset:2048
    ds_read_b128 v[60:63], v15 offset:3072
    s_waitcnt lgkmcnt(4)
    v_smfmac_f32_16x16x64_bf16 v[20:23], v[64:67], v[40:47], v6
    ds_read_b128 v[32:35], v14 offset:4096
    ds_read_b128 v[36:39], v14 offset:5120
    s_add_u32 m0, s35, 0
    s_add_u32 s60, s38, 0
    buffer_load_dwordx4 v2, s[4:7], s60 offen offset:0 sc1 lds
    s_mov_b64 exec, -1
    s_waitcnt vmcnt(23)
    s_waitcnt lgkmcnt(4)
    v_smfmac_f32_16x16x64_bf16 v[16:19], v[68:71], v[48:55], v6
    ds_read_b128 v[40:43], v15 offset:4096
    ds_read_b128 v[44:47], v15 offset:5120
    s_waitcnt lgkmcnt(4)
    v_smfmac_f32_16x16x64_bf16 v[20:23], v[68:71], v[56:63], v6
    ds_read_b128 v[48:51], v14 offset:6144
    ds_read_b128 v[52:55], v14 offset:7168
    buffer_load_dwordx4 v2, s[4:7], s60 offen offset:1024 sc1 lds
    s_mov_b64 exec, -1
    s_waitcnt vmcnt(23)
    s_waitcnt lgkmcnt(4)
    v_smfmac_f32_16x16x64_bf16 v[16:19], v[72:75], v[32:39], v6
    ds_read_b128 v[56:59], v15 offset:6144
    ds_read_b128 v[60:63], v15 offset:7168
    s_waitcnt lgkmcnt(4)
    v_smfmac_f32_16x16x64_bf16 v[20:23], v[72:75], v[40:47], v6
    ds_read_b128 v[32:35], v14 offset:8192
    ds_read_b128 v[36:39], v14 offset:9216
    buffer_load_dwordx4 v2, s[4:7], s60 offen offset:2048 sc1 lds
    s_mov_b64 exec, -1
    s_waitcnt vmcnt(23)
    s_waitcnt lgkmcnt(4)
    v_smfmac_f32_16x16x64_bf16 v[16:19], v[76:79], v[48:55], v6
    ds_read_b128 v[40:43], v15 offset:8192
    ds_read_b128 v[44:47], v15 offset:9216
    s_waitcnt lgkmcnt(4)
    v_smfmac_f32_16x16x64_bf16 v[20:23], v[76:79], v[56:63], v6
    ds_read_b128 v[48:51], v14 offset:10240
    ds_read_b128 v[52:55], v14 offset:11264
    buffer_load_dwordx4 v2, s[4:7], s60 offen offset:3072 sc1 lds
    s_mov_b64 exec, -1
    s_waitcnt vmcnt(23)
    s_waitcnt lgkmcnt(4)
    v_smfmac_f32_16x16x64_bf16 v[16:19], v[80:83], v[32:39], v6
    ds_read_b128 v[56:59], v15 offset:10240
    ds_read_b128 v[60:63], v15 offset:11264
    s_waitcnt lgkmcnt(4)
    v_smfmac_f32_16x16x64_bf16 v[20:23], v[80:83], v[40:47], v6
    s_add_u32 s30, s66, 33792
    s_add_u32 s31, s71, 6
    v_mov_b32 v4, s31
    s_cmp_ge_u32 s25, 56
    s_cselect_b32 s31, s3, 0
    s_cmp_eq_u32 s31, 3
    s_cselect_b64 exec, 1, 0
    buffer_store_dword v4, v3, s[4:7], s30 offen sc1
    s_mov_b64 exec, -1
    ds_read_b128 v[32:35], v14 offset:12288
    ds_read_b128 v[36:39], v14 offset:13312
    s_add_u32 m0, s35, 4096
    s_add_u32 s60, s38, 4096
    buffer_load_dwordx4 v2, s[4:7], s60 offen offset:0 sc1 lds
    s_mov_b64 exec, -1
    s_waitcnt vmcnt(24)
    s_waitcnt lgkmcnt(4)
    v_smfmac_f32_16x16x64_bf16 v[16:19], v[84:87], v[48:55], v6
    ds_read_b128 v[40:43], v15 offset:12288
    ds_read_b128 v[44:47], v15 offset:13312
    s_waitcnt lgkmcnt(4)
    v_smfmac_f32_16x16x64_bf16 v[20:23], v[84:87], v[56:63], v6
    ds_read_b128 v[48:51], v14 offset:14336
    ds_read_b128 v[52:55], v14 offset:15360
    buffer_load_dwordx4 v2, s[4:7], s60 offen offset:1024 sc1 lds
    s_mov_b64 exec, -1
    s_waitcnt vmcnt(24)
    s_waitcnt lgkmcnt(4)
    v_smfmac_f32_16x16x64_bf16 v[16:19], v[88:91], v[32:39], v6
    ds_read_b128 v[56:59], v15 offset:14336
    ds_read_b128 v[60:63], v15 offset:15360
    s_waitcnt lgkmcnt(4)
    v_smfmac_f32_16x16x64_bf16 v[20:23], v[88:91], v[40:47], v6
    ds_read_b128 v[32:35], v14 offset:16384
    ds_read_b128 v[36:39], v14 offset:17408
    buffer_load_dwordx4 v2, s[4:7], s60 offen offset:2048 sc1 lds
    s_mov_b64 exec, -1
    s_waitcnt vmcnt(24)
    s_waitcnt lgkmcnt(4)
    v_smfmac_f32_16x16x64_bf16 v[16:19], v[92:95], v[48:55], v6
    ds_read_b128 v[40:43], v15 offset:16384
    ds_read_b128 v[44:47], v15 offset:17408
    s_waitcnt lgkmcnt(4)
    v_smfmac_f32_16x16x64_bf16 v[20:23], v[92:95], v[56:63], v6
    ds_read_b128 v[48:51], v14 offset:18432
    ds_read_b128 v[52:55], v14 offset:19456
    buffer_load_dwordx4 v2, s[4:7], s60 offen offset:3072 sc1 lds
    s_mov_b64 exec, -1
    s_waitcnt vmcnt(24)
    s_waitcnt lgkmcnt(4)
    v_smfmac_f32_16x16x64_bf16 v[16:19], v[96:99], v[32:39], v6
    ds_read_b128 v[56:59], v15 offset:18432
    ds_read_b128 v[60:63], v15 offset:19456
    s_waitcnt lgkmcnt(4)
    v_smfmac_f32_16x16x64_bf16 v[20:23], v[96:99], v[40:47], v6
    ds_read_b128 v[32:35], v14 offset:20480
    ds_read_b128 v[36:39], v14 offset:21504
    s_add_u32 m0, s35, 8192
    s_add_u32 s60, s38, 8192
    buffer_load_dwordx4 v2, s[4:7], s60 offen offset:0 sc1 lds
    s_mov_b64 exec, -1
    s_waitcnt vmcnt(24)
    s_waitcnt lgkmcnt(4)
    v_smfmac_f32_16x16x64_bf16 v[16:19], v[100:103], v[48:55], v6
    ds_read_b128 v[40:43], v15 offset:20480
    ds_read_b128 v[44:47], v15 offset:21504
    s_waitcnt lgkmcnt(4)
    v_smfmac_f32_16x16x64_bf16 v[20:23], v[100:103], v[56:63], v6
    ds_read_b128 v[48:51], v14 offset:22528
    ds_read_b128 v[52:55], v14 offset:23552
    buffer_load_dwordx4 v2, s[4:7], s60 offen offset:1024 sc1 lds
    s_mov_b64 exec, -1
    s_waitcnt vmcnt(24)
    s_waitcnt lgkmcnt(4)
    v_smfmac_f32_16x16x64_bf16 v[16:19], v[104:107], v[32:39], v6
    ds_read_b128 v[56:59], v15 offset:22528
    ds_read_b128 v[60:63], v15 offset:23552
    s_waitcnt lgkmcnt(4)
    v_smfmac_f32_16x16x64_bf16 v[20:23], v[104:107], v[40:47], v6
    ds_read_b128 v[32:35], v14 offset:24576
    ds_read_b128 v[36:39], v14 offset:25600
    buffer_load_dwordx4 v2, s[4:7], s60 offen offset:2048 sc1 lds
    s_mov_b64 exec, -1
    s_waitcnt vmcnt(24)
    s_waitcnt lgkmcnt(4)
    v_smfmac_f32_16x16x64_bf16 v[16:19], v[108:111], v[48:55], v6
    ds_read_b128 v[40:43], v15 offset:24576
    ds_read_b128 v[44:47], v15 offset:25600
    s_waitcnt lgkmcnt(4)
    v_smfmac_f32_16x16x64_bf16 v[20:23], v[108:111], v[56:63], v6
    ds_read_b128 v[48:51], v14 offset:26624
    ds_read_b128 v[52:55], v14 offset:27648
    buffer_load_dwordx4 v2, s[4:7], s60 offen offset:3072 sc1 lds
    s_mov_b64 exec, -1
    s_waitcnt vmcnt(24)
    s_waitcnt lgkmcnt(4)
    v_smfmac_f32_16x16x64_bf16 v[16:19], v[112:115], v[32:39], v6
    ds_read_b128 v[56:59], v15 offset:26624
    ds_read_b128 v[60:63], v15 offset:27648
    s_waitcnt lgkmcnt(4)
    v_smfmac_f32_16x16x64_bf16 v[20:23], v[112:115], v[40:47], v6
    ds_read_b128 v[32:35], v14 offset:28672
    ds_read_b128 v[36:39], v14 offset:29696
    s_add_u32 m0, s35, 12288
    s_add_u32 s60, s38, 12288
    buffer_load_dwordx4 v2, s[4:7], s60 offen offset:0 sc1 lds
    s_mov_b64 exec, -1
    s_waitcnt vmcnt(24)
    s_waitcnt lgkmcnt(4)
    v_smfmac_f32_16x16x64_bf16 v[16:19], v[116:119], v[48:55], v6
    ds_read_b128 v[40:43], v15 offset:28672
    ds_read_b128 v[44:47], v15 offset:29696
    s_waitcnt lgkmcnt(4)
    v_smfmac_f32_16x16x64_bf16 v[20:23], v[116:119], v[56:63], v6
    ds_read_b128 v[48:51], v14 offset:30720
    ds_read_b128 v[52:55], v14 offset:31744
    buffer_load_dwordx4 v2, s[4:7], s60 offen offset:1024 sc1 lds
    s_mov_b64 exec, -1
    s_waitcnt vmcnt(24)
    s_waitcnt lgkmcnt(4)
    v_smfmac_f32_16x16x64_bf16 v[16:19], v[120:123], v[32:39], v6
    ds_read_b128 v[56:59], v15 offset:30720
    ds_read_b128 v[60:63], v15 offset:31744
    s_waitcnt lgkmcnt(4)
    v_smfmac_f32_16x16x64_bf16 v[20:23], v[120:123], v[40:47], v6
    s_barrier
    ds_read_b128 v[32:35], v14 offset:32768
    ds_read_b128 v[36:39], v14 offset:33792
    buffer_load_dwordx4 v2, s[4:7], s60 offen offset:2048 sc1 lds
    s_mov_b64 exec, -1
    s_waitcnt vmcnt(24)
    s_waitcnt lgkmcnt(4)
    v_smfmac_f32_16x16x64_bf16 v[16:19], v[124:127], v[48:55], v6
    ds_read_b128 v[40:43], v15 offset:32768
    ds_read_b128 v[44:47], v15 offset:33792
    s_waitcnt lgkmcnt(4)
    v_smfmac_f32_16x16x64_bf16 v[20:23], v[124:127], v[56:63], v6
    ds_read_b128 v[48:51], v14 offset:34816
    ds_read_b128 v[52:55], v14 offset:35840
    buffer_load_dwordx4 v2, s[4:7], s60 offen offset:3072 sc1 lds
    s_mov_b64 exec, -1
    s_waitcnt vmcnt(23)
    s_waitcnt lgkmcnt(4)
    v_smfmac_f32_16x16x64_bf16 v[16:19], v[128:131], v[32:39], v6
    ds_read_b128 v[56:59], v15 offset:34816
    ds_read_b128 v[60:63], v15 offset:35840
    s_waitcnt lgkmcnt(4)
    v_smfmac_f32_16x16x64_bf16 v[20:23], v[128:131], v[40:47], v6
    ds_read_b128 v[32:35], v14 offset:36864
    ds_read_b128 v[36:39], v14 offset:37888
    s_waitcnt vmcnt(21)
    s_waitcnt lgkmcnt(4)
    v_smfmac_f32_16x16x64_bf16 v[16:19], v[132:135], v[48:55], v6
    ds_read_b128 v[40:43], v15 offset:36864
    ds_read_b128 v[44:47], v15 offset:37888
    s_waitcnt lgkmcnt(4)
    v_smfmac_f32_16x16x64_bf16 v[20:23], v[132:135], v[56:63], v6
    ds_read_b128 v[48:51], v14 offset:38912
    ds_read_b128 v[52:55], v14 offset:39936
    s_waitcnt vmcnt(19)
    s_waitcnt lgkmcnt(4)
    v_smfmac_f32_16x16x64_bf16 v[16:19], v[136:139], v[32:39], v6
    ds_read_b128 v[56:59], v15 offset:38912
    ds_read_b128 v[60:63], v15 offset:39936
    s_waitcnt lgkmcnt(4)
    v_smfmac_f32_16x16x64_bf16 v[20:23], v[136:139], v[40:47], v6
    s_waitcnt vmcnt(17)
    s_waitcnt lgkmcnt(2)
    v_smfmac_f32_16x16x64_bf16 v[16:19], v[140:143], v[48:55], v6
    s_waitcnt lgkmcnt(0)
    v_smfmac_f32_16x16x64_bf16 v[20:23], v[140:143], v[56:63], v6
    s_cmp_lg_u32 s3, 0
    s_nop 5
    s_cbranch_scc1 Lf_185
    s_cmp_lt_u32 s69, 0
    s_cselect_b32 exec_lo, 0, -1
    s_cselect_b32 s29, 3, 1
    s_add_u32 s29, s29, s69
    buffer_load_dword v27, v10, s[4:7], s67 offen sc1
    s_mov_b64 exec, -1
Lf_185:
    v_permlane32_swap_b32 v16, v18
    v_permlane32_swap_b32 v17, v19
    v_pk_add_f32 v[16:17], v[16:17], v[18:19]
    s_mov_b64 vcc, s[74:75]
    s_nop 0
    v_cndmask_b32_dpp v18, v17, v16, vcc quad_perm:[1,0,3,2] row_mask:0xf bank_mask:0xf
    s_mov_b64 vcc, s[76:77]
    v_cndmask_b32_dpp v19, v16, v17, vcc quad_perm:[1,0,3,2] row_mask:0xf bank_mask:0xf
    v_cvt_pk_bf16_f32 v16, v18, v19
    v_lshlrev_b32 v17, 16, v16
    v_and_b32 v16, 0xffff0000, v16
    v_lshlrev_b32 v18, 16, v24
    v_and_b32 v19, 0xffff0000, v24
    v_add_f32 v17, v17, v18
    v_add_f32 v16, v16, v19
    v_cvt_pk_bf16_f32 v16, v17, v16
    v_min_u32 v16, 0xfffffffe, v16
    buffer_store_dword v16, v8, s[4:7], s64 offen offset:0 sc1
    v_permlane32_swap_b32 v20, v22
    v_permlane32_swap_b32 v21, v23
    v_pk_add_f32 v[20:21], v[20:21], v[22:23]
    s_mov_b64 vcc, s[74:75]
    s_nop 0
    v_cndmask_b32_dpp v22, v21, v20, vcc quad_perm:[1,0,3,2] row_mask:0xf bank_mask:0xf
    s_mov_b64 vcc, s[76:77]
    v_cndmask_b32_dpp v23, v20, v21, vcc quad_perm:[1,0,3,2] row_mask:0xf bank_mask:0xf
    v_cvt_pk_bf16_f32 v20, v22, v23
    v_lshlrev_b32 v21, 16, v20
    v_and_b32 v20, 0xffff0000, v20
    v_lshlrev_b32 v22, 16, v25
    v_and_b32 v23, 0xffff0000, v25
    v_add_f32 v21, v21, v22
    v_add_f32 v20, v20, v23
    v_cvt_pk_bf16_f32 v20, v21, v20
    v_min_u32 v20, 0xfffffffe, v20
    buffer_store_dword v20, v8, s[4:7], s64 offen offset:512 sc1
    s_add_u32 s71, s71, 6
    s_branch L_loop_X2
L_X2_fin0:
    s_mov_b32 s25, s69
    s_waitcnt vmcnt(0)
    s_barrier
    s_cmp_lg_u32 s3, 1
    s_cbranch_scc1 Lf_186
    v_mov_b32 v4, s71
    s_mov_b64 exec, 1
    buffer_store_dword v4, v3, s[4:7], s66 offen sc1
    s_mov_b64 exec, -1
Lf_186:
    s_cmp_lg_u32 s3, 0
    s_cbranch_scc1 Lw_187
    s_cmp_lt_u32 s69, 0
    s_cselect_b32 exec_lo, 0, -1
    s_cselect_b32 s29, 3, 1
    s_add_u32 s29, s29, s69
    v_cmp_gt_u32 vcc, s29, v27
    s_nop 0
    s_cbranch_vccz Lw_187
    s_mov_b32 s27, 0x100000
Lp_188:
    buffer_load_dword v4, v10, s[4:7], s67 offen sc1
    s_waitcnt vmcnt(0)
    v_cmp_gt_u32 vcc, s29, v4
    s_nop 0
    s_cbranch_vccz Ld_189
    s_sub_u32 s27, s27, 1
    s_cbranch_scc1 L_abort
    s_sleep 12
    s_branch Lp_188
Ld_189:
Lw_187:
    s_mov_b64 exec, -1
    s_barrier
    s_add_u32 m0, s36, 0
    s_add_u32 s60, s62, s36
    buffer_load_dwordx4 v2, s[4:7], s60 offen offset:0 sc1 lds
    buffer_load_dwordx4 v2, s[4:7], s60 offen offset:1024 sc1 lds
    buffer_load_dwordx4 v2, s[4:7], s60 offen offset:2048 sc1 lds
    buffer_load_dwordx4 v2, s[4:7], s60 offen offset:3072 sc1 lds
    s_mov_b64 exec, -1
    buffer_load_dword v24, v9, s[12:15], s65 offen offset:0
    buffer_load_dword v25, v9, s[12:15], s65 offen offset:32
    s_mov_b64 exec, s[78:79]
    s_add_u32 s61, s63, 0
    buffer_load_dwordx4 v[64:67], v2, s[4:7], s61 offen offset:0 sc1
    buffer_load_dwordx4 v[68:71], v2, s[4:7], s61 offen offset:1024 sc1
    buffer_load_dwordx4 v[72:75], v2, s[4:7], s61 offen offset:2048 sc1
    buffer_load_dwordx4 v[76:79], v2, s[4:7], s61 offen offset:3072 sc1
    s_add_u32 s61, s63, 4096
    buffer_load_dwordx4 v[80:83], v2, s[4:7], s61 offen offset:0 sc1
    buffer_load_dwordx4 v[84:87], v2, s[4:7], s61 offen offset:1024 sc1
    buffer_load_dwordx4 v[88:91], v2, s[4:7], s61 offen offset:2048 sc1
    buffer_load_dwordx4 v[92:95], v2, s[4:7], s61 offen offset:3072 sc1
    s_add_u32 s61, s63, 8192
    buffer_load_dwordx4 v[96:99], v2, s[4:7], s61 offen offset:0 sc1
    buffer_load_dwordx4 v[100:103], v2, s[4:7], s61 offen offset:1024 sc1
    buffer_load_dwordx4 v[104:107], v2, s[4:7], s61 offen offset:2048 sc1
    buffer_load_dwordx4 v[108:111], v2, s[4:7], s61 offen offset:3072 sc1
    s_add_u32 s61, s63, 12288
    buffer_load_dwordx4 v[112:115], v2, s[4:7], s61 offen offset:0 sc1
    buffer_load_dwordx4 v[116:119], v2, s[4:7], s61 offen offset:1024 sc1
    buffer_load_dwordx4 v[120:123], v2, s[4:7], s61 offen offset:2048 sc1
    buffer_load_dwordx4 v[124:127], v2, s[4:7], s61 offen offset:3072 sc1
    s_mov_b64 exec, -1
    s_add_u32 s61, s63, 16384
    buffer_load_dwordx2 v[128:129], v7, s[4:7], s61 offen offset:0 sc1
    buffer_load_dwordx2 v[130:131], v7, s[4:7], s61 offen offset:128 sc1
    buffer_load_dwordx2 v[132:133], v7, s[4:7], s61 offen offset:1024 sc1
    buffer_load_dwordx2 v[134:135], v7, s[4:7], s61 offen offset:1152 sc1
    buffer_load_dwordx2 v[136:137], v7, s[4:7], s61 offen offset:2048 sc1
    buffer_load_dwordx2 v[138:139], v7, s[4:7], s61 offen offset:2176 sc1
    buffer_load_dwordx2 v[140:141], v7, s[4:7], s61 offen offset:3072 sc1
    buffer_load_dwordx2 v[142:143], v7, s[4:7], s61 offen offset:3200 sc1
    s_mov_b32 s64, s72
    v_pk_mov_b32 v[16:17], 0, 0
    v_pk_mov_b32 v[18:19], 0, 0
    v_pk_mov_b32 v[20:21], 0, 0
    v_pk_mov_b32 v[22:23], 0, 0
    ds_read_b128 v[32:35], v12 offset:0
    ds_read_b128 v[36:39], v12 offset:1024
    ds_read_b128 v[40:43], v13 offset:0
    ds_read_b128 v[44:47], v13 offset:1024
    ds_read_b128 v[48:51], v12 offset:2048
    ds_read_b128 v[52:55], v12 offset:3072
    s_waitcnt vmcnt(23)
    s_waitcnt lgkmcnt(4)
    v_smfmac_f32_16x16x64_bf16 v[16:19], v[64:67], v[32:39], v6
    ds_read_b128 v[56:59], v13 offset:2048
    ds_read_b128 v[60:63], v13 offset:3072
    s_waitcnt lgkmcnt(4)
    v_smfmac_f32_16x16x64_bf16 v[20:23], v[64:67], v[40:47], v6
    ds_read_b128 v[32:35], v12 offset:4096
    ds_read_b128 v[36:39], v12 offset:5120
    s_waitcnt vmcnt(22)
    s_waitcnt lgkmcnt(4)
    v_smfmac_f32_16x16x64_bf16 v[16:19], v[68:71], v[48:55], v6
    ds_read_b128 v[40:43], v13 offset:4096
    ds_read_b128 v[44:47], v13 offset:5120
    s_waitcnt lgkmcnt(4)
    v_smfmac_f32_16x16x64_bf16 v[20:23], v[68:71], v[56:63], v6
    ds_read_b128 v[48:51], v12 offset:6144
    ds_read_b128 v[52:55], v12 offset:7168
    s_waitcnt vmcnt(21)
    s_waitcnt lgkmcnt(4)
    v_smfmac_f32_16x16x64_bf16 v[16:19], v[72:75], v[32:39], v6
    ds_read_b128 v[56:59], v13 offset:6144
    ds_read_b128 v[60:63], v13 offset:7168
    s_waitcnt lgkmcnt(4)
    v_smfmac_f32_16x16x64_bf16 v[20:23], v[72:75], v[40:47], v6
    ds_read_b128 v[32:35], v12 offset:8192
    ds_read_b128 v[36:39], v12 offset:9216
    s_waitcnt vmcnt(20)
    s_waitcnt lgkmcnt(4)
    v_smfmac_f32_16x16x64_bf16 v[16:19], v[76:79], v[48:55], v6
    ds_read_b128 v[40:43], v13 offset:8192
    ds_read_b128 v[44:47], v13 offset:9216
    s_waitcnt lgkmcnt(4)
    v_smfmac_f32_16x16x64_bf16 v[20:23], v[76:79], v[56:63], v6
    ds_read_b128 v[48:51], v12 offset:10240
    ds_read_b128 v[52:55], v12 offset:11264
    s_waitcnt vmcnt(19)
    s_waitcnt lgkmcnt(4)
    v_smfmac_f32_16x16x64_bf16 v[16:19], v[80:83], v[32:39], v6
    ds_read_b128 v[56:59], v13 offset:10240
    ds_read_b128 v[60:63], v13 offset:11264
    s_waitcnt lgkmcnt(4)
    v_smfmac_f32_16x16x64_bf16 v[20:23], v[80:83], v[40:47], v6
    s_add_u32 s30, s66, 33792
    s_add_u32 s31, s71, 6
    v_mov_b32 v4, s31
    s_cmp_ge_u32 s25, 56
    s_cselect_b32 s31, s3, 0
    s_cmp_eq_u32 s31, 3
    s_cselect_b64 exec, 1, 0
    buffer_store_dword v4, v3, s[4:7], s30 offen sc1
    s_mov_b64 exec, -1
    ds_read_b128 v[32:35], v12 offset:12288
    ds_read_b128 v[36:39], v12 offset:13312
    s_waitcnt vmcnt(19)
    s_waitcnt lgkmcnt(4)
    v_smfmac_f32_16x16x64_bf16 v[16:19], v[84:87], v[48:55], v6
    ds_read_b128 v[40:43], v13 offset:12288
    ds_read_b128 v[44:47], v13 offset:13312
    s_waitcnt lgkmcnt(4)
    v_smfmac_f32_16x16x64_bf16 v[20:23], v[84:87], v[56:63], v6
    ds_read_b128 v[48:51], v12 offset:14336
    ds_read_b128 v[52:55], v12 offset:15360
    s_waitcnt vmcnt(18)
    s_waitcnt lgkmcnt(4)
    v_smfmac_f32_16x16x64_bf16 v[16:19], v[88:91], v[32:39], v6
    ds_read_b128 v[56:59], v13 offset:14336
    ds_read_b128 v[60:63], v13 offset:15360
    s_waitcnt lgkmcnt(4)
    v_smfmac_f32_16x16x64_bf16 v[20:23], v[88:91], v[40:47], v6
    ds_read_b128 v[32:35], v12 offset:16384
    ds_read_b128 v[36:39], v12 offset:17408
    s_waitcnt vmcnt(17)
    s_waitcnt lgkmcnt(4)
    v_smfmac_f32_16x16x64_bf16 v[16:19], v[92:95], v[48:55], v6
    ds_read_b128 v[40:43], v13 offset:16384
    ds_read_b128 v[44:47], v13 offset:17408
    s_waitcnt lgkmcnt(4)
    v_smfmac_f32_16x16x64_bf16 v[20:23], v[92:95], v[56:63], v6
    ds_read_b128 v[48:51], v12 offset:18432
    ds_read_b128 v[52:55], v12 offset:19456
    s_waitcnt vmcnt(16)
    s_waitcnt lgkmcnt(4)
    v_smfmac_f32_16x16x64_bf16 v[16:19], v[96:99], v[32:39], v6
    ds_read_b128 v[56:59], v13 offset:18432
    ds_read_b128 v[60:63], v13 offset:19456
    s_waitcnt lgkmcnt(4)
    v_smfmac_f32_16x16x64_bf16 v[20:23], v[96:99], v[40:47], v6
    ds_read_b128 v[32:35], v12 offset:20480
    ds_read_b128 v[36:39], v12 offset:21504
    s_waitcnt vmcnt(15)
    s_waitcnt lgkmcnt(4)
    v_smfmac_f32_16x16x64_bf16 v[16:19], v[100:103], v[48:55], v6
    ds_read_b128 v[40:43], v13 offset:20480
    ds_read_b128 v[44:47], v13 offset:21504
    s_waitcnt lgkmcnt(4)
    v_smfmac_f32_16x16x64_bf16 v[20:23], v[100:103], v[56:63], v6
    ds_read_b128 v[48:51], v12 offset:22528
    ds_read_b128 v[52:55], v12 offset:23552
    s_waitcnt vmcnt(14)
    s_waitcnt lgkmcnt(4)
    v_smfmac_f32_16x16x64_bf16 v[16:19], v[104:107], v[32:39], v6
    ds_read_b128 v[56:59], v13 offset:22528
    ds_read_b128 v[60:63], v13 offset:23552
    s_waitcnt lgkmcnt(4)
    v_smfmac_f32_16x16x64_bf16 v[20:23], v[104:107], v[40:47], v6
    ds_read_b128 v[32:35], v12 offset:24576
    ds_read_b128 v[36:39], v12 offset:25600
    s_waitcnt vmcnt(13)
    s_waitcnt lgkmcnt(4)
    v_smfmac_f32_16x16x64_bf16 v[16:19], v[108:111], v[48:55], v6
    ds_read_b128 v[40:43], v13 offset:24576
    ds_read_b128 v[44:47], v13 offset:25600
    s_waitcnt lgkmcnt(4)
    v_smfmac_f32_16x16x64_bf16 v[20:23], v[108:111], v[56:63], v6
    ds_read_b128 v[48:51], v12 offset:26624
    ds_read_b128 v[52:55], v12 offset:27648
    s_waitcnt vmcnt(12)
    s_waitcnt lgkmcnt(4)
    v_smfmac_f32_16x16x64_bf16 v[16:19], v[112:115], v[32:39], v6
    ds_read_b128 v[56:59], v13 offset:26624
    ds_read_b128 v[60:63], v13 offset:27648
    s_waitcnt lgkmcnt(4)
    v_smfmac_f32_16x16x64_bf16 v[20:23], v[112:115], v[40:47], v6
    ds_read_b128 v[32:35], v12 offset:28672
    ds_read_b128 v[36:39], v12 offset:29696
    s_waitcnt vmcnt(11)
    s_waitcnt lgkmcnt(4)
    v_smfmac_f32_16x16x64_bf16 v[16:19], v[116:119], v[48:55], v6
    ds_read_b128 v[40:43], v13 offset:28672
    ds_read_b128 v[44:47], v13 offset:29696
    s_waitcnt lgkmcnt(4)
    v_smfmac_f32_16x16x64_bf16 v[20:23], v[116:119], v[56:63], v6
    ds_read_b128 v[48:51], v12 offset:30720
    ds_read_b128 v[52:55], v12 offset:31744
    s_waitcnt vmcnt(10)
    s_waitcnt lgkmcnt(4)
    v_smfmac_f32_16x16x64_bf16 v[16:19], v[120:123], v[32:39], v6
    ds_read_b128 v[56:59], v13 offset:30720
    ds_read_b128 v[60:63], v13 offset:31744
    s_waitcnt lgkmcnt(4)
    v_smfmac_f32_16x16x64_bf16 v[20:23], v[120:123], v[40:47], v6
    s_barrier
    ds_read_b128 v[32:35], v12 offset:32768
    ds_read_b128 v[36:39], v12 offset:33792
    s_waitcnt vmcnt(9)
    s_waitcnt lgkmcnt(4)
    v_smfmac_f32_16x16x64_bf16 v[16:19], v[124:127], v[48:55], v6
    ds_read_b128 v[40:43], v13 offset:32768
    ds_read_b128 v[44:47], v13 offset:33792
    s_waitcnt lgkmcnt(4)
    v_smfmac_f32_16x16x64_bf16 v[20:23], v[124:127], v[56:63], v6
    ds_read_b128 v[48:51], v12 offset:34816
    ds_read_b128 v[52:55], v12 offset:35840
    s_waitcnt vmcnt(7)
    s_waitcnt lgkmcnt(4)
    v_smfmac_f32_16x16x64_bf16 v[16:19], v[128:131], v[32:39], v6
    ds_read_b128 v[56:59], v13 offset:34816
    ds_read_b128 v[60:63], v13 offset:35840
    s_waitcnt lgkmcnt(4)
    v_smfmac_f32_16x16x64_bf16 v[20:23], v[128:131], v[40:47], v6
    ds_read_b128 v[32:35], v12 offset:36864
    ds_read_b128 v[36:39], v12 offset:37888
    s_waitcnt vmcnt(5)
    s_waitcnt lgkmcnt(4)
    v_smfmac_f32_16x16x64_bf16 v[16:19], v[132:135], v[48:55], v6
    ds_read_b128 v[40:43], v13 offset:36864
    ds_read_b128 v[44:47], v13 offset:37888
    s_waitcnt lgkmcnt(4)
    v_smfmac_f32_16x16x64_bf16 v[20:23], v[132:135], v[56:63], v6
    ds_read_b128 v[48:51], v12 offset:38912
    ds_read_b128 v[52:55], v12 offset:39936
    s_waitcnt vmcnt(3)
    s_waitcnt lgkmcnt(4)
    v_smfmac_f32_16x16x64_bf16 v[16:19], v[136:139], v[32:39], v6
    ds_read_b128 v[56:59], v13 offset:38912
    ds_read_b128 v[60:63], v13 offset:39936
    s_waitcnt lgkmcnt(4)
    v_smfmac_f32_16x16x64_bf16 v[20:23], v[136:139], v[40:47], v6
    s_waitcnt vmcnt(1)
    s_waitcnt lgkmcnt(2)
    v_smfmac_f32_16x16x64_bf16 v[16:19], v[140:143], v[48:55], v6
    s_waitcnt lgkmcnt(0)
    v_smfmac_f32_16x16x64_bf16 v[20:23], v[140:143], v[56:63], v6
    s_nop 5
    v_permlane32_swap_b32 v16, v18
    v_permlane32_swap_b32 v17, v19
    v_pk_add_f32 v[16:17], v[16:17], v[18:19]
    s_mov_b64 vcc, s[74:75]
    s_nop 0
    v_cndmask_b32_dpp v18, v17, v16, vcc quad_perm:[1,0,3,2] row_mask:0xf bank_mask:0xf
    s_mov_b64 vcc, s[76:77]
    v_cndmask_b32_dpp v19, v16, v17, vcc quad_perm:[1,0,3,2] row_mask:0xf bank_mask:0xf
    v_cvt_pk_bf16_f32 v16, v18, v19
    v_lshlrev_b32 v17, 16, v16
    v_and_b32 v16, 0xffff0000, v16
    v_lshlrev_b32 v18, 16, v24
    v_and_b32 v19, 0xffff0000, v24
    v_add_f32 v17, v17, v18
    v_add_f32 v16, v16, v19
    v_cvt_pk_bf16_f32 v16, v17, v16
    v_min_u32 v16, 0xfffffffe, v16
    buffer_store_dword v16, v8, s[4:7], s64 offen offset:0 sc1
    v_permlane32_swap_b32 v20, v22
    v_permlane32_swap_b32 v21, v23
    v_pk_add_f32 v[20:21], v[20:21], v[22:23]
    s_mov_b64 vcc, s[74:75]
    s_nop 0
    v_cndmask_b32_dpp v22, v21, v20, vcc quad_perm:[1,0,3,2] row_mask:0xf bank_mask:0xf
    s_mov_b64 vcc, s[76:77]
    v_cndmask_b32_dpp v23, v20, v21, vcc quad_perm:[1,0,3,2] row_mask:0xf bank_mask:0xf
    v_cvt_pk_bf16_f32 v20, v22, v23
    v_lshlrev_b32 v21, 16, v20
    v_and_b32 v20, 0xffff0000, v20
    v_lshlrev_b32 v22, 16, v25
    v_and_b32 v23, 0xffff0000, v25
    v_add_f32 v21, v21, v22
    v_add_f32 v20, v20, v23
    v_cvt_pk_bf16_f32 v20, v21, v20
    v_min_u32 v20, 0xfffffffe, v20
    buffer_store_dword v20, v8, s[4:7], s64 offen offset:512 sc1
    s_add_u32 s71, s71, 6
    s_branch L_X2_end
L_X2_fin1:
    s_mov_b32 s25, s69
    s_waitcnt vmcnt(0)
    s_barrier
    s_cmp_lg_u32 s3, 1
    s_cbranch_scc1 Lf_190
    v_mov_b32 v4, s71
    s_mov_b64 exec, 1
    buffer_store_dword v4, v3, s[4:7], s66 offen sc1
    s_mov_b64 exec, -1
Lf_190:
    s_cmp_lg_u32 s3, 0
    s_cbranch_scc1 Lw_191
    s_cmp_lt_u32 s69, 0
    s_cselect_b32 exec_lo, 0, -1
    s_cselect_b32 s29, 3, 1
    s_add_u32 s29, s29, s69
    v_cmp_gt_u32 vcc, s29, v27
    s_nop 0
    s_cbranch_vccz Lw_191
    s_mov_b32 s27, 0x100000
Lp_192:
    buffer_load_dword v4, v10, s[4:7], s67 offen sc1
    s_waitcnt vmcnt(0)
    v_cmp_gt_u32 vcc, s29, v4
    s_nop 0
    s_cbranch_vccz Ld_193
    s_sub_u32 s27, s27, 1
    s_cbranch_scc1 L_abort
    s_sleep 12
    s_branch Lp_192
Ld_193:
Lw_191:
    s_mov_b64 exec, -1
    s_barrier
    s_add_u32 m0, s36, 81920
    s_add_u32 s60, s62, s36
    buffer_load_dwordx4 v2, s[4:7], s60 offen offset:0 sc1 lds
    buffer_load_dwordx4 v2, s[4:7], s60 offen offset:1024 sc1 lds
    buffer_load_dwordx4 v2, s[4:7], s60 offen offset:2048 sc1 lds
    buffer_load_dwordx4 v2, s[4:7], s60 offen offset:3072 sc1 lds
    s_mov_b64 exec, -1
    buffer_load_dword v24, v9, s[12:15], s65 offen offset:0
    buffer_load_dword v25, v9, s[12:15], s65 offen offset:32
    s_mov_b64 exec, s[78:79]
    s_add_u32 s61, s63, 0
    buffer_load_dwordx4 v[64:67], v2, s[4:7], s61 offen offset:0 sc1
    buffer_load_dwordx4 v[68:71], v2, s[4:7], s61 offen offset:1024 sc1
    buffer_load_dwordx4 v[72:75], v2, s[4:7], s61 offen offset:2048 sc1
    buffer_load_dwordx4 v[76:79], v2, s[4:7], s61 offen offset:3072 sc1
    s_add_u32 s61, s63, 4096
    buffer_load_dwordx4 v[80:83], v2, s[4:7], s61 offen offset:0 sc1
    buffer_load_dwordx4 v[84:87], v2, s[4:7], s61 offen offset:1024 sc1
    buffer_load_dwordx4 v[88:91], v2, s[4:7], s61 offen offset:2048 sc1
    buffer_load_dwordx4 v[92:95], v2, s[4:7], s61 offen offset:3072 sc1
    s_add_u32 s61, s63, 8192
    buffer_load_dwordx4 v[96:99], v2, s[4:7], s61 offen offset:0 sc1
    buffer_load_dwordx4 v[100:103], v2, s[4:7], s61 offen offset:1024 sc1
    buffer_load_dwordx4 v[104:107], v2, s[4:7], s61 offen offset:2048 sc1
    buffer_load_dwordx4 v[108:111], v2, s[4:7], s61 offen offset:3072 sc1
    s_add_u32 s61, s63, 12288
    buffer_load_dwordx4 v[112:115], v2, s[4:7], s61 offen offset:0 sc1
    buffer_load_dwordx4 v[116:119], v2, s[4:7], s61 offen offset:1024 sc1
    buffer_load_dwordx4 v[120:123], v2, s[4:7], s61 offen offset:2048 sc1
    buffer_load_dwordx4 v[124:127], v2, s[4:7], s61 offen offset:3072 sc1
    s_mov_b64 exec, -1
    s_add_u32 s61, s63, 16384
    buffer_load_dwordx2 v[128:129], v7, s[4:7], s61 offen offset:0 sc1
    buffer_load_dwordx2 v[130:131], v7, s[4:7], s61 offen offset:128 sc1
    buffer_load_dwordx2 v[132:133], v7, s[4:7], s61 offen offset:1024 sc1
    buffer_load_dwordx2 v[134:135], v7, s[4:7], s61 offen offset:1152 sc1
    buffer_load_dwordx2 v[136:137], v7, s[4:7], s61 offen offset:2048 sc1
    buffer_load_dwordx2 v[138:139], v7, s[4:7], s61 offen offset:2176 sc1
    buffer_load_dwordx2 v[140:141], v7, s[4:7], s61 offen offset:3072 sc1
    buffer_load_dwordx2 v[142:143], v7, s[4:7], s61 offen offset:3200 sc1
    s_mov_b32 s64, s72
    v_pk_mov_b32 v[16:17], 0, 0
    v_pk_mov_b32 v[18:19], 0, 0
    v_pk_mov_b32 v[20:21], 0, 0
    v_pk_mov_b32 v[22:23], 0, 0
    ds_read_b128 v[32:35], v14 offset:0
    ds_read_b128 v[36:39], v14 offset:1024
    ds_read_b128 v[40:43], v15 offset:0
    ds_read_b128 v[44:47], v15 offset:1024
    ds_read_b128 v[48:51], v14 offset:2048
    ds_read_b128 v[52:55], v14 offset:3072
    s_waitcnt vmcnt(23)
    s_waitcnt lgkmcnt(4)
    v_smfmac_f32_16x16x64_bf16 v[16:19], v[64:67], v[32:39], v6
    ds_read_b128 v[56:59], v15 offset:2048
    ds_read_b128 v[60:63], v15 offset:3072
    s_waitcnt lgkmcnt(4)
    v_smfmac_f32_16x16x64_bf16 v[20:23], v[64:67], v[40:47], v6
    ds_read_b128 v[32:35], v14 offset:4096
    ds_read_b128 v[36:39], v14 offset:5120
    s_waitcnt vmcnt(22)
    s_waitcnt lgkmcnt(4)
    v_smfmac_f32_16x16x64_bf16 v[16:19], v[68:71], v[48:55], v6
    ds_read_b128 v[40:43], v15 offset:4096
    ds_read_b128 v[44:47], v15 offset:5120
    s_waitcnt lgkmcnt(4)
    v_smfmac_f32_16x16x64_bf16 v[20:23], v[68:71], v[56:63], v6
    ds_read_b128 v[48:51], v14 offset:6144
    ds_read_b128 v[52:55], v14 offset:7168
    s_waitcnt vmcnt(21)
    s_waitcnt lgkmcnt(4)
    v_smfmac_f32_16x16x64_bf16 v[16:19], v[72:75], v[32:39], v6
    ds_read_b128 v[56:59], v15 offset:6144
    ds_read_b128 v[60:63], v15 offset:7168
    s_waitcnt lgkmcnt(4)
    v_smfmac_f32_16x16x64_bf16 v[20:23], v[72:75], v[40:47], v6
    ds_read_b128 v[32:35], v14 offset:8192
    ds_read_b128 v[36:39], v14 offset:9216
    s_waitcnt vmcnt(20)
    s_waitcnt lgkmcnt(4)
    v_smfmac_f32_16x16x64_bf16 v[16:19], v[76:79], v[48:55], v6
    ds_read_b128 v[40:43], v15 offset:8192
    ds_read_b128 v[44:47], v15 offset:9216
    s_waitcnt lgkmcnt(4)
    v_smfmac_f32_16x16x64_bf16 v[20:23], v[76:79], v[56:63], v6
    ds_read_b128 v[48:51], v14 offset:10240
    ds_read_b128 v[52:55], v14 offset:11264
    s_waitcnt vmcnt(19)
    s_waitcnt lgkmcnt(4)
    v_smfmac_f32_16x16x64_bf16 v[16:19], v[80:83], v[32:39], v6
    ds_read_b128 v[56:59], v15 offset:10240
    ds_read_b128 v[60:63], v15 offset:11264
    s_waitcnt lgkmcnt(4)
    v_smfmac_f32_16x16x64_bf16 v[20:23], v[80:83], v[40:47], v6
    s_add_u32 s30, s66, 33792
    s_add_u32 s31, s71, 6
    v_mov_b32 v4, s31
    s_cmp_ge_u32 s25, 56
    s_cselect_b32 s31, s3, 0
    s_cmp_eq_u32 s31, 3
    s_cselect_b64 exec, 1, 0
    buffer_store_dword v4, v3, s[4:7], s30 offen sc1
    s_mov_b64 exec, -1
    ds_read_b128 v[32:35], v14 offset:12288
    ds_read_b128 v[36:39], v14 offset:13312
    s_waitcnt vmcnt(19)
    s_waitcnt lgkmcnt(4)
    v_smfmac_f32_16x16x64_bf16 v[16:19], v[84:87], v[48:55], v6
    ds_read_b128 v[40:43], v15 offset:12288
    ds_read_b128 v[44:47], v15 offset:13312
    s_waitcnt lgkmcnt(4)
    v_smfmac_f32_16x16x64_bf16 v[20:23], v[84:87], v[56:63], v6
    ds_read_b128 v[48:51], v14 offset:14336
    ds_read_b128 v[52:55], v14 offset:15360
    s_waitcnt vmcnt(18)
    s_waitcnt lgkmcnt(4)
    v_smfmac_f32_16x16x64_bf16 v[16:19], v[88:91], v[32:39], v6
    ds_read_b128 v[56:59], v15 offset:14336
    ds_read_b128 v[60:63], v15 offset:15360
    s_waitcnt lgkmcnt(4)
    v_smfmac_f32_16x16x64_bf16 v[20:23], v[88:91], v[40:47], v6
    ds_read_b128 v[32:35], v14 offset:16384
    ds_read_b128 v[36:39], v14 offset:17408
    s_waitcnt vmcnt(17)
    s_waitcnt lgkmcnt(4)
    v_smfmac_f32_16x16x64_bf16 v[16:19], v[92:95], v[48:55], v6
    ds_read_b128 v[40:43], v15 offset:16384
    ds_read_b128 v[44:47], v15 offset:17408
    s_waitcnt lgkmcnt(4)
    v_smfmac_f32_16x16x64_bf16 v[20:23], v[92:95], v[56:63], v6
    ds_read_b128 v[48:51], v14 offset:18432
    ds_read_b128 v[52:55], v14 offset:19456
    s_waitcnt vmcnt(16)
    s_waitcnt lgkmcnt(4)
    v_smfmac_f32_16x16x64_bf16 v[16:19], v[96:99], v[32:39], v6
    ds_read_b128 v[56:59], v15 offset:18432
    ds_read_b128 v[60:63], v15 offset:19456
    s_waitcnt lgkmcnt(4)
    v_smfmac_f32_16x16x64_bf16 v[20:23], v[96:99], v[40:47], v6
    ds_read_b128 v[32:35], v14 offset:20480
    ds_read_b128 v[36:39], v14 offset:21504
    s_waitcnt vmcnt(15)
    s_waitcnt lgkmcnt(4)
    v_smfmac_f32_16x16x64_bf16 v[16:19], v[100:103], v[48:55], v6
    ds_read_b128 v[40:43], v15 offset:20480
    ds_read_b128 v[44:47], v15 offset:21504
    s_waitcnt lgkmcnt(4)
    v_smfmac_f32_16x16x64_bf16 v[20:23], v[100:103], v[56:63], v6
    ds_read_b128 v[48:51], v14 offset:22528
    ds_read_b128 v[52:55], v14 offset:23552
    s_waitcnt vmcnt(14)
    s_waitcnt lgkmcnt(4)
    v_smfmac_f32_16x16x64_bf16 v[16:19], v[104:107], v[32:39], v6
    ds_read_b128 v[56:59], v15 offset:22528
    ds_read_b128 v[60:63], v15 offset:23552
    s_waitcnt lgkmcnt(4)
    v_smfmac_f32_16x16x64_bf16 v[20:23], v[104:107], v[40:47], v6
    ds_read_b128 v[32:35], v14 offset:24576
    ds_read_b128 v[36:39], v14 offset:25600
    s_waitcnt vmcnt(13)
    s_waitcnt lgkmcnt(4)
    v_smfmac_f32_16x16x64_bf16 v[16:19], v[108:111], v[48:55], v6
    ds_read_b128 v[40:43], v15 offset:24576
    ds_read_b128 v[44:47], v15 offset:25600
    s_waitcnt lgkmcnt(4)
    v_smfmac_f32_16x16x64_bf16 v[20:23], v[108:111], v[56:63], v6
    ds_read_b128 v[48:51], v14 offset:26624
    ds_read_b128 v[52:55], v14 offset:27648
    s_waitcnt vmcnt(12)
    s_waitcnt lgkmcnt(4)
    v_smfmac_f32_16x16x64_bf16 v[16:19], v[112:115], v[32:39], v6
    ds_read_b128 v[56:59], v15 offset:26624
    ds_read_b128 v[60:63], v15 offset:27648
    s_waitcnt lgkmcnt(4)
    v_smfmac_f32_16x16x64_bf16 v[20:23], v[112:115], v[40:47], v6
    ds_read_b128 v[32:35], v14 offset:28672
    ds_read_b128 v[36:39], v14 offset:29696
    s_waitcnt vmcnt(11)
    s_waitcnt lgkmcnt(4)
    v_smfmac_f32_16x16x64_bf16 v[16:19], v[116:119], v[48:55], v6
    ds_read_b128 v[40:43], v15 offset:28672
    ds_read_b128 v[44:47], v15 offset:29696
    s_waitcnt lgkmcnt(4)
    v_smfmac_f32_16x16x64_bf16 v[20:23], v[116:119], v[56:63], v6
    ds_read_b128 v[48:51], v14 offset:30720
    ds_read_b128 v[52:55], v14 offset:31744
    s_waitcnt vmcnt(10)
    s_waitcnt lgkmcnt(4)
    v_smfmac_f32_16x16x64_bf16 v[16:19], v[120:123], v[32:39], v6
    ds_read_b128 v[56:59], v15 offset:30720
    ds_read_b128 v[60:63], v15 offset:31744
    s_waitcnt lgkmcnt(4)
    v_smfmac_f32_16x16x64_bf16 v[20:23], v[120:123], v[40:47], v6
    s_barrier
    ds_read_b128 v[32:35], v14 offset:32768
    ds_read_b128 v[36:39], v14 offset:33792
    s_waitcnt vmcnt(9)
    s_waitcnt lgkmcnt(4)
    v_smfmac_f32_16x16x64_bf16 v[16:19], v[124:127], v[48:55], v6
    ds_read_b128 v[40:43], v15 offset:32768
    ds_read_b128 v[44:47], v15 offset:33792
    s_waitcnt lgkmcnt(4)
    v_smfmac_f32_16x16x64_bf16 v[20:23], v[124:127], v[56:63], v6
    ds_read_b128 v[48:51], v14 offset:34816
    ds_read_b128 v[52:55], v14 offset:35840
    s_waitcnt vmcnt(7)
    s_waitcnt lgkmcnt(4)
    v_smfmac_f32_16x16x64_bf16 v[16:19], v[128:131], v[32:39], v6
    ds_read_b128 v[56:59], v15 offset:34816
    ds_read_b128 v[60:63], v15 offset:35840
    s_waitcnt lgkmcnt(4)
    v_smfmac_f32_16x16x64_bf16 v[20:23], v[128:131], v[40:47], v6
    ds_read_b128 v[32:35], v14 offset:36864
    ds_read_b128 v[36:39], v14 offset:37888
    s_waitcnt vmcnt(5)
    s_waitcnt lgkmcnt(4)
    v_smfmac_f32_16x16x64_bf16 v[16:19], v[132:135], v[48:55], v6
    ds_read_b128 v[40:43], v15 offset:36864
    ds_read_b128 v[44:47], v15 offset:37888
    s_waitcnt lgkmcnt(4)
    v_smfmac_f32_16x16x64_bf16 v[20:23], v[132:135], v[56:63], v6
    ds_read_b128 v[48:51], v14 offset:38912
    ds_read_b128 v[52:55], v14 offset:39936
    s_waitcnt vmcnt(3)
    s_waitcnt lgkmcnt(4)
    v_smfmac_f32_16x16x64_bf16 v[16:19], v[136:139], v[32:39], v6
    ds_read_b128 v[56:59], v15 offset:38912
    ds_read_b128 v[60:63], v15 offset:39936
    s_waitcnt lgkmcnt(4)
    v_smfmac_f32_16x16x64_bf16 v[20:23], v[136:139], v[40:47], v6
    s_waitcnt vmcnt(1)
    s_waitcnt lgkmcnt(2)
    v_smfmac_f32_16x16x64_bf16 v[16:19], v[140:143], v[48:55], v6
    s_waitcnt lgkmcnt(0)
    v_smfmac_f32_16x16x64_bf16 v[20:23], v[140:143], v[56:63], v6
    s_nop 5
    v_permlane32_swap_b32 v16, v18
    v_permlane32_swap_b32 v17, v19
    v_pk_add_f32 v[16:17], v[16:17], v[18:19]
    s_mov_b64 vcc, s[74:75]
    s_nop 0
    v_cndmask_b32_dpp v18, v17, v16, vcc quad_perm:[1,0,3,2] row_mask:0xf bank_mask:0xf
    s_mov_b64 vcc, s[76:77]
    v_cndmask_b32_dpp v19, v16, v17, vcc quad_perm:[1,0,3,2] row_mask:0xf bank_mask:0xf
    v_cvt_pk_bf16_f32 v16, v18, v19
    v_lshlrev_b32 v17, 16, v16
    v_and_b32 v16, 0xffff0000, v16
    v_lshlrev_b32 v18, 16, v24
    v_and_b32 v19, 0xffff0000, v24
    v_add_f32 v17, v17, v18
    v_add_f32 v16, v16, v19
    v_cvt_pk_bf16_f32 v16, v17, v16
    v_min_u32 v16, 0xfffffffe, v16
    buffer_store_dword v16, v8, s[4:7], s64 offen offset:0 sc1
    v_permlane32_swap_b32 v20, v22
    v_permlane32_swap_b32 v21, v23
    v_pk_add_f32 v[20:21], v[20:21], v[22:23]
    s_mov_b64 vcc, s[74:75]
    s_nop 0
    v_cndmask_b32_dpp v22, v21, v20, vcc quad_perm:[1,0,3,2] row_mask:0xf bank_mask:0xf
    s_mov_b64 vcc, s[76:77]
    v_cndmask_b32_dpp v23, v20, v21, vcc quad_perm:[1,0,3,2] row_mask:0xf bank_mask:0xf
    v_cvt_pk_bf16_f32 v20, v22, v23
    v_lshlrev_b32 v21, 16, v20
    v_and_b32 v20, 0xffff0000, v20
    v_lshlrev_b32 v22, 16, v25
    v_and_b32 v23, 0xffff0000, v25
    v_add_f32 v21, v21, v22
    v_add_f32 v20, v20, v23
    v_cvt_pk_bf16_f32 v20, v21, v20
    v_min_u32 v20, 0xfffffffe, v20
    buffer_store_dword v20, v8, s[4:7], s64 offen offset:512 sc1
    s_add_u32 s71, s71, 6
L_X2_end:
    s_waitcnt vmcnt(0)
    s_barrier
    s_cmp_lg_u32 s3, 1
    s_cbranch_scc1 Lf_194
    v_mov_b32 v4, s71
    s_mov_b64 exec, 1
    buffer_store_dword v4, v3, s[4:7], s66 offen sc1
    s_mov_b64 exec, -1
Lf_194:
    s_branch L_exit
L_role_F2:
    s_mov_b32 s8, s52
    s_and_b32 s9, s53, 0xffff
    s_mov_b32 s10, 0x1e0000
    s_mov_b32 s11, 0x20000
    s_mov_b32 s20, s54
    s_and_b32 s21, s55, 0xffff
    s_mov_b32 s22, 0x280000
    s_mov_b32 s23, 0x20000
    v_lshrrev_b32 v9, 4, v1
    v_bfe_u32 v10, v1, 2, 2
    v_and_b32 v11, 3, v1
    s_lshr_b32 s64, s24, 1
    s_and_b32 s65, s24, 1
    s_mul_i32 s71, s64, 160
    s_mul_i32 s28, s3, 491520
    s_add_u32 s71, s71, s28
    v_add_u32 v4, 0, v1
    v_mul_u32_u24 v5, 6554, v4
    v_lshrrev_b32 v5, 16, v5
    v_mul_u32_u24 v17, 10, v5
    v_sub_u32 v4, v4, v17
    v_lshlrev_b32 v4, 4, v4
    v_mul_u32_u24 v5, 1280, v5
    v_add_u32 v17, v4, v5
    v_add_u32 v4, 64, v1
    v_mul_u32_u24 v5, 6554, v4
    v_lshrrev_b32 v5, 16, v5
    v_mul_u32_u24 v18, 10, v5
    v_sub_u32 v4, v4, v18
    v_lshlrev_b32 v4, 4, v4
    v_mul_u32_u24 v5, 1280, v5
    v_add_u32 v18, v4, v5
    v_add_u32 v4, 128, v1
    v_mul_u32_u24 v5, 6554, v4
    v_lshrrev_b32 v5, 16, v5
    v_mul_u32_u24 v19, 10, v5
    v_sub_u32 v4, v4, v19
    v_lshlrev_b32 v4, 4, v4
    v_mul_u32_u24 v5, 1280, v5
    v_add_u32 v19, v4, v5
    v_add_u32 v4, 192, v1
    v_mul_u32_u24 v5, 6554, v4
    v_lshrrev_b32 v5, 16, v5
    v_mul_u32_u24 v20, 10, v5
    v_sub_u32 v4, v4, v20
    v_lshlrev_b32 v4, 4, v4
    v_mul_u32_u24 v5, 1280, v5
    v_add_u32 v20, v4, v5
    v_add_u32 v4, 256, v1
    v_mul_u32_u24 v5, 6554, v4
    v_lshrrev_b32 v5, 16, v5
    v_mul_u32_u24 v21, 10, v5
    v_sub_u32 v4, v4, v21
    v_lshlrev_b32 v4, 4, v4
    v_mul_u32_u24 v5, 1280, v5
    v_add_u32 v21, v4, v5
    v_lshl_add_u32 v7, v9, 2, v10
    v_mul_u32_u24 v7, 160, v7
    v_lshl_add_u32 v7, v11, 3, v7
    s_mul_i32 s28, s3, 5120
    v_add_u32 v7, s28, v7
    s_mul_i32 s61, s3, 5120
    s_add_u32 m0, s61, 0
    s_add_u32 s60, s71, 0x0
    buffer_load_dwordx4 v17, s[8:11], s60 offen nt lds
    s_add_u32 m0, s61, 1024
    s_add_u32 s60, s71, 0x0
    buffer_load_dwordx4 v18, s[8:11], s60 offen nt lds
    s_add_u32 m0, s61, 2048
    s_add_u32 s60, s71, 0x0
    buffer_load_dwordx4 v19, s[8:11], s60 offen nt lds
    s_add_u32 m0, s61, 3072
    s_add_u32 s60, s71, 0x0
    buffer_load_dwordx4 v20, s[8:11], s60 offen nt lds
    s_add_u32 m0, s61, 4096
    s_add_u32 s60, s71, 0x0
    buffer_load_dwordx4 v21, s[8:11], s60 offen nt lds
    s_add_u32 m0, s61, 20480
    s_add_u32 s60, s71, 0xa000
    buffer_load_dwordx4 v17, s[8:11], s60 offen nt lds
    s_add_u32 m0, s61, 21504
    s_add_u32 s60, s71, 0xa000
    buffer_load_dwordx4 v18, s[8:11], s60 offen nt lds
    s_add_u32 m0, s61, 22528
    s_add_u32 s60, s71, 0xa000
    buffer_load_dwordx4 v19, s[8:11], s60 offen nt lds
    s_add_u32 m0, s61, 23552
    s_add_u32 s60, s71, 0xa000
    buffer_load_dwordx4 v20, s[8:11], s60 offen nt lds
    s_add_u32 m0, s61, 24576
    s_add_u32 s60, s71, 0xa000
    buffer_load_dwordx4 v21, s[8:11], s60 offen nt lds
    s_waitcnt vmcnt(5)
    s_barrier
    s_add_u32 m0, s61, 40960
    s_add_u32 s60, s71, 0x14000
    buffer_load_dwordx4 v17, s[8:11], s60 offen nt lds
    s_add_u32 m0, s61, 41984
    s_add_u32 s60, s71, 0x14000
    buffer_load_dwordx4 v18, s[8:11], s60 offen nt lds
    s_add_u32 m0, s61, 43008
    s_add_u32 s60, s71, 0x14000
    buffer_load_dwordx4 v19, s[8:11], s60 offen nt lds
    s_add_u32 m0, s61, 44032
    s_add_u32 s60, s71, 0x14000
    buffer_load_dwordx4 v20, s[8:11], s60 offen nt lds
    s_add_u32 m0, s61, 45056
    s_add_u32 s60, s71, 0x14000
    buffer_load_dwordx4 v21, s[8:11], s60 offen nt lds
    v_add_u32 v8, 0x0, v7
    ds_read_b64_tr_b16 a[0:1], v8 offset:0
    ds_read_b64_tr_b16 a[2:3], v8 offset:2560
    ds_read_b64_tr_b16 a[4:5], v8 offset:32
    ds_read_b64_tr_b16 a[6:7], v8 offset:2592
    ds_read_b64_tr_b16 a[8:9], v8 offset:64
    ds_read_b64_tr_b16 a[10:11], v8 offset:2624
    ds_read_b64_tr_b16 a[12:13], v8 offset:96
    ds_read_b64_tr_b16 a[14:15], v8 offset:2656
    ds_read_b64_tr_b16 a[16:17], v8 offset:128
    ds_read_b64_tr_b16 a[18:19], v8 offset:2688
    s_waitcnt lgkmcnt(0)
    s_waitcnt vmcnt(5)
    s_barrier
    s_add_u32 m0, s61, 0
    s_add_u32 s60, s71, 0x1e000
    buffer_load_dwordx4 v17, s[8:11], s60 offen nt lds
    s_add_u32 m0, s61, 1024
    s_add_u32 s60, s71, 0x1e000
    buffer_load_dwordx4 v18, s[8:11], s60 offen nt lds
    s_add_u32 m0, s61, 2048
    s_add_u32 s60, s71, 0x1e000
    buffer_load_dwordx4 v19, s[8:11], s60 offen nt lds
    s_add_u32 m0, s61, 3072
    s_add_u32 s60, s71, 0x1e000
    buffer_load_dwordx4 v20, s[8:11], s60 offen nt lds
    s_add_u32 m0, s61, 4096
    s_add_u32 s60, s71, 0x1e000
    buffer_load_dwordx4 v21, s[8:11], s60 offen nt lds
    v_add_u32 v8, 0x5000, v7
    ds_read_b64_tr_b16 a[20:21], v8 offset:0
    ds_read_b64_tr_b16 a[22:23], v8 offset:2560
    ds_read_b64_tr_b16 a[24:25], v8 offset:32
    ds_read_b64_tr_b16 a[26:27], v8 offset:2592
    ds_read_b64_tr_b16 a[28:29], v8 offset:64
    ds_read_b64_tr_b16 a[30:31], v8 offset:2624
    ds_read_b64_tr_b16 a[32:33], v8 offset:96
    ds_read_b64_tr_b16 a[34:35], v8 offset:2656
    ds_read_b64_tr_b16 a[36:37], v8 offset:128
    ds_read_b64_tr_b16 a[38:39], v8 offset:2688
    s_waitcnt lgkmcnt(0)
    s_waitcnt vmcnt(5)
    s_barrier
    s_add_u32 m0, s61, 20480
    s_add_u32 s60, s71, 0x28000
    buffer_load_dwordx4 v17, s[8:11], s60 offen nt lds
    s_add_u32 m0, s61, 21504
    s_add_u32 s60, s71, 0x28000
    buffer_load_dwordx4 v18, s[8:11], s60 offen nt lds
    s_add_u32 m0, s61, 22528
    s_add_u32 s60, s71, 0x28000
    buffer_load_dwordx4 v19, s[8:11], s60 offen nt lds
    s_add_u32 m0, s61, 23552
    s_add_u32 s60, s71, 0x28000
    buffer_load_dwordx4 v20, s[8:11], s60 offen nt lds
    s_add_u32 m0, s61, 24576
    s_add_u32 s60, s71, 0x28000
    buffer_load_dwordx4 v21, s[8:11], s60 offen nt lds
    v_add_u32 v8, 0xa000, v7
    ds_read_b64_tr_b16 a[40:41], v8 offset:0
    ds_read_b64_tr_b16 a[42:43], v8 offset:2560
    ds_read_b64_tr_b16 a[44:45], v8 offset:32
    ds_read_b64_tr_b16 a[46:47], v8 offset:2592
    ds_read_b64_tr_b16 a[48:49], v8 offset:64
    ds_read_b64_tr_b16 a[50:51], v8 offset:2624
    ds_read_b64_tr_b16 a[52:53], v8 offset:96
    ds_read_b64_tr_b16 a[54:55], v8 offset:2656
    ds_read_b64_tr_b16 a[56:57], v8 offset:128
    ds_read_b64_tr_b16 a[58:59], v8 offset:2688
    s_waitcnt lgkmcnt(0)
    s_waitcnt vmcnt(5)
    s_barrier
    s_add_u32 m0, s61, 40960
    s_add_u32 s60, s71, 0x32000
    buffer_load_dwordx4 v17, s[8:11], s60 offen nt lds
    s_add_u32 m0, s61, 41984
    s_add_u32 s60, s71, 0x32000
    buffer_load_dwordx4 v18, s[8:11], s60 offen nt lds
    s_add_u32 m0, s61, 43008
    s_add_u32 s60, s71, 0x32000
    buffer_load_dwordx4 v19, s[8:11], s60 offen nt lds
    s_add_u32 m0, s61, 44032
    s_add_u32 s60, s71, 0x32000
    buffer_load_dwordx4 v20, s[8:11], s60 offen nt lds
    s_add_u32 m0, s61, 45056
    s_add_u32 s60, s71, 0x32000
    buffer_load_dwordx4 v21, s[8:11], s60 offen nt lds
    v_add_u32 v8, 0x0, v7
    ds_read_b64_tr_b16 a[60:61], v8 offset:0
    ds_read_b64_tr_b16 a[62:63], v8 offset:2560
    ds_read_b64_tr_b16 a[64:65], v8 offset:32
    ds_read_b64_tr_b16 a[66:67], v8 offset:2592
    ds_read_b64_tr_b16 a[68:69], v8 offset:64
    ds_read_b64_tr_b16 a[70:71], v8 offset:2624
    ds_read_b64_tr_b16 a[72:73], v8 offset:96
    ds_read_b64_tr_b16 a[74:75], v8 offset:2656
    ds_read_b64_tr_b16 a[76:77], v8 offset:128
    ds_read_b64_tr_b16 a[78:79], v8 offset:2688
    s_waitcnt lgkmcnt(0)
    s_waitcnt vmcnt(5)
    s_barrier
    s_add_u32 m0, s61, 0
    s_add_u32 s60, s71, 0x3c000
    buffer_load_dwordx4 v17, s[8:11], s60 offen nt lds
    s_add_u32 m0, s61, 1024
    s_add_u32 s60, s71, 0x3c000
    buffer_load_dwordx4 v18, s[8:11], s60 offen nt lds
    s_add_u32 m0, s61, 2048
    s_add_u32 s60, s71, 0x3c000
    buffer_load_dwordx4 v19, s[8:11], s60 offen nt lds
    s_add_u32 m0, s61, 3072
    s_add_u32 s60, s71, 0x3c000
    buffer_load_dwordx4 v20, s[8:11], s60 offen nt lds
    s_add_u32 m0, s61, 4096
    s_add_u32 s60, s71, 0x3c000
    buffer_load_dwordx4 v21, s[8:11], s60 offen nt lds
    v_add_u32 v8, 0x5000, v7
    ds_read_b64_tr_b16 a[80:81], v8 offset:0
    ds_read_b64_tr_b16 a[82:83], v8 offset:2560
    ds_read_b64_tr_b16 a[84:85], v8 offset:32
    ds_read_b64_tr_b16 a[86:87], v8 offset:2592
    ds_read_b64_tr_b16 a[88:89], v8 offset:64
    ds_read_b64_tr_b16 a[90:91], v8 offset:2624
    ds_read_b64_tr_b16 a[92:93], v8 offset:96
    ds_read_b64_tr_b16 a[94:95], v8 offset:2656
    ds_read_b64_tr_b16 a[96:97], v8 offset:128
    ds_read_b64_tr_b16 a[98:99], v8 offset:2688
    s_waitcnt lgkmcnt(0)
    s_waitcnt vmcnt(5)
    s_barrier
    s_add_u32 m0, s61, 20480
    s_add_u32 s60, s71, 0x46000
    buffer_load_dwordx4 v17, s[8:11], s60 offen nt lds
    s_add_u32 m0, s61, 21504
    s_add_u32 s60, s71, 0x46000
    buffer_load_dwordx4 v18, s[8:11], s60 offen nt lds
    s_add_u32 m0, s61, 22528
    s_add_u32 s60, s71, 0x46000
    buffer_load_dwordx4 v19, s[8:11], s60 offen nt lds
    s_add_u32 m0, s61, 23552
    s_add_u32 s60, s71, 0x46000
    buffer_load_dwordx4 v20, s[8:11], s60 offen nt lds
    s_add_u32 m0, s61, 24576
    s_add_u32 s60, s71, 0x46000
    buffer_load_dwordx4 v21, s[8:11], s60 offen nt lds
    v_add_u32 v8, 0xa000, v7
    ds_read_b64_tr_b16 a[100:101], v8 offset:0
    ds_read_b64_tr_b16 a[102:103], v8 offset:2560
    ds_read_b64_tr_b16 a[104:105], v8 offset:32
    ds_read_b64_tr_b16 a[106:107], v8 offset:2592
    ds_read_b64_tr_b16 a[108:109], v8 offset:64
    ds_read_b64_tr_b16 a[110:111], v8 offset:2624
    ds_read_b64_tr_b16 a[112:113], v8 offset:96
    ds_read_b64_tr_b16 a[114:115], v8 offset:2656
    ds_read_b64_tr_b16 a[116:117], v8 offset:128
    ds_read_b64_tr_b16 a[118:119], v8 offset:2688
    s_waitcnt lgkmcnt(0)
    s_waitcnt vmcnt(5)
    s_barrier
    s_add_u32 m0, s61, 40960
    s_add_u32 s60, s71, 0x50000
    buffer_load_dwordx4 v17, s[8:11], s60 offen nt lds
    s_add_u32 m0, s61, 41984
    s_add_u32 s60, s71, 0x50000
    buffer_load_dwordx4 v18, s[8:11], s60 offen nt lds
    s_add_u32 m0, s61, 43008
    s_add_u32 s60, s71, 0x50000
    buffer_load_dwordx4 v19, s[8:11], s60 offen nt lds
    s_add_u32 m0, s61, 44032
    s_add_u32 s60, s71, 0x50000
    buffer_load_dwordx4 v20, s[8:11], s60 offen nt lds
    s_add_u32 m0, s61, 45056
    s_add_u32 s60, s71, 0x50000
    buffer_load_dwordx4 v21, s[8:11], s60 offen nt lds
    v_add_u32 v8, 0x0, v7
    ds_read_b64_tr_b16 a[120:121], v8 offset:0
    ds_read_b64_tr_b16 a[122:123], v8 offset:2560
    ds_read_b64_tr_b16 a[124:125], v8 offset:32
    ds_read_b64_tr_b16 a[126:127], v8 offset:2592
    ds_read_b64_tr_b16 a[128:129], v8 offset:64
    ds_read_b64_tr_b16 a[130:131], v8 offset:2624
    ds_read_b64_tr_b16 a[132:133], v8 offset:96
    ds_read_b64_tr_b16 a[134:135], v8 offset:2656
    ds_read_b64_tr_b16 a[136:137], v8 offset:128
    ds_read_b64_tr_b16 a[138:139], v8 offset:2688
    s_waitcnt lgkmcnt(0)
    s_waitcnt vmcnt(5)
    s_barrier
    s_add_u32 m0, s61, 0
    s_add_u32 s60, s71, 0x5a000
    buffer_load_dwordx4 v17, s[8:11], s60 offen nt lds
    s_add_u32 m0, s61, 1024
    s_add_u32 s60, s71, 0x5a000
    buffer_load_dwordx4 v18, s[8:11], s60 offen nt lds
    s_add_u32 m0, s61, 2048
    s_add_u32 s60, s71, 0x5a000
    buffer_load_dwordx4 v19, s[8:11], s60 offen nt lds
    s_add_u32 m0, s61, 3072
    s_add_u32 s60, s71, 0x5a000
    buffer_load_dwordx4 v20, s[8:11], s60 offen nt lds
    s_add_u32 m0, s61, 4096
    s_add_u32 s60, s71, 0x5a000
    buffer_load_dwordx4 v21, s[8:11], s60 offen nt lds
    v_add_u32 v8, 0x5000, v7
    ds_read_b64_tr_b16 a[140:141], v8 offset:0
    ds_read_b64_tr_b16 a[142:143], v8 offset:2560
    ds_read_b64_tr_b16 a[144:145], v8 offset:32
    ds_read_b64_tr_b16 a[146:147], v8 offset:2592
    ds_read_b64_tr_b16 a[148:149], v8 offset:64
    ds_read_b64_tr_b16 a[150:151], v8 offset:2624
    ds_read_b64_tr_b16 a[152:153], v8 offset:96
    ds_read_b64_tr_b16 a[154:155], v8 offset:2656
    ds_read_b64_tr_b16 a[156:157], v8 offset:128
    ds_read_b64_tr_b16 a[158:159], v8 offset:2688
    s_waitcnt lgkmcnt(0)
    s_waitcnt vmcnt(5)
    s_barrier
    s_add_u32 m0, s61, 20480
    s_add_u32 s60, s71, 0x64000
    buffer_load_dwordx4 v17, s[8:11], s60 offen nt lds
    s_add_u32 m0, s61, 21504
    s_add_u32 s60, s71, 0x64000
    buffer_load_dwordx4 v18, s[8:11], s60 offen nt lds
    s_add_u32 m0, s61, 22528
    s_add_u32 s60, s71, 0x64000
    buffer_load_dwordx4 v19, s[8:11], s60 offen nt lds
    s_add_u32 m0, s61, 23552
    s_add_u32 s60, s71, 0x64000
    buffer_load_dwordx4 v20, s[8:11], s60 offen nt lds
    s_add_u32 m0, s61, 24576
    s_add_u32 s60, s71, 0x64000
    buffer_load_dwordx4 v21, s[8:11], s60 offen nt lds
    v_add_u32 v8, 0xa000, v7
    ds_read_b64_tr_b16 a[160:161], v8 offset:0
    ds_read_b64_tr_b16 a[162:163], v8 offset:2560
    ds_read_b64_tr_b16 a[164:165], v8 offset:32
    ds_read_b64_tr_b16 a[166:167], v8 offset:2592
    ds_read_b64_tr_b16 a[168:169], v8 offset:64
    ds_read_b64_tr_b16 a[170:171], v8 offset:2624
    ds_read_b64_tr_b16 a[172:173], v8 offset:96
    ds_read_b64_tr_b16 a[174:175], v8 offset:2656
    ds_read_b64_tr_b16 a[176:177], v8 offset:128
    ds_read_b64_tr_b16 a[178:179], v8 offset:2688
    s_waitcnt lgkmcnt(0)
    s_waitcnt vmcnt(5)
    s_barrier
    s_add_u32 m0, s61, 40960
    s_add_u32 s60, s71, 0x6e000
    buffer_load_dwordx4 v17, s[8:11], s60 offen nt lds
    s_add_u32 m0, s61, 41984
    s_add_u32 s60, s71, 0x6e000
    buffer_load_dwordx4 v18, s[8:11], s60 offen nt lds
    s_add_u32 m0, s61, 43008
    s_add_u32 s60, s71, 0x6e000
    buffer_load_dwordx4 v19, s[8:11], s60 offen nt lds
    s_add_u32 m0, s61, 44032
    s_add_u32 s60, s71, 0x6e000
    buffer_load_dwordx4 v20, s[8:11], s60 offen nt lds
    s_add_u32 m0, s61, 45056
    s_add_u32 s60, s71, 0x6e000
    buffer_load_dwordx4 v21, s[8:11], s60 offen nt lds
    v_add_u32 v8, 0x0, v7
    ds_read_b64_tr_b16 a[180:181], v8 offset:0
    ds_read_b64_tr_b16 a[182:183], v8 offset:2560
    ds_read_b64_tr_b16 a[184:185], v8 offset:32
    ds_read_b64_tr_b16 a[186:187], v8 offset:2592
    ds_read_b64_tr_b16 a[188:189], v8 offset:64
    ds_read_b64_tr_b16 a[190:191], v8 offset:2624
    ds_read_b64_tr_b16 a[192:193], v8 offset:96
    ds_read_b64_tr_b16 a[194:195], v8 offset:2656
    ds_read_b64_tr_b16 a[196:197], v8 offset:128
    ds_read_b64_tr_b16 a[198:199], v8 offset:2688
    s_waitcnt lgkmcnt(0)
    s_waitcnt vmcnt(5)
    s_barrier
    v_add_u32 v8, 0x5000, v7
    ds_read_b64_tr_b16 a[200:201], v8 offset:0
    ds_read_b64_tr_b16 a[202:203], v8 offset:2560
    ds_read_b64_tr_b16 a[204:205], v8 offset:32
    ds_read_b64_tr_b16 a[206:207], v8 offset:2592
    ds_read_b64_tr_b16 a[208:209], v8 offset:64
    ds_read_b64_tr_b16 a[210:211], v8 offset:2624
    ds_read_b64_tr_b16 a[212:213], v8 offset:96
    ds_read_b64_tr_b16 a[214:215], v8 offset:2656
    ds_read_b64_tr_b16 a[216:217], v8 offset:128
    ds_read_b64_tr_b16 a[218:219], v8 offset:2688
    s_waitcnt lgkmcnt(0)
    s_waitcnt vmcnt(0)
    s_barrier
    v_add_u32 v8, 0xa000, v7
    ds_read_b64_tr_b16 a[220:221], v8 offset:0
    ds_read_b64_tr_b16 a[222:223], v8 offset:2560
    ds_read_b64_tr_b16 a[224:225], v8 offset:32
    ds_read_b64_tr_b16 a[226:227], v8 offset:2592
    ds_read_b64_tr_b16 a[228:229], v8 offset:64
    ds_read_b64_tr_b16 a[230:231], v8 offset:2624
    ds_read_b64_tr_b16 a[232:233], v8 offset:96
    ds_read_b64_tr_b16 a[234:235], v8 offset:2656
    ds_read_b64_tr_b16 a[236:237], v8 offset:128
    ds_read_b64_tr_b16 a[238:239], v8 offset:2688
    s_waitcnt lgkmcnt(0)
    s_barrier
    v_min_u32 v12, 5, v1
    v_lshlrev_b32 v12, 7, v12
    s_mul_i32 s63, s81, 3072
    s_mul_i32 s28, s3, 768
    s_add_u32 s63, s63, s28
    s_add_u32 s63, s63, 0x604000
    v_and_b32 v4, 15, v1
    v_mul_u32_u24 v13, 336, v4
    v_lshl_add_u32 v13, v9, 4, v13
    s_mul_i32 s28, s3, 5376
    v_add_u32 v13, s28, v13
    v_min_u32 v4, 39, v1
    v_mul_u32_u24 v28, 6554, v4
    v_lshrrev_b32 v28, 16, v28
    v_mul_u32_u24 v29, 10, v28
    v_sub_u32 v29, v4, v29
    s_lshl_b32 s28, s3, 2
    v_add_u32 v28, s28, v28
    v_mul_u32_u24 v14, 336, v28
    v_lshl_add_u32 v14, v29, 5, v14
    v_mul_u32_u24 v16, 1280, v28
    v_lshl_add_u32 v16, v29, 4, v16
    v_lshlrev_b32 v15, 8, v29
    v_lshl_add_u32 v15, v28, 4, v15
    s_mov_b32 s66, -1
    s_mov_b32 s67, 0xff
    s_mul_i32 s28, s81, 40960
    s_mul_i32 s29, s65, 20480
    s_add_u32 s28, s28, s29
    s_mul_i32 s73, s64, 2560
    s_add_u32 s73, s73, s28
    s_add_u32 s73, s73, 0xd00000
    s_mul_i32 s62, s64, 160
    s_add_u32 s62, s62, s28
    s_mul_i32 s72, s3, 12288
    s_mul_i32 s28, s81, 98304
    s_add_u32 s72, s72, s28
    s_mul_i32 s28, s65, 49152
    s_add_u32 s72, s72, s28
    s_add_u32 s72, s72, 0x1000000
    s_mov_b32 s25, s81
    s_mov_b32 s68, 0
L_loop_F2:
    s_add_u32 s25, s25, 1
    s_add_u32 s29, s25, 3
    s_cmp_eq_u32 s68, 1
    s_cbranch_scc1 Lp_197
    s_mov_b32 s27, 0x100000
Lp_200:
    buffer_load_dword v23, v12, s[4:7], s63 offen sc1
    s_waitcnt vmcnt(0)
    v_cmp_gt_u32 vcc, s25, v23
    s_nop 0
    s_cbranch_vccz Ld_201
    s_sub_u32 s27, s27, 1
    s_cbranch_scc1 L_abort
    s_sleep 3
    s_branch Lp_200
Ld_201:
    v_cmp_gt_u32 vcc, s29, v23
    s_nop 0
    s_cbranch_vccnz Ld_195
    s_add_u32 s28, s72, 0
    buffer_load_dwordx4 v[96:99], v2, s[4:7], s28 offen offset:0 sc1
    buffer_load_dwordx4 v[100:103], v2, s[4:7], s28 offen offset:1024 sc1
    buffer_load_dwordx4 v[104:107], v2, s[4:7], s28 offen offset:2048 sc1
    buffer_load_dwordx4 v[108:111], v2, s[4:7], s28 offen offset:3072 sc1
    s_add_u32 s28, s72, 4096
    buffer_load_dwordx4 v[112:115], v2, s[4:7], s28 offen offset:0 sc1
    buffer_load_dwordx4 v[116:119], v2, s[4:7], s28 offen offset:1024 sc1
    buffer_load_dwordx4 v[120:123], v2, s[4:7], s28 offen offset:2048 sc1
    buffer_load_dwordx4 v[124:127], v2, s[4:7], s28 offen offset:3072 sc1
    s_add_u32 s28, s72, 8192
    buffer_load_dwordx4 v[128:131], v2, s[4:7], s28 offen offset:0 sc1
    buffer_load_dwordx4 v[132:135], v2, s[4:7], s28 offen offset:1024 sc1
    buffer_load_dwordx4 v[136:139], v2, s[4:7], s28 offen offset:2048 sc1
    buffer_load_dwordx4 v[140:143], v2, s[4:7], s28 offen offset:3072 sc1
    s_add_u32 s28, s73, 0
    buffer_load_dwordx4 v[144:147], v15, s[4:7], s28 offen sc1
    s_waitcnt vmcnt(0)
Lp_197:
    s_waitcnt vmcnt(1)
    s_mov_b32 s68, 0
    v_cmp_gt_u32 vcc, s29, v23
    s_nop 0
    s_cbranch_vccnz Ln_198
    s_cmp_gt_u32 s29, 58
    s_cbranch_scc1 Ln_198
    s_add_u32 s28, s72, 294912
    buffer_load_dwordx4 v[148:151], v2, s[4:7], s28 offen offset:0 sc1
    buffer_load_dwordx4 v[152:155], v2, s[4:7], s28 offen offset:1024 sc1
    buffer_load_dwordx4 v[156:159], v2, s[4:7], s28 offen offset:2048 sc1
    buffer_load_dwordx4 v[160:163], v2, s[4:7], s28 offen offset:3072 sc1
    s_add_u32 s28, s72, 299008
    buffer_load_dwordx4 v[164:167], v2, s[4:7], s28 offen offset:0 sc1
    buffer_load_dwordx4 v[168:171], v2, s[4:7], s28 offen offset:1024 sc1
    buffer_load_dwordx4 v[172:175], v2, s[4:7], s28 offen offset:2048 sc1
    buffer_load_dwordx4 v[176:179], v2, s[4:7], s28 offen offset:3072 sc1
    s_add_u32 s28, s72, 303104
    buffer_load_dwordx4 v[180:183], v2, s[4:7], s28 offen offset:0 sc1
    buffer_load_dwordx4 v[184:187], v2, s[4:7], s28 offen offset:1024 sc1
    buffer_load_dwordx4 v[188:191], v2, s[4:7], s28 offen offset:2048 sc1
    buffer_load_dwordx4 v[192:195], v2, s[4:7], s28 offen offset:3072 sc1
    s_add_u32 s28, s73, 122880
    buffer_load_dwordx4 v[196:199], v15, s[4:7], s28 offen sc1
    buffer_load_dword v23, v12, s[4:7], s63 offen sc1
    s_mov_b32 s68, 1
Ln_198:
    v_mfma_f32_16x16x32_bf16 v[32:35], a[0:3], v[96:99], 0
    v_mfma_f32_16x16x32_bf16 v[36:39], a[4:7], v[96:99], 0
    v_mfma_f32_16x16x32_bf16 v[40:43], a[8:11], v[96:99], 0
    v_mfma_f32_16x16x32_bf16 v[44:47], a[12:15], v[96:99], 0
    v_mfma_f32_16x16x32_bf16 v[48:51], a[16:19], v[96:99], 0
    v_mfma_f32_16x16x32_bf16 v[32:35], a[20:23], v[100:103], v[32:35]
    v_mfma_f32_16x16x32_bf16 v[36:39], a[24:27], v[100:103], v[36:39]
    v_mfma_f32_16x16x32_bf16 v[40:43], a[28:31], v[100:103], v[40:43]
    v_mfma_f32_16x16x32_bf16 v[44:47], a[32:35], v[100:103], v[44:47]
    v_mfma_f32_16x16x32_bf16 v[48:51], a[36:39], v[100:103], v[48:51]
    v_mfma_f32_16x16x32_bf16 v[32:35], a[40:43], v[104:107], v[32:35]
    v_mfma_f32_16x16x32_bf16 v[36:39], a[44:47], v[104:107], v[36:39]
    v_mfma_f32_16x16x32_bf16 v[40:43], a[48:51], v[104:107], v[40:43]
    v_mfma_f32_16x16x32_bf16 v[44:47], a[52:55], v[104:107], v[44:47]
    v_mfma_f32_16x16x32_bf16 v[48:51], a[56:59], v[104:107], v[48:51]
    v_mfma_f32_16x16x32_bf16 v[32:35], a[60:63], v[108:111], v[32:35]
    v_mfma_f32_16x16x32_bf16 v[36:39], a[64:67], v[108:111], v[36:39]
    v_mfma_f32_16x16x32_bf16 v[40:43], a[68:71], v[108:111], v[40:43]
    v_mfma_f32_16x16x32_bf16 v[44:47], a[72:75], v[108:111], v[44:47]
    v_mfma_f32_16x16x32_bf16 v[48:51], a[76:79], v[108:111], v[48:51]
    v_mfma_f32_16x16x32_bf16 v[32:35], a[80:83], v[112:115], v[32:35]
    v_mfma_f32_16x16x32_bf16 v[36:39], a[84:87], v[112:115], v[36:39]
    v_mfma_f32_16x16x32_bf16 v[40:43], a[88:91], v[112:115], v[40:43]
    v_mfma_f32_16x16x32_bf16 v[44:47], a[92:95], v[112:115], v[44:47]
    v_mfma_f32_16x16x32_bf16 v[48:51], a[96:99], v[112:115], v[48:51]
    v_mfma_f32_16x16x32_bf16 v[32:35], a[100:103], v[116:119], v[32:35]
    v_mfma_f32_16x16x32_bf16 v[36:39], a[104:107], v[116:119], v[36:39]
    v_mfma_f32_16x16x32_bf16 v[40:43], a[108:111], v[116:119], v[40:43]
    v_mfma_f32_16x16x32_bf16 v[44:47], a[112:115], v[116:119], v[44:47]
    v_mfma_f32_16x16x32_bf16 v[48:51], a[116:119], v[116:119], v[48:51]
    v_mfma_f32_16x16x32_bf16 v[32:35], a[120:123], v[120:123], v[32:35]
    v_mfma_f32_16x16x32_bf16 v[36:39], a[124:127], v[120:123], v[36:39]
    v_mfma_f32_16x16x32_bf16 v[40:43], a[128:131], v[120:123], v[40:43]
    v_mfma_f32_16x16x32_bf16 v[44:47], a[132:135], v[120:123], v[44:47]
    v_mfma_f32_16x16x32_bf16 v[48:51], a[136:139], v[120:123], v[48:51]
    v_mfma_f32_16x16x32_bf16 v[32:35], a[140:143], v[124:127], v[32:35]
    v_mfma_f32_16x16x32_bf16 v[36:39], a[144:147], v[124:127], v[36:39]
    v_mfma_f32_16x16x32_bf16 v[40:43], a[148:151], v[124:127], v[40:43]
    v_mfma_f32_16x16x32_bf16 v[44:47], a[152:155], v[124:127], v[44:47]
    v_mfma_f32_16x16x32_bf16 v[48:51], a[156:159], v[124:127], v[48:51]
    v_mfma_f32_16x16x32_bf16 v[32:35], a[160:163], v[128:131], v[32:35]
    v_mfma_f32_16x16x32_bf16 v[36:39], a[164:167], v[128:131], v[36:39]
    v_mfma_f32_16x16x32_bf16 v[40:43], a[168:171], v[128:131], v[40:43]
    v_mfma_f32_16x16x32_bf16 v[44:47], a[172:175], v[128:131], v[44:47]
    v_mfma_f32_16x16x32_bf16 v[48:51], a[176:179], v[128:131], v[48:51]
    v_mfma_f32_16x16x32_bf16 v[32:35], a[180:183], v[132:135], v[32:35]
    v_mfma_f32_16x16x32_bf16 v[36:39], a[184:187], v[132:135], v[36:39]
    v_mfma_f32_16x16x32_bf16 v[40:43], a[188:191], v[132:135], v[40:43]
    v_mfma_f32_16x16x32_bf16 v[44:47], a[192:195], v[132:135], v[44:47]
    v_mfma_f32_16x16x32_bf16 v[48:51], a[196:199], v[132:135], v[48:51]
    v_mfma_f32_16x16x32_bf16 v[32:35], a[200:203], v[136:139], v[32:35]
    v_mfma_f32_16x16x32_bf16 v[36:39], a[204:207], v[136:139], v[36:39]
    v_mfma_f32_16x16x32_bf16 v[40:43], a[208:211], v[136:139], v[40:43]
    v_mfma_f32_16x16x32_bf16 v[44:47], a[212:215], v[136:139], v[44:47]
    v_mfma_f32_16x16x32_bf16 v[48:51], a[216:219], v[136:139], v[48:51]
    v_mfma_f32_16x16x32_bf16 v[32:35], a[220:223], v[140:143], v[32:35]
    v_mfma_f32_16x16x32_bf16 v[36:39], a[224:227], v[140:143], v[36:39]
    v_mfma_f32_16x16x32_bf16 v[40:43], a[228:231], v[140:143], v[40:43]
    v_mfma_f32_16x16x32_bf16 v[44:47], a[232:235], v[140:143], v[44:47]
    v_mfma_f32_16x16x32_bf16 v[48:51], a[236:239], v[140:143], v[48:51]
    s_nop 6
    s_branch Lm_199
Ld_195:
    s_add_u32 s28, s72, 0
    buffer_load_dwordx4 v[96:99], v2, s[4:7], s28 offen offset:0 sc1
    buffer_load_dwordx4 v[100:103], v2, s[4:7], s28 offen offset:1024 sc1
    buffer_load_dwordx4 v[104:107], v2, s[4:7], s28 offen offset:2048 sc1
    buffer_load_dwordx4 v[108:111], v2, s[4:7], s28 offen offset:3072 sc1
    s_add_u32 s28, s72, 4096
    buffer_load_dwordx4 v[112:115], v2, s[4:7], s28 offen offset:0 sc1
    buffer_load_dwordx4 v[116:119], v2, s[4:7], s28 offen offset:1024 sc1
    buffer_load_dwordx4 v[120:123], v2, s[4:7], s28 offen offset:2048 sc1
    buffer_load_dwordx4 v[124:127], v2, s[4:7], s28 offen offset:3072 sc1
    s_add_u32 s28, s72, 8192
    buffer_load_dwordx4 v[128:131], v2, s[4:7], s28 offen offset:0 sc1
    buffer_load_dwordx4 v[132:135], v2, s[4:7], s28 offen offset:1024 sc1
    buffer_load_dwordx4 v[136:139], v2, s[4:7], s28 offen offset:2048 sc1
    buffer_load_dwordx4 v[140:143], v2, s[4:7], s28 offen offset:3072 sc1
    s_add_u32 s28, s73, 0
    buffer_load_dwordx4 v[144:147], v15, s[4:7], s28 offen sc1
    s_waitcnt vmcnt(12)
    v_mfma_f32_16x16x32_bf16 v[32:35], a[0:3], v[96:99], 0
    v_mfma_f32_16x16x32_bf16 v[36:39], a[4:7], v[96:99], 0
    v_mfma_f32_16x16x32_bf16 v[40:43], a[8:11], v[96:99], 0
    v_mfma_f32_16x16x32_bf16 v[44:47], a[12:15], v[96:99], 0
    v_mfma_f32_16x16x32_bf16 v[48:51], a[16:19], v[96:99], 0
    s_waitcnt vmcnt(11)
    v_mfma_f32_16x16x32_bf16 v[32:35], a[20:23], v[100:103], v[32:35]
    v_mfma_f32_16x16x32_bf16 v[36:39], a[24:27], v[100:103], v[36:39]
    v_mfma_f32_16x16x32_bf16 v[40:43], a[28:31], v[100:103], v[40:43]
    v_mfma_f32_16x16x32_bf16 v[44:47], a[32:35], v[100:103], v[44:47]
    v_mfma_f32_16x16x32_bf16 v[48:51], a[36:39], v[100:103], v[48:51]
    s_waitcnt vmcnt(10)
    v_mfma_f32_16x16x32_bf16 v[32:35], a[40:43], v[104:107], v[32:35]
    v_mfma_f32_16x16x32_bf16 v[36:39], a[44:47], v[104:107], v[36:39]
    v_mfma_f32_16x16x32_bf16 v[40:43], a[48:51], v[104:107], v[40:43]
    v_mfma_f32_16x16x32_bf16 v[44:47], a[52:55], v[104:107], v[44:47]
    v_mfma_f32_16x16x32_bf16 v[48:51], a[56:59], v[104:107], v[48:51]
    s_waitcnt vmcnt(9)
    v_mfma_f32_16x16x32_bf16 v[32:35], a[60:63], v[108:111], v[32:35]
    v_mfma_f32_16x16x32_bf16 v[36:39], a[64:67], v[108:111], v[36:39]
    v_mfma_f32_16x16x32_bf16 v[40:43], a[68:71], v[108:111], v[40:43]
    v_mfma_f32_16x16x32_bf16 v[44:47], a[72:75], v[108:111], v[44:47]
    v_mfma_f32_16x16x32_bf16 v[48:51], a[76:79], v[108:111], v[48:51]
    s_waitcnt vmcnt(8)
    v_mfma_f32_16x16x32_bf16 v[32:35], a[80:83], v[112:115], v[32:35]
    v_mfma_f32_16x16x32_bf16 v[36:39], a[84:87], v[112:115], v[36:39]
    v_mfma_f32_16x16x32_bf16 v[40:43], a[88:91], v[112:115], v[40:43]
    v_mfma_f32_16x16x32_bf16 v[44:47], a[92:95], v[112:115], v[44:47]
    v_mfma_f32_16x16x32_bf16 v[48:51], a[96:99], v[112:115], v[48:51]
    s_waitcnt vmcnt(7)
    v_mfma_f32_16x16x32_bf16 v[32:35], a[100:103], v[116:119], v[32:35]
    v_mfma_f32_16x16x32_bf16 v[36:39], a[104:107], v[116:119], v[36:39]
    v_mfma_f32_16x16x32_bf16 v[40:43], a[108:111], v[116:119], v[40:43]
    v_mfma_f32_16x16x32_bf16 v[44:47], a[112:115], v[116:119], v[44:47]
    v_mfma_f32_16x16x32_bf16 v[48:51], a[116:119], v[116:119], v[48:51]
    s_waitcnt vmcnt(6)
    v_mfma_f32_16x16x32_bf16 v[32:35], a[120:123], v[120:123], v[32:35]
    v_mfma_f32_16x16x32_bf16 v[36:39], a[124:127], v[120:123], v[36:39]
    v_mfma_f32_16x16x32_bf16 v[40:43], a[128:131], v[120:123], v[40:43]
    v_mfma_f32_16x16x32_bf16 v[44:47], a[132:135], v[120:123], v[44:47]
    v_mfma_f32_16x16x32_bf16 v[48:51], a[136:139], v[120:123], v[48:51]
    s_waitcnt vmcnt(5)
    v_mfma_f32_16x16x32_bf16 v[32:35], a[140:143], v[124:127], v[32:35]
    v_mfma_f32_16x16x32_bf16 v[36:39], a[144:147], v[124:127], v[36:39]
    v_mfma_f32_16x16x32_bf16 v[40:43], a[148:151], v[124:127], v[40:43]
    v_mfma_f32_16x16x32_bf16 v[44:47], a[152:155], v[124:127], v[44:47]
    v_mfma_f32_16x16x32_bf16 v[48:51], a[156:159], v[124:127], v[48:51]
    s_waitcnt vmcnt(4)
    v_mfma_f32_16x16x32_bf16 v[32:35], a[160:163], v[128:131], v[32:35]
    v_mfma_f32_16x16x32_bf16 v[36:39], a[164:167], v[128:131], v[36:39]
    v_mfma_f32_16x16x32_bf16 v[40:43], a[168:171], v[128:131], v[40:43]
    v_mfma_f32_16x16x32_bf16 v[44:47], a[172:175], v[128:131], v[44:47]
    v_mfma_f32_16x16x32_bf16 v[48:51], a[176:179], v[128:131], v[48:51]
    s_waitcnt vmcnt(3)
    v_mfma_f32_16x16x32_bf16 v[32:35], a[180:183], v[132:135], v[32:35]
    v_mfma_f32_16x16x32_bf16 v[36:39], a[184:187], v[132:135], v[36:39]
    v_mfma_f32_16x16x32_bf16 v[40:43], a[188:191], v[132:135], v[40:43]
    v_mfma_f32_16x16x32_bf16 v[44:47], a[192:195], v[132:135], v[44:47]
    v_mfma_f32_16x16x32_bf16 v[48:51], a[196:199], v[132:135], v[48:51]
    s_waitcnt vmcnt(2)
    v_mfma_f32_16x16x32_bf16 v[32:35], a[200:203], v[136:139], v[32:35]
    v_mfma_f32_16x16x32_bf16 v[36:39], a[204:207], v[136:139], v[36:39]
    v_mfma_f32_16x16x32_bf16 v[40:43], a[208:211], v[136:139], v[40:43]
    v_mfma_f32_16x16x32_bf16 v[44:47], a[212:215], v[136:139], v[44:47]
    v_mfma_f32_16x16x32_bf16 v[48:51], a[216:219], v[136:139], v[48:51]
    s_waitcnt vmcnt(1)
    v_mfma_f32_16x16x32_bf16 v[32:35], a[220:223], v[140:143], v[32:35]
    v_mfma_f32_16x16x32_bf16 v[36:39], a[224:227], v[140:143], v[36:39]
    v_mfma_f32_16x16x32_bf16 v[40:43], a[228:231], v[140:143], v[40:43]
    v_mfma_f32_16x16x32_bf16 v[44:47], a[232:235], v[140:143], v[44:47]
    v_mfma_f32_16x16x32_bf16 v[48:51], a[236:239], v[140:143], v[48:51]
    s_waitcnt vmcnt(0)
Lm_199:
    s_cmp_le_u32 s25, 58
    s_nop 4
    s_cbranch_scc1 Lg_196
    v_fma_f32 v4, v144, v145, v146
    v_fma_f32 v4, v4, v147, v32
    v_cmp_u_f32 vcc, v4, v4
    s_nop 0
    s_cbranch_vccz Lg_196
    v_max3_u32 v4, v144, v145, v146
    v_max_u32 v4, v4, v147
    v_max3_u32 v4, v4, v96, v97
    v_max3_u32 v4, v4, v98, v99
    v_max3_u32 v4, v4, v100, v101
    v_max3_u32 v4, v4, v102, v103
    v_max3_u32 v4, v4, v104, v105
    v_max3_u32 v4, v4, v106, v107
    v_max3_u32 v4, v4, v108, v109
    v_max3_u32 v4, v4, v110, v111
    v_max3_u32 v4, v4, v112, v113
    v_max3_u32 v4, v4, v114, v115
    v_max3_u32 v4, v4, v116, v117
    v_max3_u32 v4, v4, v118, v119
    v_max3_u32 v4, v4, v120, v121
    v_max3_u32 v4, v4, v122, v123
    v_max3_u32 v4, v4, v124, v125
    v_max3_u32 v4, v4, v126, v127
    v_max3_u32 v4, v4, v128, v129
    v_max3_u32 v4, v4, v130, v131
    v_max3_u32 v4, v4, v132, v133
    v_max3_u32 v4, v4, v134, v135
    v_max3_u32 v4, v4, v136, v137
    v_max3_u32 v4, v4, v138, v139
    v_max3_u32 v4, v4, v140, v141
    v_max3_u32 v4, v4, v142, v143
    v_cmp_eq_u32 vcc, -1, v4
    s_nop 0
    s_cbranch_vccz Lg_196
    s_sub_u32 s27, s27, 1
    s_cbranch_scc1 L_abort
    s_branch Ld_195
Lg_196:
    ds_write_b128 v13, v[32:35] offset:0
    ds_write_b128 v13, v[36:39] offset:64
    ds_write_b128 v13, v[40:43] offset:128
    ds_write_b128 v13, v[44:47] offset:192
    ds_write_b128 v13, v[48:51] offset:256
    s_waitcnt lgkmcnt(0)
    s_barrier
    ds_read_b128 v[56:59], v14 offset:0
    ds_read_b128 v[60:63], v14 offset:16
    ds_read_b128 v[64:67], v14 offset:5376
    ds_read_b128 v[68:71], v14 offset:5392
    ds_read_b128 v[72:75], v14 offset:10752
    ds_read_b128 v[76:79], v14 offset:10768
    ds_read_b128 v[80:83], v14 offset:16128
    ds_read_b128 v[84:87], v14 offset:16144
    s_waitcnt lgkmcnt(4)
    v_pk_add_f32 v[56:57], v[56:57], v[64:65]
    v_pk_add_f32 v[58:59], v[58:59], v[66:67]
    v_pk_add_f32 v[60:61], v[60:61], v[68:69]
    v_pk_add_f32 v[62:63], v[62:63], v[70:71]
    s_waitcnt lgkmcnt(0)
    v_pk_add_f32 v[72:73], v[72:73], v[80:81]
    v_pk_add_f32 v[74:75], v[74:75], v[82:83]
    v_pk_add_f32 v[76:77], v[76:77], v[84:85]
    v_pk_add_f32 v[78:79], v[78:79], v[86:87]
    v_pk_add_f32 v[56:57], v[56:57], v[72:73]
    v_pk_add_f32 v[58:59], v[58:59], v[74:75]
    v_pk_add_f32 v[60:61], v[60:61], v[76:77]
    v_pk_add_f32 v[62:63], v[62:63], v[78:79]
    v_cvt_pk_bf16_f32 v64, v56, v57
    v_cvt_pk_bf16_f32 v65, v58, v59
    v_cvt_pk_bf16_f32 v66, v60, v61
    v_cvt_pk_bf16_f32 v67, v62, v63
    v_lshlrev_b32 v56, 16, v64
    v_and_b32 v57, 0xffff0000, v64
    v_lshlrev_b32 v72, 16, v144
    v_and_b32 v73, 0xffff0000, v144
    v_lshlrev_b32 v58, 16, v65
    v_and_b32 v59, 0xffff0000, v65
    v_lshlrev_b32 v74, 16, v145
    v_and_b32 v75, 0xffff0000, v145
    v_lshlrev_b32 v60, 16, v66
    v_and_b32 v61, 0xffff0000, v66
    v_lshlrev_b32 v76, 16, v146
    v_and_b32 v77, 0xffff0000, v146
    v_lshlrev_b32 v62, 16, v67
    v_and_b32 v63, 0xffff0000, v67
    v_lshlrev_b32 v78, 16, v147
    v_and_b32 v79, 0xffff0000, v147
    v_pk_add_f32 v[56:57], v[56:57], v[72:73]
    v_pk_add_f32 v[58:59], v[58:59], v[74:75]
    v_pk_add_f32 v[60:61], v[60:61], v[76:77]
    v_pk_add_f32 v[62:63], v[62:63], v[78:79]
    v_cvt_pk_bf16_f32 v64, v56, v57
    v_cvt_pk_bf16_f32 v65, v58, v59
    v_cvt_pk_bf16_f32 v66, v60, v61
    v_cvt_pk_bf16_f32 v67, v62, v63
    s_mov_b64 exec, s[66:67]
    buffer_store_dwordx4 v[64:67], v16, s[20:23], s62 offen
    s_mov_b64 exec, -1
    s_add_u32 s62, s62, 122880
    s_add_u32 s73, s73, 122880
    s_add_u32 s72, s72, 294912
    s_add_u32 s25, s25, 2
    s_cmp_ge_u32 s25, 64
    s_cbranch_scc1 L_exit
    s_add_u32 s25, s25, 1
    s_add_u32 s29, s25, 3
    s_cmp_eq_u32 s68, 1
    s_cbranch_scc1 Lp_204
    s_mov_b32 s27, 0x100000
Lp_207:
    buffer_load_dword v23, v12, s[4:7], s63 offen sc1
    s_waitcnt vmcnt(0)
    v_cmp_gt_u32 vcc, s25, v23
    s_nop 0
    s_cbranch_vccz Ld_208
    s_sub_u32 s27, s27, 1
    s_cbranch_scc1 L_abort
    s_sleep 3
    s_branch Lp_207
Ld_208:
    v_cmp_gt_u32 vcc, s29, v23
    s_nop 0
    s_cbranch_vccnz Ld_202
    s_add_u32 s28, s72, 0
    buffer_load_dwordx4 v[148:151], v2, s[4:7], s28 offen offset:0 sc1
    buffer_load_dwordx4 v[152:155], v2, s[4:7], s28 offen offset:1024 sc1
    buffer_load_dwordx4 v[156:159], v2, s[4:7], s28 offen offset:2048 sc1
    buffer_load_dwordx4 v[160:163], v2, s[4:7], s28 offen offset:3072 sc1
    s_add_u32 s28, s72, 4096
    buffer_load_dwordx4 v[164:167], v2, s[4:7], s28 offen offset:0 sc1
    buffer_load_dwordx4 v[168:171], v2, s[4:7], s28 offen offset:1024 sc1
    buffer_load_dwordx4 v[172:175], v2, s[4:7], s28 offen offset:2048 sc1
    buffer_load_dwordx4 v[176:179], v2, s[4:7], s28 offen offset:3072 sc1
    s_add_u32 s28, s72, 8192
    buffer_load_dwordx4 v[180:183], v2, s[4:7], s28 offen offset:0 sc1
    buffer_load_dwordx4 v[184:187], v2, s[4:7], s28 offen offset:1024 sc1
    buffer_load_dwordx4 v[188:191], v2, s[4:7], s28 offen offset:2048 sc1
    buffer_load_dwordx4 v[192:195], v2, s[4:7], s28 offen offset:3072 sc1
    s_add_u32 s28, s73, 0
    buffer_load_dwordx4 v[196:199], v15, s[4:7], s28 offen sc1
    s_waitcnt vmcnt(0)
Lp_204:
    s_waitcnt vmcnt(1)
    s_mov_b32 s68, 0
    v_cmp_gt_u32 vcc, s29, v23
    s_nop 0
    s_cbranch_vccnz Ln_205
    s_cmp_gt_u32 s29, 58
    s_cbranch_scc1 Ln_205
    s_add_u32 s28, s72, 294912
    buffer_load_dwordx4 v[96:99], v2, s[4:7], s28 offen offset:0 sc1
    buffer_load_dwordx4 v[100:103], v2, s[4:7], s28 offen offset:1024 sc1
    buffer_load_dwordx4 v[104:107], v2, s[4:7], s28 offen offset:2048 sc1
    buffer_load_dwordx4 v[108:111], v2, s[4:7], s28 offen offset:3072 sc1
    s_add_u32 s28, s72, 299008
    buffer_load_dwordx4 v[112:115], v2, s[4:7], s28 offen offset:0 sc1
    buffer_load_dwordx4 v[116:119], v2, s[4:7], s28 offen offset:1024 sc1
    buffer_load_dwordx4 v[120:123], v2, s[4:7], s28 offen offset:2048 sc1
    buffer_load_dwordx4 v[124:127], v2, s[4:7], s28 offen offset:3072 sc1
    s_add_u32 s28, s72, 303104
    buffer_load_dwordx4 v[128:131], v2, s[4:7], s28 offen offset:0 sc1
    buffer_load_dwordx4 v[132:135], v2, s[4:7], s28 offen offset:1024 sc1
    buffer_load_dwordx4 v[136:139], v2, s[4:7], s28 offen offset:2048 sc1
    buffer_load_dwordx4 v[140:143], v2, s[4:7], s28 offen offset:3072 sc1
    s_add_u32 s28, s73, 122880
    buffer_load_dwordx4 v[144:147], v15, s[4:7], s28 offen sc1
    buffer_load_dword v23, v12, s[4:7], s63 offen sc1
    s_mov_b32 s68, 1
Ln_205:
    v_mfma_f32_16x16x32_bf16 v[32:35], a[0:3], v[148:151], 0
    v_mfma_f32_16x16x32_bf16 v[36:39], a[4:7], v[148:151], 0
    v_mfma_f32_16x16x32_bf16 v[40:43], a[8:11], v[148:151], 0
    v_mfma_f32_16x16x32_bf16 v[44:47], a[12:15], v[148:151], 0
    v_mfma_f32_16x16x32_bf16 v[48:51], a[16:19], v[148:151], 0
    v_mfma_f32_16x16x32_bf16 v[32:35], a[20:23], v[152:155], v[32:35]
    v_mfma_f32_16x16x32_bf16 v[36:39], a[24:27], v[152:155], v[36:39]
    v_mfma_f32_16x16x32_bf16 v[40:43], a[28:31], v[152:155], v[40:43]
    v_mfma_f32_16x16x32_bf16 v[44:47], a[32:35], v[152:155], v[44:47]
    v_mfma_f32_16x16x32_bf16 v[48:51], a[36:39], v[152:155], v[48:51]
    v_mfma_f32_16x16x32_bf16 v[32:35], a[40:43], v[156:159], v[32:35]
    v_mfma_f32_16x16x32_bf16 v[36:39], a[44:47], v[156:159], v[36:39]
    v_mfma_f32_16x16x32_bf16 v[40:43], a[48:51], v[156:159], v[40:43]
    v_mfma_f32_16x16x32_bf16 v[44:47], a[52:55], v[156:159], v[44:47]
    v_mfma_f32_16x16x32_bf16 v[48:51], a[56:59], v[156:159], v[48:51]
    v_mfma_f32_16x16x32_bf16 v[32:35], a[60:63], v[160:163], v[32:35]
    v_mfma_f32_16x16x32_bf16 v[36:39], a[64:67], v[160:163], v[36:39]
    v_mfma_f32_16x16x32_bf16 v[40:43], a[68:71], v[160:163], v[40:43]
    v_mfma_f32_16x16x32_bf16 v[44:47], a[72:75], v[160:163], v[44:47]
    v_mfma_f32_16x16x32_bf16 v[48:51], a[76:79], v[160:163], v[48:51]
    v_mfma_f32_16x16x32_bf16 v[32:35], a[80:83], v[164:167], v[32:35]
    v_mfma_f32_16x16x32_bf16 v[36:39], a[84:87], v[164:167], v[36:39]
    v_mfma_f32_16x16x32_bf16 v[40:43], a[88:91], v[164:167], v[40:43]
    v_mfma_f32_16x16x32_bf16 v[44:47], a[92:95], v[164:167], v[44:47]
    v_mfma_f32_16x16x32_bf16 v[48:51], a[96:99], v[164:167], v[48:51]
    v_mfma_f32_16x16x32_bf16 v[32:35], a[100:103], v[168:171], v[32:35]
    v_mfma_f32_16x16x32_bf16 v[36:39], a[104:107], v[168:171], v[36:39]
    v_mfma_f32_16x16x32_bf16 v[40:43], a[108:111], v[168:171], v[40:43]
    v_mfma_f32_16x16x32_bf16 v[44:47], a[112:115], v[168:171], v[44:47]
    v_mfma_f32_16x16x32_bf16 v[48:51], a[116:119], v[168:171], v[48:51]
    v_mfma_f32_16x16x32_bf16 v[32:35], a[120:123], v[172:175], v[32:35]
    v_mfma_f32_16x16x32_bf16 v[36:39], a[124:127], v[172:175], v[36:39]
    v_mfma_f32_16x16x32_bf16 v[40:43], a[128:131], v[172:175], v[40:43]
    v_mfma_f32_16x16x32_bf16 v[44:47], a[132:135], v[172:175], v[44:47]
    v_mfma_f32_16x16x32_bf16 v[48:51], a[136:139], v[172:175], v[48:51]
    v_mfma_f32_16x16x32_bf16 v[32:35], a[140:143], v[176:179], v[32:35]
    v_mfma_f32_16x16x32_bf16 v[36:39], a[144:147], v[176:179], v[36:39]
    v_mfma_f32_16x16x32_bf16 v[40:43], a[148:151], v[176:179], v[40:43]
    v_mfma_f32_16x16x32_bf16 v[44:47], a[152:155], v[176:179], v[44:47]
    v_mfma_f32_16x16x32_bf16 v[48:51], a[156:159], v[176:179], v[48:51]
    v_mfma_f32_16x16x32_bf16 v[32:35], a[160:163], v[180:183], v[32:35]
    v_mfma_f32_16x16x32_bf16 v[36:39], a[164:167], v[180:183], v[36:39]
    v_mfma_f32_16x16x32_bf16 v[40:43], a[168:171], v[180:183], v[40:43]
    v_mfma_f32_16x16x32_bf16 v[44:47], a[172:175], v[180:183], v[44:47]
    v_mfma_f32_16x16x32_bf16 v[48:51], a[176:179], v[180:183], v[48:51]
    v_mfma_f32_16x16x32_bf16 v[32:35], a[180:183], v[184:187], v[32:35]
    v_mfma_f32_16x16x32_bf16 v[36:39], a[184:187], v[184:187], v[36:39]
    v_mfma_f32_16x16x32_bf16 v[40:43], a[188:191], v[184:187], v[40:43]
    v_mfma_f32_16x16x32_bf16 v[44:47], a[192:195], v[184:187], v[44:47]
    v_mfma_f32_16x16x32_bf16 v[48:51], a[196:199], v[184:187], v[48:51]
    v_mfma_f32_16x16x32_bf16 v[32:35], a[200:203], v[188:191], v[32:35]
    v_mfma_f32_16x16x32_bf16 v[36:39], a[204:207], v[188:191], v[36:39]
    v_mfma_f32_16x16x32_bf16 v[40:43], a[208:211], v[188:191], v[40:43]
    v_mfma_f32_16x16x32_bf16 v[44:47], a[212:215], v[188:191], v[44:47]
    v_mfma_f32_16x16x32_bf16 v[48:51], a[216:219], v[188:191], v[48:51]
    v_mfma_f32_16x16x32_bf16 v[32:35], a[220:223], v[192:195], v[32:35]
    v_mfma_f32_16x16x32_bf16 v[36:39], a[224:227], v[192:195], v[36:39]
    v_mfma_f32_16x16x32_bf16 v[40:43], a[228:231], v[192:195], v[40:43]
    v_mfma_f32_16x16x32_bf16 v[44:47], a[232:235], v[192:195], v[44:47]
    v_mfma_f32_16x16x32_bf16 v[48:51], a[236:239], v[192:195], v[48:51]
    s_nop 6
    s_branch Lm_206
Ld_202:
    s_add_u32 s28, s72, 0
    buffer_load_dwordx4 v[148:151], v2, s[4:7], s28 offen offset:0 sc1
    buffer_load_dwordx4 v[152:155], v2, s[4:7], s28 offen offset:1024 sc1
    buffer_load_dwordx4 v[156:159], v2, s[4:7], s28 offen offset:2048 sc1
    buffer_load_dwordx4 v[160:163], v2, s[4:7], s28 offen offset:3072 sc1
    s_add_u32 s28, s72, 4096
    buffer_load_dwordx4 v[164:167], v2, s[4:7], s28 offen offset:0 sc1
    buffer_load_dwordx4 v[168:171], v2, s[4:7], s28 offen offset:1024 sc1
    buffer_load_dwordx4 v[172:175], v2, s[4:7], s28 offen offset:2048 sc1
    buffer_load_dwordx4 v[176:179], v2, s[4:7], s28 offen offset:3072 sc1
    s_add_u32 s28, s72, 8192
    buffer_load_dwordx4 v[180:183], v2, s[4:7], s28 offen offset:0 sc1
    buffer_load_dwordx4 v[184:187], v2, s[4:7], s28 offen offset:1024 sc1
    buffer_load_dwordx4 v[188:191], v2, s[4:7], s28 offen offset:2048 sc1
    buffer_load_dwordx4 v[192:195], v2, s[4:7], s28 offen offset:3072 sc1
    s_add_u32 s28, s73, 0
    buffer_load_dwordx4 v[196:199], v15, s[4:7], s28 offen sc1
    s_waitcnt vmcnt(12)
    v_mfma_f32_16x16x32_bf16 v[32:35], a[0:3], v[148:151], 0
    v_mfma_f32_16x16x32_bf16 v[36:39], a[4:7], v[148:151], 0
    v_mfma_f32_16x16x32_bf16 v[40:43], a[8:11], v[148:151], 0
    v_mfma_f32_16x16x32_bf16 v[44:47], a[12:15], v[148:151], 0
    v_mfma_f32_16x16x32_bf16 v[48:51], a[16:19], v[148:151], 0
    s_waitcnt vmcnt(11)
    v_mfma_f32_16x16x32_bf16 v[32:35], a[20:23], v[152:155], v[32:35]
    v_mfma_f32_16x16x32_bf16 v[36:39], a[24:27], v[152:155], v[36:39]
    v_mfma_f32_16x16x32_bf16 v[40:43], a[28:31], v[152:155], v[40:43]
    v_mfma_f32_16x16x32_bf16 v[44:47], a[32:35], v[152:155], v[44:47]
    v_mfma_f32_16x16x32_bf16 v[48:51], a[36:39], v[152:155], v[48:51]
    s_waitcnt vmcnt(10)
    v_mfma_f32_16x16x32_bf16 v[32:35], a[40:43], v[156:159], v[32:35]
    v_mfma_f32_16x16x32_bf16 v[36:39], a[44:47], v[156:159], v[36:39]
    v_mfma_f32_16x16x32_bf16 v[40:43], a[48:51], v[156:159], v[40:43]
    v_mfma_f32_16x16x32_bf16 v[44:47], a[52:55], v[156:159], v[44:47]
    v_mfma_f32_16x16x32_bf16 v[48:51], a[56:59], v[156:159], v[48:51]
    s_waitcnt vmcnt(9)
    v_mfma_f32_16x16x32_bf16 v[32:35], a[60:63], v[160:163], v[32:35]
    v_mfma_f32_16x16x32_bf16 v[36:39], a[64:67], v[160:163], v[36:39]
    v_mfma_f32_16x16x32_bf16 v[40:43], a[68:71], v[160:163], v[40:43]
    v_mfma_f32_16x16x32_bf16 v[44:47], a[72:75], v[160:163], v[44:47]
    v_mfma_f32_16x16x32_bf16 v[48:51], a[76:79], v[160:163], v[48:51]
    s_waitcnt vmcnt(8)
    v_mfma_f32_16x16x32_bf16 v[32:35], a[80:83], v[164:167], v[32:35]
    v_mfma_f32_16x16x32_bf16 v[36:39], a[84:87], v[164:167], v[36:39]
    v_mfma_f32_16x16x32_bf16 v[40:43], a[88:91], v[164:167], v[40:43]
    v_mfma_f32_16x16x32_bf16 v[44:47], a[92:95], v[164:167], v[44:47]
    v_mfma_f32_16x16x32_bf16 v[48:51], a[96:99], v[164:167], v[48:51]
    s_waitcnt vmcnt(7)
    v_mfma_f32_16x16x32_bf16 v[32:35], a[100:103], v[168:171], v[32:35]
    v_mfma_f32_16x16x32_bf16 v[36:39], a[104:107], v[168:171], v[36:39]
    v_mfma_f32_16x16x32_bf16 v[40:43], a[108:111], v[168:171], v[40:43]
    v_mfma_f32_16x16x32_bf16 v[44:47], a[112:115], v[168:171], v[44:47]
    v_mfma_f32_16x16x32_bf16 v[48:51], a[116:119], v[168:171], v[48:51]
    s_waitcnt vmcnt(6)
    v_mfma_f32_16x16x32_bf16 v[32:35], a[120:123], v[172:175], v[32:35]
    v_mfma_f32_16x16x32_bf16 v[36:39], a[124:127], v[172:175], v[36:39]
    v_mfma_f32_16x16x32_bf16 v[40:43], a[128:131], v[172:175], v[40:43]
    v_mfma_f32_16x16x32_bf16 v[44:47], a[132:135], v[172:175], v[44:47]
    v_mfma_f32_16x16x32_bf16 v[48:51], a[136:139], v[172:175], v[48:51]
    s_waitcnt vmcnt(5)
    v_mfma_f32_16x16x32_bf16 v[32:35], a[140:143], v[176:179], v[32:35]
    v_mfma_f32_16x16x32_bf16 v[36:39], a[144:147], v[176:179], v[36:39]
    v_mfma_f32_16x16x32_bf16 v[40:43], a[148:151], v[176:179], v[40:43]
    v_mfma_f32_16x16x32_bf16 v[44:47], a[152:155], v[176:179], v[44:47]
    v_mfma_f32_16x16x32_bf16 v[48:51], a[156:159], v[176:179], v[48:51]
    s_waitcnt vmcnt(4)
    v_mfma_f32_16x16x32_bf16 v[32:35], a[160:163], v[180:183], v[32:35]
    v_mfma_f32_16x16x32_bf16 v[36:39], a[164:167], v[180:183], v[36:39]
    v_mfma_f32_16x16x32_bf16 v[40:43], a[168:171], v[180:183], v[40:43]
    v_mfma_f32_16x16x32_bf16 v[44:47], a[172:175], v[180:183], v[44:47]
    v_mfma_f32_16x16x32_bf16 v[48:51], a[176:179], v[180:183], v[48:51]
    s_waitcnt vmcnt(3)
    v_mfma_f32_16x16x32_bf16 v[32:35], a[180:183], v[184:187], v[32:35]
    v_mfma_f32_16x16x32_bf16 v[36:39], a[184:187], v[184:187], v[36:39]
    v_mfma_f32_16x16x32_bf16 v[40:43], a[188:191], v[184:187], v[40:43]
    v_mfma_f32_16x16x32_bf16 v[44:47], a[192:195], v[184:187], v[44:47]
    v_mfma_f32_16x16x32_bf16 v[48:51], a[196:199], v[184:187], v[48:51]
    s_waitcnt vmcnt(2)
    v_mfma_f32_16x16x32_bf16 v[32:35], a[200:203], v[188:191], v[32:35]
    v_mfma_f32_16x16x32_bf16 v[36:39], a[204:207], v[188:191], v[36:39]
    v_mfma_f32_16x16x32_bf16 v[40:43], a[208:211], v[188:191], v[40:43]
    v_mfma_f32_16x16x32_bf16 v[44:47], a[212:215], v[188:191], v[44:47]
    v_mfma_f32_16x16x32_bf16 v[48:51], a[216:219], v[188:191], v[48:51]
    s_waitcnt vmcnt(1)
    v_mfma_f32_16x16x32_bf16 v[32:35], a[220:223], v[192:195], v[32:35]
    v_mfma_f32_16x16x32_bf16 v[36:39], a[224:227], v[192:195], v[36:39]
    v_mfma_f32_16x16x32_bf16 v[40:43], a[228:231], v[192:195], v[40:43]
    v_mfma_f32_16x16x32_bf16 v[44:47], a[232:235], v[192:195], v[44:47]
    v_mfma_f32_16x16x32_bf16 v[48:51], a[236:239], v[192:195], v[48:51]
    s_waitcnt vmcnt(0)
Lm_206:
    s_cmp_le_u32 s25, 58
    s_nop 4
    s_cbranch_scc1 Lg_203
    v_fma_f32 v4, v196, v197, v198
    v_fma_f32 v4, v4, v199, v32
    v_cmp_u_f32 vcc, v4, v4
    s_nop 0
    s_cbranch_vccz Lg_203
    v_max3_u32 v4, v196, v197, v198
    v_max_u32 v4, v4, v199
    v_max3_u32 v4, v4, v148, v149
    v_max3_u32 v4, v4, v150, v151
    v_max3_u32 v4, v4, v152, v153
    v_max3_u32 v4, v4, v154, v155
    v_max3_u32 v4, v4, v156, v157
    v_max3_u32 v4, v4, v158, v159
    v_max3_u32 v4, v4, v160, v161
    v_max3_u32 v4, v4, v162, v163
    v_max3_u32 v4, v4, v164, v165
    v_max3_u32 v4, v4, v166, v167
    v_max3_u32 v4, v4, v168, v169
    v_max3_u32 v4, v4, v170, v171
    v_max3_u32 v4, v4, v172, v173
    v_max3_u32 v4, v4, v174, v175
    v_max3_u32 v4, v4, v176, v177
    v_max3_u32 v4, v4, v178, v179
    v_max3_u32 v4, v4, v180, v181
    v_max3_u32 v4, v4, v182, v183
    v_max3_u32 v4, v4, v184, v185
    v_max3_u32 v4, v4, v186, v187
    v_max3_u32 v4, v4, v188, v189
    v_max3_u32 v4, v4, v190, v191
    v_max3_u32 v4, v4, v192, v193
    v_max3_u32 v4, v4, v194, v195
    v_cmp_eq_u32 vcc, -1, v4
    s_nop 0
    s_cbranch_vccz Lg_203
    s_sub_u32 s27, s27, 1
    s_cbranch_scc1 L_abort
    s_branch Ld_202
Lg_203:
    ds_write_b128 v13, v[32:35] offset:21504
    ds_write_b128 v13, v[36:39] offset:21568
    ds_write_b128 v13, v[40:43] offset:21632
    ds_write_b128 v13, v[44:47] offset:21696
    ds_write_b128 v13, v[48:51] offset:21760
    s_waitcnt lgkmcnt(0)
    s_barrier
    ds_read_b128 v[56:59], v14 offset:21504
    ds_read_b128 v[60:63], v14 offset:21520
    ds_read_b128 v[64:67], v14 offset:26880
    ds_read_b128 v[68:71], v14 offset:26896
    ds_read_b128 v[72:75], v14 offset:32256
    ds_read_b128 v[76:79], v14 offset:32272
    ds_read_b128 v[80:83], v14 offset:37632
    ds_read_b128 v[84:87], v14 offset:37648
    s_waitcnt lgkmcnt(4)
    v_pk_add_f32 v[56:57], v[56:57], v[64:65]
    v_pk_add_f32 v[58:59], v[58:59], v[66:67]
    v_pk_add_f32 v[60:61], v[60:61], v[68:69]
    v_pk_add_f32 v[62:63], v[62:63], v[70:71]
    s_waitcnt lgkmcnt(0)
    v_pk_add_f32 v[72:73], v[72:73], v[80:81]
    v_pk_add_f32 v[74:75], v[74:75], v[82:83]
    v_pk_add_f32 v[76:77], v[76:77], v[84:85]
    v_pk_add_f32 v[78:79], v[78:79], v[86:87]
    v_pk_add_f32 v[56:57], v[56:57], v[72:73]
    v_pk_add_f32 v[58:59], v[58:59], v[74:75]
    v_pk_add_f32 v[60:61], v[60:61], v[76:77]
    v_pk_add_f32 v[62:63], v[62:63], v[78:79]
    v_cvt_pk_bf16_f32 v64, v56, v57
    v_cvt_pk_bf16_f32 v65, v58, v59
    v_cvt_pk_bf16_f32 v66, v60, v61
    v_cvt_pk_bf16_f32 v67, v62, v63
    v_lshlrev_b32 v56, 16, v64
    v_and_b32 v57, 0xffff0000, v64
    v_lshlrev_b32 v72, 16, v196
    v_and_b32 v73, 0xffff0000, v196
    v_lshlrev_b32 v58, 16, v65
    v_and_b32 v59, 0xffff0000, v65
    v_lshlrev_b32 v74, 16, v197
    v_and_b32 v75, 0xffff0000, v197
    v_lshlrev_b32 v60, 16, v66
    v_and_b32 v61, 0xffff0000, v66
    v_lshlrev_b32 v76, 16, v198
    v_and_b32 v77, 0xffff0000, v198
    v_lshlrev_b32 v62, 16, v67
    v_and_b32 v63, 0xffff0000, v67
    v_lshlrev_b32 v78, 16, v199
    v_and_b32 v79, 0xffff0000, v199
    v_pk_add_f32 v[56:57], v[56:57], v[72:73]
    v_pk_add_f32 v[58:59], v[58:59], v[74:75]
    v_pk_add_f32 v[60:61], v[60:61], v[76:77]
    v_pk_add_f32 v[62:63], v[62:63], v[78:79]
    v_cvt_pk_bf16_f32 v64, v56, v57
    v_cvt_pk_bf16_f32 v65, v58, v59
    v_cvt_pk_bf16_f32 v66, v60, v61
    v_cvt_pk_bf16_f32 v67, v62, v63
    s_mov_b64 exec, s[66:67]
    buffer_store_dwordx4 v[64:67], v16, s[20:23], s62 offen
    s_mov_b64 exec, -1
    s_add_u32 s62, s62, 122880
    s_add_u32 s73, s73, 122880
    s_add_u32 s72, s72, 294912
    s_add_u32 s25, s25, 2
    s_cmp_ge_u32 s25, 64
    s_cbranch_scc1 L_exit
    s_branch L_loop_F2
L_end:
    s_endpgm
.section .rodata,"a"
.p2align 6
.amdhsa_kernel sequential_preLN__memory_aug_recurrent_mem_tr__dense_activation_mish__prompt_kernel
  .amdhsa_next_free_vgpr 512
  .amdhsa_next_free_sgpr 102
  .amdhsa_accum_offset 256
  .amdhsa_group_segment_fixed_size 0
  .amdhsa_kernarg_size 112
  .amdhsa_user_sgpr_count 2
  .amdhsa_user_sgpr_kernarg_segment_ptr 1
  .amdhsa_system_sgpr_workgroup_id_x 1
.end_amdhsa_kernel
```
